```python
import torch

def _softmax(x, axis=-1):
    return torch.softmax(x, dim=axis)

def _gelu(x):
    return torch.nn.functional.gelu(x, approximate='tanh')

def _silu(x):
    return torch.nn.functional.silu(x)

def _sigmoid(x):
    return torch.sigmoid(x)

def _layernorm(x, axis=-1, eps=1e-05):
    m = x.mean(dim=axis, keepdim=True)
    v = x.var(dim=axis, keepdim=True, unbiased=False)
    return (x - m) / torch.sqrt(v + eps)

def _scatter_add(tgt, idx, src, axis=0):
    return tgt.clone().index_add_(axis, idx, src)

def _segment_sum(src, seg, n):
    out = torch.zeros((n,) + src.shape[1:], dtype=src.dtype)
    return out.index_add_(0, seg, src)

def _pad(x, pw):
    flat = tuple((v for pair in reversed(pw) for v in pair))
    return torch.nn.functional.pad(x, flat)
kernel_name = 'parallel_sum__linear_kernel_hedgehog__mixer_gmlp__prompt'

def setup_inputs():

    _w = lambda a: (lambda t: t.to(torch.bfloat16) if t.is_floating_point() else t)(torch.as_tensor(a))

    def _A_setup():
        B, S, D, H = (1, 2048, 576, 32)
        Dh = D // H
        return {'x': _w((lambda *s: torch.randn(*s, dtype=torch.bfloat16) * 0.05)(B, S, D)), 'wqkv': _w((lambda *s: torch.randn(*s, dtype=torch.bfloat16) * 0.4)(D, 3 * D)), 'w_phi': _w((lambda *s: torch.randn(*s, dtype=torch.bfloat16) * 0.4)(H, Dh, Dh) * Dh ** (-0.5)), 'wo': _w((lambda *s: torch.randn(*s, dtype=torch.bfloat16) * 0.4)(D, D))}
    _A_in = _A_setup()

    def _B_setup():
        B, S, D, F = (1, 2048, 576, 4608)
        Fh = F // 2
        return {'x': _w((lambda *s: torch.randn(*s, dtype=torch.bfloat16) * 0.05)(B, S, D)), 'w_in': _w((lambda *s: torch.randn(*s, dtype=torch.bfloat16) * 0.4)(D, 2 * Fh)), 'w_sp': _w(0.01 * (lambda *s: torch.randn(*s, dtype=torch.bfloat16) * 0.4)(S, S)), 'b_sp': _w(1.0 + 0.01 * (lambda *s: torch.randn(*s, dtype=torch.bfloat16) * 0.05)(S)), 'w_out': _w((lambda *s: torch.randn(*s, dtype=torch.bfloat16) * 0.05)(Fh, D))}
    _B_in = _B_setup()
    return {'A_x': _A_in['x'], 'A_wqkv': _A_in['wqkv'], 'A_w_phi': _A_in['w_phi'], 'A_wo': _A_in['wo'], 'B_x': _B_in['x'], 'B_w_in': _B_in['w_in'], 'B_w_sp': _B_in['w_sp'], 'B_b_sp': _B_in['b_sp'], 'B_w_out': _B_in['w_out']}

def reference(A_x, A_wqkv, A_w_phi, A_wo, B_x, B_w_in, B_w_sp, B_b_sp, B_w_out):

    def _A_ref(x, wqkv, w_phi, wo):
        B, S, D = x.shape
        H = 32
        Dh = D // H
        qkv = (lambda x, *d: x.permute(*d))((x @ wqkv).reshape(B, S, 3, H, Dh), 2, 0, 3, 1, 4)
        q, k, v = (qkv[0], qkv[1], qkv[2])
        pq = torch.einsum('bhsd,hdf->bhsf', q, w_phi)
        pk = torch.einsum('bhsd,hdf->bhsf', k, w_phi)
        phi_q = torch.concatenate([_softmax(pq, axis=-1), _softmax(-pq, axis=-1)], axis=-1)
        phi_k = torch.concatenate([_softmax(pk, axis=-1), _softmax(-pk, axis=-1)], axis=-1)
        kv = torch.einsum('bhsf,bhsd->bhfd', phi_k, v)
        z = torch.einsum('bhsf->bhf', phi_k)
        num = torch.einsum('bhqf,bhfd->bhqd', phi_q, kv)
        den = torch.einsum('bhqf,bhf->bhq', phi_q, z)[..., None] + 1e-06
        o = num / den
        return (lambda x, *d: x.permute(*d))(o, 0, 2, 1, 3).reshape(B, S, D) @ wo

    def _B_ref(x, w_in, w_sp, b_sp, w_out):
        B, S, D = x.shape
        F = w_in.shape[-1]
        Fh = F // 2
        z = _gelu(torch.einsum('bsd,df->bsf', x, w_in))
        z1 = z[..., :Fh].clone()
        z2 = _layernorm(z[..., Fh:], axis=-1)
        g = torch.einsum('ts,bsf->btf', w_sp, z2) + b_sp[None, :, None]
        return torch.einsum('bsf,fd->bsd', z1 * g, w_out)
    x = A_x
    xn = _layernorm(x, axis=-1)
    return x + _A_ref(xn, A_wqkv, A_w_phi, A_wo) + _B_ref(xn, B_w_in, B_w_sp, B_b_sp, B_w_out)
```

```asm
; @launch grid=(256,1,1) block=(512,1,1) lds=162816
.amdgcn_target "amdgcn-amd-amdhsa--gfx950"
.text
.globl parallel_sum__linear_kernel_hedgehog__mixer_gmlp__prompt_kernel
.p2align 8
.type parallel_sum__linear_kernel_hedgehog__mixer_gmlp__prompt_kernel,@function
parallel_sum__linear_kernel_hedgehog__mixer_gmlp__prompt_kernel:
    s_cmp_ge_u32 s2, 256
    s_cbranch_scc1 parallel_sum__linear_kernel_hedgehog__mixer_gmlp__prompt_kernel_end
    s_load_dwordx4 s[4:7], s[0:1], 0
    s_load_dwordx2 s[74:75], s[0:1], 16
    s_load_dwordx2 s[72:73], s[0:1], 24
    s_load_dwordx2 s[28:29], s[0:1], 40
    s_load_dwordx2 s[70:71], s[0:1], 64
    s_load_dwordx4 s[64:67], s[0:1], 80
    v_lshrrev_b32 v1, 6, v0
    v_and_b32 v2, 63, v0
    v_readfirstlane_b32 s3, v1
    s_and_b32 s30, s2, 7
    s_lshr_b32 s31, s2, 3
    s_and_b32 s35, s30, 1
    s_lshr_b32 s30, s30, 1
    s_getpc_b64 s[38:39]
    s_and_b32 s38, s38, 0xffffff80
    s_lshl_b32 s40, s31, 3
    s_add_u32 s40, s40, s3
    s_mul_i32 s40, s40, 3
    v_min_u32 v62, 2, v2
    v_add_u32 v62, s40, v62
    v_min_u32 v62, (parallel_sum__linear_kernel_hedgehog__mixer_gmlp__prompt_kernel_end - parallel_sum__linear_kernel_hedgehog__mixer_gmlp__prompt_kernel - 256) / 128, v62
    v_lshlrev_b32 v62, 7, v62
    v_mov_b32 v63, s39
    v_add_co_u32 v62, vcc, s38, v62
    s_nop 1
    v_addc_co_u32 v63, vcc, 0, v63, vcc
    global_load_dword v63, v[62:63], off
    s_cmp_ge_u32 s31, 24
    s_cbranch_scc1 parallel_sum__linear_kernel_hedgehog__mixer_gmlp__prompt_kernel_attn
    s_lshl_b32 s32, s35, 3
    s_and_b32 s33, s31, 7
    s_add_u32 s32, s32, s33
    s_mul_i32 s33, s30, 3
    s_lshr_b32 s34, s31, 3
    s_add_u32 s33, s33, s34
    s_lshr_b32 s34, s33, 2
    s_sub_u32 s34, s33, s34
    v_lshrrev_b32 v28, 3, v2
    v_and_b32 v29, 7, v2
    v_lshrrev_b32 v31, 4, v2
    v_xor_b32 v31, v31, v29
    v_mul_u32_u24 v7, 1152, v28
    v_lshl_add_u32 v7, v31, 4, v7
    v_bfe_u32 v30, v2, 4, 1
    v_lshlrev_b32 v30, 2, v30
    v_xor_b32 v30, v30, v29
    v_lshlrev_b32 v30, 4, v30
    v_mul_u32_u24 v5, 9216, v28
    v_add_u32 v5, v5, v30
    v_xor_b32 v8, 64, v7
    v_add_u32 v8, 8192, v8
    s_mul_i32 s41, s33, 384
    s_add_u32 s41, s41, 4608
    s_mul_i32 s40, s3, 73728
    s_add_u32 s40, s40, s41
    s_lshl_b32 s42, s3, 10
    s_lshl_b32 s43, s32, 7
    s_lshl_b32 s44, s3, 4
    s_add_u32 s43, s43, s44
    s_mul_i32 s43, s43, 1152
    s_lshl_b32 s44, s3, 11
    s_add_u32 s44, s44, 98304
    s_waitcnt lgkmcnt(0)
    s_mov_b32 s8, s4
    s_mov_b32 s9, s5
    s_mov_b32 s10, 2359296
    s_mov_b32 s11, 0x20000
    s_mov_b32 s12, s28
    s_mov_b32 s13, s29
    s_mov_b32 s14, 5308416
    s_mov_b32 s15, 0x20000
    s_add_u32 m0, s44, 0
    s_add_u32 s46, s43, 0
    buffer_load_dwordx4 v7, s[8:11], s46 offen lds
    buffer_load_dwordx4 v8, s[8:11], s46 offen offset:1024 lds
    s_add_u32 m0, s42, 0
    s_add_u32 s46, s40, 0
    buffer_load_dwordx4 v5, s[12:15], s46 offen lds
    s_mov_b32 s24, s64
    s_mov_b32 s25, s65
    s_mov_b32 s26, 256
    s_mov_b32 s27, 0x20000
    s_or_b32 s38, s2, s3
    s_cmp_eq_u32 s38, 0
    s_cbranch_scc0 parallel_sum__linear_kernel_hedgehog__mixer_gmlp__prompt_kernel_ep
    s_memrealtime s[38:39]
    s_waitcnt lgkmcnt(0)
    s_or_b32 s38, s38, 1
    v_mov_b32 v10, s38
    v_mov_b32 v11, 0
    s_mov_b64 exec, 1
    buffer_store_dword v10, v11, s[24:27], 0 offen sc1
    s_mov_b64 exec, -1
parallel_sum__linear_kernel_hedgehog__mixer_gmlp__prompt_kernel_ep:
    s_mov_b32 s16, s6
    s_mov_b32 s17, s7
    s_mov_b32 s18, 1990656
    s_mov_b32 s19, 0x20000
    s_and_b32 s36, s33, 3
    s_cmp_eq_u32 s36, 3
    s_cselect_b32 s18, 0, s18
    s_cselect_b32 s34, 0, s34
    s_mov_b32 s20, s66
    s_mov_b32 s21, s67
    s_mov_b32 s22, 57671680
    s_mov_b32 s23, 0x20000
    s_load_dwordx4 s[4:7], s[0:1], 48
    s_load_dwordx2 s[88:89], s[0:1], 72
    s_lshl_b32 s38, s32, 7
    s_lshl_b32 s39, s33, 4
    s_add_u32 s38, s38, s39
    s_lshl_b32 s39, s3, 1
    s_add_u32 s61, s38, s39
    s_mul_i32 s39, s61, 1152
    v_lshrrev_b32 v32, 5, v2
    v_mul_u32_u24 v32, 640, v32
    v_lshl_add_u32 v32, v2, 4, v32
    v_mov_b32 v33, 1073741824
    s_cmp_lt_u32 s33, 8
    s_cselect_b64 vcc, -1, 0
    v_cndmask_b32 v32, v33, v32, vcc
    v_and_b32 v34, 24, v2
    v_cmp_eq_u32 vcc, 0, v34
    buffer_load_dwordx4 v[80:83], v32, s[8:11], s39 offen
    buffer_load_dwordx4 v[84:87], v32, s[8:11], s39 offen offset:512
    v_cndmask_b32 v33, v33, v32, vcc
    buffer_load_dwordx4 v[88:91], v33, s[8:11], s39 offen offset:1024
    s_cmp_lt_u32 s3, 6
    s_cselect_b32 s28, s12, s16
    s_cselect_b32 s29, s13, s17
    s_cselect_b32 s30, s14, s18
    s_mov_b32 s31, 0x20000
    s_mov_b32 s45, 3456
    s_cselect_b32 s45, 9216, s45
    s_lshl_b32 s39, s3, 7
    s_add_u32 s39, s39, s41
    s_lshl_b32 s47, s34, 7
    s_sub_u32 s48, s39, 4992
    s_cmp_lt_u32 s3, 6
    s_cselect_b32 s47, s48, s47
    s_cmp_lt_u32 s3, 3
    s_cselect_b32 s39, s39, s47
    s_cmp_eq_u32 s3, 7
    s_cselect_b32 s30, 0, s30
    s_mul_i32 s38, s32, 36
    s_mul_i32 s38, s38, s45
    s_add_u32 s39, s39, s38
    s_mov_b32 s68, s39
    s_lshl_b32 s38, s45, 3
    v_mul_lo_u32 v38, v28, s45
    v_lshl_add_u32 v38, v29, 4, v38
    v_cmp_gt_u32 vcc, 32, v2
    v_mov_b32 v39, 1073741824
    s_nop 0
    v_cndmask_b32 v39, v39, v38, vcc
    s_mov_b32 s62, s39
    s_mov_b32 s63, s38
    s_cmp_gt_u32 s3, 1
    s_cbranch_scc1 parallel_sum__linear_kernel_hedgehog__mixer_gmlp__prompt_kernel_cw0
    buffer_load_dwordx4 v[92:95], v38, s[28:31], s39 offen
    s_add_u32 s39, s39, s38
    buffer_load_dwordx4 v[96:99], v38, s[28:31], s39 offen
    s_add_u32 s39, s39, s38
    buffer_load_dwordx4 v[100:103], v38, s[28:31], s39 offen
    s_add_u32 s39, s39, s38
    buffer_load_dwordx4 v[104:107], v38, s[28:31], s39 offen
    s_add_u32 s39, s39, s38
    buffer_load_dwordx4 v[108:111], v39, s[28:31], s39 offen
parallel_sum__linear_kernel_hedgehog__mixer_gmlp__prompt_kernel_cw0:
    s_add_u32 m0, s44, 16384
    s_add_u32 s46, s43, 128
    buffer_load_dwordx4 v7, s[8:11], s46 offen lds
    buffer_load_dwordx4 v8, s[8:11], s46 offen offset:1024 lds
    s_add_u32 m0, s42, 8192
    s_add_u32 s46, s40, 589824
    buffer_load_dwordx4 v5, s[12:15], s46 offen lds
    s_and_b32 s36, s3, 3
    s_lshr_b32 s37, s3, 2
    v_mul_u32_u24 v13, 3456, v28
    v_add_u32 v13, v13, v30
    v_and_b32 v22, 15, v2
    v_lshrrev_b32 v23, 2, v22
    v_and_b32 v22, 3, v22
    v_lshrrev_b32 v24, 5, v2
    v_bfe_u32 v25, v2, 4, 1
    v_lshlrev_b32 v1, 3, v24
    v_add_u32 v1, v1, v23
    v_lshlrev_b32 v1, 7, v1
    v_lshrrev_b32 v26, 1, v23
    v_xor_b32 v26, s37, v26
    v_lshl_add_u32 v1, v26, 6, v1
    v_lshl_add_u32 v1, v25, 5, v1
    v_lshl_add_u32 v1, v22, 3, v1
    v_add_u32 v3, 49152, v1
    v_and_b32 v32, 31, v2
    v_bfe_u32 v33, v2, 1, 3
    v_xor_b32 v33, v33, v24
    v_lshlrev_b32 v33, 4, v33
    v_lshl_add_u32 v9, v32, 7, v33
    s_lshl_b32 s38, s36, 12
    s_add_u32 s38, s38, 98304
    v_add_u32 v9, s38, v9
    v_xor_b32 v10, 32, v9
    v_xor_b32 v11, 64, v9
    v_xor_b32 v12, 96, v9
    v_lshlrev_b32 v21, 3, v32
    v_lshlrev_b32 v0, 4, v2
    s_waitcnt vmcnt(6)
    s_barrier
    ds_read_b128 v[112:115], v9 offset:0
    ds_read_b64_tr_b16 v[44:45], v1 offset:0
    ds_read_b64_tr_b16 v[46:47], v1 offset:512
    ds_read_b128 v[116:119], v10 offset:0
    ds_read_b64_tr_b16 v[48:49], v1 offset:2048
    ds_read_b64_tr_b16 v[50:51], v1 offset:2560
    s_cmp_eq_u32 s3, 4
    s_cselect_b32 s38, 0, 1073741824
    v_mov_b32 v4, s38
    buffer_load_dword v60, v4, s[24:27], 0 offen sc1
    s_add_u32 m0, s44, 32768
    s_add_u32 s46, s43, 256
    buffer_load_dwordx4 v7, s[8:11], s46 offen lds
    buffer_load_dwordx4 v8, s[8:11], s46 offen offset:1024 lds
    s_add_u32 m0, s42, 16384
    s_add_u32 s46, s40, 1179648
    buffer_load_dwordx4 v5, s[12:15], s46 offen lds
    s_mov_b32 s39, s62
    s_mov_b32 s38, s63
    s_cmp_gt_u32 s3, 1
    s_cbranch_scc0 parallel_sum__linear_kernel_hedgehog__mixer_gmlp__prompt_kernel_cw1
    buffer_load_dwordx4 v[92:95], v38, s[28:31], s39 offen
    s_add_u32 s39, s39, s38
    buffer_load_dwordx4 v[96:99], v38, s[28:31], s39 offen
    s_add_u32 s39, s39, s38
    buffer_load_dwordx4 v[100:103], v38, s[28:31], s39 offen
    s_add_u32 s39, s39, s38
    buffer_load_dwordx4 v[104:107], v38, s[28:31], s39 offen
    s_add_u32 s39, s39, s38
    buffer_load_dwordx4 v[108:111], v39, s[28:31], s39 offen
parallel_sum__linear_kernel_hedgehog__mixer_gmlp__prompt_kernel_cw1:
    buffer_load_dword v41, v4, s[24:27], 0 offen
    s_waitcnt lgkmcnt(3)
    ds_read_b128 v[120:123], v11 offset:0
    ds_read_b64_tr_b16 v[52:53], v1 offset:4096
    ds_read_b64_tr_b16 v[54:55], v1 offset:4608
    v_mfma_f32_32x32x16_bf16 v[64:79], v[44:47], v[112:115], 0
    s_mul_i32 s57, s33, 57344
    s_add_u32 s57, s57, 44040192
    s_mul_i32 s47, s32, 3584
    s_add_u32 s47, s47, s57
    s_lshl_b32 s48, s3, 9
    s_add_u32 s47, s47, s48
    v_lshlrev_b32 v40, 6, v29
    v_lshrrev_b32 v41, 4, v2
    v_lshl_add_u32 v40, v41, 3, v40
    v_and_b32 v41, 8, v2
    v_cmp_eq_u32 vcc, 0, v41
    v_mov_b32 v41, 1073741824
    s_cmp_eq_u32 s3, 7
    s_cselect_b64 vcc, 0, vcc
    v_cndmask_b32 v42, v41, v40, vcc
    s_mov_b32 s62, 0x00003f80
    s_mov_b32 s63, 0x3f800000
    s_lshl_b32 s38, s61, 4
    s_add_u32 s38, s38, 43909120
    v_lshrrev_b32 v40, 5, v2
    v_lshl_add_u32 v40, v40, 4, s38
    v_and_b32 v43, 31, v2
    v_cmp_eq_u32 vcc, 31, v43
    v_mov_b32 v43, 1073741824
    s_cmp_lt_u32 s33, 8
    s_cselect_b64 vcc, vcc, 0
    v_cndmask_b32 v43, v43, v40, vcc
    s_waitcnt lgkmcnt(3)
    ds_read_b128 v[124:127], v12 offset:0
    ds_read_b64_tr_b16 v[56:57], v1 offset:6144
    ds_read_b64_tr_b16 v[58:59], v1 offset:6656
    v_mfma_f32_32x32x16_bf16 v[64:79], v[48:51], v[116:119], v[64:79]
    s_waitcnt lgkmcnt(3)
    s_waitcnt vmcnt(5) lgkmcnt(0)
    s_barrier
    ds_read_b128 v[128:131], v9 offset:16384
    ds_read_b64_tr_b16 v[44:45], v1 offset:8192
    ds_read_b64_tr_b16 v[46:47], v1 offset:8704
    v_mfma_f32_32x32x16_bf16 v[64:79], v[52:55], v[120:123], v[64:79]
    s_add_u32 m0, s44, 0
    s_add_u32 s46, s43, 384
    buffer_load_dwordx4 v7, s[8:11], s46 offen lds
    buffer_load_dwordx4 v8, s[8:11], s46 offen offset:1024 lds
    ds_read_b128 v[132:135], v10 offset:16384
    ds_read_b64_tr_b16 v[48:49], v1 offset:10240
    ds_read_b64_tr_b16 v[50:51], v1 offset:10752
    v_mfma_f32_32x32x16_bf16 v[64:79], v[56:59], v[124:127], v[64:79]
    s_add_u32 m0, s42, 24576
    s_add_u32 s46, s40, 1769472
    buffer_load_dwordx4 v5, s[12:15], s46 offen lds
    s_waitcnt lgkmcnt(3)
    ds_read_b128 v[136:139], v11 offset:16384
    ds_read_b64_tr_b16 v[52:53], v1 offset:12288
    ds_read_b64_tr_b16 v[54:55], v1 offset:12800
    v_mfma_f32_32x32x16_bf16 v[64:79], v[44:47], v[128:131], v[64:79]
    s_waitcnt vmcnt(3)
    v_mov_b32 v36, 0
    v_mov_b32 v38, 0
    s_mov_b32 s45, 1065369472
    v_dot2c_f32_bf16 v36, s45, v80
    v_dot2c_f32_bf16 v38, v80, v80
    v_dot2c_f32_bf16 v36, s45, v81
    v_dot2c_f32_bf16 v38, v81, v81
    v_dot2c_f32_bf16 v36, s45, v82
    v_dot2c_f32_bf16 v38, v82, v82
    v_dot2c_f32_bf16 v36, s45, v83
    v_dot2c_f32_bf16 v38, v83, v83
    v_dot2c_f32_bf16 v36, s45, v84
    v_dot2c_f32_bf16 v38, v84, v84
    v_dot2c_f32_bf16 v36, s45, v85
    v_dot2c_f32_bf16 v38, v85, v85
    v_dot2c_f32_bf16 v36, s45, v86
    v_dot2c_f32_bf16 v38, v86, v86
    v_dot2c_f32_bf16 v36, s45, v87
    v_dot2c_f32_bf16 v38, v87, v87
    v_dot2c_f32_bf16 v36, s45, v88
    v_dot2c_f32_bf16 v38, v88, v88
    v_dot2c_f32_bf16 v36, s45, v89
    v_dot2c_f32_bf16 v38, v89, v89
    v_dot2c_f32_bf16 v36, s45, v90
    v_dot2c_f32_bf16 v38, v90, v90
    v_dot2c_f32_bf16 v36, s45, v91
    v_dot2c_f32_bf16 v38, v91, v91
    s_nop 2
    s_waitcnt lgkmcnt(3)
    ds_read_b128 v[140:143], v12 offset:16384
    ds_read_b64_tr_b16 v[56:57], v1 offset:14336
    ds_read_b64_tr_b16 v[58:59], v1 offset:14848
    v_mfma_f32_32x32x16_bf16 v[64:79], v[48:51], v[132:135], v[64:79]
    s_nop 1
    v_add_f32_dpp v36, v36, v36 row_shr:1 row_mask:0xf bank_mask:0xf bound_ctrl:0
    v_add_f32_dpp v38, v38, v38 row_shr:1 row_mask:0xf bank_mask:0xf bound_ctrl:0
    s_nop 1
    v_add_f32_dpp v36, v36, v36 row_shr:2 row_mask:0xf bank_mask:0xf bound_ctrl:0
    v_add_f32_dpp v38, v38, v38 row_shr:2 row_mask:0xf bank_mask:0xf bound_ctrl:0
    s_nop 1
    v_add_f32_dpp v36, v36, v36 row_shr:4 row_mask:0xf bank_mask:0xf bound_ctrl:0
    v_add_f32_dpp v38, v38, v38 row_shr:4 row_mask:0xf bank_mask:0xf bound_ctrl:0
    s_nop 1
    v_add_f32_dpp v36, v36, v36 row_shr:8 row_mask:0xf bank_mask:0xf bound_ctrl:0
    v_add_f32_dpp v38, v38, v38 row_shr:8 row_mask:0xf bank_mask:0xf bound_ctrl:0
    s_nop 1
    v_add_f32_dpp v36, v36, v36 row_bcast:15 row_mask:0xa bank_mask:0xf
    v_add_f32_dpp v38, v38, v38 row_bcast:15 row_mask:0xa bank_mask:0xf
    v_mul_f32 v36, 3135475257, v36
    v_mul_f32 v38, 987991609, v38
    v_fma_f32 v38, -v36, v36, v38
    v_max_f32 v38, 0, v38
    v_add_f32 v38, 925353388, v38
    v_rsq_f32 v38, v38
    v_lshlrev_b32 v24, 16, v92
    v_and_b32 v25, 0xffff0000, v92
    v_lshlrev_b32 v26, 16, v93
    v_and_b32 v27, 0xffff0000, v93
    v_lshlrev_b32 v28, 16, v94
    v_and_b32 v29, 0xffff0000, v94
    s_waitcnt lgkmcnt(3)
    s_cmp_eq_u32 s3, 4
    s_cbranch_scc0 parallel_sum__linear_kernel_hedgehog__mixer_gmlp__prompt_kernel_es_1
    v_readfirstlane_b32 s69, v60
    s_mov_b32 s58, 400000
parallel_sum__linear_kernel_hedgehog__mixer_gmlp__prompt_kernel_epl_2:
    s_cmp_lg_u32 s69, 0
    s_cbranch_scc1 parallel_sum__linear_kernel_hedgehog__mixer_gmlp__prompt_kernel_epk_3
    s_sub_u32 s58, s58, 1
    s_cmp_eq_u32 s58, 0
    s_cbranch_scc1 parallel_sum__linear_kernel_hedgehog__mixer_gmlp__prompt_kernel_epk_3
    s_sleep 4
    buffer_load_dword v60, v4, s[24:27], 0 offen sc1
    s_waitcnt vmcnt(0)
    v_readfirstlane_b32 s69, v60
    s_branch parallel_sum__linear_kernel_hedgehog__mixer_gmlp__prompt_kernel_epl_2
parallel_sum__linear_kernel_hedgehog__mixer_gmlp__prompt_kernel_epk_3:
    v_mov_b32 v4, 155648
    ds_write_b32 v4, v60
    s_waitcnt lgkmcnt(0)
parallel_sum__linear_kernel_hedgehog__mixer_gmlp__prompt_kernel_es_1:
    s_waitcnt lgkmcnt(0)
    s_barrier
    v_mov_b32 v4, 155648
    ds_read_b128 v[144:147], v9 offset:32768
    ds_read_b64_tr_b16 v[44:45], v1 offset:16384
    ds_read_b64_tr_b16 v[46:47], v1 offset:16896
    v_mfma_f32_32x32x16_bf16 v[64:79], v[52:55], v[136:139], v[64:79]
    s_add_u32 m0, s44, 16384
    s_add_u32 s46, s43, 512
    buffer_load_dwordx4 v7, s[8:11], s46 offen lds
    buffer_load_dwordx4 v8, s[8:11], s46 offen offset:1024 lds
    v_lshlrev_b32 v30, 16, v95
    v_and_b32 v31, 0xffff0000, v95
    v_dot2c_f32_bf16 v24, s62, v96
    v_dot2c_f32_bf16 v25, s63, v96
    v_dot2c_f32_bf16 v26, s62, v97
    v_dot2c_f32_bf16 v27, s63, v97
    v_dot2c_f32_bf16 v28, s62, v98
    v_dot2c_f32_bf16 v29, s63, v98
    v_dot2c_f32_bf16 v30, s62, v99
    v_dot2c_f32_bf16 v31, s63, v99
    v_dot2c_f32_bf16 v24, s62, v100
    v_dot2c_f32_bf16 v25, s63, v100
    v_dot2c_f32_bf16 v26, s62, v101
    v_dot2c_f32_bf16 v27, s63, v101
    v_dot2c_f32_bf16 v28, s62, v102
    v_dot2c_f32_bf16 v29, s63, v102
    v_dot2c_f32_bf16 v30, s62, v103
    v_dot2c_f32_bf16 v31, s63, v103
    v_dot2c_f32_bf16 v24, s62, v104
    v_dot2c_f32_bf16 v25, s63, v104
    v_dot2c_f32_bf16 v26, s62, v105
    v_dot2c_f32_bf16 v27, s63, v105
    v_dot2c_f32_bf16 v28, s62, v106
    v_dot2c_f32_bf16 v29, s63, v106
    v_dot2c_f32_bf16 v30, s62, v107
    v_dot2c_f32_bf16 v31, s63, v107
    v_dot2c_f32_bf16 v24, s62, v108
    v_dot2c_f32_bf16 v25, s63, v108
    ds_read_b128 v[148:151], v10 offset:32768
    ds_read_b64_tr_b16 v[48:49], v1 offset:18432
    ds_read_b64_tr_b16 v[50:51], v1 offset:18944
    v_mfma_f32_32x32x16_bf16 v[64:79], v[56:59], v[140:143], v[64:79]
    s_add_u32 m0, s42, 32768
    s_add_u32 s46, s40, 2359296
    buffer_load_dwordx4 v5, s[12:15], s46 offen lds
    v_dot2c_f32_bf16 v26, s62, v109
    v_dot2c_f32_bf16 v27, s63, v109
    v_dot2c_f32_bf16 v28, s62, v110
    v_dot2c_f32_bf16 v29, s63, v110
    v_dot2c_f32_bf16 v30, s62, v111
    v_dot2c_f32_bf16 v31, s63, v111
    s_nop 2
    v_add_f32_dpp v24, v24, v24 row_ror:8 row_mask:0xf bank_mask:0xf
    v_add_f32_dpp v25, v25, v25 row_ror:8 row_mask:0xf bank_mask:0xf
    v_add_f32_dpp v26, v26, v26 row_ror:8 row_mask:0xf bank_mask:0xf
    v_add_f32_dpp v27, v27, v27 row_ror:8 row_mask:0xf bank_mask:0xf
    v_add_f32_dpp v28, v28, v28 row_ror:8 row_mask:0xf bank_mask:0xf
    v_add_f32_dpp v29, v29, v29 row_ror:8 row_mask:0xf bank_mask:0xf
    v_add_f32_dpp v30, v30, v30 row_ror:8 row_mask:0xf bank_mask:0xf
    v_add_f32_dpp v31, v31, v31 row_ror:8 row_mask:0xf bank_mask:0xf
    s_nop 1
    v_permlane16_swap_b32 v24, v25
    v_permlane16_swap_b32 v26, v27
    v_permlane16_swap_b32 v28, v29
    v_permlane16_swap_b32 v30, v31
    s_nop 1
    v_add_f32 v24, v24, v25
    v_add_f32 v26, v26, v27
    v_add_f32 v28, v28, v29
    v_add_f32 v30, v30, v31
    s_nop 1
    v_permlane32_swap_b32 v24, v26
    v_permlane32_swap_b32 v28, v30
    s_waitcnt lgkmcnt(3)
    ds_read_b128 v[152:155], v11 offset:32768
    ds_read_b64_tr_b16 v[52:53], v1 offset:20480
    ds_read_b64_tr_b16 v[54:55], v1 offset:20992
    v_mfma_f32_32x32x16_bf16 v[64:79], v[44:47], v[144:147], v[64:79]
    s_nop 1
    v_add_f32 v24, v24, v26
    v_add_f32 v28, v28, v30
    s_waitcnt lgkmcnt(3)
    ds_read_b128 v[156:159], v12 offset:32768
    ds_read_b64_tr_b16 v[56:57], v1 offset:22528
    ds_read_b64_tr_b16 v[58:59], v1 offset:23040
    v_mfma_f32_32x32x16_bf16 v[64:79], v[48:51], v[148:151], v[64:79]
    ds_read_b32 v60, v4
    s_waitcnt lgkmcnt(0)
    v_mov_b32 v37, v60
    v_mov_b32 v39, v60
    v_mov_b32 v25, v60
    v_mov_b32 v29, v60
    buffer_store_dwordx4 v[36:39], v43, s[20:23], 0 offen sc1
    buffer_store_dwordx2 v[24:25], v42, s[20:23], s47 offen sc1
    buffer_store_dwordx2 v[28:29], v42, s[20:23], s47 offen offset:32 sc1
    s_lshl_b32 s49, s37, 8
    s_add_u32 s49, s49, 151552
    v_lshrrev_b32 v40, 5, v2
    v_add_u32 v17, s49, v21
    s_mul_i32 s49, s3, 6656
    s_add_u32 s49, s49, 98304
    v_mul_u32_u24 v19, 26, v21
    v_lshl_add_u32 v19, v40, 4, v19
    v_add_u32 v19, s49, v19
    v_bfe_u32 v20, v2, 4, 1
    v_mul_u32_u24 v20, 92160, v20
    v_and_b32 v41, 15, v2
    v_lshl_add_u32 v41, v40, 4, v41
    v_lshl_add_u32 v20, v41, 4, v20
    s_lshl_b32 s49, s36, 10
    v_add_u32 v18, s49, v0
    v_cmp_gt_u32 vcc, 3584, v18
    v_mov_b32 v63, 1073741824
    v_lshlrev_b32 v21, 1, v21
    v_cndmask_b32 v63, v63, v18, vcc
    v_add_u32 v18, 151552, v18
    s_lshl_b32 s47, s32, 3
    s_lshl_b32 s48, s36, 1
    s_add_u32 s47, s47, s48
    s_waitcnt vmcnt(6)
    s_barrier
    ds_read_b128 v[160:163], v9 offset:0
    ds_read_b64_tr_b16 v[44:45], v1 offset:24576
    ds_read_b64_tr_b16 v[46:47], v1 offset:25088
    v_mfma_f32_32x32x16_bf16 v[64:79], v[52:55], v[152:155], v[64:79]
    s_add_u32 m0, s44, 32768
    s_add_u32 s46, s43, 640
    buffer_load_dwordx4 v7, s[8:11], s46 offen lds
    buffer_load_dwordx4 v8, s[8:11], s46 offen offset:1024 lds
    s_mul_i32 s47, s47, 90
    s_mul_i32 s48, s33, 6
    s_add_u32 s47, s47, s48
    s_add_u32 s47, s47, s37
    s_lshl_b32 s47, s47, 10
    s_add_u32 s50, s47, 20971520
    s_add_u32 s51, s50, 2048
    s_add_u32 s52, s50, 4096
    s_lshl_b32 s47, s32, 2
    s_add_u32 s47, s47, s36
    s_lshl_b32 s59, s47, 9
    s_add_u32 s59, s59, 43909120
    s_mul_i32 s48, s47, 36
    s_lshl_b32 s49, s34, 2
    s_add_u32 s48, s48, s49
    s_lshl_b32 s49, s37, 1
    s_add_u32 s48, s48, s49
    s_lshl_b32 s48, s48, 10
    s_add_u32 s53, s48, 37748736
    s_mul_i32 s54, s47, 144
    s_mul_i32 s48, s33, 12
    s_add_u32 s54, s54, s48
    s_add_u32 s54, s54, s49
    s_lshl_b32 s54, s54, 10
    s_mul_i32 s55, s32, 12
    s_add_u32 s48, s33, s55
    s_lshl_b32 s48, s48, 11
    s_lshl_b32 s49, s36, 9
    ds_read_b128 v[164:167], v10 offset:0
    ds_read_b64_tr_b16 v[48:49], v1 offset:26624
    ds_read_b64_tr_b16 v[50:51], v1 offset:27136
    v_mfma_f32_32x32x16_bf16 v[64:79], v[56:59], v[156:159], v[64:79]
    s_add_u32 m0, s42, 40960
    s_add_u32 s46, s40, 2949120
    buffer_load_dwordx4 v5, s[12:15], s46 offen lds
    s_add_u32 s48, s48, s49
    s_add_u32 s56, s48, 42991616
    s_lshl_b32 s55, s55, 11
    s_add_u32 s55, s55, s49
    s_add_u32 s55, s55, 42991616
    s_waitcnt lgkmcnt(3)
    ds_read_b128 v[168:171], v11 offset:0
    ds_read_b64_tr_b16 v[52:53], v1 offset:28672
    ds_read_b64_tr_b16 v[54:55], v1 offset:29184
    v_mfma_f32_32x32x16_bf16 v[64:79], v[44:47], v[160:163], v[64:79]
    s_waitcnt lgkmcnt(3)
    ds_read_b128 v[172:175], v12 offset:0
    ds_read_b64_tr_b16 v[56:57], v1 offset:30720
    ds_read_b64_tr_b16 v[58:59], v1 offset:31232
    v_mfma_f32_32x32x16_bf16 v[64:79], v[48:51], v[164:167], v[64:79]
    s_waitcnt lgkmcnt(3)
    s_waitcnt vmcnt(6) lgkmcnt(0)
    s_barrier
    ds_read_b128 v[176:179], v9 offset:16384
    ds_read_b64_tr_b16 v[44:45], v1 offset:32768
    ds_read_b64_tr_b16 v[46:47], v1 offset:33280
    v_mfma_f32_32x32x16_bf16 v[64:79], v[52:55], v[168:171], v[64:79]
    s_add_u32 m0, s44, 0
    s_add_u32 s46, s43, 768
    buffer_load_dwordx4 v7, s[8:11], s46 offen lds
    buffer_load_dwordx4 v8, s[8:11], s46 offen offset:1024 lds
    ds_read_b128 v[180:183], v10 offset:16384
    ds_read_b64_tr_b16 v[48:49], v1 offset:34816
    ds_read_b64_tr_b16 v[50:51], v1 offset:35328
    v_mfma_f32_32x32x16_bf16 v[64:79], v[56:59], v[172:175], v[64:79]
    s_add_u32 m0, s42, 49152
    s_add_u32 s46, s40, 3538944
    buffer_load_dwordx4 v5, s[12:15], s46 offen lds
    s_waitcnt lgkmcnt(3)
    ds_read_b128 v[184:187], v11 offset:16384
    ds_read_b64_tr_b16 v[52:53], v1 offset:36864
    ds_read_b64_tr_b16 v[54:55], v1 offset:37376
    v_mfma_f32_32x32x16_bf16 v[64:79], v[44:47], v[176:179], v[64:79]
    s_waitcnt lgkmcnt(3)
    ds_read_b128 v[188:191], v12 offset:16384
    ds_read_b64_tr_b16 v[56:57], v1 offset:38912
    ds_read_b64_tr_b16 v[58:59], v1 offset:39424
    v_mfma_f32_32x32x16_bf16 v[64:79], v[48:51], v[180:183], v[64:79]
    s_waitcnt lgkmcnt(3)
    s_waitcnt vmcnt(3) lgkmcnt(0)
    s_barrier
    ds_read_b128 v[192:195], v9 offset:32768
    ds_read_b64_tr_b16 v[44:45], v1 offset:40960
    ds_read_b64_tr_b16 v[46:47], v1 offset:41472
    v_mfma_f32_32x32x16_bf16 v[64:79], v[52:55], v[184:187], v[64:79]
    s_add_u32 m0, s44, 16384
    s_add_u32 s46, s43, 896
    buffer_load_dwordx4 v7, s[8:11], s46 offen lds
    buffer_load_dwordx4 v8, s[8:11], s46 offen offset:1024 lds
    ds_read_b128 v[196:199], v10 offset:32768
    ds_read_b64_tr_b16 v[48:49], v1 offset:43008
    ds_read_b64_tr_b16 v[50:51], v1 offset:43520
    v_mfma_f32_32x32x16_bf16 v[64:79], v[56:59], v[188:191], v[64:79]
    s_add_u32 m0, s42, 57344
    s_add_u32 s46, s40, 4128768
    buffer_load_dwordx4 v5, s[12:15], s46 offen lds
    s_waitcnt lgkmcnt(3)
    ds_read_b128 v[200:203], v11 offset:32768
    ds_read_b64_tr_b16 v[52:53], v1 offset:45056
    ds_read_b64_tr_b16 v[54:55], v1 offset:45568
    v_mfma_f32_32x32x16_bf16 v[64:79], v[44:47], v[192:195], v[64:79]
    s_waitcnt lgkmcnt(3)
    ds_read_b128 v[204:207], v12 offset:32768
    ds_read_b64_tr_b16 v[56:57], v1 offset:47104
    ds_read_b64_tr_b16 v[58:59], v1 offset:47616
    v_mfma_f32_32x32x16_bf16 v[64:79], v[48:51], v[196:199], v[64:79]
    s_waitcnt lgkmcnt(3)
    s_waitcnt vmcnt(3) lgkmcnt(0)
    s_barrier
    v_lshrrev_b32 v40, 2, v2
    v_mul_u32_u24 v40, 3584, v40
    v_and_b32 v41, 3, v2
    v_lshl_add_u32 v40, v41, 3, v40
    s_mul_i32 s38, s32, 28
    s_lshl_b32 s39, s3, 2
    s_add_u32 s38, s38, s39
    s_lshl_b32 s38, s38, 3
    s_cmp_eq_u32 s3, 7
    s_cselect_b32 s38, 1073741824, s38
    v_add_u32 v40, s38, v40
    v_lshl_add_u32 v41, v41, 3, s38
    v_cmp_gt_u32 vcc, 4, v2
    v_mov_b32 v42, 1073741824
    s_mul_i32 s65, s33, 3584
    s_add_u32 s65, s65, 44843008
    v_cndmask_b32 v41, v42, v41, vcc
    buffer_load_dwordx2 v[36:37], v40, s[20:23], s57 offen
    ds_read_b128 v[208:211], v9 offset:0
    ds_read_b64_tr_b16 v[44:45], v3 offset:0
    ds_read_b64_tr_b16 v[46:47], v3 offset:512
    v_mfma_f32_32x32x16_bf16 v[64:79], v[52:55], v[200:203], v[64:79]
    s_add_u32 m0, s44, 32768
    s_add_u32 s46, s43, 1024
    buffer_load_dwordx4 v7, s[8:11], s46 offen lds
    buffer_load_dwordx4 v8, s[8:11], s46 offen offset:1024 lds
    ds_read_b128 v[212:215], v10 offset:0
    ds_read_b64_tr_b16 v[48:49], v3 offset:2048
    ds_read_b64_tr_b16 v[50:51], v3 offset:2560
    v_mfma_f32_32x32x16_bf16 v[64:79], v[56:59], v[204:207], v[64:79]
    s_add_u32 m0, s42, 65536
    s_add_u32 s46, s40, 4718592
    buffer_load_dwordx4 v5, s[12:15], s46 offen lds
    s_waitcnt lgkmcnt(3)
    ds_read_b128 v[216:219], v11 offset:0
    ds_read_b64_tr_b16 v[52:53], v3 offset:4096
    ds_read_b64_tr_b16 v[54:55], v3 offset:4608
    v_mfma_f32_32x32x16_bf16 v[64:79], v[44:47], v[208:211], v[64:79]
    s_waitcnt lgkmcnt(3)
    ds_read_b128 v[220:223], v12 offset:0
    ds_read_b64_tr_b16 v[56:57], v3 offset:6144
    ds_read_b64_tr_b16 v[58:59], v3 offset:6656
    v_mfma_f32_32x32x16_bf16 v[64:79], v[48:51], v[212:215], v[64:79]
    s_waitcnt lgkmcnt(3)
    s_waitcnt vmcnt(4) lgkmcnt(0)
    s_barrier
    ds_read_b128 v[224:227], v9 offset:16384
    ds_read_b64_tr_b16 v[44:45], v3 offset:8192
    ds_read_b64_tr_b16 v[46:47], v3 offset:8704
    v_mfma_f32_32x32x16_bf16 v[64:79], v[52:55], v[216:219], v[64:79]
    s_add_u32 m0, s42, 73728
    s_add_u32 s46, s40, 128
    buffer_load_dwordx4 v5, s[12:15], s46 offen lds
    ds_read_b128 v[228:231], v10 offset:16384
    ds_read_b64_tr_b16 v[48:49], v3 offset:10240
    ds_read_b64_tr_b16 v[50:51], v3 offset:10752
    v_mfma_f32_32x32x16_bf16 v[64:79], v[56:59], v[220:223], v[64:79]
    s_add_u32 m0, s42, 81920
    s_add_u32 s46, s40, 589952
    buffer_load_dwordx4 v5, s[12:15], s46 offen lds
    s_waitcnt lgkmcnt(3)
    ds_read_b128 v[232:235], v11 offset:16384
    ds_read_b64_tr_b16 v[52:53], v3 offset:12288
    ds_read_b64_tr_b16 v[54:55], v3 offset:12800
    v_mfma_f32_32x32x16_bf16 v[64:79], v[44:47], v[224:227], v[64:79]
    s_add_u32 m0, s42, 90112
    s_add_u32 s46, s40, 1179776
    buffer_load_dwordx4 v5, s[12:15], s46 offen lds
    s_waitcnt lgkmcnt(3)
    ds_read_b128 v[236:239], v12 offset:16384
    ds_read_b64_tr_b16 v[56:57], v3 offset:14336
    ds_read_b64_tr_b16 v[58:59], v3 offset:14848
    v_mfma_f32_32x32x16_bf16 v[64:79], v[48:51], v[228:231], v[64:79]
    s_waitcnt lgkmcnt(3)
    s_waitcnt vmcnt(3) lgkmcnt(0)
    s_barrier
    s_mov_b32 s58, 100000
parallel_sum__linear_kernel_hedgehog__mixer_gmlp__prompt_kernel_tg_4:
    v_min3_u32 v38, v37, v37, v37
    v_max3_u32 v39, v37, v37, v37
    v_xor_b32 v38, v38, v60
    v_xor_b32 v39, v39, v60
    v_or_b32 v38, v38, v39
    v_lshrrev_b32 v39, 30, v40
    v_subrev_u32 v39, 1, v39
    v_and_b32 v38, v38, v39
    v_cmp_ne_u32 vcc, 0, v38
    s_sub_u32 s58, s58, 1
    s_cmp_eq_u32 s58, 0
    s_cbranch_scc1 parallel_sum__linear_kernel_hedgehog__mixer_gmlp__prompt_kernel_tk_5
    s_cmp_eq_u64 vcc, 0
    s_cbranch_scc1 parallel_sum__linear_kernel_hedgehog__mixer_gmlp__prompt_kernel_tk_5
    s_sleep 8
    buffer_load_dwordx2 v[36:37], v40, s[20:23], s57 offen sc1
    s_waitcnt vmcnt(0)
    s_branch parallel_sum__linear_kernel_hedgehog__mixer_gmlp__prompt_kernel_tg_4
parallel_sum__linear_kernel_hedgehog__mixer_gmlp__prompt_kernel_tk_5:
    v_add_f32_dpp v36, v36, v36 row_ror:4 row_mask:0xf bank_mask:0xf
    s_nop 1
    v_add_f32_dpp v36, v36, v36 row_ror:8 row_mask:0xf bank_mask:0xf
    s_nop 0
    v_mov_b32 v38, v36
    s_nop 1
    v_permlane16_swap_b32 v36, v38
    s_nop 1
    v_add_f32 v36, v36, v38
    v_mov_b32 v38, v36
    s_nop 1
    v_permlane32_swap_b32 v36, v38
    s_nop 1
    v_add_f32 v36, v36, v38
    buffer_store_dwordx2 v[36:37], v41, s[20:23], s65 offen sc1
    ds_read_b128 v[240:243], v9 offset:32768
    ds_read_b64_tr_b16 v[44:45], v3 offset:16384
    ds_read_b64_tr_b16 v[46:47], v3 offset:16896
    v_mfma_f32_32x32x16_bf16 v[64:79], v[52:55], v[232:235], v[64:79]
    s_add_u32 m0, s42, 0
    s_add_u32 s46, s40, 1769600
    buffer_load_dwordx4 v5, s[12:15], s46 offen lds
    ds_read_b128 v[244:247], v10 offset:32768
    ds_read_b64_tr_b16 v[48:49], v3 offset:18432
    ds_read_b64_tr_b16 v[50:51], v3 offset:18944
    v_mfma_f32_32x32x16_bf16 v[64:79], v[56:59], v[236:239], v[64:79]
    s_add_u32 m0, s42, 8192
    s_add_u32 s46, s40, 2359424
    buffer_load_dwordx4 v5, s[12:15], s46 offen lds
    s_waitcnt lgkmcnt(3)
    ds_read_b128 v[248:251], v11 offset:32768
    ds_read_b64_tr_b16 v[52:53], v3 offset:20480
    ds_read_b64_tr_b16 v[54:55], v3 offset:20992
    v_mfma_f32_32x32x16_bf16 v[64:79], v[44:47], v[240:243], v[64:79]
    s_add_u32 m0, s42, 16384
    s_add_u32 s46, s40, 2949248
    buffer_load_dwordx4 v5, s[12:15], s46 offen lds
    s_waitcnt lgkmcnt(3)
    ds_read_b128 v[252:255], v12 offset:32768
    ds_read_b64_tr_b16 v[56:57], v3 offset:22528
    ds_read_b64_tr_b16 v[58:59], v3 offset:23040
    v_mfma_f32_32x32x16_bf16 v[64:79], v[48:51], v[244:247], v[64:79]
    s_waitcnt lgkmcnt(3)
    s_waitcnt vmcnt(4) lgkmcnt(0)
    s_barrier
    buffer_load_dwordx4 v[108:111], v21, s[20:23], s59 offen
    v_mfma_f32_32x32x16_bf16 v[64:79], v[52:55], v[248:251], v[64:79]
    s_add_u32 m0, s42, 24576
    s_add_u32 s46, s40, 3539072
    buffer_load_dwordx4 v5, s[12:15], s46 offen lds
    v_mfma_f32_32x32x16_bf16 v[64:79], v[56:59], v[252:255], v[64:79]
    s_add_u32 m0, s42, 32768
    s_add_u32 s46, s40, 4128896
    buffer_load_dwordx4 v5, s[12:15], s46 offen lds
    s_add_u32 m0, s42, 40960
    s_add_u32 s46, s40, 4718720
    buffer_load_dwordx4 v5, s[12:15], s46 offen lds
    s_mul_i32 s40, s36, 147456
    s_add_u32 s40, s40, s41
    s_mul_i32 s41, s36, 55296
    s_lshl_b32 s42, s34, 7
    s_add_u32 s41, s41, s42
    s_lshl_b32 s42, s36, 11
    v_add_u32 v104, 72704, v5
    v_add_u32 v105, 26624, v13
    s_cmp_eq_u32 s37, 0
    s_cbranch_scc0 parallel_sum__linear_kernel_hedgehog__mixer_gmlp__prompt_kernel_p1
    s_setprio 1
    ds_read_b64_tr_b16 v[44:45], v3 offset:24576
    ds_read_b64_tr_b16 v[46:47], v3 offset:25088
    ds_read_b64_tr_b16 v[48:49], v3 offset:26624
    ds_read_b64_tr_b16 v[50:51], v3 offset:27136
    ds_read_b64_tr_b16 v[52:53], v3 offset:28672
    ds_read_b64_tr_b16 v[54:55], v3 offset:29184
    s_waitcnt lgkmcnt(4)
    ds_read_b64_tr_b16 v[56:57], v3 offset:30720
    ds_read_b64_tr_b16 v[58:59], v3 offset:31232
    v_mfma_f32_32x32x16_bf16 v[80:95], v[44:47], v[112:115], 0
    s_waitcnt lgkmcnt(4)
    ds_read_b64_tr_b16 v[96:97], v3 offset:32768
    ds_read_b64_tr_b16 v[98:99], v3 offset:33280
    v_mfma_f32_32x32x16_bf16 v[80:95], v[48:51], v[116:119], v[80:95]
    s_add_u32 m0, s42, 49152
    s_add_u32 s46, s40, 256
    buffer_load_dwordx4 v5, s[12:15], s46 offen lds
    s_waitcnt lgkmcnt(4)
    ds_read_b64_tr_b16 v[100:101], v3 offset:34816
    ds_read_b64_tr_b16 v[102:103], v3 offset:35328
    v_mfma_f32_32x32x16_bf16 v[80:95], v[52:55], v[120:123], v[80:95]
    s_waitcnt lgkmcnt(4)
    ds_read_b64_tr_b16 v[44:45], v3 offset:36864
    ds_read_b64_tr_b16 v[46:47], v3 offset:37376
    v_mfma_f32_32x32x16_bf16 v[80:95], v[56:59], v[124:127], v[80:95]
    s_waitcnt lgkmcnt(4)
    ds_read_b64_tr_b16 v[48:49], v3 offset:38912
    ds_read_b64_tr_b16 v[50:51], v3 offset:39424
    v_mfma_f32_32x32x16_bf16 v[80:95], v[96:99], v[128:131], v[80:95]
    s_waitcnt lgkmcnt(4)
    ds_read_b64_tr_b16 v[52:53], v3 offset:40960
    ds_read_b64_tr_b16 v[54:55], v3 offset:41472
    v_mfma_f32_32x32x16_bf16 v[80:95], v[100:103], v[132:135], v[80:95]
    s_waitcnt lgkmcnt(4)
    ds_read_b64_tr_b16 v[56:57], v3 offset:43008
    ds_read_b64_tr_b16 v[58:59], v3 offset:43520
    v_mfma_f32_32x32x16_bf16 v[80:95], v[44:47], v[136:139], v[80:95]
    buffer_load_dwordx4 v104, s[12:15], s46 offen offset:1024 lds
    s_waitcnt lgkmcnt(4)
    ds_read_b64_tr_b16 v[96:97], v3 offset:45056
    ds_read_b64_tr_b16 v[98:99], v3 offset:45568
    v_mfma_f32_32x32x16_bf16 v[80:95], v[48:51], v[140:143], v[80:95]
    s_waitcnt lgkmcnt(4)
    ds_read_b64_tr_b16 v[100:101], v3 offset:47104
    ds_read_b64_tr_b16 v[102:103], v3 offset:47616
    v_mfma_f32_32x32x16_bf16 v[80:95], v[52:55], v[144:147], v[80:95]
    s_waitcnt lgkmcnt(4)
    v_mfma_f32_32x32x16_bf16 v[80:95], v[56:59], v[148:151], v[80:95]
    s_waitcnt vmcnt(6)
    s_barrier
    ds_read_b64_tr_b16 v[44:45], v1 offset:0
    ds_read_b64_tr_b16 v[46:47], v1 offset:512
    s_waitcnt lgkmcnt(4)
    ds_read_b64_tr_b16 v[48:49], v1 offset:2048
    ds_read_b64_tr_b16 v[50:51], v1 offset:2560
    v_mfma_f32_32x32x16_bf16 v[80:95], v[96:99], v[152:155], v[80:95]
    s_waitcnt lgkmcnt(4)
    ds_read_b64_tr_b16 v[52:53], v1 offset:4096
    ds_read_b64_tr_b16 v[54:55], v1 offset:4608
    v_mfma_f32_32x32x16_bf16 v[80:95], v[100:103], v[156:159], v[80:95]
    s_add_u32 m0, s42, 57344
    s_add_u32 s46, s40, 590080
    buffer_load_dwordx4 v5, s[12:15], s46 offen lds
    s_waitcnt lgkmcnt(4)
    ds_read_b64_tr_b16 v[56:57], v1 offset:6144
    ds_read_b64_tr_b16 v[58:59], v1 offset:6656
    v_mfma_f32_32x32x16_bf16 v[80:95], v[44:47], v[160:163], v[80:95]
    s_waitcnt lgkmcnt(4)
    ds_read_b64_tr_b16 v[96:97], v1 offset:8192
    ds_read_b64_tr_b16 v[98:99], v1 offset:8704
    v_mfma_f32_32x32x16_bf16 v[80:95], v[48:51], v[164:167], v[80:95]
    s_waitcnt lgkmcnt(4)
    ds_read_b64_tr_b16 v[100:101], v1 offset:10240
    ds_read_b64_tr_b16 v[102:103], v1 offset:10752
    v_mfma_f32_32x32x16_bf16 v[80:95], v[52:55], v[168:171], v[80:95]
    s_waitcnt lgkmcnt(4)
    ds_read_b64_tr_b16 v[44:45], v1 offset:12288
    ds_read_b64_tr_b16 v[46:47], v1 offset:12800
    v_mfma_f32_32x32x16_bf16 v[80:95], v[56:59], v[172:175], v[80:95]
    s_waitcnt lgkmcnt(4)
    ds_read_b64_tr_b16 v[48:49], v1 offset:14336
    ds_read_b64_tr_b16 v[50:51], v1 offset:14848
    v_mfma_f32_32x32x16_bf16 v[80:95], v[96:99], v[176:179], v[80:95]
    buffer_load_dwordx4 v104, s[12:15], s46 offen offset:1024 lds
    s_waitcnt lgkmcnt(4)
    ds_read_b64_tr_b16 v[52:53], v1 offset:16384
    ds_read_b64_tr_b16 v[54:55], v1 offset:16896
    v_mfma_f32_32x32x16_bf16 v[80:95], v[100:103], v[180:183], v[80:95]
    s_waitcnt lgkmcnt(4)
    ds_read_b64_tr_b16 v[56:57], v1 offset:18432
    ds_read_b64_tr_b16 v[58:59], v1 offset:18944
    v_mfma_f32_32x32x16_bf16 v[80:95], v[44:47], v[184:187], v[80:95]
    s_waitcnt lgkmcnt(4)
    ds_read_b64_tr_b16 v[96:97], v1 offset:20480
    ds_read_b64_tr_b16 v[98:99], v1 offset:20992
    v_mfma_f32_32x32x16_bf16 v[80:95], v[48:51], v[188:191], v[80:95]
    s_waitcnt lgkmcnt(4)
    ds_read_b64_tr_b16 v[100:101], v1 offset:22528
    ds_read_b64_tr_b16 v[102:103], v1 offset:23040
    v_mfma_f32_32x32x16_bf16 v[80:95], v[52:55], v[192:195], v[80:95]
    s_waitcnt lgkmcnt(4)
    v_mfma_f32_32x32x16_bf16 v[80:95], v[56:59], v[196:199], v[80:95]
    s_waitcnt vmcnt(4)
    s_barrier
    ds_read_b64_tr_b16 v[44:45], v1 offset:24576
    ds_read_b64_tr_b16 v[46:47], v1 offset:25088
    s_add_u32 m0, s42, 65536
    s_add_u32 s46, s40, 1179904
    buffer_load_dwordx4 v5, s[12:15], s46 offen lds
    s_waitcnt lgkmcnt(4)
    ds_read_b64_tr_b16 v[48:49], v1 offset:26624
    ds_read_b64_tr_b16 v[50:51], v1 offset:27136
    v_mfma_f32_32x32x16_bf16 v[80:95], v[96:99], v[200:203], v[80:95]
    s_waitcnt lgkmcnt(4)
    ds_read_b64_tr_b16 v[52:53], v1 offset:28672
    ds_read_b64_tr_b16 v[54:55], v1 offset:29184
    v_mfma_f32_32x32x16_bf16 v[80:95], v[100:103], v[204:207], v[80:95]
    s_waitcnt lgkmcnt(4)
    ds_read_b64_tr_b16 v[56:57], v1 offset:30720
    ds_read_b64_tr_b16 v[58:59], v1 offset:31232
    v_mfma_f32_32x32x16_bf16 v[80:95], v[44:47], v[208:211], v[80:95]
    s_waitcnt lgkmcnt(4)
    ds_read_b64_tr_b16 v[96:97], v1 offset:32768
    ds_read_b64_tr_b16 v[98:99], v1 offset:33280
    v_mfma_f32_32x32x16_bf16 v[80:95], v[48:51], v[212:215], v[80:95]
    s_waitcnt lgkmcnt(4)
    ds_read_b64_tr_b16 v[100:101], v1 offset:34816
    ds_read_b64_tr_b16 v[102:103], v1 offset:35328
    v_mfma_f32_32x32x16_bf16 v[80:95], v[52:55], v[216:219], v[80:95]
    buffer_load_dwordx4 v104, s[12:15], s46 offen offset:1024 lds
    s_waitcnt lgkmcnt(4)
    ds_read_b64_tr_b16 v[44:45], v1 offset:36864
    ds_read_b64_tr_b16 v[46:47], v1 offset:37376
    v_mfma_f32_32x32x16_bf16 v[80:95], v[56:59], v[220:223], v[80:95]
    s_waitcnt lgkmcnt(4)
    ds_read_b64_tr_b16 v[48:49], v1 offset:38912
    ds_read_b64_tr_b16 v[50:51], v1 offset:39424
    v_mfma_f32_32x32x16_bf16 v[80:95], v[96:99], v[224:227], v[80:95]
    s_waitcnt lgkmcnt(4)
    ds_read_b64_tr_b16 v[52:53], v1 offset:40960
    ds_read_b64_tr_b16 v[54:55], v1 offset:41472
    v_mfma_f32_32x32x16_bf16 v[80:95], v[100:103], v[228:231], v[80:95]
    s_waitcnt lgkmcnt(4)
    ds_read_b64_tr_b16 v[56:57], v1 offset:43008
    ds_read_b64_tr_b16 v[58:59], v1 offset:43520
    v_mfma_f32_32x32x16_bf16 v[80:95], v[44:47], v[232:235], v[80:95]
    s_waitcnt lgkmcnt(4)
    ds_read_b64_tr_b16 v[96:97], v1 offset:45056
    ds_read_b64_tr_b16 v[98:99], v1 offset:45568
    v_mfma_f32_32x32x16_bf16 v[80:95], v[48:51], v[236:239], v[80:95]
    s_waitcnt lgkmcnt(4)
    ds_read_b64_tr_b16 v[100:101], v1 offset:47104
    ds_read_b64_tr_b16 v[102:103], v1 offset:47616
    v_mfma_f32_32x32x16_bf16 v[80:95], v[52:55], v[240:243], v[80:95]
    s_waitcnt lgkmcnt(4)
    v_mfma_f32_32x32x16_bf16 v[80:95], v[56:59], v[244:247], v[80:95]
    s_waitcnt lgkmcnt(2)
    v_mfma_f32_32x32x16_bf16 v[80:95], v[96:99], v[248:251], v[80:95]
    s_waitcnt lgkmcnt(0)
    v_mfma_f32_32x32x16_bf16 v[80:95], v[100:103], v[252:255], v[80:95]
    s_setprio 0
    s_barrier
    s_mov_b32 s58, 100000
parallel_sum__linear_kernel_hedgehog__mixer_gmlp__prompt_kernel_tg_101:
    v_min3_u32 v61, v109, v111, v111
    v_max3_u32 v62, v109, v111, v111
    v_xor_b32 v61, v61, v60
    v_xor_b32 v62, v62, v60
    v_or_b32 v61, v61, v62
    v_cmp_ne_u32 vcc, 0, v61
    s_sub_u32 s58, s58, 1
    s_cmp_eq_u32 s58, 0
    s_cbranch_scc1 parallel_sum__linear_kernel_hedgehog__mixer_gmlp__prompt_kernel_tk_102
    s_cmp_eq_u64 vcc, 0
    s_cbranch_scc1 parallel_sum__linear_kernel_hedgehog__mixer_gmlp__prompt_kernel_tk_102
    s_sleep 8
    buffer_load_dwordx4 v[108:111], v21, s[20:23], s59 offen sc1
    s_waitcnt vmcnt(0)
    s_branch parallel_sum__linear_kernel_hedgehog__mixer_gmlp__prompt_kernel_tg_101
parallel_sum__linear_kernel_hedgehog__mixer_gmlp__prompt_kernel_tk_102:
    v_mov_b32 v12, v110
    s_mov_b32 s67, 1065369472
    v_mul_f32 v15, v12, v12
    v_mul_f32 v14, 3222493025, v12
    v_mul_f32 v15, v15, v12
    v_mov_b32 v61, 0
    v_mul_f32 v15, 3184710632, v15
    v_mov_b32 v62, 0
    v_mov_b32 v7, 0
    v_mov_b32 v8, 0
    v_cvt_pk_bf16_f32 v24, v108, v108
    v_mov_b32 v26, 0
    v_lshlrev_b32 v24, 16, v24
    v_mov_b32 v27, 0
    v_sub_f32 v24, v108, v24
    v_cmp_gt_u32 vcc, 32, v2
    v_cvt_pk_bf16_f32 v24, v108, v24
    v_mov_b32 v30, 0
    v_cndmask_b32 v24, v26, v24, vcc
    v_mov_b32 v31, 0
    v_mov_b32 v25, v24
    ds_read_b64 v[28:29], v17 offset:0
    s_waitcnt lgkmcnt(0)
    v_mfma_f32_32x32x16_bf16 v[64:79], v[28:31], v[24:27], v[64:79]
    s_nop 7
    s_nop 3
    v_mul_f32 v32, v64, v64
    v_mul_f32 v33, v65, v65
    v_mul_f32 v34, v66, v66
    v_mul_f32 v35, v67, v67
    v_mul_f32 v6, v68, v68
    v_mul_f32 v16, v69, v69
    v_mul_f32 v22, v70, v70
    v_mul_f32 v23, v71, v71
    v_fma_f32 v32, v32, v15, v14
    v_fma_f32 v33, v33, v15, v14
    v_fma_f32 v34, v34, v15, v14
    v_fma_f32 v35, v35, v15, v14
    v_fma_f32 v6, v6, v15, v14
    v_fma_f32 v16, v16, v15, v14
    v_fma_f32 v22, v22, v15, v14
    v_fma_f32 v23, v23, v15, v14
    v_mul_f32 v32, v32, v64
    v_mul_f32 v33, v33, v65
    v_mul_f32 v34, v34, v66
    v_mul_f32 v35, v35, v67
    v_mul_f32 v6, v6, v68
    v_mul_f32 v16, v16, v69
    v_mul_f32 v22, v22, v70
    v_mul_f32 v23, v23, v71
    v_exp_f32 v32, v32
    v_exp_f32 v33, v33
    v_exp_f32 v34, v34
    v_exp_f32 v35, v35
    v_exp_f32 v6, v6
    v_exp_f32 v16, v16
    v_exp_f32 v22, v22
    v_exp_f32 v23, v23
    v_add_f32 v32, 1.0, v32
    v_add_f32 v33, 1.0, v33
    v_add_f32 v34, 1.0, v34
    v_add_f32 v35, 1.0, v35
    v_add_f32 v6, 1.0, v6
    v_add_f32 v16, 1.0, v16
    v_add_f32 v22, 1.0, v22
    v_add_f32 v23, 1.0, v23
    s_barrier
    v_rcp_f32 v32, v32
    v_rcp_f32 v33, v33
    v_rcp_f32 v34, v34
    v_rcp_f32 v35, v35
    v_rcp_f32 v6, v6
    v_rcp_f32 v16, v16
    v_rcp_f32 v22, v22
    v_rcp_f32 v23, v23
    v_mul_f32 v64, v64, v32
    v_mul_f32 v65, v65, v33
    v_mul_f32 v66, v66, v34
    v_mul_f32 v67, v67, v35
    v_mul_f32 v68, v68, v6
    v_mul_f32 v69, v69, v16
    v_mul_f32 v70, v70, v22
    v_mul_f32 v71, v71, v23
    v_cvt_pk_bf16_f32 v36, v64, v65
    v_cvt_pk_bf16_f32 v37, v66, v67
    v_cvt_pk_bf16_f32 v38, v68, v69
    v_cvt_pk_bf16_f32 v39, v70, v71
    v_add_f32 v61, v61, v64
    v_fmac_f32 v62, v64, v64
    v_add_f32 v7, v7, v65
    v_fmac_f32 v8, v65, v65
    v_add_f32 v61, v61, v66
    v_fmac_f32 v62, v66, v66
    v_add_f32 v7, v7, v67
    v_fmac_f32 v8, v67, v67
    v_add_f32 v61, v61, v68
    v_fmac_f32 v62, v68, v68
    v_add_f32 v7, v7, v69
    v_fmac_f32 v8, v69, v69
    v_add_f32 v61, v61, v70
    v_fmac_f32 v62, v70, v70
    v_add_f32 v7, v7, v71
    v_fmac_f32 v8, v71, v71
    v_mul_f32 v32, v72, v72
    v_mul_f32 v33, v73, v73
    v_mul_f32 v34, v74, v74
    v_mul_f32 v35, v75, v75
    v_mul_f32 v6, v76, v76
    v_mul_f32 v16, v77, v77
    v_mul_f32 v22, v78, v78
    v_mul_f32 v23, v79, v79
    v_fma_f32 v32, v32, v15, v14
    v_fma_f32 v33, v33, v15, v14
    v_fma_f32 v34, v34, v15, v14
    v_fma_f32 v35, v35, v15, v14
    v_fma_f32 v6, v6, v15, v14
    v_fma_f32 v16, v16, v15, v14
    v_fma_f32 v22, v22, v15, v14
    v_fma_f32 v23, v23, v15, v14
    v_mul_f32 v32, v32, v72
    v_mul_f32 v33, v33, v73
    v_mul_f32 v34, v34, v74
    v_mul_f32 v35, v35, v75
    v_mul_f32 v6, v6, v76
    v_mul_f32 v16, v16, v77
    v_mul_f32 v22, v22, v78
    v_mul_f32 v23, v23, v79
    v_exp_f32 v32, v32
    v_exp_f32 v33, v33
    s_waitcnt vmcnt(0)
    s_barrier
    v_exp_f32 v34, v34
    v_exp_f32 v35, v35
    v_exp_f32 v6, v6
    v_exp_f32 v16, v16
    v_exp_f32 v22, v22
    v_exp_f32 v23, v23
    v_add_f32 v32, 1.0, v32
    v_add_f32 v33, 1.0, v33
    v_add_f32 v34, 1.0, v34
    v_add_f32 v35, 1.0, v35
    v_add_f32 v6, 1.0, v6
    v_add_f32 v16, 1.0, v16
    v_add_f32 v22, 1.0, v22
    v_add_f32 v23, 1.0, v23
    v_rcp_f32 v32, v32
    v_rcp_f32 v33, v33
    v_rcp_f32 v34, v34
    v_rcp_f32 v35, v35
    v_rcp_f32 v6, v6
    v_rcp_f32 v16, v16
    v_rcp_f32 v22, v22
    v_rcp_f32 v23, v23
    v_mul_f32 v72, v72, v32
    v_mul_f32 v73, v73, v33
    v_mul_f32 v74, v74, v34
    v_mul_f32 v75, v75, v35
    v_mul_f32 v76, v76, v6
    v_mul_f32 v77, v77, v16
    v_mul_f32 v78, v78, v22
    v_mul_f32 v79, v79, v23
    v_cvt_pk_bf16_f32 v40, v72, v73
    v_cvt_pk_bf16_f32 v41, v74, v75
    v_cvt_pk_bf16_f32 v42, v76, v77
    v_cvt_pk_bf16_f32 v43, v78, v79
    v_add_f32 v61, v61, v72
    v_fmac_f32 v62, v72, v72
    v_add_f32 v7, v7, v73
    v_fmac_f32 v8, v73, v73
    v_add_f32 v61, v61, v74
    v_fmac_f32 v62, v74, v74
    v_add_f32 v7, v7, v75
    v_fmac_f32 v8, v75, v75
    v_add_f32 v61, v61, v76
    v_fmac_f32 v62, v76, v76
    v_add_f32 v7, v7, v77
    v_fmac_f32 v8, v77, v77
    v_add_f32 v61, v61, v78
    v_fmac_f32 v62, v78, v78
    v_add_f32 v7, v7, v79
    v_fmac_f32 v8, v79, v79
    ds_read_b64_tr_b16 v[44:45], v3 offset:0
    ds_read_b64_tr_b16 v[46:47], v3 offset:512
    ds_read_b64_tr_b16 v[48:49], v3 offset:2048
    ds_read_b64_tr_b16 v[50:51], v3 offset:2560
    ds_read_b64_tr_b16 v[52:53], v3 offset:4096
    ds_read_b64_tr_b16 v[54:55], v3 offset:4608
    s_barrier
    s_setprio 1
    s_waitcnt lgkmcnt(4)
    ds_read_b64_tr_b16 v[56:57], v3 offset:6144
    ds_read_b64_tr_b16 v[58:59], v3 offset:6656
    v_mfma_f32_32x32x16_bf16 v[64:79], v[44:47], v[112:115], 0
    s_waitcnt lgkmcnt(4)
    ds_read_b64_tr_b16 v[96:97], v3 offset:8192
    ds_read_b64_tr_b16 v[98:99], v3 offset:8704
    v_mfma_f32_32x32x16_bf16 v[64:79], v[48:51], v[116:119], v[64:79]
    s_add_u32 m0, s42, 24576
    s_add_u32 s46, s40, 4294962688
    buffer_load_dwordx4 v5, s[12:15], s46 offen lds
    s_waitcnt lgkmcnt(4)
    ds_read_b64_tr_b16 v[100:101], v3 offset:10240
    ds_read_b64_tr_b16 v[102:103], v3 offset:10752
    v_mfma_f32_32x32x16_bf16 v[64:79], v[52:55], v[120:123], v[64:79]
    ds_write_b128 v19, v[36:39] offset:0
    s_waitcnt lgkmcnt(5)
    ds_read_b64_tr_b16 v[44:45], v3 offset:12288
    ds_read_b64_tr_b16 v[46:47], v3 offset:12800
    v_mfma_f32_32x32x16_bf16 v[64:79], v[56:59], v[124:127], v[64:79]
    s_waitcnt lgkmcnt(5)
    ds_read_b64_tr_b16 v[48:49], v3 offset:14336
    ds_read_b64_tr_b16 v[50:51], v3 offset:14848
    v_mfma_f32_32x32x16_bf16 v[64:79], v[96:99], v[128:131], v[64:79]
    ds_write_b128 v19, v[40:43] offset:32
    s_waitcnt lgkmcnt(6)
    ds_read_b64_tr_b16 v[52:53], v3 offset:16384
    ds_read_b64_tr_b16 v[54:55], v3 offset:16896
    v_mfma_f32_32x32x16_bf16 v[64:79], v[100:103], v[132:135], v[64:79]
    s_waitcnt lgkmcnt(5)
    ds_read_b64_tr_b16 v[56:57], v3 offset:18432
    ds_read_b64_tr_b16 v[58:59], v3 offset:18944
    v_mfma_f32_32x32x16_bf16 v[64:79], v[44:47], v[136:139], v[64:79]
    buffer_load_dwordx4 v104, s[12:15], s46 offen offset:1024 lds
    s_waitcnt lgkmcnt(5)
    ds_read_b64_tr_b16 v[96:97], v3 offset:20480
    ds_read_b64_tr_b16 v[98:99], v3 offset:20992
    v_mfma_f32_32x32x16_bf16 v[64:79], v[48:51], v[140:143], v[64:79]
    s_waitcnt lgkmcnt(4)
    ds_read_b64_tr_b16 v[100:101], v3 offset:22528
    ds_read_b64_tr_b16 v[102:103], v3 offset:23040
    v_mfma_f32_32x32x16_bf16 v[64:79], v[52:55], v[144:147], v[64:79]
    s_waitcnt lgkmcnt(4)
    v_mfma_f32_32x32x16_bf16 v[64:79], v[56:59], v[148:151], v[64:79]
    s_barrier
    ds_read_b64_tr_b16 v[44:45], v3 offset:24576
    ds_read_b64_tr_b16 v[46:47], v3 offset:25088
    s_waitcnt lgkmcnt(4)
    ds_read_b64_tr_b16 v[48:49], v3 offset:26624
    ds_read_b64_tr_b16 v[50:51], v3 offset:27136
    v_mfma_f32_32x32x16_bf16 v[64:79], v[96:99], v[152:155], v[64:79]
    s_waitcnt lgkmcnt(4)
    ds_read_b64_tr_b16 v[52:53], v3 offset:28672
    ds_read_b64_tr_b16 v[54:55], v3 offset:29184
    v_mfma_f32_32x32x16_bf16 v[64:79], v[100:103], v[156:159], v[64:79]
    s_add_u32 m0, s42, 32768
    s_add_u32 s46, s40, 585216
    buffer_load_dwordx4 v5, s[12:15], s46 offen lds
    s_waitcnt lgkmcnt(4)
    ds_read_b64_tr_b16 v[56:57], v3 offset:30720
    ds_read_b64_tr_b16 v[58:59], v3 offset:31232
    v_mfma_f32_32x32x16_bf16 v[64:79], v[44:47], v[160:163], v[64:79]
    s_waitcnt lgkmcnt(4)
    ds_read_b64_tr_b16 v[96:97], v3 offset:32768
    ds_read_b64_tr_b16 v[98:99], v3 offset:33280
    v_mfma_f32_32x32x16_bf16 v[64:79], v[48:51], v[164:167], v[64:79]
    s_waitcnt lgkmcnt(4)
    ds_read_b64_tr_b16 v[100:101], v3 offset:34816
    ds_read_b64_tr_b16 v[102:103], v3 offset:35328
    v_mfma_f32_32x32x16_bf16 v[64:79], v[52:55], v[168:171], v[64:79]
    s_waitcnt lgkmcnt(4)
    ds_read_b64_tr_b16 v[44:45], v3 offset:36864
    ds_read_b64_tr_b16 v[46:47], v3 offset:37376
    v_mfma_f32_32x32x16_bf16 v[64:79], v[56:59], v[172:175], v[64:79]
    s_waitcnt lgkmcnt(4)
    ds_read_b64_tr_b16 v[48:49], v3 offset:38912
    ds_read_b64_tr_b16 v[50:51], v3 offset:39424
    v_mfma_f32_32x32x16_bf16 v[64:79], v[96:99], v[176:179], v[64:79]
    buffer_load_dwordx4 v104, s[12:15], s46 offen offset:1024 lds
    s_waitcnt lgkmcnt(4)
    ds_read_b64_tr_b16 v[52:53], v3 offset:40960
    ds_read_b64_tr_b16 v[54:55], v3 offset:41472
    v_mfma_f32_32x32x16_bf16 v[64:79], v[100:103], v[180:183], v[64:79]
    s_waitcnt lgkmcnt(4)
    ds_read_b64_tr_b16 v[56:57], v3 offset:43008
    ds_read_b64_tr_b16 v[58:59], v3 offset:43520
    v_mfma_f32_32x32x16_bf16 v[64:79], v[44:47], v[184:187], v[64:79]
    s_waitcnt lgkmcnt(4)
    ds_read_b64_tr_b16 v[96:97], v3 offset:45056
    ds_read_b64_tr_b16 v[98:99], v3 offset:45568
    v_mfma_f32_32x32x16_bf16 v[64:79], v[48:51], v[188:191], v[64:79]
    s_waitcnt lgkmcnt(4)
    ds_read_b64_tr_b16 v[100:101], v3 offset:47104
    ds_read_b64_tr_b16 v[102:103], v3 offset:47616
    v_mfma_f32_32x32x16_bf16 v[64:79], v[52:55], v[192:195], v[64:79]
    s_waitcnt lgkmcnt(4)
    v_mfma_f32_32x32x16_bf16 v[64:79], v[56:59], v[196:199], v[64:79]
    s_barrier
    ds_read_b64_tr_b16 v[44:45], v1 offset:0
    ds_read_b64_tr_b16 v[46:47], v1 offset:512
    s_add_u32 m0, s42, 40960
    s_add_u32 s46, s40, 1175040
    buffer_load_dwordx4 v5, s[12:15], s46 offen lds
    s_waitcnt lgkmcnt(4)
    ds_read_b64_tr_b16 v[48:49], v1 offset:2048
    ds_read_b64_tr_b16 v[50:51], v1 offset:2560
    v_mfma_f32_32x32x16_bf16 v[64:79], v[96:99], v[200:203], v[64:79]
    s_waitcnt lgkmcnt(4)
    ds_read_b64_tr_b16 v[52:53], v1 offset:4096
    ds_read_b64_tr_b16 v[54:55], v1 offset:4608
    v_mfma_f32_32x32x16_bf16 v[64:79], v[100:103], v[204:207], v[64:79]
    s_waitcnt lgkmcnt(4)
    ds_read_b64_tr_b16 v[56:57], v1 offset:6144
    ds_read_b64_tr_b16 v[58:59], v1 offset:6656
    v_mfma_f32_32x32x16_bf16 v[64:79], v[44:47], v[208:211], v[64:79]
    s_waitcnt lgkmcnt(4)
    ds_read_b64_tr_b16 v[96:97], v1 offset:8192
    ds_read_b64_tr_b16 v[98:99], v1 offset:8704
    v_mfma_f32_32x32x16_bf16 v[64:79], v[48:51], v[212:215], v[64:79]
    s_waitcnt lgkmcnt(4)
    ds_read_b64_tr_b16 v[100:101], v1 offset:10240
    ds_read_b64_tr_b16 v[102:103], v1 offset:10752
    v_mfma_f32_32x32x16_bf16 v[64:79], v[52:55], v[216:219], v[64:79]
    buffer_load_dwordx4 v104, s[12:15], s46 offen offset:1024 lds
    s_waitcnt lgkmcnt(4)
    ds_read_b64_tr_b16 v[44:45], v1 offset:12288
    ds_read_b64_tr_b16 v[46:47], v1 offset:12800
    v_mfma_f32_32x32x16_bf16 v[64:79], v[56:59], v[220:223], v[64:79]
    s_waitcnt lgkmcnt(4)
    ds_read_b64_tr_b16 v[48:49], v1 offset:14336
    ds_read_b64_tr_b16 v[50:51], v1 offset:14848
    v_mfma_f32_32x32x16_bf16 v[64:79], v[96:99], v[224:227], v[64:79]
    s_waitcnt lgkmcnt(4)
    ds_read_b64_tr_b16 v[52:53], v1 offset:16384
    ds_read_b64_tr_b16 v[54:55], v1 offset:16896
    v_mfma_f32_32x32x16_bf16 v[64:79], v[100:103], v[228:231], v[64:79]
    s_waitcnt lgkmcnt(4)
    ds_read_b64_tr_b16 v[56:57], v1 offset:18432
    ds_read_b64_tr_b16 v[58:59], v1 offset:18944
    v_mfma_f32_32x32x16_bf16 v[64:79], v[44:47], v[232:235], v[64:79]
    ds_read_b64 v[28:29], v17 offset:1024
    s_waitcnt lgkmcnt(5)
    ds_read_b64_tr_b16 v[96:97], v1 offset:20480
    ds_read_b64_tr_b16 v[98:99], v1 offset:20992
    v_mfma_f32_32x32x16_bf16 v[64:79], v[48:51], v[236:239], v[64:79]
    s_waitcnt lgkmcnt(5)
    ds_read_b64_tr_b16 v[100:101], v1 offset:22528
    ds_read_b64_tr_b16 v[102:103], v1 offset:23040
    v_mfma_f32_32x32x16_bf16 v[64:79], v[52:55], v[240:243], v[64:79]
    s_waitcnt lgkmcnt(5)
    v_mfma_f32_32x32x16_bf16 v[64:79], v[56:59], v[244:247], v[64:79]
    s_waitcnt lgkmcnt(2)
    v_mfma_f32_32x32x16_bf16 v[64:79], v[96:99], v[248:251], v[64:79]
    s_waitcnt lgkmcnt(0)
    v_mfma_f32_32x32x16_bf16 v[64:79], v[100:103], v[252:255], v[64:79]
    v_mfma_f32_32x32x16_bf16 v[64:79], v[28:31], v[24:27], v[64:79]
    s_setprio 0
    s_barrier
    ds_read_b64 v[28:29], v17 offset:512
    s_waitcnt lgkmcnt(0)
    v_mfma_f32_32x32x16_bf16 v[80:95], v[28:31], v[24:27], v[80:95]
    s_nop 7
    s_nop 3
    v_mul_f32 v32, v80, v80
    v_mul_f32 v33, v81, v81
    v_mul_f32 v34, v82, v82
    v_mul_f32 v35, v83, v83
    v_mul_f32 v6, v84, v84
    v_mul_f32 v16, v85, v85
    v_mul_f32 v22, v86, v86
    v_mul_f32 v23, v87, v87
    v_fma_f32 v32, v32, v15, v14
    v_fma_f32 v33, v33, v15, v14
    v_fma_f32 v34, v34, v15, v14
    v_fma_f32 v35, v35, v15, v14
    v_fma_f32 v6, v6, v15, v14
    v_fma_f32 v16, v16, v15, v14
    v_fma_f32 v22, v22, v15, v14
    v_fma_f32 v23, v23, v15, v14
    v_mul_f32 v32, v32, v80
    v_mul_f32 v33, v33, v81
    v_mul_f32 v34, v34, v82
    v_mul_f32 v35, v35, v83
    v_mul_f32 v6, v6, v84
    v_mul_f32 v16, v16, v85
    v_mul_f32 v22, v22, v86
    v_mul_f32 v23, v23, v87
    v_exp_f32 v32, v32
    v_exp_f32 v33, v33
    v_exp_f32 v34, v34
    v_exp_f32 v35, v35
    v_exp_f32 v6, v6
    v_exp_f32 v16, v16
    v_exp_f32 v22, v22
    v_exp_f32 v23, v23
    v_add_f32 v32, 1.0, v32
    v_add_f32 v33, 1.0, v33
    v_add_f32 v34, 1.0, v34
    v_add_f32 v35, 1.0, v35
    v_add_f32 v6, 1.0, v6
    v_add_f32 v16, 1.0, v16
    v_add_f32 v22, 1.0, v22
    v_add_f32 v23, 1.0, v23
    v_rcp_f32 v32, v32
    v_rcp_f32 v33, v33
    v_rcp_f32 v34, v34
    v_rcp_f32 v35, v35
    v_rcp_f32 v6, v6
    v_rcp_f32 v16, v16
    v_rcp_f32 v22, v22
    s_barrier
    v_rcp_f32 v23, v23
    v_mul_f32 v80, v80, v32
    v_mul_f32 v81, v81, v33
    v_mul_f32 v82, v82, v34
    v_mul_f32 v83, v83, v35
    v_mul_f32 v84, v84, v6
    v_mul_f32 v85, v85, v16
    v_mul_f32 v86, v86, v22
    v_mul_f32 v87, v87, v23
    v_cvt_pk_bf16_f32 v36, v80, v81
    v_cvt_pk_bf16_f32 v37, v82, v83
    v_cvt_pk_bf16_f32 v38, v84, v85
    v_cvt_pk_bf16_f32 v39, v86, v87
    v_add_f32 v61, v61, v80
    v_fmac_f32 v62, v80, v80
    v_add_f32 v7, v7, v81
    v_fmac_f32 v8, v81, v81
    v_add_f32 v61, v61, v82
    v_fmac_f32 v62, v82, v82
    v_add_f32 v7, v7, v83
    v_fmac_f32 v8, v83, v83
    v_add_f32 v61, v61, v84
    v_fmac_f32 v62, v84, v84
    v_add_f32 v7, v7, v85
    v_fmac_f32 v8, v85, v85
    v_add_f32 v61, v61, v86
    v_fmac_f32 v62, v86, v86
    v_add_f32 v7, v7, v87
    v_fmac_f32 v8, v87, v87
    v_mul_f32 v32, v88, v88
    v_mul_f32 v33, v89, v89
    v_mul_f32 v34, v90, v90
    v_mul_f32 v35, v91, v91
    v_mul_f32 v6, v92, v92
    v_mul_f32 v16, v93, v93
    v_mul_f32 v22, v94, v94
    v_mul_f32 v23, v95, v95
    v_fma_f32 v32, v32, v15, v14
    v_fma_f32 v33, v33, v15, v14
    v_fma_f32 v34, v34, v15, v14
    v_fma_f32 v35, v35, v15, v14
    v_fma_f32 v6, v6, v15, v14
    v_fma_f32 v16, v16, v15, v14
    v_fma_f32 v22, v22, v15, v14
    v_fma_f32 v23, v23, v15, v14
    v_mul_f32 v32, v32, v88
    v_mul_f32 v33, v33, v89
    v_mul_f32 v34, v34, v90
    v_mul_f32 v35, v35, v91
    v_mul_f32 v6, v6, v92
    v_mul_f32 v16, v16, v93
    v_mul_f32 v22, v22, v94
    v_mul_f32 v23, v23, v95
    v_exp_f32 v32, v32
    v_exp_f32 v33, v33
    v_exp_f32 v34, v34
    v_exp_f32 v35, v35
    v_exp_f32 v6, v6
    v_exp_f32 v16, v16
    s_waitcnt vmcnt(0)
    s_barrier
    v_exp_f32 v22, v22
    v_exp_f32 v23, v23
    v_add_f32 v32, 1.0, v32
    v_add_f32 v33, 1.0, v33
    v_add_f32 v34, 1.0, v34
    v_add_f32 v35, 1.0, v35
    v_add_f32 v6, 1.0, v6
    v_add_f32 v16, 1.0, v16
    v_add_f32 v22, 1.0, v22
    v_add_f32 v23, 1.0, v23
    v_rcp_f32 v32, v32
    v_rcp_f32 v33, v33
    v_rcp_f32 v34, v34
    v_rcp_f32 v35, v35
    v_rcp_f32 v6, v6
    v_rcp_f32 v16, v16
    v_rcp_f32 v22, v22
    v_rcp_f32 v23, v23
    v_mul_f32 v88, v88, v32
    v_mul_f32 v89, v89, v33
    v_mul_f32 v90, v90, v34
    v_mul_f32 v91, v91, v35
    v_mul_f32 v92, v92, v6
    v_mul_f32 v93, v93, v16
    v_mul_f32 v94, v94, v22
    v_mul_f32 v95, v95, v23
    v_cvt_pk_bf16_f32 v40, v88, v89
    v_cvt_pk_bf16_f32 v41, v90, v91
    v_cvt_pk_bf16_f32 v42, v92, v93
    v_cvt_pk_bf16_f32 v43, v94, v95
    v_add_f32 v61, v61, v88
    v_fmac_f32 v62, v88, v88
    v_add_f32 v7, v7, v89
    v_fmac_f32 v8, v89, v89
    v_add_f32 v61, v61, v90
    v_fmac_f32 v62, v90, v90
    v_add_f32 v7, v7, v91
    v_fmac_f32 v8, v91, v91
    v_add_f32 v61, v61, v92
    v_fmac_f32 v62, v92, v92
    v_add_f32 v7, v7, v93
    v_fmac_f32 v8, v93, v93
    v_add_f32 v61, v61, v94
    v_fmac_f32 v62, v94, v94
    v_add_f32 v7, v7, v95
    v_fmac_f32 v8, v95, v95
    ds_read_b64_tr_b16 v[44:45], v1 offset:24576
    ds_read_b64_tr_b16 v[46:47], v1 offset:25088
    ds_read_b64_tr_b16 v[48:49], v1 offset:26624
    ds_read_b64_tr_b16 v[50:51], v1 offset:27136
    ds_read_b64_tr_b16 v[52:53], v1 offset:28672
    ds_read_b64_tr_b16 v[54:55], v1 offset:29184
    s_barrier
    s_setprio 1
    s_waitcnt lgkmcnt(4)
    ds_read_b64_tr_b16 v[56:57], v1 offset:30720
    ds_read_b64_tr_b16 v[58:59], v1 offset:31232
    v_mfma_f32_32x32x16_bf16 v[80:95], v[44:47], v[112:115], 0
    s_waitcnt lgkmcnt(4)
    ds_read_b64_tr_b16 v[96:97], v1 offset:32768
    ds_read_b64_tr_b16 v[98:99], v1 offset:33280
    v_mfma_f32_32x32x16_bf16 v[80:95], v[48:51], v[116:119], v[80:95]
    s_add_u32 m0, s42, 0
    s_add_u32 s46, s40, 4294962816
    buffer_load_dwordx4 v5, s[12:15], s46 offen lds
    s_waitcnt lgkmcnt(4)
    ds_read_b64_tr_b16 v[100:101], v1 offset:34816
    ds_read_b64_tr_b16 v[102:103], v1 offset:35328
    v_mfma_f32_32x32x16_bf16 v[80:95], v[52:55], v[120:123], v[80:95]
    ds_write_b128 v19, v[36:39] offset:64
    s_waitcnt lgkmcnt(5)
    ds_read_b64_tr_b16 v[44:45], v1 offset:36864
    ds_read_b64_tr_b16 v[46:47], v1 offset:37376
    v_mfma_f32_32x32x16_bf16 v[80:95], v[56:59], v[124:127], v[80:95]
    s_waitcnt lgkmcnt(5)
    ds_read_b64_tr_b16 v[48:49], v1 offset:38912
    ds_read_b64_tr_b16 v[50:51], v1 offset:39424
    v_mfma_f32_32x32x16_bf16 v[80:95], v[96:99], v[128:131], v[80:95]
    ds_write_b128 v19, v[40:43] offset:96
    s_waitcnt lgkmcnt(6)
    ds_read_b64_tr_b16 v[52:53], v1 offset:40960
    ds_read_b64_tr_b16 v[54:55], v1 offset:41472
    v_mfma_f32_32x32x16_bf16 v[80:95], v[100:103], v[132:135], v[80:95]
    s_waitcnt lgkmcnt(5)
    ds_read_b64_tr_b16 v[56:57], v1 offset:43008
    ds_read_b64_tr_b16 v[58:59], v1 offset:43520
    v_mfma_f32_32x32x16_bf16 v[80:95], v[44:47], v[136:139], v[80:95]
    buffer_load_dwordx4 v104, s[12:15], s46 offen offset:1024 lds
    s_waitcnt lgkmcnt(5)
    ds_read_b64_tr_b16 v[96:97], v1 offset:45056
    ds_read_b64_tr_b16 v[98:99], v1 offset:45568
    v_mfma_f32_32x32x16_bf16 v[80:95], v[48:51], v[140:143], v[80:95]
    s_waitcnt lgkmcnt(4)
    ds_read_b64_tr_b16 v[100:101], v1 offset:47104
    ds_read_b64_tr_b16 v[102:103], v1 offset:47616
    v_mfma_f32_32x32x16_bf16 v[80:95], v[52:55], v[144:147], v[80:95]
    s_waitcnt lgkmcnt(4)
    v_mfma_f32_32x32x16_bf16 v[80:95], v[56:59], v[148:151], v[80:95]
    s_barrier
    ds_read_b64_tr_b16 v[44:45], v3 offset:0
    ds_read_b64_tr_b16 v[46:47], v3 offset:512
    s_waitcnt lgkmcnt(4)
    ds_read_b64_tr_b16 v[48:49], v3 offset:2048
    ds_read_b64_tr_b16 v[50:51], v3 offset:2560
    v_mfma_f32_32x32x16_bf16 v[80:95], v[96:99], v[152:155], v[80:95]
    s_waitcnt lgkmcnt(4)
    ds_read_b64_tr_b16 v[52:53], v3 offset:4096
    ds_read_b64_tr_b16 v[54:55], v3 offset:4608
    v_mfma_f32_32x32x16_bf16 v[80:95], v[100:103], v[156:159], v[80:95]
    s_add_u32 m0, s42, 8192
    s_add_u32 s46, s40, 585344
    buffer_load_dwordx4 v5, s[12:15], s46 offen lds
    s_waitcnt lgkmcnt(4)
    ds_read_b64_tr_b16 v[56:57], v3 offset:6144
    ds_read_b64_tr_b16 v[58:59], v3 offset:6656
    v_mfma_f32_32x32x16_bf16 v[80:95], v[44:47], v[160:163], v[80:95]
    s_waitcnt lgkmcnt(4)
    ds_read_b64_tr_b16 v[96:97], v3 offset:8192
    ds_read_b64_tr_b16 v[98:99], v3 offset:8704
    v_mfma_f32_32x32x16_bf16 v[80:95], v[48:51], v[164:167], v[80:95]
    s_waitcnt lgkmcnt(4)
    ds_read_b64_tr_b16 v[100:101], v3 offset:10240
    ds_read_b64_tr_b16 v[102:103], v3 offset:10752
    v_mfma_f32_32x32x16_bf16 v[80:95], v[52:55], v[168:171], v[80:95]
    s_waitcnt lgkmcnt(4)
    ds_read_b64_tr_b16 v[44:45], v3 offset:12288
    ds_read_b64_tr_b16 v[46:47], v3 offset:12800
    v_mfma_f32_32x32x16_bf16 v[80:95], v[56:59], v[172:175], v[80:95]
    s_waitcnt lgkmcnt(4)
    ds_read_b64_tr_b16 v[48:49], v3 offset:14336
    ds_read_b64_tr_b16 v[50:51], v3 offset:14848
    v_mfma_f32_32x32x16_bf16 v[80:95], v[96:99], v[176:179], v[80:95]
    buffer_load_dwordx4 v104, s[12:15], s46 offen offset:1024 lds
    s_waitcnt lgkmcnt(4)
    ds_read_b64_tr_b16 v[52:53], v3 offset:16384
    ds_read_b64_tr_b16 v[54:55], v3 offset:16896
    v_mfma_f32_32x32x16_bf16 v[80:95], v[100:103], v[180:183], v[80:95]
    s_waitcnt lgkmcnt(4)
    ds_read_b64_tr_b16 v[56:57], v3 offset:18432
    ds_read_b64_tr_b16 v[58:59], v3 offset:18944
    v_mfma_f32_32x32x16_bf16 v[80:95], v[44:47], v[184:187], v[80:95]
    s_waitcnt lgkmcnt(4)
    ds_read_b64_tr_b16 v[96:97], v3 offset:20480
    ds_read_b64_tr_b16 v[98:99], v3 offset:20992
    v_mfma_f32_32x32x16_bf16 v[80:95], v[48:51], v[188:191], v[80:95]
    s_waitcnt lgkmcnt(4)
    ds_read_b64_tr_b16 v[100:101], v3 offset:22528
    ds_read_b64_tr_b16 v[102:103], v3 offset:23040
    v_mfma_f32_32x32x16_bf16 v[80:95], v[52:55], v[192:195], v[80:95]
    s_waitcnt lgkmcnt(4)
    v_mfma_f32_32x32x16_bf16 v[80:95], v[56:59], v[196:199], v[80:95]
    s_barrier
    ds_read_b64_tr_b16 v[44:45], v3 offset:24576
    ds_read_b64_tr_b16 v[46:47], v3 offset:25088
    s_add_u32 m0, s42, 16384
    s_add_u32 s46, s40, 1175168
    buffer_load_dwordx4 v5, s[12:15], s46 offen lds
    s_waitcnt lgkmcnt(4)
    ds_read_b64_tr_b16 v[48:49], v3 offset:26624
    ds_read_b64_tr_b16 v[50:51], v3 offset:27136
    v_mfma_f32_32x32x16_bf16 v[80:95], v[96:99], v[200:203], v[80:95]
    s_waitcnt lgkmcnt(4)
    ds_read_b64_tr_b16 v[52:53], v3 offset:28672
    ds_read_b64_tr_b16 v[54:55], v3 offset:29184
    v_mfma_f32_32x32x16_bf16 v[80:95], v[100:103], v[204:207], v[80:95]
    s_waitcnt lgkmcnt(4)
    ds_read_b64_tr_b16 v[56:57], v3 offset:30720
    ds_read_b64_tr_b16 v[58:59], v3 offset:31232
    v_mfma_f32_32x32x16_bf16 v[80:95], v[44:47], v[208:211], v[80:95]
    s_waitcnt lgkmcnt(4)
    ds_read_b64_tr_b16 v[96:97], v3 offset:32768
    ds_read_b64_tr_b16 v[98:99], v3 offset:33280
    v_mfma_f32_32x32x16_bf16 v[80:95], v[48:51], v[212:215], v[80:95]
    s_waitcnt lgkmcnt(4)
    ds_read_b64_tr_b16 v[100:101], v3 offset:34816
    ds_read_b64_tr_b16 v[102:103], v3 offset:35328
    v_mfma_f32_32x32x16_bf16 v[80:95], v[52:55], v[216:219], v[80:95]
    buffer_load_dwordx4 v104, s[12:15], s46 offen offset:1024 lds
    s_waitcnt lgkmcnt(4)
    ds_read_b64_tr_b16 v[44:45], v3 offset:36864
    ds_read_b64_tr_b16 v[46:47], v3 offset:37376
    v_mfma_f32_32x32x16_bf16 v[80:95], v[56:59], v[220:223], v[80:95]
    s_waitcnt lgkmcnt(4)
    ds_read_b64_tr_b16 v[48:49], v3 offset:38912
    ds_read_b64_tr_b16 v[50:51], v3 offset:39424
    v_mfma_f32_32x32x16_bf16 v[80:95], v[96:99], v[224:227], v[80:95]
    s_waitcnt lgkmcnt(4)
    ds_read_b64_tr_b16 v[52:53], v3 offset:40960
    ds_read_b64_tr_b16 v[54:55], v3 offset:41472
    v_mfma_f32_32x32x16_bf16 v[80:95], v[100:103], v[228:231], v[80:95]
    s_waitcnt lgkmcnt(4)
    ds_read_b64_tr_b16 v[56:57], v3 offset:43008
    ds_read_b64_tr_b16 v[58:59], v3 offset:43520
    v_mfma_f32_32x32x16_bf16 v[80:95], v[44:47], v[232:235], v[80:95]
    ds_read_b64 v[28:29], v17 offset:1536
    s_waitcnt lgkmcnt(5)
    ds_read_b64_tr_b16 v[96:97], v3 offset:45056
    ds_read_b64_tr_b16 v[98:99], v3 offset:45568
    v_mfma_f32_32x32x16_bf16 v[80:95], v[48:51], v[236:239], v[80:95]
    s_waitcnt lgkmcnt(5)
    ds_read_b64_tr_b16 v[100:101], v3 offset:47104
    ds_read_b64_tr_b16 v[102:103], v3 offset:47616
    v_mfma_f32_32x32x16_bf16 v[80:95], v[52:55], v[240:243], v[80:95]
    s_waitcnt lgkmcnt(5)
    v_mfma_f32_32x32x16_bf16 v[80:95], v[56:59], v[244:247], v[80:95]
    s_waitcnt lgkmcnt(2)
    v_mfma_f32_32x32x16_bf16 v[80:95], v[96:99], v[248:251], v[80:95]
    s_waitcnt lgkmcnt(0)
    v_mfma_f32_32x32x16_bf16 v[80:95], v[100:103], v[252:255], v[80:95]
    v_mfma_f32_32x32x16_bf16 v[80:95], v[28:31], v[24:27], v[80:95]
    s_setprio 0
    s_barrier
    v_mul_f32 v32, v64, v64
    v_mul_f32 v33, v65, v65
    v_mul_f32 v34, v66, v66
    v_mul_f32 v35, v67, v67
    v_mul_f32 v6, v68, v68
    v_mul_f32 v16, v69, v69
    v_mul_f32 v22, v70, v70
    v_mul_f32 v23, v71, v71
    v_fma_f32 v32, v32, v15, v14
    v_fma_f32 v33, v33, v15, v14
    v_fma_f32 v34, v34, v15, v14
    v_fma_f32 v35, v35, v15, v14
    v_fma_f32 v6, v6, v15, v14
    v_fma_f32 v16, v16, v15, v14
    v_fma_f32 v22, v22, v15, v14
    v_fma_f32 v23, v23, v15, v14
    v_mul_f32 v32, v32, v64
    v_mul_f32 v33, v33, v65
    v_mul_f32 v34, v34, v66
    v_mul_f32 v35, v35, v67
    v_mul_f32 v6, v6, v68
    v_mul_f32 v16, v16, v69
    v_mul_f32 v22, v22, v70
    v_mul_f32 v23, v23, v71
    v_exp_f32 v32, v32
    v_exp_f32 v33, v33
    v_exp_f32 v34, v34
    v_exp_f32 v35, v35
    v_exp_f32 v6, v6
    v_exp_f32 v16, v16
    v_exp_f32 v22, v22
    v_exp_f32 v23, v23
    v_add_f32 v32, 1.0, v32
    v_add_f32 v33, 1.0, v33
    v_add_f32 v34, 1.0, v34
    v_add_f32 v35, 1.0, v35
    v_add_f32 v6, 1.0, v6
    v_add_f32 v16, 1.0, v16
    v_add_f32 v22, 1.0, v22
    v_add_f32 v23, 1.0, v23
    v_rcp_f32 v32, v32
    v_rcp_f32 v33, v33
    v_rcp_f32 v34, v34
    v_rcp_f32 v35, v35
    v_rcp_f32 v6, v6
    v_rcp_f32 v16, v16
    v_rcp_f32 v22, v22
    v_rcp_f32 v23, v23
    v_mul_f32 v64, v64, v32
    v_mul_f32 v65, v65, v33
    v_mul_f32 v66, v66, v34
    v_mul_f32 v67, v67, v35
    v_mul_f32 v68, v68, v6
    v_mul_f32 v69, v69, v16
    s_barrier
    v_mul_f32 v70, v70, v22
    v_mul_f32 v71, v71, v23
    v_cvt_pk_bf16_f32 v36, v64, v65
    v_cvt_pk_bf16_f32 v37, v66, v67
    v_cvt_pk_bf16_f32 v38, v68, v69
    v_cvt_pk_bf16_f32 v39, v70, v71
    v_add_f32 v61, v61, v64
    v_fmac_f32 v62, v64, v64
    v_add_f32 v7, v7, v65
    v_fmac_f32 v8, v65, v65
    v_add_f32 v61, v61, v66
    v_fmac_f32 v62, v66, v66
    v_add_f32 v7, v7, v67
    v_fmac_f32 v8, v67, v67
    v_add_f32 v61, v61, v68
    v_fmac_f32 v62, v68, v68
    v_add_f32 v7, v7, v69
    v_fmac_f32 v8, v69, v69
    v_add_f32 v61, v61, v70
    v_fmac_f32 v62, v70, v70
    v_add_f32 v7, v7, v71
    v_fmac_f32 v8, v71, v71
    v_mul_f32 v32, v72, v72
    v_mul_f32 v33, v73, v73
    v_mul_f32 v34, v74, v74
    v_mul_f32 v35, v75, v75
    v_mul_f32 v6, v76, v76
    v_mul_f32 v16, v77, v77
    v_mul_f32 v22, v78, v78
    v_mul_f32 v23, v79, v79
    v_fma_f32 v32, v32, v15, v14
    v_fma_f32 v33, v33, v15, v14
    v_fma_f32 v34, v34, v15, v14
    v_fma_f32 v35, v35, v15, v14
    v_fma_f32 v6, v6, v15, v14
    v_fma_f32 v16, v16, v15, v14
    v_fma_f32 v22, v22, v15, v14
    v_fma_f32 v23, v23, v15, v14
    v_mul_f32 v32, v32, v72
    v_mul_f32 v33, v33, v73
    v_mul_f32 v34, v34, v74
    v_mul_f32 v35, v35, v75
    v_mul_f32 v6, v6, v76
    v_mul_f32 v16, v16, v77
    v_mul_f32 v22, v22, v78
    v_mul_f32 v23, v23, v79
    v_exp_f32 v32, v32
    v_exp_f32 v33, v33
    v_exp_f32 v34, v34
    v_exp_f32 v35, v35
    v_exp_f32 v6, v6
    v_exp_f32 v16, v16
    v_exp_f32 v22, v22
    v_exp_f32 v23, v23
    v_add_f32 v32, 1.0, v32
    v_add_f32 v33, 1.0, v33
    v_add_f32 v34, 1.0, v34
    v_add_f32 v35, 1.0, v35
    v_add_f32 v6, 1.0, v6
    v_add_f32 v16, 1.0, v16
    v_add_f32 v22, 1.0, v22
    v_add_f32 v23, 1.0, v23
    s_waitcnt vmcnt(0)
    s_barrier
    v_rcp_f32 v32, v32
    v_rcp_f32 v33, v33
    v_rcp_f32 v34, v34
    v_rcp_f32 v35, v35
    v_rcp_f32 v6, v6
    v_rcp_f32 v16, v16
    v_rcp_f32 v22, v22
    v_rcp_f32 v23, v23
    v_mul_f32 v72, v72, v32
    v_mul_f32 v73, v73, v33
    v_mul_f32 v74, v74, v34
    v_mul_f32 v75, v75, v35
    v_mul_f32 v76, v76, v6
    v_mul_f32 v77, v77, v16
    v_mul_f32 v78, v78, v22
    v_mul_f32 v79, v79, v23
    v_cvt_pk_bf16_f32 v40, v72, v73
    v_cvt_pk_bf16_f32 v41, v74, v75
    v_cvt_pk_bf16_f32 v42, v76, v77
    v_cvt_pk_bf16_f32 v43, v78, v79
    v_add_f32 v61, v61, v72
    v_fmac_f32 v62, v72, v72
    v_add_f32 v7, v7, v73
    v_fmac_f32 v8, v73, v73
    v_add_f32 v61, v61, v74
    v_fmac_f32 v62, v74, v74
    v_add_f32 v7, v7, v75
    v_fmac_f32 v8, v75, v75
    v_add_f32 v61, v61, v76
    v_fmac_f32 v62, v76, v76
    v_add_f32 v7, v7, v77
    v_fmac_f32 v8, v77, v77
    v_add_f32 v61, v61, v78
    v_fmac_f32 v62, v78, v78
    v_add_f32 v7, v7, v79
    v_fmac_f32 v8, v79, v79
    v_add_f32 v61, v61, v7
    v_add_f32 v62, v62, v8
    v_mov_b32 v7, v61
    v_mov_b32 v8, v62
    s_nop 1
    v_permlane32_swap_b32 v61, v7
    v_permlane32_swap_b32 v62, v8
    s_nop 1
    v_add_f32 v8, v62, v8
    v_add_f32 v7, v61, v7
    v_mul_f32 v10, v12, v8
    v_mul_f32 v8, v12, v7
    v_mul_f32 v10, v12, v10
    s_lshl_b32 s39, s36, 8
    s_add_u32 s39, s39, 156672
    v_lshrrev_b32 v63, 1, v21
    v_add_u32 v63, s39, v63
    v_mov_b32 v9, v10
    ds_write_b64 v63, v[8:9] offset:256
    s_waitcnt lgkmcnt(0)
    ds_read_b64_tr_b16 v[44:45], v1 offset:0
    ds_read_b64_tr_b16 v[46:47], v1 offset:512
    ds_read_b64_tr_b16 v[48:49], v1 offset:2048
    ds_read_b64_tr_b16 v[50:51], v1 offset:2560
    ds_read_b64_tr_b16 v[52:53], v1 offset:4096
    ds_read_b64_tr_b16 v[54:55], v1 offset:4608
    s_barrier
    s_setprio 1
    s_waitcnt lgkmcnt(4)
    ds_read_b64_tr_b16 v[56:57], v1 offset:6144
    ds_read_b64_tr_b16 v[58:59], v1 offset:6656
    v_mfma_f32_32x32x16_bf16 v[64:79], v[44:47], v[112:115], 0
    s_waitcnt lgkmcnt(4)
    ds_read_b64_tr_b16 v[96:97], v1 offset:8192
    ds_read_b64_tr_b16 v[98:99], v1 offset:8704
    v_mfma_f32_32x32x16_bf16 v[64:79], v[48:51], v[116:119], v[64:79]
    s_add_u32 m0, s42, 73728
    s_add_u32 s46, s40, 4294962944
    buffer_load_dwordx4 v5, s[12:15], s46 offen lds
    s_waitcnt lgkmcnt(4)
    ds_read_b64_tr_b16 v[100:101], v1 offset:10240
    ds_read_b64_tr_b16 v[102:103], v1 offset:10752
    v_mfma_f32_32x32x16_bf16 v[64:79], v[52:55], v[120:123], v[64:79]
    ds_write_b128 v19, v[36:39] offset:128
    s_waitcnt lgkmcnt(5)
    ds_read_b64_tr_b16 v[44:45], v1 offset:12288
    ds_read_b64_tr_b16 v[46:47], v1 offset:12800
    v_mfma_f32_32x32x16_bf16 v[64:79], v[56:59], v[124:127], v[64:79]
    s_waitcnt lgkmcnt(5)
    ds_read_b64_tr_b16 v[48:49], v1 offset:14336
    ds_read_b64_tr_b16 v[50:51], v1 offset:14848
    v_mfma_f32_32x32x16_bf16 v[64:79], v[96:99], v[128:131], v[64:79]
    ds_write_b128 v19, v[40:43] offset:160
    s_waitcnt lgkmcnt(6)
    ds_read_b64_tr_b16 v[52:53], v1 offset:16384
    ds_read_b64_tr_b16 v[54:55], v1 offset:16896
    v_mfma_f32_32x32x16_bf16 v[64:79], v[100:103], v[132:135], v[64:79]
    s_waitcnt lgkmcnt(5)
    ds_read_b64_tr_b16 v[56:57], v1 offset:18432
    ds_read_b64_tr_b16 v[58:59], v1 offset:18944
    v_mfma_f32_32x32x16_bf16 v[64:79], v[44:47], v[136:139], v[64:79]
    buffer_load_dwordx4 v104, s[12:15], s46 offen offset:1024 lds
    s_waitcnt lgkmcnt(5)
    ds_read_b64_tr_b16 v[96:97], v1 offset:20480
    ds_read_b64_tr_b16 v[98:99], v1 offset:20992
    v_mfma_f32_32x32x16_bf16 v[64:79], v[48:51], v[140:143], v[64:79]
    s_waitcnt lgkmcnt(4)
    ds_read_b64_tr_b16 v[100:101], v1 offset:22528
    ds_read_b64_tr_b16 v[102:103], v1 offset:23040
    v_mfma_f32_32x32x16_bf16 v[64:79], v[52:55], v[144:147], v[64:79]
    s_waitcnt lgkmcnt(4)
    v_mfma_f32_32x32x16_bf16 v[64:79], v[56:59], v[148:151], v[64:79]
    s_barrier
    ds_read_b64_tr_b16 v[44:45], v1 offset:24576
    ds_read_b64_tr_b16 v[46:47], v1 offset:25088
    s_waitcnt lgkmcnt(4)
    ds_read_b64_tr_b16 v[48:49], v1 offset:26624
    ds_read_b64_tr_b16 v[50:51], v1 offset:27136
    v_mfma_f32_32x32x16_bf16 v[64:79], v[96:99], v[152:155], v[64:79]
    s_waitcnt lgkmcnt(4)
    ds_read_b64_tr_b16 v[52:53], v1 offset:28672
    ds_read_b64_tr_b16 v[54:55], v1 offset:29184
    v_mfma_f32_32x32x16_bf16 v[64:79], v[100:103], v[156:159], v[64:79]
    s_add_u32 m0, s42, 81920
    s_add_u32 s46, s40, 585472
    buffer_load_dwordx4 v5, s[12:15], s46 offen lds
    s_waitcnt lgkmcnt(4)
    ds_read_b64_tr_b16 v[56:57], v1 offset:30720
    ds_read_b64_tr_b16 v[58:59], v1 offset:31232
    v_mfma_f32_32x32x16_bf16 v[64:79], v[44:47], v[160:163], v[64:79]
    s_waitcnt lgkmcnt(4)
    ds_read_b64_tr_b16 v[96:97], v1 offset:32768
    ds_read_b64_tr_b16 v[98:99], v1 offset:33280
    v_mfma_f32_32x32x16_bf16 v[64:79], v[48:51], v[164:167], v[64:79]
    s_waitcnt lgkmcnt(4)
    ds_read_b64_tr_b16 v[100:101], v1 offset:34816
    ds_read_b64_tr_b16 v[102:103], v1 offset:35328
    v_mfma_f32_32x32x16_bf16 v[64:79], v[52:55], v[168:171], v[64:79]
    s_waitcnt lgkmcnt(4)
    ds_read_b64_tr_b16 v[44:45], v1 offset:36864
    ds_read_b64_tr_b16 v[46:47], v1 offset:37376
    v_mfma_f32_32x32x16_bf16 v[64:79], v[56:59], v[172:175], v[64:79]
    s_waitcnt lgkmcnt(4)
    ds_read_b64_tr_b16 v[48:49], v1 offset:38912
    ds_read_b64_tr_b16 v[50:51], v1 offset:39424
    v_mfma_f32_32x32x16_bf16 v[64:79], v[96:99], v[176:179], v[64:79]
    buffer_load_dwordx4 v104, s[12:15], s46 offen offset:1024 lds
    s_waitcnt lgkmcnt(4)
    ds_read_b64_tr_b16 v[52:53], v1 offset:40960
    ds_read_b64_tr_b16 v[54:55], v1 offset:41472
    v_mfma_f32_32x32x16_bf16 v[64:79], v[100:103], v[180:183], v[64:79]
    s_waitcnt lgkmcnt(4)
    ds_read_b64_tr_b16 v[56:57], v1 offset:43008
    ds_read_b64_tr_b16 v[58:59], v1 offset:43520
    v_mfma_f32_32x32x16_bf16 v[64:79], v[44:47], v[184:187], v[64:79]
    s_waitcnt lgkmcnt(4)
    ds_read_b64_tr_b16 v[96:97], v1 offset:45056
    ds_read_b64_tr_b16 v[98:99], v1 offset:45568
    v_mfma_f32_32x32x16_bf16 v[64:79], v[48:51], v[188:191], v[64:79]
    s_waitcnt lgkmcnt(4)
    ds_read_b64_tr_b16 v[100:101], v1 offset:47104
    ds_read_b64_tr_b16 v[102:103], v1 offset:47616
    v_mfma_f32_32x32x16_bf16 v[64:79], v[52:55], v[192:195], v[64:79]
    s_waitcnt lgkmcnt(4)
    v_mfma_f32_32x32x16_bf16 v[64:79], v[56:59], v[196:199], v[64:79]
    s_barrier
    ds_read_b64_tr_b16 v[44:45], v3 offset:0
    ds_read_b64_tr_b16 v[46:47], v3 offset:512
    s_add_u32 m0, s42, 90112
    s_add_u32 s46, s40, 1175296
    buffer_load_dwordx4 v5, s[12:15], s46 offen lds
    s_waitcnt lgkmcnt(4)
    ds_read_b64_tr_b16 v[48:49], v3 offset:2048
    ds_read_b64_tr_b16 v[50:51], v3 offset:2560
    v_mfma_f32_32x32x16_bf16 v[64:79], v[96:99], v[200:203], v[64:79]
    s_waitcnt lgkmcnt(4)
    ds_read_b64_tr_b16 v[52:53], v3 offset:4096
    ds_read_b64_tr_b16 v[54:55], v3 offset:4608
    v_mfma_f32_32x32x16_bf16 v[64:79], v[100:103], v[204:207], v[64:79]
    s_waitcnt lgkmcnt(4)
    ds_read_b64_tr_b16 v[56:57], v3 offset:6144
    ds_read_b64_tr_b16 v[58:59], v3 offset:6656
    v_mfma_f32_32x32x16_bf16 v[64:79], v[44:47], v[208:211], v[64:79]
    s_waitcnt lgkmcnt(4)
    ds_read_b64_tr_b16 v[96:97], v3 offset:8192
    ds_read_b64_tr_b16 v[98:99], v3 offset:8704
    v_mfma_f32_32x32x16_bf16 v[64:79], v[48:51], v[212:215], v[64:79]
    s_waitcnt lgkmcnt(4)
    ds_read_b64_tr_b16 v[100:101], v3 offset:10240
    ds_read_b64_tr_b16 v[102:103], v3 offset:10752
    v_mfma_f32_32x32x16_bf16 v[64:79], v[52:55], v[216:219], v[64:79]
    buffer_load_dwordx4 v104, s[12:15], s46 offen offset:1024 lds
    s_waitcnt lgkmcnt(4)
    ds_read_b64_tr_b16 v[44:45], v3 offset:12288
    ds_read_b64_tr_b16 v[46:47], v3 offset:12800
    v_mfma_f32_32x32x16_bf16 v[64:79], v[56:59], v[220:223], v[64:79]
    s_waitcnt lgkmcnt(4)
    ds_read_b64_tr_b16 v[48:49], v3 offset:14336
    ds_read_b64_tr_b16 v[50:51], v3 offset:14848
    v_mfma_f32_32x32x16_bf16 v[64:79], v[96:99], v[224:227], v[64:79]
    s_waitcnt lgkmcnt(4)
    ds_read_b64_tr_b16 v[52:53], v3 offset:16384
    ds_read_b64_tr_b16 v[54:55], v3 offset:16896
    v_mfma_f32_32x32x16_bf16 v[64:79], v[100:103], v[228:231], v[64:79]
    s_waitcnt lgkmcnt(4)
    ds_read_b64_tr_b16 v[56:57], v3 offset:18432
    ds_read_b64_tr_b16 v[58:59], v3 offset:18944
    v_mfma_f32_32x32x16_bf16 v[64:79], v[44:47], v[232:235], v[64:79]
    ds_read_b64 v[28:29], v17 offset:2048
    s_waitcnt lgkmcnt(5)
    ds_read_b64_tr_b16 v[96:97], v3 offset:20480
    ds_read_b64_tr_b16 v[98:99], v3 offset:20992
    v_mfma_f32_32x32x16_bf16 v[64:79], v[48:51], v[236:239], v[64:79]
    s_waitcnt lgkmcnt(5)
    ds_read_b64_tr_b16 v[100:101], v3 offset:22528
    ds_read_b64_tr_b16 v[102:103], v3 offset:23040
    v_mfma_f32_32x32x16_bf16 v[64:79], v[52:55], v[240:243], v[64:79]
    s_waitcnt lgkmcnt(5)
    v_mfma_f32_32x32x16_bf16 v[64:79], v[56:59], v[244:247], v[64:79]
    s_waitcnt lgkmcnt(2)
    v_mfma_f32_32x32x16_bf16 v[64:79], v[96:99], v[248:251], v[64:79]
    s_waitcnt lgkmcnt(0)
    v_mfma_f32_32x32x16_bf16 v[64:79], v[100:103], v[252:255], v[64:79]
    v_mfma_f32_32x32x16_bf16 v[64:79], v[28:31], v[24:27], v[64:79]
    s_setprio 0
    s_barrier
    v_mul_f32 v32, v80, v80
    v_mul_f32 v33, v81, v81
    v_mul_f32 v34, v82, v82
    v_mul_f32 v35, v83, v83
    v_mul_f32 v6, v84, v84
    v_mul_f32 v16, v85, v85
    v_mul_f32 v22, v86, v86
    v_mul_f32 v23, v87, v87
    v_fma_f32 v32, v32, v15, v14
    v_fma_f32 v33, v33, v15, v14
    v_fma_f32 v34, v34, v15, v14
    v_fma_f32 v35, v35, v15, v14
    v_fma_f32 v6, v6, v15, v14
    v_fma_f32 v16, v16, v15, v14
    v_fma_f32 v22, v22, v15, v14
    v_fma_f32 v23, v23, v15, v14
    v_mul_f32 v32, v32, v80
    v_mul_f32 v33, v33, v81
    v_mul_f32 v34, v34, v82
    v_mul_f32 v35, v35, v83
    v_mul_f32 v6, v6, v84
    v_mul_f32 v16, v16, v85
    v_mul_f32 v22, v22, v86
    v_mul_f32 v23, v23, v87
    v_exp_f32 v32, v32
    v_exp_f32 v33, v33
    v_exp_f32 v34, v34
    v_exp_f32 v35, v35
    v_exp_f32 v6, v6
    v_exp_f32 v16, v16
    v_exp_f32 v22, v22
    v_exp_f32 v23, v23
    v_add_f32 v32, 1.0, v32
    v_add_f32 v33, 1.0, v33
    v_add_f32 v34, 1.0, v34
    v_add_f32 v35, 1.0, v35
    v_add_f32 v6, 1.0, v6
    v_add_f32 v16, 1.0, v16
    v_add_f32 v22, 1.0, v22
    v_add_f32 v23, 1.0, v23
    v_rcp_f32 v32, v32
    v_rcp_f32 v33, v33
    v_rcp_f32 v34, v34
    s_barrier
    v_rcp_f32 v35, v35
    v_rcp_f32 v6, v6
    v_rcp_f32 v16, v16
    v_rcp_f32 v22, v22
    v_rcp_f32 v23, v23
    v_mul_f32 v80, v80, v32
    v_mul_f32 v81, v81, v33
    v_mul_f32 v82, v82, v34
    v_mul_f32 v83, v83, v35
    v_mul_f32 v84, v84, v6
    v_mul_f32 v85, v85, v16
    v_mul_f32 v86, v86, v22
    v_mul_f32 v87, v87, v23
    v_cvt_pk_bf16_f32 v36, v80, v81
    v_cvt_pk_bf16_f32 v37, v82, v83
    v_cvt_pk_bf16_f32 v40, v84, v85
    v_cvt_pk_bf16_f32 v41, v86, v87
    v_mul_f32 v32, v88, v88
    v_mul_f32 v33, v89, v89
    v_mul_f32 v34, v90, v90
    v_mul_f32 v35, v91, v91
    v_mul_f32 v6, v92, v92
    v_mul_f32 v16, v93, v93
    v_mul_f32 v22, v94, v94
    v_mul_f32 v23, v95, v95
    v_fma_f32 v32, v32, v15, v14
    v_fma_f32 v33, v33, v15, v14
    v_fma_f32 v34, v34, v15, v14
    v_fma_f32 v35, v35, v15, v14
    v_fma_f32 v6, v6, v15, v14
    v_fma_f32 v16, v16, v15, v14
    v_fma_f32 v22, v22, v15, v14
    v_fma_f32 v23, v23, v15, v14
    v_mul_f32 v32, v32, v88
    v_mul_f32 v33, v33, v89
    v_mul_f32 v34, v34, v90
    v_mul_f32 v35, v35, v91
    v_mul_f32 v6, v6, v92
    v_mul_f32 v16, v16, v93
    v_mul_f32 v22, v22, v94
    v_mul_f32 v23, v23, v95
    v_exp_f32 v32, v32
    v_exp_f32 v33, v33
    v_exp_f32 v34, v34
    v_exp_f32 v35, v35
    s_waitcnt vmcnt(0)
    s_barrier
    v_exp_f32 v6, v6
    v_exp_f32 v16, v16
    v_exp_f32 v22, v22
    v_exp_f32 v23, v23
    v_add_f32 v32, 1.0, v32
    v_add_f32 v33, 1.0, v33
    v_add_f32 v34, 1.0, v34
    v_add_f32 v35, 1.0, v35
    v_add_f32 v6, 1.0, v6
    v_add_f32 v16, 1.0, v16
    v_add_f32 v22, 1.0, v22
    v_add_f32 v23, 1.0, v23
    v_rcp_f32 v32, v32
    v_rcp_f32 v33, v33
    v_rcp_f32 v34, v34
    v_rcp_f32 v35, v35
    v_rcp_f32 v6, v6
    v_rcp_f32 v16, v16
    v_rcp_f32 v22, v22
    v_rcp_f32 v23, v23
    v_mul_f32 v88, v88, v32
    v_mul_f32 v89, v89, v33
    v_mul_f32 v90, v90, v34
    v_mul_f32 v91, v91, v35
    v_mul_f32 v92, v92, v6
    v_mul_f32 v93, v93, v16
    v_mul_f32 v94, v94, v22
    v_mul_f32 v95, v95, v23
    v_cvt_pk_bf16_f32 v38, v88, v89
    v_cvt_pk_bf16_f32 v39, v90, v91
    v_cvt_pk_bf16_f32 v42, v92, v93
    v_cvt_pk_bf16_f32 v43, v94, v95
    ds_read_b64_tr_b16 v[44:45], v3 offset:24576
    ds_read_b64_tr_b16 v[46:47], v3 offset:25088
    ds_read_b64_tr_b16 v[48:49], v3 offset:26624
    ds_read_b64_tr_b16 v[50:51], v3 offset:27136
    ds_read_b64_tr_b16 v[52:53], v3 offset:28672
    ds_read_b64_tr_b16 v[54:55], v3 offset:29184
    s_barrier
    s_cmp_eq_u32 s18, 0
    s_cbranch_scc1 parallel_sum__linear_kernel_hedgehog__mixer_gmlp__prompt_kernel_noq0
    s_setprio 1
    s_waitcnt lgkmcnt(4)
    ds_read_b64_tr_b16 v[56:57], v3 offset:30720
    ds_read_b64_tr_b16 v[58:59], v3 offset:31232
    v_mfma_f32_32x32x16_bf16 v[80:95], v[44:47], v[112:115], 0
    s_waitcnt lgkmcnt(4)
    ds_read_b64_tr_b16 v[96:97], v3 offset:32768
    ds_read_b64_tr_b16 v[98:99], v3 offset:33280
    v_mfma_f32_32x32x16_bf16 v[80:95], v[48:51], v[116:119], v[80:95]
    s_add_u32 m0, s42, 49152
    s_add_u32 s46, s41, 0
    buffer_load_dwordx4 v13, s[16:19], s46 offen lds
    s_waitcnt lgkmcnt(4)
    ds_read_b64_tr_b16 v[100:101], v3 offset:34816
    ds_read_b64_tr_b16 v[102:103], v3 offset:35328
    v_mfma_f32_32x32x16_bf16 v[80:95], v[52:55], v[120:123], v[80:95]
    buffer_store_dwordx4 v[36:39], v20, s[20:23], s50 offen offset:0 sc1
    s_waitcnt lgkmcnt(4)
    ds_read_b64_tr_b16 v[44:45], v3 offset:36864
    ds_read_b64_tr_b16 v[46:47], v3 offset:37376
    v_mfma_f32_32x32x16_bf16 v[80:95], v[56:59], v[124:127], v[80:95]
    s_waitcnt lgkmcnt(4)
    ds_read_b64_tr_b16 v[48:49], v3 offset:38912
    ds_read_b64_tr_b16 v[50:51], v3 offset:39424
    v_mfma_f32_32x32x16_bf16 v[80:95], v[96:99], v[128:131], v[80:95]
    buffer_store_dwordx4 v[40:43], v20, s[20:23], s50 offen offset:512 sc1
    s_waitcnt lgkmcnt(4)
    ds_read_b64_tr_b16 v[52:53], v3 offset:40960
    ds_read_b64_tr_b16 v[54:55], v3 offset:41472
    v_mfma_f32_32x32x16_bf16 v[80:95], v[100:103], v[132:135], v[80:95]
    s_waitcnt lgkmcnt(4)
    ds_read_b64_tr_b16 v[56:57], v3 offset:43008
    ds_read_b64_tr_b16 v[58:59], v3 offset:43520
    v_mfma_f32_32x32x16_bf16 v[80:95], v[44:47], v[136:139], v[80:95]
    buffer_load_dwordx4 v105, s[16:19], s46 offen offset:1024 lds
    s_waitcnt lgkmcnt(4)
    ds_read_b64_tr_b16 v[96:97], v3 offset:45056
    ds_read_b64_tr_b16 v[98:99], v3 offset:45568
    v_mfma_f32_32x32x16_bf16 v[80:95], v[48:51], v[140:143], v[80:95]
    s_waitcnt lgkmcnt(4)
    ds_read_b64_tr_b16 v[100:101], v3 offset:47104
    ds_read_b64_tr_b16 v[102:103], v3 offset:47616
    v_mfma_f32_32x32x16_bf16 v[80:95], v[52:55], v[144:147], v[80:95]
    s_waitcnt lgkmcnt(4)
    v_mfma_f32_32x32x16_bf16 v[80:95], v[56:59], v[148:151], v[80:95]
    s_barrier
    ds_read_b64_tr_b16 v[44:45], v1 offset:0
    ds_read_b64_tr_b16 v[46:47], v1 offset:512
    s_waitcnt lgkmcnt(4)
    ds_read_b64_tr_b16 v[48:49], v1 offset:2048
    ds_read_b64_tr_b16 v[50:51], v1 offset:2560
    v_mfma_f32_32x32x16_bf16 v[80:95], v[96:99], v[152:155], v[80:95]
    s_waitcnt lgkmcnt(4)
    ds_read_b64_tr_b16 v[52:53], v1 offset:4096
    ds_read_b64_tr_b16 v[54:55], v1 offset:4608
    v_mfma_f32_32x32x16_bf16 v[80:95], v[100:103], v[156:159], v[80:95]
    s_add_u32 m0, s42, 57344
    s_add_u32 s46, s41, 221184
    buffer_load_dwordx4 v13, s[16:19], s46 offen lds
    s_waitcnt lgkmcnt(4)
    ds_read_b64_tr_b16 v[56:57], v1 offset:6144
    ds_read_b64_tr_b16 v[58:59], v1 offset:6656
    v_mfma_f32_32x32x16_bf16 v[80:95], v[44:47], v[160:163], v[80:95]
    s_waitcnt lgkmcnt(4)
    ds_read_b64_tr_b16 v[96:97], v1 offset:8192
    ds_read_b64_tr_b16 v[98:99], v1 offset:8704
    v_mfma_f32_32x32x16_bf16 v[80:95], v[48:51], v[164:167], v[80:95]
    s_waitcnt lgkmcnt(4)
    ds_read_b64_tr_b16 v[100:101], v1 offset:10240
    ds_read_b64_tr_b16 v[102:103], v1 offset:10752
    v_mfma_f32_32x32x16_bf16 v[80:95], v[52:55], v[168:171], v[80:95]
    s_waitcnt lgkmcnt(4)
    ds_read_b64_tr_b16 v[44:45], v1 offset:12288
    ds_read_b64_tr_b16 v[46:47], v1 offset:12800
    v_mfma_f32_32x32x16_bf16 v[80:95], v[56:59], v[172:175], v[80:95]
    s_waitcnt lgkmcnt(4)
    ds_read_b64_tr_b16 v[48:49], v1 offset:14336
    ds_read_b64_tr_b16 v[50:51], v1 offset:14848
    v_mfma_f32_32x32x16_bf16 v[80:95], v[96:99], v[176:179], v[80:95]
    buffer_load_dwordx4 v105, s[16:19], s46 offen offset:1024 lds
    s_waitcnt lgkmcnt(4)
    ds_read_b64_tr_b16 v[52:53], v1 offset:16384
    ds_read_b64_tr_b16 v[54:55], v1 offset:16896
    v_mfma_f32_32x32x16_bf16 v[80:95], v[100:103], v[180:183], v[80:95]
    s_waitcnt lgkmcnt(4)
    ds_read_b64_tr_b16 v[56:57], v1 offset:18432
    ds_read_b64_tr_b16 v[58:59], v1 offset:18944
    v_mfma_f32_32x32x16_bf16 v[80:95], v[44:47], v[184:187], v[80:95]
    s_waitcnt lgkmcnt(4)
    ds_read_b64_tr_b16 v[96:97], v1 offset:20480
    ds_read_b64_tr_b16 v[98:99], v1 offset:20992
    v_mfma_f32_32x32x16_bf16 v[80:95], v[48:51], v[188:191], v[80:95]
    s_waitcnt lgkmcnt(4)
    ds_read_b64_tr_b16 v[100:101], v1 offset:22528
    ds_read_b64_tr_b16 v[102:103], v1 offset:23040
    v_mfma_f32_32x32x16_bf16 v[80:95], v[52:55], v[192:195], v[80:95]
    s_waitcnt lgkmcnt(4)
    v_mfma_f32_32x32x16_bf16 v[80:95], v[56:59], v[196:199], v[80:95]
    s_barrier
    ds_read_b64_tr_b16 v[44:45], v1 offset:24576
    ds_read_b64_tr_b16 v[46:47], v1 offset:25088
    s_add_u32 m0, s42, 65536
    s_add_u32 s46, s41, 442368
    buffer_load_dwordx4 v13, s[16:19], s46 offen lds
    s_waitcnt lgkmcnt(4)
    ds_read_b64_tr_b16 v[48:49], v1 offset:26624
    ds_read_b64_tr_b16 v[50:51], v1 offset:27136
    v_mfma_f32_32x32x16_bf16 v[80:95], v[96:99], v[200:203], v[80:95]
    s_waitcnt lgkmcnt(4)
    ds_read_b64_tr_b16 v[52:53], v1 offset:28672
    ds_read_b64_tr_b16 v[54:55], v1 offset:29184
    v_mfma_f32_32x32x16_bf16 v[80:95], v[100:103], v[204:207], v[80:95]
    s_waitcnt lgkmcnt(4)
    ds_read_b64_tr_b16 v[56:57], v1 offset:30720
    ds_read_b64_tr_b16 v[58:59], v1 offset:31232
    v_mfma_f32_32x32x16_bf16 v[80:95], v[44:47], v[208:211], v[80:95]
    s_waitcnt lgkmcnt(4)
    ds_read_b64_tr_b16 v[96:97], v1 offset:32768
    ds_read_b64_tr_b16 v[98:99], v1 offset:33280
    v_mfma_f32_32x32x16_bf16 v[80:95], v[48:51], v[212:215], v[80:95]
    s_waitcnt lgkmcnt(4)
    ds_read_b64_tr_b16 v[100:101], v1 offset:34816
    ds_read_b64_tr_b16 v[102:103], v1 offset:35328
    v_mfma_f32_32x32x16_bf16 v[80:95], v[52:55], v[216:219], v[80:95]
    buffer_load_dwordx4 v105, s[16:19], s46 offen offset:1024 lds
    s_waitcnt lgkmcnt(4)
    ds_read_b64_tr_b16 v[44:45], v1 offset:36864
    ds_read_b64_tr_b16 v[46:47], v1 offset:37376
    v_mfma_f32_32x32x16_bf16 v[80:95], v[56:59], v[220:223], v[80:95]
    s_waitcnt lgkmcnt(4)
    ds_read_b64_tr_b16 v[48:49], v1 offset:38912
    ds_read_b64_tr_b16 v[50:51], v1 offset:39424
    v_mfma_f32_32x32x16_bf16 v[80:95], v[96:99], v[224:227], v[80:95]
    s_waitcnt lgkmcnt(4)
    ds_read_b64_tr_b16 v[52:53], v1 offset:40960
    ds_read_b64_tr_b16 v[54:55], v1 offset:41472
    v_mfma_f32_32x32x16_bf16 v[80:95], v[100:103], v[228:231], v[80:95]
    s_waitcnt lgkmcnt(4)
    ds_read_b64_tr_b16 v[56:57], v1 offset:43008
    ds_read_b64_tr_b16 v[58:59], v1 offset:43520
    v_mfma_f32_32x32x16_bf16 v[80:95], v[44:47], v[232:235], v[80:95]
    ds_read_b64 v[28:29], v17 offset:2560
    s_waitcnt lgkmcnt(5)
    ds_read_b64_tr_b16 v[96:97], v1 offset:45056
    ds_read_b64_tr_b16 v[98:99], v1 offset:45568
    v_mfma_f32_32x32x16_bf16 v[80:95], v[48:51], v[236:239], v[80:95]
    s_waitcnt lgkmcnt(5)
    ds_read_b64_tr_b16 v[100:101], v1 offset:47104
    ds_read_b64_tr_b16 v[102:103], v1 offset:47616
    v_mfma_f32_32x32x16_bf16 v[80:95], v[52:55], v[240:243], v[80:95]
    s_waitcnt lgkmcnt(5)
    v_mfma_f32_32x32x16_bf16 v[80:95], v[56:59], v[244:247], v[80:95]
    s_waitcnt lgkmcnt(2)
    v_mfma_f32_32x32x16_bf16 v[80:95], v[96:99], v[248:251], v[80:95]
    s_waitcnt lgkmcnt(0)
    v_mfma_f32_32x32x16_bf16 v[80:95], v[100:103], v[252:255], v[80:95]
    v_mfma_f32_32x32x16_bf16 v[80:95], v[28:31], v[24:27], v[80:95]
    s_setprio 0
    s_barrier
    v_lshrrev_b32 v106, 8, v0
    v_bfe_u32 v63, v0, 6, 2
    s_lshl_b32 s39, s36, 8
    s_add_u32 s39, s39, 155904
    v_lshl_add_u32 v107, v106, 5, s39
    ds_read_b128 v[44:47], v107 offset:0
    ds_read_b128 v[48:51], v107 offset:16
    ds_read_b128 v[52:55], v107 offset:128
    ds_read_b128 v[56:59], v107 offset:144
    v_lshl_add_u32 v63, v106, 3, v63
    v_mul_u32_u24 v63, 208, v63
    v_bfe_u32 v106, v0, 4, 1
    v_lshl_add_u32 v63, v106, 4, v63
    v_bfe_u32 v106, v0, 5, 1
    v_lshl_add_u32 v63, v106, 3, v63
    s_mul_i32 s39, s3, 6656
    s_add_u32 s39, s39, 98304
    v_add_u32 v63, s39, v63
    ds_read_b64_tr_b16 v[96:97], v63 offset:0
    ds_read_b64_tr_b16 v[98:99], v63 offset:832
    ds_read_b64_tr_b16 v[100:101], v63 offset:32
    ds_read_b64_tr_b16 v[102:103], v63 offset:864
    s_waitcnt lgkmcnt(2)
    v_lshlrev_b32 v106, 16, v96
    v_and_b32 v107, 0xffff0000, v96
    v_fma_f32 v106, v106, v44, v52
    v_fma_f32 v107, v107, v45, v53
    v_cvt_pk_bf16_f32 v96, v106, v107
    v_lshlrev_b32 v8, 16, v97
    v_and_b32 v9, 0xffff0000, v97
    v_fma_f32 v8, v8, v46, v54
    v_fma_f32 v9, v9, v47, v55
    v_cvt_pk_bf16_f32 v97, v8, v9
    ds_read_b64_tr_b16 v[108:109], v63 offset:64
    ds_read_b64_tr_b16 v[110:111], v63 offset:896
    v_lshlrev_b32 v106, 16, v98
    v_and_b32 v107, 0xffff0000, v98
    v_fma_f32 v106, v106, v48, v56
    v_fma_f32 v107, v107, v49, v57
    v_cvt_pk_bf16_f32 v98, v106, v107
    v_lshlrev_b32 v8, 16, v99
    v_and_b32 v9, 0xffff0000, v99
    v_fma_f32 v8, v8, v50, v58
    v_fma_f32 v9, v9, v51, v59
    v_cvt_pk_bf16_f32 v99, v8, v9
    buffer_store_dwordx4 v[96:99], v0, s[20:23], s54 offen offset:0 sc1
    s_waitcnt lgkmcnt(2)
    v_lshlrev_b32 v106, 16, v100
    v_and_b32 v107, 0xffff0000, v100
    v_fma_f32 v106, v106, v44, v52
    v_fma_f32 v107, v107, v45, v53
    v_cvt_pk_bf16_f32 v100, v106, v107
    v_lshlrev_b32 v8, 16, v101
    v_and_b32 v9, 0xffff0000, v101
    v_fma_f32 v8, v8, v46, v54
    v_fma_f32 v9, v9, v47, v55
    v_cvt_pk_bf16_f32 v101, v8, v9
    ds_read_b64_tr_b16 v[96:97], v63 offset:96
    ds_read_b64_tr_b16 v[98:99], v63 offset:928
    v_lshlrev_b32 v106, 16, v102
    v_and_b32 v107, 0xffff0000, v102
    v_fma_f32 v106, v106, v48, v56
    v_fma_f32 v107, v107, v49, v57
    v_cvt_pk_bf16_f32 v102, v106, v107
    v_lshlrev_b32 v8, 16, v103
    v_and_b32 v9, 0xffff0000, v103
    v_fma_f32 v8, v8, v50, v58
    v_fma_f32 v9, v9, v51, v59
    v_cvt_pk_bf16_f32 v103, v8, v9
    buffer_store_dwordx4 v[100:103], v0, s[20:23], s54 offen offset:1024 sc1
    s_waitcnt lgkmcnt(2)
    v_lshlrev_b32 v106, 16, v108
    v_and_b32 v107, 0xffff0000, v108
    v_fma_f32 v106, v106, v44, v52
    v_fma_f32 v107, v107, v45, v53
    v_cvt_pk_bf16_f32 v108, v106, v107
    v_lshlrev_b32 v8, 16, v109
    v_and_b32 v9, 0xffff0000, v109
    v_fma_f32 v8, v8, v46, v54
    v_fma_f32 v9, v9, v47, v55
    v_cvt_pk_bf16_f32 v109, v8, v9
    ds_read_b64_tr_b16 v[100:101], v63 offset:128
    ds_read_b64_tr_b16 v[102:103], v63 offset:960
    v_lshlrev_b32 v106, 16, v110
    v_and_b32 v107, 0xffff0000, v110
    v_fma_f32 v106, v106, v48, v56
    v_fma_f32 v107, v107, v49, v57
    v_cvt_pk_bf16_f32 v110, v106, v107
    v_lshlrev_b32 v8, 16, v111
    v_and_b32 v9, 0xffff0000, v111
    v_fma_f32 v8, v8, v50, v58
    v_fma_f32 v9, v9, v51, v59
    v_cvt_pk_bf16_f32 v111, v8, v9
    s_add_u32 s54, s54, 4096
    buffer_store_dwordx4 v[108:111], v0, s[20:23], s54 offen offset:0 sc1
    s_waitcnt lgkmcnt(2)
    v_lshlrev_b32 v106, 16, v96
    v_and_b32 v107, 0xffff0000, v96
    v_fma_f32 v106, v106, v44, v52
    v_fma_f32 v107, v107, v45, v53
    v_cvt_pk_bf16_f32 v96, v106, v107
    v_lshlrev_b32 v8, 16, v97
    v_and_b32 v9, 0xffff0000, v97
    v_fma_f32 v8, v8, v46, v54
    v_fma_f32 v9, v9, v47, v55
    v_cvt_pk_bf16_f32 v97, v8, v9
    ds_read_b64_tr_b16 v[108:109], v63 offset:160
    ds_read_b64_tr_b16 v[110:111], v63 offset:992
    v_lshlrev_b32 v106, 16, v98
    v_and_b32 v107, 0xffff0000, v98
    v_fma_f32 v106, v106, v48, v56
    v_fma_f32 v107, v107, v49, v57
    v_cvt_pk_bf16_f32 v98, v106, v107
    v_lshlrev_b32 v8, 16, v99
    v_and_b32 v9, 0xffff0000, v99
    v_fma_f32 v8, v8, v50, v58
    v_fma_f32 v9, v9, v51, v59
    v_cvt_pk_bf16_f32 v99, v8, v9
    buffer_store_dwordx4 v[96:99], v0, s[20:23], s54 offen offset:1024 sc1
    s_waitcnt lgkmcnt(2)
    v_lshlrev_b32 v106, 16, v100
    v_and_b32 v107, 0xffff0000, v100
    v_fma_f32 v106, v106, v44, v52
    v_fma_f32 v107, v107, v45, v53
    s_barrier
    v_cvt_pk_bf16_f32 v100, v106, v107
    v_lshlrev_b32 v8, 16, v101
    v_and_b32 v9, 0xffff0000, v101
    v_fma_f32 v8, v8, v46, v54
    v_fma_f32 v9, v9, v47, v55
    v_cvt_pk_bf16_f32 v101, v8, v9
    v_lshlrev_b32 v106, 16, v102
    v_and_b32 v107, 0xffff0000, v102
    v_fma_f32 v106, v106, v48, v56
    v_fma_f32 v107, v107, v49, v57
    v_cvt_pk_bf16_f32 v102, v106, v107
    v_lshlrev_b32 v8, 16, v103
    v_and_b32 v9, 0xffff0000, v103
    v_fma_f32 v8, v8, v50, v58
    v_fma_f32 v9, v9, v51, v59
    v_cvt_pk_bf16_f32 v103, v8, v9
    s_add_u32 s54, s54, 4096
    buffer_store_dwordx4 v[100:103], v0, s[20:23], s54 offen offset:0 sc1
    s_waitcnt lgkmcnt(0)
    v_lshlrev_b32 v106, 16, v108
    v_and_b32 v107, 0xffff0000, v108
    v_fma_f32 v106, v106, v44, v52
    v_fma_f32 v107, v107, v45, v53
    v_cvt_pk_bf16_f32 v108, v106, v107
    v_lshlrev_b32 v8, 16, v109
    v_and_b32 v9, 0xffff0000, v109
    v_fma_f32 v8, v8, v46, v54
    v_fma_f32 v9, v9, v47, v55
    v_cvt_pk_bf16_f32 v109, v8, v9
    v_lshlrev_b32 v106, 16, v110
    v_and_b32 v107, 0xffff0000, v110
    v_fma_f32 v106, v106, v48, v56
    v_fma_f32 v107, v107, v49, v57
    v_cvt_pk_bf16_f32 v110, v106, v107
    v_lshlrev_b32 v8, 16, v111
    v_and_b32 v9, 0xffff0000, v111
    v_fma_f32 v8, v8, v50, v58
    v_fma_f32 v9, v9, v51, v59
    v_cvt_pk_bf16_f32 v111, v8, v9
    buffer_store_dwordx4 v[108:111], v0, s[20:23], s54 offen offset:1024 sc1
    v_mul_f32 v32, v64, v64
    v_mul_f32 v33, v65, v65
    v_mul_f32 v34, v66, v66
    v_mul_f32 v35, v67, v67
    v_mul_f32 v6, v68, v68
    v_mul_f32 v16, v69, v69
    v_mul_f32 v22, v70, v70
    v_mul_f32 v23, v71, v71
    v_fma_f32 v32, v32, v15, v14
    v_fma_f32 v33, v33, v15, v14
    v_fma_f32 v34, v34, v15, v14
    v_fma_f32 v35, v35, v15, v14
    v_fma_f32 v6, v6, v15, v14
    v_fma_f32 v16, v16, v15, v14
    v_fma_f32 v22, v22, v15, v14
    v_fma_f32 v23, v23, v15, v14
    v_mul_f32 v32, v32, v64
    v_mul_f32 v33, v33, v65
    v_mul_f32 v34, v34, v66
    v_mul_f32 v35, v35, v67
    v_mul_f32 v6, v6, v68
    v_mul_f32 v16, v16, v69
    v_mul_f32 v22, v22, v70
    v_mul_f32 v23, v23, v71
    v_exp_f32 v32, v32
    v_exp_f32 v33, v33
    v_exp_f32 v34, v34
    v_exp_f32 v35, v35
    v_exp_f32 v6, v6
    v_exp_f32 v16, v16
    v_exp_f32 v22, v22
    v_exp_f32 v23, v23
    v_add_f32 v32, 1.0, v32
    v_add_f32 v33, 1.0, v33
    v_add_f32 v34, 1.0, v34
    v_add_f32 v35, 1.0, v35
    v_add_f32 v6, 1.0, v6
    v_add_f32 v16, 1.0, v16
    v_add_f32 v22, 1.0, v22
    v_add_f32 v23, 1.0, v23
    v_rcp_f32 v32, v32
    v_rcp_f32 v33, v33
    v_rcp_f32 v34, v34
    v_rcp_f32 v35, v35
    v_rcp_f32 v6, v6
    v_rcp_f32 v16, v16
    v_rcp_f32 v22, v22
    s_waitcnt vmcnt(6)
    s_barrier
    v_rcp_f32 v23, v23
    v_mul_f32 v64, v64, v32
    v_mul_f32 v65, v65, v33
    v_mul_f32 v66, v66, v34
    v_mul_f32 v67, v67, v35
    v_mul_f32 v68, v68, v6
    v_mul_f32 v69, v69, v16
    v_mul_f32 v70, v70, v22
    v_mul_f32 v71, v71, v23
    v_cvt_pk_bf16_f32 v36, v64, v65
    v_cvt_pk_bf16_f32 v37, v66, v67
    v_cvt_pk_bf16_f32 v40, v68, v69
    v_cvt_pk_bf16_f32 v41, v70, v71
    v_mul_f32 v32, v72, v72
    v_mul_f32 v33, v73, v73
    v_mul_f32 v34, v74, v74
    v_mul_f32 v35, v75, v75
    v_mul_f32 v6, v76, v76
    v_mul_f32 v16, v77, v77
    v_mul_f32 v22, v78, v78
    v_mul_f32 v23, v79, v79
    v_fma_f32 v32, v32, v15, v14
    v_fma_f32 v33, v33, v15, v14
    v_fma_f32 v34, v34, v15, v14
    v_fma_f32 v35, v35, v15, v14
    v_fma_f32 v6, v6, v15, v14
    v_fma_f32 v16, v16, v15, v14
    v_fma_f32 v22, v22, v15, v14
    v_fma_f32 v23, v23, v15, v14
    v_mul_f32 v32, v32, v72
    v_mul_f32 v33, v33, v73
    v_mul_f32 v34, v34, v74
    v_mul_f32 v35, v35, v75
    v_mul_f32 v6, v6, v76
    v_mul_f32 v16, v16, v77
    v_mul_f32 v22, v22, v78
    v_mul_f32 v23, v23, v79
    v_exp_f32 v32, v32
    v_exp_f32 v33, v33
    v_exp_f32 v34, v34
    v_exp_f32 v35, v35
    v_exp_f32 v6, v6
    v_exp_f32 v16, v16
    v_exp_f32 v22, v22
    v_exp_f32 v23, v23
    v_add_f32 v32, 1.0, v32
    v_add_f32 v33, 1.0, v33
    v_add_f32 v34, 1.0, v34
    v_add_f32 v35, 1.0, v35
    v_add_f32 v6, 1.0, v6
    v_add_f32 v16, 1.0, v16
    v_add_f32 v22, 1.0, v22
    v_add_f32 v23, 1.0, v23
    v_rcp_f32 v32, v32
    v_rcp_f32 v33, v33
    v_rcp_f32 v34, v34
    v_rcp_f32 v35, v35
    v_rcp_f32 v6, v6
    v_rcp_f32 v16, v16
    v_rcp_f32 v22, v22
    v_rcp_f32 v23, v23
    v_mul_f32 v72, v72, v32
    v_mul_f32 v73, v73, v33
    v_mul_f32 v74, v74, v34
    v_mul_f32 v75, v75, v35
    v_mul_f32 v76, v76, v6
    v_mul_f32 v77, v77, v16
    v_mul_f32 v78, v78, v22
    v_mul_f32 v79, v79, v23
    v_cvt_pk_bf16_f32 v38, v72, v73
    v_cvt_pk_bf16_f32 v39, v74, v75
    v_cvt_pk_bf16_f32 v42, v76, v77
    v_cvt_pk_bf16_f32 v43, v78, v79
    ds_read_b64_tr_b16 v[44:45], v3 offset:0
    ds_read_b64_tr_b16 v[46:47], v3 offset:512
    ds_read_b64_tr_b16 v[48:49], v3 offset:2048
    ds_read_b64_tr_b16 v[50:51], v3 offset:2560
    ds_read_b64_tr_b16 v[52:53], v3 offset:4096
    ds_read_b64_tr_b16 v[54:55], v3 offset:4608
    s_barrier
    s_setprio 1
    s_waitcnt lgkmcnt(4)
    ds_read_b64_tr_b16 v[56:57], v3 offset:6144
    ds_read_b64_tr_b16 v[58:59], v3 offset:6656
    v_mfma_f32_32x32x16_bf16 v[64:79], v[44:47], v[112:115], 0
    s_waitcnt lgkmcnt(4)
    ds_read_b64_tr_b16 v[96:97], v3 offset:8192
    ds_read_b64_tr_b16 v[98:99], v3 offset:8704
    v_mfma_f32_32x32x16_bf16 v[64:79], v[48:51], v[116:119], v[64:79]
    s_waitcnt lgkmcnt(4)
    ds_read_b64_tr_b16 v[100:101], v3 offset:10240
    ds_read_b64_tr_b16 v[102:103], v3 offset:10752
    v_mfma_f32_32x32x16_bf16 v[64:79], v[52:55], v[120:123], v[64:79]
    buffer_store_dwordx4 v[36:39], v20, s[20:23], s51 offen offset:0 sc1
    s_waitcnt lgkmcnt(4)
    ds_read_b64_tr_b16 v[44:45], v3 offset:12288
    ds_read_b64_tr_b16 v[46:47], v3 offset:12800
    v_mfma_f32_32x32x16_bf16 v[64:79], v[56:59], v[124:127], v[64:79]
    s_waitcnt lgkmcnt(4)
    ds_read_b64_tr_b16 v[48:49], v3 offset:14336
    ds_read_b64_tr_b16 v[50:51], v3 offset:14848
    v_mfma_f32_32x32x16_bf16 v[64:79], v[96:99], v[128:131], v[64:79]
    buffer_store_dwordx4 v[40:43], v20, s[20:23], s51 offen offset:512 sc1
    s_waitcnt lgkmcnt(4)
    ds_read_b64_tr_b16 v[52:53], v3 offset:16384
    ds_read_b64_tr_b16 v[54:55], v3 offset:16896
    v_mfma_f32_32x32x16_bf16 v[64:79], v[100:103], v[132:135], v[64:79]
    s_waitcnt lgkmcnt(4)
    ds_read_b64_tr_b16 v[56:57], v3 offset:18432
    ds_read_b64_tr_b16 v[58:59], v3 offset:18944
    v_mfma_f32_32x32x16_bf16 v[64:79], v[44:47], v[136:139], v[64:79]
    s_waitcnt lgkmcnt(4)
    ds_read_b64_tr_b16 v[96:97], v3 offset:20480
    ds_read_b64_tr_b16 v[98:99], v3 offset:20992
    v_mfma_f32_32x32x16_bf16 v[64:79], v[48:51], v[140:143], v[64:79]
    s_waitcnt lgkmcnt(4)
    ds_read_b64_tr_b16 v[100:101], v3 offset:22528
    ds_read_b64_tr_b16 v[102:103], v3 offset:23040
    v_mfma_f32_32x32x16_bf16 v[64:79], v[52:55], v[144:147], v[64:79]
    s_waitcnt lgkmcnt(4)
    v_mfma_f32_32x32x16_bf16 v[64:79], v[56:59], v[148:151], v[64:79]
    s_barrier
    ds_read_b64_tr_b16 v[44:45], v3 offset:24576
    ds_read_b64_tr_b16 v[46:47], v3 offset:25088
    s_waitcnt lgkmcnt(4)
    ds_read_b64_tr_b16 v[48:49], v3 offset:26624
    ds_read_b64_tr_b16 v[50:51], v3 offset:27136
    v_mfma_f32_32x32x16_bf16 v[64:79], v[96:99], v[152:155], v[64:79]
    s_waitcnt lgkmcnt(4)
    ds_read_b64_tr_b16 v[52:53], v3 offset:28672
    ds_read_b64_tr_b16 v[54:55], v3 offset:29184
    v_mfma_f32_32x32x16_bf16 v[64:79], v[100:103], v[156:159], v[64:79]
    s_waitcnt lgkmcnt(4)
    ds_read_b64_tr_b16 v[56:57], v3 offset:30720
    ds_read_b64_tr_b16 v[58:59], v3 offset:31232
    v_mfma_f32_32x32x16_bf16 v[64:79], v[44:47], v[160:163], v[64:79]
    s_waitcnt lgkmcnt(4)
    ds_read_b64_tr_b16 v[96:97], v3 offset:32768
    ds_read_b64_tr_b16 v[98:99], v3 offset:33280
    v_mfma_f32_32x32x16_bf16 v[64:79], v[48:51], v[164:167], v[64:79]
    s_waitcnt lgkmcnt(4)
    ds_read_b64_tr_b16 v[100:101], v3 offset:34816
    ds_read_b64_tr_b16 v[102:103], v3 offset:35328
    v_mfma_f32_32x32x16_bf16 v[64:79], v[52:55], v[168:171], v[64:79]
    s_waitcnt lgkmcnt(4)
    ds_read_b64_tr_b16 v[44:45], v3 offset:36864
    ds_read_b64_tr_b16 v[46:47], v3 offset:37376
    v_mfma_f32_32x32x16_bf16 v[64:79], v[56:59], v[172:175], v[64:79]
    s_waitcnt lgkmcnt(4)
    ds_read_b64_tr_b16 v[48:49], v3 offset:38912
    ds_read_b64_tr_b16 v[50:51], v3 offset:39424
    v_mfma_f32_32x32x16_bf16 v[64:79], v[96:99], v[176:179], v[64:79]
    s_waitcnt lgkmcnt(4)
    ds_read_b64_tr_b16 v[52:53], v3 offset:40960
    ds_read_b64_tr_b16 v[54:55], v3 offset:41472
    v_mfma_f32_32x32x16_bf16 v[64:79], v[100:103], v[180:183], v[64:79]
    s_waitcnt lgkmcnt(4)
    ds_read_b64_tr_b16 v[56:57], v3 offset:43008
    ds_read_b64_tr_b16 v[58:59], v3 offset:43520
    v_mfma_f32_32x32x16_bf16 v[64:79], v[44:47], v[184:187], v[64:79]
    s_waitcnt lgkmcnt(4)
    ds_read_b64_tr_b16 v[96:97], v3 offset:45056
    ds_read_b64_tr_b16 v[98:99], v3 offset:45568
    v_mfma_f32_32x32x16_bf16 v[64:79], v[48:51], v[188:191], v[64:79]
    s_waitcnt lgkmcnt(4)
    ds_read_b64_tr_b16 v[100:101], v3 offset:47104
    ds_read_b64_tr_b16 v[102:103], v3 offset:47616
    v_mfma_f32_32x32x16_bf16 v[64:79], v[52:55], v[192:195], v[64:79]
    s_waitcnt lgkmcnt(4)
    v_mfma_f32_32x32x16_bf16 v[64:79], v[56:59], v[196:199], v[64:79]
    s_barrier
    ds_read_b64_tr_b16 v[44:45], v1 offset:0
    ds_read_b64_tr_b16 v[46:47], v1 offset:512
    s_waitcnt lgkmcnt(4)
    ds_read_b64_tr_b16 v[48:49], v1 offset:2048
    ds_read_b64_tr_b16 v[50:51], v1 offset:2560
    v_mfma_f32_32x32x16_bf16 v[64:79], v[96:99], v[200:203], v[64:79]
    s_waitcnt lgkmcnt(4)
    ds_read_b64_tr_b16 v[52:53], v1 offset:4096
    ds_read_b64_tr_b16 v[54:55], v1 offset:4608
    v_mfma_f32_32x32x16_bf16 v[64:79], v[100:103], v[204:207], v[64:79]
    s_waitcnt lgkmcnt(4)
    ds_read_b64_tr_b16 v[56:57], v1 offset:6144
    ds_read_b64_tr_b16 v[58:59], v1 offset:6656
    v_mfma_f32_32x32x16_bf16 v[64:79], v[44:47], v[208:211], v[64:79]
    s_waitcnt lgkmcnt(4)
    ds_read_b64_tr_b16 v[96:97], v1 offset:8192
    ds_read_b64_tr_b16 v[98:99], v1 offset:8704
    v_mfma_f32_32x32x16_bf16 v[64:79], v[48:51], v[212:215], v[64:79]
    s_waitcnt lgkmcnt(4)
    ds_read_b64_tr_b16 v[100:101], v1 offset:10240
    ds_read_b64_tr_b16 v[102:103], v1 offset:10752
    v_mfma_f32_32x32x16_bf16 v[64:79], v[52:55], v[216:219], v[64:79]
    s_waitcnt lgkmcnt(4)
    ds_read_b64_tr_b16 v[44:45], v1 offset:12288
    ds_read_b64_tr_b16 v[46:47], v1 offset:12800
    v_mfma_f32_32x32x16_bf16 v[64:79], v[56:59], v[220:223], v[64:79]
    s_waitcnt lgkmcnt(4)
    ds_read_b64_tr_b16 v[48:49], v1 offset:14336
    ds_read_b64_tr_b16 v[50:51], v1 offset:14848
    v_mfma_f32_32x32x16_bf16 v[64:79], v[96:99], v[224:227], v[64:79]
    s_waitcnt lgkmcnt(4)
    ds_read_b64_tr_b16 v[52:53], v1 offset:16384
    ds_read_b64_tr_b16 v[54:55], v1 offset:16896
    v_mfma_f32_32x32x16_bf16 v[64:79], v[100:103], v[228:231], v[64:79]
    s_waitcnt lgkmcnt(4)
    ds_read_b64_tr_b16 v[56:57], v1 offset:18432
    ds_read_b64_tr_b16 v[58:59], v1 offset:18944
    v_mfma_f32_32x32x16_bf16 v[64:79], v[44:47], v[232:235], v[64:79]
    ds_read_b64 v[28:29], v17 offset:3072
    s_waitcnt lgkmcnt(5)
    ds_read_b64_tr_b16 v[96:97], v1 offset:20480
    ds_read_b64_tr_b16 v[98:99], v1 offset:20992
    v_mfma_f32_32x32x16_bf16 v[64:79], v[48:51], v[236:239], v[64:79]
    s_waitcnt lgkmcnt(5)
    ds_read_b64_tr_b16 v[100:101], v1 offset:22528
    ds_read_b64_tr_b16 v[102:103], v1 offset:23040
    v_mfma_f32_32x32x16_bf16 v[64:79], v[52:55], v[240:243], v[64:79]
    s_waitcnt lgkmcnt(5)
    v_mfma_f32_32x32x16_bf16 v[64:79], v[56:59], v[244:247], v[64:79]
    s_waitcnt lgkmcnt(2)
    v_mfma_f32_32x32x16_bf16 v[64:79], v[96:99], v[248:251], v[64:79]
    s_waitcnt lgkmcnt(0)
    v_mfma_f32_32x32x16_bf16 v[64:79], v[100:103], v[252:255], v[64:79]
    v_mfma_f32_32x32x16_bf16 v[64:79], v[28:31], v[24:27], v[64:79]
    s_setprio 0
    s_barrier
    v_mul_f32 v32, v80, v80
    v_mul_f32 v33, v81, v81
    v_mul_f32 v34, v82, v82
    v_mul_f32 v35, v83, v83
    v_mul_f32 v6, v84, v84
    v_mul_f32 v16, v85, v85
    v_mul_f32 v22, v86, v86
    v_mul_f32 v23, v87, v87
    v_fma_f32 v32, v32, v15, v14
    v_fma_f32 v33, v33, v15, v14
    v_fma_f32 v34, v34, v15, v14
    v_fma_f32 v35, v35, v15, v14
    v_fma_f32 v6, v6, v15, v14
    v_fma_f32 v16, v16, v15, v14
    v_fma_f32 v22, v22, v15, v14
    v_fma_f32 v23, v23, v15, v14
    v_mul_f32 v32, v32, v80
    v_mul_f32 v33, v33, v81
    v_mul_f32 v34, v34, v82
    v_mul_f32 v35, v35, v83
    v_mul_f32 v6, v6, v84
    v_mul_f32 v16, v16, v85
    v_mul_f32 v22, v22, v86
    v_mul_f32 v23, v23, v87
    v_exp_f32 v32, v32
    v_exp_f32 v33, v33
    v_exp_f32 v34, v34
    v_exp_f32 v35, v35
    v_exp_f32 v6, v6
    v_exp_f32 v16, v16
    v_exp_f32 v22, v22
    v_exp_f32 v23, v23
    v_add_f32 v32, 1.0, v32
    v_add_f32 v33, 1.0, v33
    v_add_f32 v34, 1.0, v34
    v_add_f32 v35, 1.0, v35
    v_add_f32 v6, 1.0, v6
    v_add_f32 v16, 1.0, v16
    v_add_f32 v22, 1.0, v22
    v_add_f32 v23, 1.0, v23
    v_rcp_f32 v32, v32
    v_rcp_f32 v33, v33
    s_barrier
    v_rcp_f32 v34, v34
    v_rcp_f32 v35, v35
    v_rcp_f32 v6, v6
    v_rcp_f32 v16, v16
    v_rcp_f32 v22, v22
    v_rcp_f32 v23, v23
    v_mul_f32 v80, v80, v32
    v_mul_f32 v81, v81, v33
    v_mul_f32 v82, v82, v34
    v_mul_f32 v83, v83, v35
    v_mul_f32 v84, v84, v6
    v_mul_f32 v85, v85, v16
    v_mul_f32 v86, v86, v22
    v_mul_f32 v87, v87, v23
    v_cvt_pk_bf16_f32 v36, v80, v81
    v_cvt_pk_bf16_f32 v37, v82, v83
    v_cvt_pk_bf16_f32 v40, v84, v85
    v_cvt_pk_bf16_f32 v41, v86, v87
    v_mul_f32 v32, v88, v88
    v_mul_f32 v33, v89, v89
    v_mul_f32 v34, v90, v90
    v_mul_f32 v35, v91, v91
    v_mul_f32 v6, v92, v92
    v_mul_f32 v16, v93, v93
    v_mul_f32 v22, v94, v94
    v_mul_f32 v23, v95, v95
    v_fma_f32 v32, v32, v15, v14
    v_fma_f32 v33, v33, v15, v14
    v_fma_f32 v34, v34, v15, v14
    v_fma_f32 v35, v35, v15, v14
    v_fma_f32 v6, v6, v15, v14
    v_fma_f32 v16, v16, v15, v14
    v_fma_f32 v22, v22, v15, v14
    v_fma_f32 v23, v23, v15, v14
    v_mul_f32 v32, v32, v88
    v_mul_f32 v33, v33, v89
    v_mul_f32 v34, v34, v90
    v_mul_f32 v35, v35, v91
    v_mul_f32 v6, v6, v92
    v_mul_f32 v16, v16, v93
    v_mul_f32 v22, v22, v94
    v_mul_f32 v23, v23, v95
    v_exp_f32 v32, v32
    v_exp_f32 v33, v33
    s_waitcnt vmcnt(2)
    s_barrier
    v_exp_f32 v34, v34
    v_exp_f32 v35, v35
    v_exp_f32 v6, v6
    v_exp_f32 v16, v16
    v_exp_f32 v22, v22
    v_exp_f32 v23, v23
    v_add_f32 v32, 1.0, v32
    v_add_f32 v33, 1.0, v33
    v_add_f32 v34, 1.0, v34
    v_add_f32 v35, 1.0, v35
    v_add_f32 v6, 1.0, v6
    v_add_f32 v16, 1.0, v16
    v_add_f32 v22, 1.0, v22
    v_add_f32 v23, 1.0, v23
    v_rcp_f32 v32, v32
    v_rcp_f32 v33, v33
    v_rcp_f32 v34, v34
    v_rcp_f32 v35, v35
    v_rcp_f32 v6, v6
    v_rcp_f32 v16, v16
    v_rcp_f32 v22, v22
    v_rcp_f32 v23, v23
    v_mul_f32 v88, v88, v32
    v_mul_f32 v89, v89, v33
    v_mul_f32 v90, v90, v34
    v_mul_f32 v91, v91, v35
    v_mul_f32 v92, v92, v6
    v_mul_f32 v93, v93, v16
    v_mul_f32 v94, v94, v22
    v_mul_f32 v95, v95, v23
    v_cvt_pk_bf16_f32 v38, v88, v89
    v_cvt_pk_bf16_f32 v39, v90, v91
    v_cvt_pk_bf16_f32 v42, v92, v93
    v_cvt_pk_bf16_f32 v43, v94, v95
    s_barrier
    s_nop 7
    buffer_store_dwordx4 v[36:39], v20, s[20:23], s52 offen offset:0 sc1
    buffer_store_dwordx4 v[40:43], v20, s[20:23], s52 offen offset:512 sc1
    s_nop 3
    v_mul_f32 v64, v12, v64
    v_mul_f32 v65, v12, v65
    v_mul_f32 v66, v12, v66
    v_mul_f32 v67, v12, v67
    v_mul_f32 v68, v12, v68
    v_mul_f32 v69, v12, v69
    v_mul_f32 v70, v12, v70
    v_mul_f32 v71, v12, v71
    v_cvt_pk_bf16_f32 v36, v64, v65
    v_cvt_pk_bf16_f32 v37, v66, v67
    v_cvt_pk_bf16_f32 v38, v68, v69
    v_cvt_pk_bf16_f32 v39, v70, v71
    v_mul_f32 v72, v12, v72
    v_mul_f32 v73, v12, v73
    v_mul_f32 v74, v12, v74
    v_mul_f32 v75, v12, v75
    v_mul_f32 v76, v12, v76
    v_mul_f32 v77, v12, v77
    v_mul_f32 v78, v12, v78
    v_mul_f32 v79, v12, v79
    v_cvt_pk_bf16_f32 v40, v72, v73
    v_cvt_pk_bf16_f32 v41, v74, v75
    v_cvt_pk_bf16_f32 v42, v76, v77
    v_cvt_pk_bf16_f32 v43, v78, v79
    buffer_store_dwordx4 v[36:39], v0, s[20:23], s53 offen offset:0 sc1
    buffer_store_dwordx4 v[40:43], v0, s[20:23], s53 offen offset:1024 sc1
    s_branch parallel_sum__linear_kernel_hedgehog__mixer_gmlp__prompt_kernel_ztail
parallel_sum__linear_kernel_hedgehog__mixer_gmlp__prompt_kernel_noq0:
    s_setprio 1
    s_waitcnt lgkmcnt(4)
    ds_read_b64_tr_b16 v[56:57], v3 offset:30720
    ds_read_b64_tr_b16 v[58:59], v3 offset:31232
    v_mfma_f32_32x32x16_bf16 v[80:95], v[44:47], v[112:115], 0
    s_waitcnt lgkmcnt(4)
    ds_read_b64_tr_b16 v[96:97], v3 offset:32768
    ds_read_b64_tr_b16 v[98:99], v3 offset:33280
    v_mfma_f32_32x32x16_bf16 v[80:95], v[48:51], v[116:119], v[80:95]
    s_waitcnt lgkmcnt(4)
    ds_read_b64_tr_b16 v[100:101], v3 offset:34816
    ds_read_b64_tr_b16 v[102:103], v3 offset:35328
    v_mfma_f32_32x32x16_bf16 v[80:95], v[52:55], v[120:123], v[80:95]
    buffer_store_dwordx4 v[36:39], v20, s[20:23], s50 offen offset:0 sc1
    s_waitcnt lgkmcnt(4)
    ds_read_b64_tr_b16 v[44:45], v3 offset:36864
    ds_read_b64_tr_b16 v[46:47], v3 offset:37376
    v_mfma_f32_32x32x16_bf16 v[80:95], v[56:59], v[124:127], v[80:95]
    s_waitcnt lgkmcnt(4)
    ds_read_b64_tr_b16 v[48:49], v3 offset:38912
    ds_read_b64_tr_b16 v[50:51], v3 offset:39424
    v_mfma_f32_32x32x16_bf16 v[80:95], v[96:99], v[128:131], v[80:95]
    buffer_store_dwordx4 v[40:43], v20, s[20:23], s50 offen offset:512 sc1
    s_waitcnt lgkmcnt(4)
    ds_read_b64_tr_b16 v[52:53], v3 offset:40960
    ds_read_b64_tr_b16 v[54:55], v3 offset:41472
    v_mfma_f32_32x32x16_bf16 v[80:95], v[100:103], v[132:135], v[80:95]
    s_waitcnt lgkmcnt(4)
    ds_read_b64_tr_b16 v[56:57], v3 offset:43008
    ds_read_b64_tr_b16 v[58:59], v3 offset:43520
    v_mfma_f32_32x32x16_bf16 v[80:95], v[44:47], v[136:139], v[80:95]
    s_waitcnt lgkmcnt(4)
    ds_read_b64_tr_b16 v[96:97], v3 offset:45056
    ds_read_b64_tr_b16 v[98:99], v3 offset:45568
    v_mfma_f32_32x32x16_bf16 v[80:95], v[48:51], v[140:143], v[80:95]
    s_waitcnt lgkmcnt(4)
    ds_read_b64_tr_b16 v[100:101], v3 offset:47104
    ds_read_b64_tr_b16 v[102:103], v3 offset:47616
    v_mfma_f32_32x32x16_bf16 v[80:95], v[52:55], v[144:147], v[80:95]
    s_waitcnt lgkmcnt(4)
    v_mfma_f32_32x32x16_bf16 v[80:95], v[56:59], v[148:151], v[80:95]
    s_barrier
    ds_read_b64_tr_b16 v[44:45], v1 offset:0
    ds_read_b64_tr_b16 v[46:47], v1 offset:512
    s_waitcnt lgkmcnt(4)
    ds_read_b64_tr_b16 v[48:49], v1 offset:2048
    ds_read_b64_tr_b16 v[50:51], v1 offset:2560
    v_mfma_f32_32x32x16_bf16 v[80:95], v[96:99], v[152:155], v[80:95]
    s_waitcnt lgkmcnt(4)
    ds_read_b64_tr_b16 v[52:53], v1 offset:4096
    ds_read_b64_tr_b16 v[54:55], v1 offset:4608
    v_mfma_f32_32x32x16_bf16 v[80:95], v[100:103], v[156:159], v[80:95]
    s_waitcnt lgkmcnt(4)
    ds_read_b64_tr_b16 v[56:57], v1 offset:6144
    ds_read_b64_tr_b16 v[58:59], v1 offset:6656
    v_mfma_f32_32x32x16_bf16 v[80:95], v[44:47], v[160:163], v[80:95]
    s_waitcnt lgkmcnt(4)
    ds_read_b64_tr_b16 v[96:97], v1 offset:8192
    ds_read_b64_tr_b16 v[98:99], v1 offset:8704
    v_mfma_f32_32x32x16_bf16 v[80:95], v[48:51], v[164:167], v[80:95]
    s_waitcnt lgkmcnt(4)
    ds_read_b64_tr_b16 v[100:101], v1 offset:10240
    ds_read_b64_tr_b16 v[102:103], v1 offset:10752
    v_mfma_f32_32x32x16_bf16 v[80:95], v[52:55], v[168:171], v[80:95]
    s_waitcnt lgkmcnt(4)
    ds_read_b64_tr_b16 v[44:45], v1 offset:12288
    ds_read_b64_tr_b16 v[46:47], v1 offset:12800
    v_mfma_f32_32x32x16_bf16 v[80:95], v[56:59], v[172:175], v[80:95]
    s_waitcnt lgkmcnt(4)
    ds_read_b64_tr_b16 v[48:49], v1 offset:14336
    ds_read_b64_tr_b16 v[50:51], v1 offset:14848
    v_mfma_f32_32x32x16_bf16 v[80:95], v[96:99], v[176:179], v[80:95]
    s_waitcnt lgkmcnt(4)
    ds_read_b64_tr_b16 v[52:53], v1 offset:16384
    ds_read_b64_tr_b16 v[54:55], v1 offset:16896
    v_mfma_f32_32x32x16_bf16 v[80:95], v[100:103], v[180:183], v[80:95]
    s_waitcnt lgkmcnt(4)
    ds_read_b64_tr_b16 v[56:57], v1 offset:18432
    ds_read_b64_tr_b16 v[58:59], v1 offset:18944
    v_mfma_f32_32x32x16_bf16 v[80:95], v[44:47], v[184:187], v[80:95]
    s_waitcnt lgkmcnt(4)
    ds_read_b64_tr_b16 v[96:97], v1 offset:20480
    ds_read_b64_tr_b16 v[98:99], v1 offset:20992
    v_mfma_f32_32x32x16_bf16 v[80:95], v[48:51], v[188:191], v[80:95]
    s_waitcnt lgkmcnt(4)
    ds_read_b64_tr_b16 v[100:101], v1 offset:22528
    ds_read_b64_tr_b16 v[102:103], v1 offset:23040
    v_mfma_f32_32x32x16_bf16 v[80:95], v[52:55], v[192:195], v[80:95]
    s_waitcnt lgkmcnt(4)
    v_mfma_f32_32x32x16_bf16 v[80:95], v[56:59], v[196:199], v[80:95]
    s_barrier
    ds_read_b64_tr_b16 v[44:45], v1 offset:24576
    ds_read_b64_tr_b16 v[46:47], v1 offset:25088
    s_waitcnt lgkmcnt(4)
    ds_read_b64_tr_b16 v[48:49], v1 offset:26624
    ds_read_b64_tr_b16 v[50:51], v1 offset:27136
    v_mfma_f32_32x32x16_bf16 v[80:95], v[96:99], v[200:203], v[80:95]
    s_waitcnt lgkmcnt(4)
    ds_read_b64_tr_b16 v[52:53], v1 offset:28672
    ds_read_b64_tr_b16 v[54:55], v1 offset:29184
    v_mfma_f32_32x32x16_bf16 v[80:95], v[100:103], v[204:207], v[80:95]
    s_waitcnt lgkmcnt(4)
    ds_read_b64_tr_b16 v[56:57], v1 offset:30720
    ds_read_b64_tr_b16 v[58:59], v1 offset:31232
    v_mfma_f32_32x32x16_bf16 v[80:95], v[44:47], v[208:211], v[80:95]
    s_waitcnt lgkmcnt(4)
    ds_read_b64_tr_b16 v[96:97], v1 offset:32768
    ds_read_b64_tr_b16 v[98:99], v1 offset:33280
    v_mfma_f32_32x32x16_bf16 v[80:95], v[48:51], v[212:215], v[80:95]
    s_waitcnt lgkmcnt(4)
    ds_read_b64_tr_b16 v[100:101], v1 offset:34816
    ds_read_b64_tr_b16 v[102:103], v1 offset:35328
    v_mfma_f32_32x32x16_bf16 v[80:95], v[52:55], v[216:219], v[80:95]
    s_waitcnt lgkmcnt(4)
    ds_read_b64_tr_b16 v[44:45], v1 offset:36864
    ds_read_b64_tr_b16 v[46:47], v1 offset:37376
    v_mfma_f32_32x32x16_bf16 v[80:95], v[56:59], v[220:223], v[80:95]
    s_waitcnt lgkmcnt(4)
    ds_read_b64_tr_b16 v[48:49], v1 offset:38912
    ds_read_b64_tr_b16 v[50:51], v1 offset:39424
    v_mfma_f32_32x32x16_bf16 v[80:95], v[96:99], v[224:227], v[80:95]
    s_waitcnt lgkmcnt(4)
    ds_read_b64_tr_b16 v[52:53], v1 offset:40960
    ds_read_b64_tr_b16 v[54:55], v1 offset:41472
    v_mfma_f32_32x32x16_bf16 v[80:95], v[100:103], v[228:231], v[80:95]
    s_waitcnt lgkmcnt(4)
    ds_read_b64_tr_b16 v[56:57], v1 offset:43008
    ds_read_b64_tr_b16 v[58:59], v1 offset:43520
    v_mfma_f32_32x32x16_bf16 v[80:95], v[44:47], v[232:235], v[80:95]
    ds_read_b64 v[28:29], v17 offset:2560
    s_waitcnt lgkmcnt(5)
    ds_read_b64_tr_b16 v[96:97], v1 offset:45056
    ds_read_b64_tr_b16 v[98:99], v1 offset:45568
    v_mfma_f32_32x32x16_bf16 v[80:95], v[48:51], v[236:239], v[80:95]
    s_waitcnt lgkmcnt(5)
    ds_read_b64_tr_b16 v[100:101], v1 offset:47104
    ds_read_b64_tr_b16 v[102:103], v1 offset:47616
    v_mfma_f32_32x32x16_bf16 v[80:95], v[52:55], v[240:243], v[80:95]
    s_waitcnt lgkmcnt(5)
    v_mfma_f32_32x32x16_bf16 v[80:95], v[56:59], v[244:247], v[80:95]
    s_waitcnt lgkmcnt(2)
    v_mfma_f32_32x32x16_bf16 v[80:95], v[96:99], v[248:251], v[80:95]
    s_waitcnt lgkmcnt(0)
    v_mfma_f32_32x32x16_bf16 v[80:95], v[100:103], v[252:255], v[80:95]
    v_mfma_f32_32x32x16_bf16 v[80:95], v[28:31], v[24:27], v[80:95]
    s_setprio 0
    s_barrier
    v_lshrrev_b32 v106, 8, v0
    v_bfe_u32 v63, v0, 6, 2
    s_lshl_b32 s39, s36, 8
    s_add_u32 s39, s39, 155904
    v_lshl_add_u32 v107, v106, 5, s39
    ds_read_b128 v[44:47], v107 offset:0
    ds_read_b128 v[48:51], v107 offset:16
    ds_read_b128 v[52:55], v107 offset:128
    ds_read_b128 v[56:59], v107 offset:144
    v_lshl_add_u32 v63, v106, 3, v63
    v_mul_u32_u24 v63, 208, v63
    v_bfe_u32 v106, v0, 4, 1
    v_lshl_add_u32 v63, v106, 4, v63
    v_bfe_u32 v106, v0, 5, 1
    v_lshl_add_u32 v63, v106, 3, v63
    s_mul_i32 s39, s3, 6656
    s_add_u32 s39, s39, 98304
    v_add_u32 v63, s39, v63
    ds_read_b64_tr_b16 v[96:97], v63 offset:0
    ds_read_b64_tr_b16 v[98:99], v63 offset:832
    ds_read_b64_tr_b16 v[100:101], v63 offset:32
    ds_read_b64_tr_b16 v[102:103], v63 offset:864
    s_waitcnt lgkmcnt(2)
    v_lshlrev_b32 v106, 16, v96
    v_and_b32 v107, 0xffff0000, v96
    v_fma_f32 v106, v106, v44, v52
    v_fma_f32 v107, v107, v45, v53
    v_cvt_pk_bf16_f32 v96, v106, v107
    v_lshlrev_b32 v8, 16, v97
    v_and_b32 v9, 0xffff0000, v97
    v_fma_f32 v8, v8, v46, v54
    v_fma_f32 v9, v9, v47, v55
    v_cvt_pk_bf16_f32 v97, v8, v9
    ds_read_b64_tr_b16 v[108:109], v63 offset:64
    ds_read_b64_tr_b16 v[110:111], v63 offset:896
    v_lshlrev_b32 v106, 16, v98
    v_and_b32 v107, 0xffff0000, v98
    v_fma_f32 v106, v106, v48, v56
    v_fma_f32 v107, v107, v49, v57
    v_cvt_pk_bf16_f32 v98, v106, v107
    v_lshlrev_b32 v8, 16, v99
    v_and_b32 v9, 0xffff0000, v99
    v_fma_f32 v8, v8, v50, v58
    v_fma_f32 v9, v9, v51, v59
    v_cvt_pk_bf16_f32 v99, v8, v9
    buffer_store_dwordx4 v[96:99], v0, s[20:23], s54 offen offset:0 sc1
    s_waitcnt lgkmcnt(2)
    v_lshlrev_b32 v106, 16, v100
    v_and_b32 v107, 0xffff0000, v100
    v_fma_f32 v106, v106, v44, v52
    v_fma_f32 v107, v107, v45, v53
    v_cvt_pk_bf16_f32 v100, v106, v107
    v_lshlrev_b32 v8, 16, v101
    v_and_b32 v9, 0xffff0000, v101
    v_fma_f32 v8, v8, v46, v54
    v_fma_f32 v9, v9, v47, v55
    v_cvt_pk_bf16_f32 v101, v8, v9
    ds_read_b64_tr_b16 v[96:97], v63 offset:96
    ds_read_b64_tr_b16 v[98:99], v63 offset:928
    v_lshlrev_b32 v106, 16, v102
    v_and_b32 v107, 0xffff0000, v102
    v_fma_f32 v106, v106, v48, v56
    v_fma_f32 v107, v107, v49, v57
    v_cvt_pk_bf16_f32 v102, v106, v107
    v_lshlrev_b32 v8, 16, v103
    v_and_b32 v9, 0xffff0000, v103
    v_fma_f32 v8, v8, v50, v58
    v_fma_f32 v9, v9, v51, v59
    v_cvt_pk_bf16_f32 v103, v8, v9
    buffer_store_dwordx4 v[100:103], v0, s[20:23], s54 offen offset:1024 sc1
    s_waitcnt lgkmcnt(2)
    v_lshlrev_b32 v106, 16, v108
    v_and_b32 v107, 0xffff0000, v108
    v_fma_f32 v106, v106, v44, v52
    v_fma_f32 v107, v107, v45, v53
    v_cvt_pk_bf16_f32 v108, v106, v107
    v_lshlrev_b32 v8, 16, v109
    v_and_b32 v9, 0xffff0000, v109
    v_fma_f32 v8, v8, v46, v54
    v_fma_f32 v9, v9, v47, v55
    v_cvt_pk_bf16_f32 v109, v8, v9
    ds_read_b64_tr_b16 v[100:101], v63 offset:128
    ds_read_b64_tr_b16 v[102:103], v63 offset:960
    v_lshlrev_b32 v106, 16, v110
    v_and_b32 v107, 0xffff0000, v110
    v_fma_f32 v106, v106, v48, v56
    v_fma_f32 v107, v107, v49, v57
    v_cvt_pk_bf16_f32 v110, v106, v107
    v_lshlrev_b32 v8, 16, v111
    v_and_b32 v9, 0xffff0000, v111
    v_fma_f32 v8, v8, v50, v58
    v_fma_f32 v9, v9, v51, v59
    v_cvt_pk_bf16_f32 v111, v8, v9
    s_add_u32 s54, s54, 4096
    buffer_store_dwordx4 v[108:111], v0, s[20:23], s54 offen offset:0 sc1
    s_waitcnt lgkmcnt(2)
    v_lshlrev_b32 v106, 16, v96
    v_and_b32 v107, 0xffff0000, v96
    v_fma_f32 v106, v106, v44, v52
    v_fma_f32 v107, v107, v45, v53
    v_cvt_pk_bf16_f32 v96, v106, v107
    v_lshlrev_b32 v8, 16, v97
    v_and_b32 v9, 0xffff0000, v97
    v_fma_f32 v8, v8, v46, v54
    v_fma_f32 v9, v9, v47, v55
    v_cvt_pk_bf16_f32 v97, v8, v9
    ds_read_b64_tr_b16 v[108:109], v63 offset:160
    ds_read_b64_tr_b16 v[110:111], v63 offset:992
    v_lshlrev_b32 v106, 16, v98
    v_and_b32 v107, 0xffff0000, v98
    v_fma_f32 v106, v106, v48, v56
    v_fma_f32 v107, v107, v49, v57
    v_cvt_pk_bf16_f32 v98, v106, v107
    v_lshlrev_b32 v8, 16, v99
    v_and_b32 v9, 0xffff0000, v99
    v_fma_f32 v8, v8, v50, v58
    v_fma_f32 v9, v9, v51, v59
    v_cvt_pk_bf16_f32 v99, v8, v9
    buffer_store_dwordx4 v[96:99], v0, s[20:23], s54 offen offset:1024 sc1
    s_waitcnt lgkmcnt(2)
    v_lshlrev_b32 v106, 16, v100
    s_barrier
    v_and_b32 v107, 0xffff0000, v100
    v_fma_f32 v106, v106, v44, v52
    v_fma_f32 v107, v107, v45, v53
    v_cvt_pk_bf16_f32 v100, v106, v107
    v_lshlrev_b32 v8, 16, v101
    v_and_b32 v9, 0xffff0000, v101
    v_fma_f32 v8, v8, v46, v54
    v_fma_f32 v9, v9, v47, v55
    v_cvt_pk_bf16_f32 v101, v8, v9
    v_lshlrev_b32 v106, 16, v102
    v_and_b32 v107, 0xffff0000, v102
    v_fma_f32 v106, v106, v48, v56
    v_fma_f32 v107, v107, v49, v57
    v_cvt_pk_bf16_f32 v102, v106, v107
    v_lshlrev_b32 v8, 16, v103
    v_and_b32 v9, 0xffff0000, v103
    v_fma_f32 v8, v8, v50, v58
    v_fma_f32 v9, v9, v51, v59
    v_cvt_pk_bf16_f32 v103, v8, v9
    s_add_u32 s54, s54, 4096
    buffer_store_dwordx4 v[100:103], v0, s[20:23], s54 offen offset:0 sc1
    s_waitcnt lgkmcnt(0)
    v_lshlrev_b32 v106, 16, v108
    v_and_b32 v107, 0xffff0000, v108
    v_fma_f32 v106, v106, v44, v52
    v_fma_f32 v107, v107, v45, v53
    v_cvt_pk_bf16_f32 v108, v106, v107
    v_lshlrev_b32 v8, 16, v109
    v_and_b32 v9, 0xffff0000, v109
    v_fma_f32 v8, v8, v46, v54
    v_fma_f32 v9, v9, v47, v55
    v_cvt_pk_bf16_f32 v109, v8, v9
    v_lshlrev_b32 v106, 16, v110
    v_and_b32 v107, 0xffff0000, v110
    v_fma_f32 v106, v106, v48, v56
    v_fma_f32 v107, v107, v49, v57
    v_cvt_pk_bf16_f32 v110, v106, v107
    v_lshlrev_b32 v8, 16, v111
    v_and_b32 v9, 0xffff0000, v111
    v_fma_f32 v8, v8, v50, v58
    v_fma_f32 v9, v9, v51, v59
    v_cvt_pk_bf16_f32 v111, v8, v9
    buffer_store_dwordx4 v[108:111], v0, s[20:23], s54 offen offset:1024 sc1
    v_mul_f32 v32, v64, v64
    v_mul_f32 v33, v65, v65
    v_mul_f32 v34, v66, v66
    v_mul_f32 v35, v67, v67
    v_mul_f32 v6, v68, v68
    v_mul_f32 v16, v69, v69
    v_mul_f32 v22, v70, v70
    v_mul_f32 v23, v71, v71
    v_fma_f32 v32, v32, v15, v14
    v_fma_f32 v33, v33, v15, v14
    v_fma_f32 v34, v34, v15, v14
    v_fma_f32 v35, v35, v15, v14
    v_fma_f32 v6, v6, v15, v14
    v_fma_f32 v16, v16, v15, v14
    v_fma_f32 v22, v22, v15, v14
    v_fma_f32 v23, v23, v15, v14
    v_mul_f32 v32, v32, v64
    v_mul_f32 v33, v33, v65
    v_mul_f32 v34, v34, v66
    v_mul_f32 v35, v35, v67
    v_mul_f32 v6, v6, v68
    v_mul_f32 v16, v16, v69
    v_mul_f32 v22, v22, v70
    v_mul_f32 v23, v23, v71
    v_exp_f32 v32, v32
    v_exp_f32 v33, v33
    v_exp_f32 v34, v34
    v_exp_f32 v35, v35
    v_exp_f32 v6, v6
    v_exp_f32 v16, v16
    v_exp_f32 v22, v22
    v_exp_f32 v23, v23
    v_add_f32 v32, 1.0, v32
    v_add_f32 v33, 1.0, v33
    v_add_f32 v34, 1.0, v34
    v_add_f32 v35, 1.0, v35
    v_add_f32 v6, 1.0, v6
    v_add_f32 v16, 1.0, v16
    v_add_f32 v22, 1.0, v22
    v_add_f32 v23, 1.0, v23
    v_rcp_f32 v32, v32
    v_rcp_f32 v33, v33
    v_rcp_f32 v34, v34
    v_rcp_f32 v35, v35
    s_barrier
    v_rcp_f32 v6, v6
    v_rcp_f32 v16, v16
    v_rcp_f32 v22, v22
    v_rcp_f32 v23, v23
    v_mul_f32 v64, v64, v32
    v_mul_f32 v65, v65, v33
    v_mul_f32 v66, v66, v34
    v_mul_f32 v67, v67, v35
    v_mul_f32 v68, v68, v6
    v_mul_f32 v69, v69, v16
    v_mul_f32 v70, v70, v22
    v_mul_f32 v71, v71, v23
    v_cvt_pk_bf16_f32 v36, v64, v65
    v_cvt_pk_bf16_f32 v37, v66, v67
    v_cvt_pk_bf16_f32 v40, v68, v69
    v_cvt_pk_bf16_f32 v41, v70, v71
    v_mul_f32 v32, v72, v72
    v_mul_f32 v33, v73, v73
    v_mul_f32 v34, v74, v74
    v_mul_f32 v35, v75, v75
    v_mul_f32 v6, v76, v76
    v_mul_f32 v16, v77, v77
    v_mul_f32 v22, v78, v78
    v_mul_f32 v23, v79, v79
    v_fma_f32 v32, v32, v15, v14
    v_fma_f32 v33, v33, v15, v14
    v_fma_f32 v34, v34, v15, v14
    v_fma_f32 v35, v35, v15, v14
    v_fma_f32 v6, v6, v15, v14
    v_fma_f32 v16, v16, v15, v14
    v_fma_f32 v22, v22, v15, v14
    v_fma_f32 v23, v23, v15, v14
    v_mul_f32 v32, v32, v72
    v_mul_f32 v33, v33, v73
    v_mul_f32 v34, v34, v74
    v_mul_f32 v35, v35, v75
    v_mul_f32 v6, v6, v76
    v_mul_f32 v16, v16, v77
    v_mul_f32 v22, v22, v78
    v_mul_f32 v23, v23, v79
    v_exp_f32 v32, v32
    v_exp_f32 v33, v33
    v_exp_f32 v34, v34
    v_exp_f32 v35, v35
    v_exp_f32 v6, v6
    v_exp_f32 v16, v16
    v_exp_f32 v22, v22
    v_exp_f32 v23, v23
    v_add_f32 v32, 1.0, v32
    v_add_f32 v33, 1.0, v33
    v_add_f32 v34, 1.0, v34
    v_add_f32 v35, 1.0, v35
    v_add_f32 v6, 1.0, v6
    v_add_f32 v16, 1.0, v16
    v_add_f32 v22, 1.0, v22
    v_add_f32 v23, 1.0, v23
    v_rcp_f32 v32, v32
    v_rcp_f32 v33, v33
    v_rcp_f32 v34, v34
    v_rcp_f32 v35, v35
    v_rcp_f32 v6, v6
    v_rcp_f32 v16, v16
    v_rcp_f32 v22, v22
    v_rcp_f32 v23, v23
    v_mul_f32 v72, v72, v32
    v_mul_f32 v73, v73, v33
    v_mul_f32 v74, v74, v34
    v_mul_f32 v75, v75, v35
    v_mul_f32 v76, v76, v6
    v_mul_f32 v77, v77, v16
    v_mul_f32 v78, v78, v22
    v_mul_f32 v79, v79, v23
    v_cvt_pk_bf16_f32 v38, v72, v73
    v_cvt_pk_bf16_f32 v39, v74, v75
    v_cvt_pk_bf16_f32 v42, v76, v77
    v_cvt_pk_bf16_f32 v43, v78, v79
    s_barrier
    s_nop 7
    buffer_store_dwordx4 v[36:39], v20, s[20:23], s51 offen offset:0 sc1
    buffer_store_dwordx4 v[40:43], v20, s[20:23], s51 offen offset:512 sc1
    s_nop 3
    v_mul_f32 v32, v80, v80
    v_mul_f32 v33, v81, v81
    v_mul_f32 v34, v82, v82
    v_mul_f32 v35, v83, v83
    v_mul_f32 v6, v84, v84
    v_mul_f32 v16, v85, v85
    v_mul_f32 v22, v86, v86
    v_mul_f32 v23, v87, v87
    v_fma_f32 v32, v32, v15, v14
    v_fma_f32 v33, v33, v15, v14
    v_fma_f32 v34, v34, v15, v14
    v_fma_f32 v35, v35, v15, v14
    v_fma_f32 v6, v6, v15, v14
    v_fma_f32 v16, v16, v15, v14
    v_fma_f32 v22, v22, v15, v14
    v_fma_f32 v23, v23, v15, v14
    v_mul_f32 v32, v32, v80
    v_mul_f32 v33, v33, v81
    v_mul_f32 v34, v34, v82
    v_mul_f32 v35, v35, v83
    v_mul_f32 v6, v6, v84
    v_mul_f32 v16, v16, v85
    v_mul_f32 v22, v22, v86
    v_mul_f32 v23, v23, v87
    v_exp_f32 v32, v32
    v_exp_f32 v33, v33
    v_exp_f32 v34, v34
    v_exp_f32 v35, v35
    v_exp_f32 v6, v6
    v_exp_f32 v16, v16
    v_exp_f32 v22, v22
    v_exp_f32 v23, v23
    v_add_f32 v32, 1.0, v32
    v_add_f32 v33, 1.0, v33
    v_add_f32 v34, 1.0, v34
    v_add_f32 v35, 1.0, v35
    v_add_f32 v6, 1.0, v6
    v_add_f32 v16, 1.0, v16
    v_add_f32 v22, 1.0, v22
    v_add_f32 v23, 1.0, v23
    v_rcp_f32 v32, v32
    v_rcp_f32 v33, v33
    v_rcp_f32 v34, v34
    v_rcp_f32 v35, v35
    v_rcp_f32 v6, v6
    v_rcp_f32 v16, v16
    v_rcp_f32 v22, v22
    v_rcp_f32 v23, v23
    v_mul_f32 v80, v80, v32
    v_mul_f32 v81, v81, v33
    v_mul_f32 v82, v82, v34
    v_mul_f32 v83, v83, v35
    v_mul_f32 v84, v84, v6
    v_mul_f32 v85, v85, v16
    v_mul_f32 v86, v86, v22
    v_mul_f32 v87, v87, v23
    v_cvt_pk_bf16_f32 v36, v80, v81
    v_cvt_pk_bf16_f32 v37, v82, v83
    v_cvt_pk_bf16_f32 v40, v84, v85
    v_cvt_pk_bf16_f32 v41, v86, v87
    v_mul_f32 v32, v88, v88
    v_mul_f32 v33, v89, v89
    v_mul_f32 v34, v90, v90
    v_mul_f32 v35, v91, v91
    v_mul_f32 v6, v92, v92
    v_mul_f32 v16, v93, v93
    v_mul_f32 v22, v94, v94
    v_mul_f32 v23, v95, v95
    v_fma_f32 v32, v32, v15, v14
    v_fma_f32 v33, v33, v15, v14
    v_fma_f32 v34, v34, v15, v14
    v_fma_f32 v35, v35, v15, v14
    v_fma_f32 v6, v6, v15, v14
    v_fma_f32 v16, v16, v15, v14
    v_fma_f32 v22, v22, v15, v14
    v_fma_f32 v23, v23, v15, v14
    v_mul_f32 v32, v32, v88
    v_mul_f32 v33, v33, v89
    v_mul_f32 v34, v34, v90
    v_mul_f32 v35, v35, v91
    v_mul_f32 v6, v6, v92
    v_mul_f32 v16, v16, v93
    v_mul_f32 v22, v22, v94
    v_mul_f32 v23, v23, v95
    v_exp_f32 v32, v32
    v_exp_f32 v33, v33
    v_exp_f32 v34, v34
    v_exp_f32 v35, v35
    v_exp_f32 v6, v6
    v_exp_f32 v16, v16
    v_exp_f32 v22, v22
    v_exp_f32 v23, v23
    v_add_f32 v32, 1.0, v32
    v_add_f32 v33, 1.0, v33
    v_add_f32 v34, 1.0, v34
    v_add_f32 v35, 1.0, v35
    v_add_f32 v6, 1.0, v6
    v_add_f32 v16, 1.0, v16
    v_add_f32 v22, 1.0, v22
    v_add_f32 v23, 1.0, v23
    v_rcp_f32 v32, v32
    v_rcp_f32 v33, v33
    v_rcp_f32 v34, v34
    v_rcp_f32 v35, v35
    v_rcp_f32 v6, v6
    v_rcp_f32 v16, v16
    v_rcp_f32 v22, v22
    v_rcp_f32 v23, v23
    v_mul_f32 v88, v88, v32
    v_mul_f32 v89, v89, v33
    v_mul_f32 v90, v90, v34
    v_mul_f32 v91, v91, v35
    v_mul_f32 v92, v92, v6
    v_mul_f32 v93, v93, v16
    v_mul_f32 v94, v94, v22
    v_mul_f32 v95, v95, v23
    v_cvt_pk_bf16_f32 v38, v88, v89
    v_cvt_pk_bf16_f32 v39, v90, v91
    v_cvt_pk_bf16_f32 v42, v92, v93
    v_cvt_pk_bf16_f32 v43, v94, v95
    buffer_store_dwordx4 v[36:39], v20, s[20:23], s52 offen offset:0 sc1
    buffer_store_dwordx4 v[40:43], v20, s[20:23], s52 offen offset:512 sc1
    s_waitcnt vmcnt(4)
    s_barrier
    s_branch parallel_sum__linear_kernel_hedgehog__mixer_gmlp__prompt_kernel_rpk
parallel_sum__linear_kernel_hedgehog__mixer_gmlp__prompt_kernel_p1:
    s_waitcnt vmcnt(4)
    s_barrier
    buffer_load_dwordx4 v[80:83], v63, s[20:23], s65 offen sc1
    s_waitcnt vmcnt(1)
    s_barrier
    s_waitcnt vmcnt(0)
    s_mov_b32 s58, 100000
parallel_sum__linear_kernel_hedgehog__mixer_gmlp__prompt_kernel_tg_201:
    v_min3_u32 v61, v109, v111, v111
    v_max3_u32 v62, v109, v111, v111
    v_xor_b32 v61, v61, v60
    v_xor_b32 v62, v62, v60
    v_or_b32 v61, v61, v62
    v_cmp_ne_u32 vcc, 0, v61
    s_sub_u32 s58, s58, 1
    s_cmp_eq_u32 s58, 0
    s_cbranch_scc1 parallel_sum__linear_kernel_hedgehog__mixer_gmlp__prompt_kernel_tk_202
    s_cmp_eq_u64 vcc, 0
    s_cbranch_scc1 parallel_sum__linear_kernel_hedgehog__mixer_gmlp__prompt_kernel_tk_202
    s_sleep 8
    buffer_load_dwordx4 v[108:111], v21, s[20:23], s59 offen sc1
    s_waitcnt vmcnt(0)
    s_branch parallel_sum__linear_kernel_hedgehog__mixer_gmlp__prompt_kernel_tg_201
parallel_sum__linear_kernel_hedgehog__mixer_gmlp__prompt_kernel_tk_202:
    s_mov_b32 s58, 100000
parallel_sum__linear_kernel_hedgehog__mixer_gmlp__prompt_kernel_tg_203:
    v_min3_u32 v61, v81, v83, v83
    v_max3_u32 v62, v81, v83, v83
    v_xor_b32 v61, v61, v60
    v_xor_b32 v62, v62, v60
    v_or_b32 v61, v61, v62
    v_lshrrev_b32 v62, 30, v63
    v_subrev_u32 v62, 1, v62
    v_and_b32 v61, v61, v62
    v_cmp_ne_u32 vcc, 0, v61
    s_sub_u32 s58, s58, 1
    s_cmp_eq_u32 s58, 0
    s_cbranch_scc1 parallel_sum__linear_kernel_hedgehog__mixer_gmlp__prompt_kernel_tk_204
    s_cmp_eq_u64 vcc, 0
    s_cbranch_scc1 parallel_sum__linear_kernel_hedgehog__mixer_gmlp__prompt_kernel_tk_204
    s_sleep 8
    buffer_load_dwordx4 v[80:83], v63, s[20:23], s65 offen sc1
    s_waitcnt vmcnt(0)
    s_branch parallel_sum__linear_kernel_hedgehog__mixer_gmlp__prompt_kernel_tg_203
parallel_sum__linear_kernel_hedgehog__mixer_gmlp__prompt_kernel_tk_204:
    v_cvt_pk_bf16_f32 v84, v80, v80
    v_cvt_pk_bf16_f32 v86, v82, v82
    v_lshlrev_b32 v85, 16, v84
    v_lshlrev_b32 v87, 16, v86
    v_sub_f32 v80, v80, v85
    v_sub_f32 v82, v82, v87
    v_cvt_pk_bf16_f32 v85, v80, v80
    v_cvt_pk_bf16_f32 v87, v82, v82
    v_add_u32 v104, 72704, v5
    v_add_u32 v105, 26624, v13
    ds_write_b128 v18, v[84:87]
    v_mov_b32 v12, v110
    s_mov_b32 s67, 1065369472
    v_mul_f32 v15, v12, v12
    v_mul_f32 v14, 3222493025, v12
    v_mul_f32 v15, v15, v12
    v_mov_b32 v61, 0
    v_mul_f32 v15, 3184710632, v15
    v_mov_b32 v62, 0
    v_mov_b32 v7, 0
    v_mov_b32 v8, 0
    v_cvt_pk_bf16_f32 v24, v108, v108
    v_mov_b32 v26, 0
    v_lshlrev_b32 v24, 16, v24
    v_mov_b32 v27, 0
    v_sub_f32 v24, v108, v24
    v_cmp_gt_u32 vcc, 32, v2
    v_cvt_pk_bf16_f32 v24, v108, v24
    v_mov_b32 v30, 0
    v_cndmask_b32 v24, v26, v24, vcc
    v_mov_b32 v31, 0
    v_mov_b32 v25, v24
    ds_read_b64_tr_b16 v[44:45], v3 offset:24576
    ds_read_b64_tr_b16 v[46:47], v3 offset:25088
    ds_read_b64_tr_b16 v[48:49], v3 offset:26624
    ds_read_b64_tr_b16 v[50:51], v3 offset:27136
    ds_read_b64_tr_b16 v[52:53], v3 offset:28672
    ds_read_b64_tr_b16 v[54:55], v3 offset:29184
    s_waitcnt lgkmcnt(6)
    s_barrier
    s_setprio 1
    s_waitcnt lgkmcnt(4)
    ds_read_b64_tr_b16 v[56:57], v3 offset:30720
    ds_read_b64_tr_b16 v[58:59], v3 offset:31232
    v_mfma_f32_32x32x16_bf16 v[80:95], v[44:47], v[112:115], 0
    s_waitcnt lgkmcnt(4)
    ds_read_b64_tr_b16 v[96:97], v3 offset:32768
    ds_read_b64_tr_b16 v[98:99], v3 offset:33280
    v_mfma_f32_32x32x16_bf16 v[80:95], v[48:51], v[116:119], v[80:95]
    s_waitcnt lgkmcnt(4)
    ds_read_b64_tr_b16 v[100:101], v3 offset:34816
    ds_read_b64_tr_b16 v[102:103], v3 offset:35328
    v_mfma_f32_32x32x16_bf16 v[80:95], v[52:55], v[120:123], v[80:95]
    s_waitcnt lgkmcnt(4)
    ds_read_b64_tr_b16 v[44:45], v3 offset:36864
    ds_read_b64_tr_b16 v[46:47], v3 offset:37376
    v_mfma_f32_32x32x16_bf16 v[80:95], v[56:59], v[124:127], v[80:95]
    s_waitcnt lgkmcnt(4)
    ds_read_b64_tr_b16 v[48:49], v3 offset:38912
    ds_read_b64_tr_b16 v[50:51], v3 offset:39424
    v_mfma_f32_32x32x16_bf16 v[80:95], v[96:99], v[128:131], v[80:95]
    s_waitcnt lgkmcnt(4)
    ds_read_b64_tr_b16 v[52:53], v3 offset:40960
    ds_read_b64_tr_b16 v[54:55], v3 offset:41472
    v_mfma_f32_32x32x16_bf16 v[80:95], v[100:103], v[132:135], v[80:95]
    s_waitcnt lgkmcnt(4)
    ds_read_b64_tr_b16 v[56:57], v3 offset:43008
    ds_read_b64_tr_b16 v[58:59], v3 offset:43520
    v_mfma_f32_32x32x16_bf16 v[80:95], v[44:47], v[136:139], v[80:95]
    s_waitcnt lgkmcnt(4)
    ds_read_b64_tr_b16 v[96:97], v3 offset:45056
    ds_read_b64_tr_b16 v[98:99], v3 offset:45568
    v_mfma_f32_32x32x16_bf16 v[80:95], v[48:51], v[140:143], v[80:95]
    s_waitcnt lgkmcnt(4)
    ds_read_b64_tr_b16 v[100:101], v3 offset:47104
    ds_read_b64_tr_b16 v[102:103], v3 offset:47616
    v_mfma_f32_32x32x16_bf16 v[80:95], v[52:55], v[144:147], v[80:95]
    s_waitcnt lgkmcnt(4)
    v_mfma_f32_32x32x16_bf16 v[80:95], v[56:59], v[148:151], v[80:95]
    s_waitcnt lgkmcnt(0)
    s_barrier
    ds_read_b64_tr_b16 v[44:45], v1 offset:0
    ds_read_b64_tr_b16 v[46:47], v1 offset:512
    ds_read_b64_tr_b16 v[48:49], v1 offset:2048
    ds_read_b64_tr_b16 v[50:51], v1 offset:2560
    v_mfma_f32_32x32x16_bf16 v[80:95], v[96:99], v[152:155], v[80:95]
    s_add_u32 m0, s42, 73728
    s_add_u32 s46, s40, 1769728
    buffer_load_dwordx4 v5, s[12:15], s46 offen lds
    ds_read_b64_tr_b16 v[52:53], v1 offset:4096
    ds_read_b64_tr_b16 v[54:55], v1 offset:4608
    v_mfma_f32_32x32x16_bf16 v[80:95], v[100:103], v[156:159], v[80:95]
    s_waitcnt lgkmcnt(4)
    ds_read_b64_tr_b16 v[56:57], v1 offset:6144
    ds_read_b64_tr_b16 v[58:59], v1 offset:6656
    v_mfma_f32_32x32x16_bf16 v[80:95], v[44:47], v[160:163], v[80:95]
    buffer_load_dwordx4 v104, s[12:15], s46 offen offset:1024 lds
    s_waitcnt lgkmcnt(4)
    ds_read_b64_tr_b16 v[96:97], v1 offset:8192
    ds_read_b64_tr_b16 v[98:99], v1 offset:8704
    v_mfma_f32_32x32x16_bf16 v[80:95], v[48:51], v[164:167], v[80:95]
    s_waitcnt lgkmcnt(4)
    ds_read_b64_tr_b16 v[100:101], v1 offset:10240
    ds_read_b64_tr_b16 v[102:103], v1 offset:10752
    v_mfma_f32_32x32x16_bf16 v[80:95], v[52:55], v[168:171], v[80:95]
    s_add_u32 m0, s42, 81920
    s_add_u32 s46, s40, 2359552
    buffer_load_dwordx4 v5, s[12:15], s46 offen lds
    s_waitcnt lgkmcnt(4)
    ds_read_b64_tr_b16 v[44:45], v1 offset:12288
    ds_read_b64_tr_b16 v[46:47], v1 offset:12800
    v_mfma_f32_32x32x16_bf16 v[80:95], v[56:59], v[172:175], v[80:95]
    s_waitcnt lgkmcnt(4)
    ds_read_b64_tr_b16 v[48:49], v1 offset:14336
    ds_read_b64_tr_b16 v[50:51], v1 offset:14848
    v_mfma_f32_32x32x16_bf16 v[80:95], v[96:99], v[176:179], v[80:95]
    buffer_load_dwordx4 v104, s[12:15], s46 offen offset:1024 lds
    s_waitcnt lgkmcnt(4)
    ds_read_b64_tr_b16 v[52:53], v1 offset:16384
    ds_read_b64_tr_b16 v[54:55], v1 offset:16896
    v_mfma_f32_32x32x16_bf16 v[80:95], v[100:103], v[180:183], v[80:95]
    s_waitcnt lgkmcnt(4)
    ds_read_b64_tr_b16 v[56:57], v1 offset:18432
    ds_read_b64_tr_b16 v[58:59], v1 offset:18944
    v_mfma_f32_32x32x16_bf16 v[80:95], v[44:47], v[184:187], v[80:95]
    s_add_u32 m0, s42, 90112
    s_add_u32 s46, s40, 2949376
    buffer_load_dwordx4 v5, s[12:15], s46 offen lds
    s_waitcnt lgkmcnt(4)
    ds_read_b64_tr_b16 v[96:97], v1 offset:20480
    ds_read_b64_tr_b16 v[98:99], v1 offset:20992
    v_mfma_f32_32x32x16_bf16 v[80:95], v[48:51], v[188:191], v[80:95]
    s_waitcnt lgkmcnt(4)
    ds_read_b64_tr_b16 v[100:101], v1 offset:22528
    ds_read_b64_tr_b16 v[102:103], v1 offset:23040
    v_mfma_f32_32x32x16_bf16 v[80:95], v[52:55], v[192:195], v[80:95]
    buffer_load_dwordx4 v104, s[12:15], s46 offen offset:1024 lds
    s_waitcnt lgkmcnt(4)
    v_mfma_f32_32x32x16_bf16 v[80:95], v[56:59], v[196:199], v[80:95]
    s_waitcnt lgkmcnt(0)
    s_barrier
    ds_read_b64_tr_b16 v[44:45], v1 offset:24576
    ds_read_b64_tr_b16 v[46:47], v1 offset:25088
    ds_read_b64_tr_b16 v[48:49], v1 offset:26624
    ds_read_b64_tr_b16 v[50:51], v1 offset:27136
    v_mfma_f32_32x32x16_bf16 v[80:95], v[96:99], v[200:203], v[80:95]
    s_add_u32 m0, s42, 0
    s_add_u32 s46, s40, 3539200
    buffer_load_dwordx4 v5, s[12:15], s46 offen lds
    ds_read_b64_tr_b16 v[52:53], v1 offset:28672
    ds_read_b64_tr_b16 v[54:55], v1 offset:29184
    v_mfma_f32_32x32x16_bf16 v[80:95], v[100:103], v[204:207], v[80:95]
    s_waitcnt lgkmcnt(4)
    ds_read_b64_tr_b16 v[56:57], v1 offset:30720
    ds_read_b64_tr_b16 v[58:59], v1 offset:31232
    v_mfma_f32_32x32x16_bf16 v[80:95], v[44:47], v[208:211], v[80:95]
    buffer_load_dwordx4 v104, s[12:15], s46 offen offset:1024 lds
    s_waitcnt lgkmcnt(4)
    ds_read_b64_tr_b16 v[96:97], v1 offset:32768
    ds_read_b64_tr_b16 v[98:99], v1 offset:33280
    v_mfma_f32_32x32x16_bf16 v[80:95], v[48:51], v[212:215], v[80:95]
    s_waitcnt lgkmcnt(4)
    ds_read_b64_tr_b16 v[100:101], v1 offset:34816
    ds_read_b64_tr_b16 v[102:103], v1 offset:35328
    v_mfma_f32_32x32x16_bf16 v[80:95], v[52:55], v[216:219], v[80:95]
    s_add_u32 m0, s42, 8192
    s_add_u32 s46, s40, 4129024
    buffer_load_dwordx4 v5, s[12:15], s46 offen lds
    s_waitcnt lgkmcnt(4)
    ds_read_b64_tr_b16 v[44:45], v1 offset:36864
    ds_read_b64_tr_b16 v[46:47], v1 offset:37376
    v_mfma_f32_32x32x16_bf16 v[80:95], v[56:59], v[220:223], v[80:95]
    s_waitcnt lgkmcnt(4)
    ds_read_b64_tr_b16 v[48:49], v1 offset:38912
    ds_read_b64_tr_b16 v[50:51], v1 offset:39424
    v_mfma_f32_32x32x16_bf16 v[80:95], v[96:99], v[224:227], v[80:95]
    buffer_load_dwordx4 v104, s[12:15], s46 offen offset:1024 lds
    s_waitcnt lgkmcnt(4)
    ds_read_b64_tr_b16 v[52:53], v1 offset:40960
    ds_read_b64_tr_b16 v[54:55], v1 offset:41472
    v_mfma_f32_32x32x16_bf16 v[80:95], v[100:103], v[228:231], v[80:95]
    s_waitcnt lgkmcnt(4)
    ds_read_b64_tr_b16 v[56:57], v1 offset:43008
    ds_read_b64_tr_b16 v[58:59], v1 offset:43520
    v_mfma_f32_32x32x16_bf16 v[80:95], v[44:47], v[232:235], v[80:95]
    s_add_u32 m0, s42, 16384
    s_add_u32 s46, s40, 4718848
    buffer_load_dwordx4 v5, s[12:15], s46 offen lds
    ds_read_b64 v[28:29], v17 offset:512
    s_waitcnt lgkmcnt(5)
    ds_read_b64_tr_b16 v[96:97], v1 offset:45056
    ds_read_b64_tr_b16 v[98:99], v1 offset:45568
    v_mfma_f32_32x32x16_bf16 v[80:95], v[48:51], v[236:239], v[80:95]
    s_waitcnt lgkmcnt(5)
    ds_read_b64_tr_b16 v[100:101], v1 offset:47104
    ds_read_b64_tr_b16 v[102:103], v1 offset:47616
    v_mfma_f32_32x32x16_bf16 v[80:95], v[52:55], v[240:243], v[80:95]
    buffer_load_dwordx4 v104, s[12:15], s46 offen offset:1024 lds
    s_waitcnt lgkmcnt(5)
    v_mfma_f32_32x32x16_bf16 v[80:95], v[56:59], v[244:247], v[80:95]
    s_waitcnt lgkmcnt(2)
    v_mfma_f32_32x32x16_bf16 v[80:95], v[96:99], v[248:251], v[80:95]
    s_waitcnt lgkmcnt(0)
    v_mfma_f32_32x32x16_bf16 v[80:95], v[100:103], v[252:255], v[80:95]
    v_mfma_f32_32x32x16_bf16 v[80:95], v[28:31], v[24:27], v[80:95]
    s_setprio 0
    s_barrier
    ds_read_b64 v[28:29], v17 offset:0
    s_waitcnt lgkmcnt(0)
    v_mfma_f32_32x32x16_bf16 v[64:79], v[28:31], v[24:27], v[64:79]
    s_nop 7
    s_nop 3
    v_mul_f32 v32, v64, v64
    v_mul_f32 v33, v65, v65
    v_mul_f32 v34, v66, v66
    v_mul_f32 v35, v67, v67
    v_mul_f32 v6, v68, v68
    v_mul_f32 v16, v69, v69
    v_mul_f32 v22, v70, v70
    v_mul_f32 v23, v71, v71
    v_fma_f32 v32, v32, v15, v14
    v_fma_f32 v33, v33, v15, v14
    v_fma_f32 v34, v34, v15, v14
    v_fma_f32 v35, v35, v15, v14
    v_fma_f32 v6, v6, v15, v14
    v_fma_f32 v16, v16, v15, v14
    v_fma_f32 v22, v22, v15, v14
    v_fma_f32 v23, v23, v15, v14
    v_mul_f32 v32, v32, v64
    v_mul_f32 v33, v33, v65
    v_mul_f32 v34, v34, v66
    v_mul_f32 v35, v35, v67
    v_mul_f32 v6, v6, v68
    v_mul_f32 v16, v16, v69
    v_mul_f32 v22, v22, v70
    v_mul_f32 v23, v23, v71
    v_exp_f32 v32, v32
    v_exp_f32 v33, v33
    v_exp_f32 v34, v34
    v_exp_f32 v35, v35
    v_exp_f32 v6, v6
    v_exp_f32 v16, v16
    v_exp_f32 v22, v22
    v_exp_f32 v23, v23
    v_add_f32 v32, 1.0, v32
    v_add_f32 v33, 1.0, v33
    v_add_f32 v34, 1.0, v34
    v_add_f32 v35, 1.0, v35
    v_add_f32 v6, 1.0, v6
    v_add_f32 v16, 1.0, v16
    v_add_f32 v22, 1.0, v22
    v_add_f32 v23, 1.0, v23
    v_rcp_f32 v32, v32
    v_rcp_f32 v33, v33
    v_rcp_f32 v34, v34
    v_rcp_f32 v35, v35
    v_rcp_f32 v6, v6
    v_rcp_f32 v16, v16
    v_rcp_f32 v22, v22
    s_waitcnt vmcnt(6)
    s_barrier
    v_rcp_f32 v23, v23
    v_mul_f32 v64, v64, v32
    v_mul_f32 v65, v65, v33
    v_mul_f32 v66, v66, v34
    v_mul_f32 v67, v67, v35
    v_mul_f32 v68, v68, v6
    v_mul_f32 v69, v69, v16
    v_mul_f32 v70, v70, v22
    v_mul_f32 v71, v71, v23
    v_cvt_pk_bf16_f32 v36, v64, v65
    v_cvt_pk_bf16_f32 v37, v66, v67
    v_cvt_pk_bf16_f32 v38, v68, v69
    v_cvt_pk_bf16_f32 v39, v70, v71
    v_add_f32 v61, v61, v64
    v_fmac_f32 v62, v64, v64
    v_add_f32 v7, v7, v65
    v_fmac_f32 v8, v65, v65
    v_add_f32 v61, v61, v66
    v_fmac_f32 v62, v66, v66
    v_add_f32 v7, v7, v67
    v_fmac_f32 v8, v67, v67
    v_add_f32 v61, v61, v68
    v_fmac_f32 v62, v68, v68
    v_add_f32 v7, v7, v69
    v_fmac_f32 v8, v69, v69
    v_add_f32 v61, v61, v70
    v_fmac_f32 v62, v70, v70
    v_add_f32 v7, v7, v71
    v_fmac_f32 v8, v71, v71
    v_mul_f32 v32, v72, v72
    v_mul_f32 v33, v73, v73
    v_mul_f32 v34, v74, v74
    v_mul_f32 v35, v75, v75
    v_mul_f32 v6, v76, v76
    v_mul_f32 v16, v77, v77
    v_mul_f32 v22, v78, v78
    v_mul_f32 v23, v79, v79
    v_fma_f32 v32, v32, v15, v14
    v_fma_f32 v33, v33, v15, v14
    v_fma_f32 v34, v34, v15, v14
    v_fma_f32 v35, v35, v15, v14
    v_fma_f32 v6, v6, v15, v14
    v_fma_f32 v16, v16, v15, v14
    v_fma_f32 v22, v22, v15, v14
    v_fma_f32 v23, v23, v15, v14
    v_mul_f32 v32, v32, v72
    v_mul_f32 v33, v33, v73
    v_mul_f32 v34, v34, v74
    v_mul_f32 v35, v35, v75
    v_mul_f32 v6, v6, v76
    v_mul_f32 v16, v16, v77
    v_mul_f32 v22, v22, v78
    v_mul_f32 v23, v23, v79
    v_exp_f32 v32, v32
    v_exp_f32 v33, v33
    v_exp_f32 v34, v34
    v_exp_f32 v35, v35
    v_exp_f32 v6, v6
    v_exp_f32 v16, v16
    s_waitcnt vmcnt(0)
    s_barrier
    v_exp_f32 v22, v22
    v_exp_f32 v23, v23
    v_add_f32 v32, 1.0, v32
    v_add_f32 v33, 1.0, v33
    v_add_f32 v34, 1.0, v34
    v_add_f32 v35, 1.0, v35
    v_add_f32 v6, 1.0, v6
    v_add_f32 v16, 1.0, v16
    v_add_f32 v22, 1.0, v22
    v_add_f32 v23, 1.0, v23
    v_rcp_f32 v32, v32
    v_rcp_f32 v33, v33
    v_rcp_f32 v34, v34
    v_rcp_f32 v35, v35
    v_rcp_f32 v6, v6
    v_rcp_f32 v16, v16
    v_rcp_f32 v22, v22
    v_rcp_f32 v23, v23
    v_mul_f32 v72, v72, v32
    v_mul_f32 v73, v73, v33
    v_mul_f32 v74, v74, v34
    v_mul_f32 v75, v75, v35
    v_mul_f32 v76, v76, v6
    v_mul_f32 v77, v77, v16
    v_mul_f32 v78, v78, v22
    v_mul_f32 v79, v79, v23
    v_cvt_pk_bf16_f32 v40, v72, v73
    v_cvt_pk_bf16_f32 v41, v74, v75
    v_cvt_pk_bf16_f32 v42, v76, v77
    v_cvt_pk_bf16_f32 v43, v78, v79
    v_add_f32 v61, v61, v72
    v_fmac_f32 v62, v72, v72
    v_add_f32 v7, v7, v73
    v_fmac_f32 v8, v73, v73
    v_add_f32 v61, v61, v74
    v_fmac_f32 v62, v74, v74
    v_add_f32 v7, v7, v75
    v_fmac_f32 v8, v75, v75
    v_add_f32 v61, v61, v76
    v_fmac_f32 v62, v76, v76
    v_add_f32 v7, v7, v77
    v_fmac_f32 v8, v77, v77
    v_add_f32 v61, v61, v78
    v_fmac_f32 v62, v78, v78
    v_add_f32 v7, v7, v79
    v_fmac_f32 v8, v79, v79
    ds_read_b64_tr_b16 v[44:45], v3 offset:0
    ds_read_b64_tr_b16 v[46:47], v3 offset:512
    ds_read_b64_tr_b16 v[48:49], v3 offset:2048
    ds_read_b64_tr_b16 v[50:51], v3 offset:2560
    ds_read_b64_tr_b16 v[52:53], v3 offset:4096
    ds_read_b64_tr_b16 v[54:55], v3 offset:4608
    s_barrier
    s_setprio 1
    s_waitcnt lgkmcnt(4)
    ds_read_b64_tr_b16 v[56:57], v3 offset:6144
    ds_read_b64_tr_b16 v[58:59], v3 offset:6656
    v_mfma_f32_32x32x16_bf16 v[64:79], v[44:47], v[112:115], 0
    s_waitcnt lgkmcnt(4)
    ds_read_b64_tr_b16 v[96:97], v3 offset:8192
    ds_read_b64_tr_b16 v[98:99], v3 offset:8704
    v_mfma_f32_32x32x16_bf16 v[64:79], v[48:51], v[116:119], v[64:79]
    s_waitcnt lgkmcnt(4)
    ds_read_b64_tr_b16 v[100:101], v3 offset:10240
    ds_read_b64_tr_b16 v[102:103], v3 offset:10752
    v_mfma_f32_32x32x16_bf16 v[64:79], v[52:55], v[120:123], v[64:79]
    ds_write_b128 v19, v[36:39] offset:0
    s_waitcnt lgkmcnt(5)
    ds_read_b64_tr_b16 v[44:45], v3 offset:12288
    ds_read_b64_tr_b16 v[46:47], v3 offset:12800
    v_mfma_f32_32x32x16_bf16 v[64:79], v[56:59], v[124:127], v[64:79]
    s_waitcnt lgkmcnt(5)
    ds_read_b64_tr_b16 v[48:49], v3 offset:14336
    ds_read_b64_tr_b16 v[50:51], v3 offset:14848
    v_mfma_f32_32x32x16_bf16 v[64:79], v[96:99], v[128:131], v[64:79]
    ds_write_b128 v19, v[40:43] offset:32
    s_waitcnt lgkmcnt(6)
    ds_read_b64_tr_b16 v[52:53], v3 offset:16384
    ds_read_b64_tr_b16 v[54:55], v3 offset:16896
    v_mfma_f32_32x32x16_bf16 v[64:79], v[100:103], v[132:135], v[64:79]
    s_waitcnt lgkmcnt(5)
    ds_read_b64_tr_b16 v[56:57], v3 offset:18432
    ds_read_b64_tr_b16 v[58:59], v3 offset:18944
    v_mfma_f32_32x32x16_bf16 v[64:79], v[44:47], v[136:139], v[64:79]
    s_waitcnt lgkmcnt(5)
    ds_read_b64_tr_b16 v[96:97], v3 offset:20480
    ds_read_b64_tr_b16 v[98:99], v3 offset:20992
    v_mfma_f32_32x32x16_bf16 v[64:79], v[48:51], v[140:143], v[64:79]
    s_waitcnt lgkmcnt(4)
    ds_read_b64_tr_b16 v[100:101], v3 offset:22528
    ds_read_b64_tr_b16 v[102:103], v3 offset:23040
    v_mfma_f32_32x32x16_bf16 v[64:79], v[52:55], v[144:147], v[64:79]
    s_waitcnt lgkmcnt(4)
    v_mfma_f32_32x32x16_bf16 v[64:79], v[56:59], v[148:151], v[64:79]
    s_waitcnt lgkmcnt(0)
    s_barrier
    ds_read_b64_tr_b16 v[44:45], v3 offset:24576
    ds_read_b64_tr_b16 v[46:47], v3 offset:25088
    ds_read_b64_tr_b16 v[48:49], v3 offset:26624
    ds_read_b64_tr_b16 v[50:51], v3 offset:27136
    v_mfma_f32_32x32x16_bf16 v[64:79], v[96:99], v[152:155], v[64:79]
    s_add_u32 m0, s42, 49152
    s_add_u32 s46, s40, 1764864
    buffer_load_dwordx4 v5, s[12:15], s46 offen lds
    ds_read_b64_tr_b16 v[52:53], v3 offset:28672
    ds_read_b64_tr_b16 v[54:55], v3 offset:29184
    v_mfma_f32_32x32x16_bf16 v[64:79], v[100:103], v[156:159], v[64:79]
    s_waitcnt lgkmcnt(4)
    ds_read_b64_tr_b16 v[56:57], v3 offset:30720
    ds_read_b64_tr_b16 v[58:59], v3 offset:31232
    v_mfma_f32_32x32x16_bf16 v[64:79], v[44:47], v[160:163], v[64:79]
    buffer_load_dwordx4 v104, s[12:15], s46 offen offset:1024 lds
    s_waitcnt lgkmcnt(4)
    ds_read_b64_tr_b16 v[96:97], v3 offset:32768
    ds_read_b64_tr_b16 v[98:99], v3 offset:33280
    v_mfma_f32_32x32x16_bf16 v[64:79], v[48:51], v[164:167], v[64:79]
    s_waitcnt lgkmcnt(4)
    ds_read_b64_tr_b16 v[100:101], v3 offset:34816
    ds_read_b64_tr_b16 v[102:103], v3 offset:35328
    v_mfma_f32_32x32x16_bf16 v[64:79], v[52:55], v[168:171], v[64:79]
    s_add_u32 m0, s42, 57344
    s_add_u32 s46, s40, 2354688
    buffer_load_dwordx4 v5, s[12:15], s46 offen lds
    s_waitcnt lgkmcnt(4)
    ds_read_b64_tr_b16 v[44:45], v3 offset:36864
    ds_read_b64_tr_b16 v[46:47], v3 offset:37376
    v_mfma_f32_32x32x16_bf16 v[64:79], v[56:59], v[172:175], v[64:79]
    s_waitcnt lgkmcnt(4)
    ds_read_b64_tr_b16 v[48:49], v3 offset:38912
    ds_read_b64_tr_b16 v[50:51], v3 offset:39424
    v_mfma_f32_32x32x16_bf16 v[64:79], v[96:99], v[176:179], v[64:79]
    buffer_load_dwordx4 v104, s[12:15], s46 offen offset:1024 lds
    s_waitcnt lgkmcnt(4)
    ds_read_b64_tr_b16 v[52:53], v3 offset:40960
    ds_read_b64_tr_b16 v[54:55], v3 offset:41472
    v_mfma_f32_32x32x16_bf16 v[64:79], v[100:103], v[180:183], v[64:79]
    s_waitcnt lgkmcnt(4)
    ds_read_b64_tr_b16 v[56:57], v3 offset:43008
    ds_read_b64_tr_b16 v[58:59], v3 offset:43520
    v_mfma_f32_32x32x16_bf16 v[64:79], v[44:47], v[184:187], v[64:79]
    s_add_u32 m0, s42, 65536
    s_add_u32 s46, s40, 2944512
    buffer_load_dwordx4 v5, s[12:15], s46 offen lds
    s_waitcnt lgkmcnt(4)
    ds_read_b64_tr_b16 v[96:97], v3 offset:45056
    ds_read_b64_tr_b16 v[98:99], v3 offset:45568
    v_mfma_f32_32x32x16_bf16 v[64:79], v[48:51], v[188:191], v[64:79]
    s_waitcnt lgkmcnt(4)
    ds_read_b64_tr_b16 v[100:101], v3 offset:47104
    ds_read_b64_tr_b16 v[102:103], v3 offset:47616
    v_mfma_f32_32x32x16_bf16 v[64:79], v[52:55], v[192:195], v[64:79]
    buffer_load_dwordx4 v104, s[12:15], s46 offen offset:1024 lds
    s_waitcnt lgkmcnt(4)
    v_mfma_f32_32x32x16_bf16 v[64:79], v[56:59], v[196:199], v[64:79]
    s_waitcnt lgkmcnt(0)
    s_barrier
    ds_read_b64_tr_b16 v[44:45], v1 offset:0
    ds_read_b64_tr_b16 v[46:47], v1 offset:512
    ds_read_b64_tr_b16 v[48:49], v1 offset:2048
    ds_read_b64_tr_b16 v[50:51], v1 offset:2560
    v_mfma_f32_32x32x16_bf16 v[64:79], v[96:99], v[200:203], v[64:79]
    s_add_u32 m0, s42, 73728
    s_add_u32 s46, s40, 3534336
    buffer_load_dwordx4 v5, s[12:15], s46 offen lds
    ds_read_b64_tr_b16 v[52:53], v1 offset:4096
    ds_read_b64_tr_b16 v[54:55], v1 offset:4608
    v_mfma_f32_32x32x16_bf16 v[64:79], v[100:103], v[204:207], v[64:79]
    s_waitcnt lgkmcnt(4)
    ds_read_b64_tr_b16 v[56:57], v1 offset:6144
    ds_read_b64_tr_b16 v[58:59], v1 offset:6656
    v_mfma_f32_32x32x16_bf16 v[64:79], v[44:47], v[208:211], v[64:79]
    buffer_load_dwordx4 v104, s[12:15], s46 offen offset:1024 lds
    s_waitcnt lgkmcnt(4)
    ds_read_b64_tr_b16 v[96:97], v1 offset:8192
    ds_read_b64_tr_b16 v[98:99], v1 offset:8704
    v_mfma_f32_32x32x16_bf16 v[64:79], v[48:51], v[212:215], v[64:79]
    s_waitcnt lgkmcnt(4)
    ds_read_b64_tr_b16 v[100:101], v1 offset:10240
    ds_read_b64_tr_b16 v[102:103], v1 offset:10752
    v_mfma_f32_32x32x16_bf16 v[64:79], v[52:55], v[216:219], v[64:79]
    s_add_u32 m0, s42, 81920
    s_add_u32 s46, s40, 4124160
    buffer_load_dwordx4 v5, s[12:15], s46 offen lds
    s_waitcnt lgkmcnt(4)
    ds_read_b64_tr_b16 v[44:45], v1 offset:12288
    ds_read_b64_tr_b16 v[46:47], v1 offset:12800
    v_mfma_f32_32x32x16_bf16 v[64:79], v[56:59], v[220:223], v[64:79]
    s_waitcnt lgkmcnt(4)
    ds_read_b64_tr_b16 v[48:49], v1 offset:14336
    ds_read_b64_tr_b16 v[50:51], v1 offset:14848
    v_mfma_f32_32x32x16_bf16 v[64:79], v[96:99], v[224:227], v[64:79]
    buffer_load_dwordx4 v104, s[12:15], s46 offen offset:1024 lds
    s_waitcnt lgkmcnt(4)
    ds_read_b64_tr_b16 v[52:53], v1 offset:16384
    ds_read_b64_tr_b16 v[54:55], v1 offset:16896
    v_mfma_f32_32x32x16_bf16 v[64:79], v[100:103], v[228:231], v[64:79]
    s_waitcnt lgkmcnt(4)
    ds_read_b64_tr_b16 v[56:57], v1 offset:18432
    ds_read_b64_tr_b16 v[58:59], v1 offset:18944
    v_mfma_f32_32x32x16_bf16 v[64:79], v[44:47], v[232:235], v[64:79]
    s_add_u32 m0, s42, 90112
    s_add_u32 s46, s40, 4713984
    buffer_load_dwordx4 v5, s[12:15], s46 offen lds
    ds_read_b64 v[28:29], v17 offset:1024
    s_waitcnt lgkmcnt(5)
    ds_read_b64_tr_b16 v[96:97], v1 offset:20480
    ds_read_b64_tr_b16 v[98:99], v1 offset:20992
    v_mfma_f32_32x32x16_bf16 v[64:79], v[48:51], v[236:239], v[64:79]
    s_waitcnt lgkmcnt(5)
    ds_read_b64_tr_b16 v[100:101], v1 offset:22528
    ds_read_b64_tr_b16 v[102:103], v1 offset:23040
    v_mfma_f32_32x32x16_bf16 v[64:79], v[52:55], v[240:243], v[64:79]
    buffer_load_dwordx4 v104, s[12:15], s46 offen offset:1024 lds
    s_waitcnt lgkmcnt(5)
    v_mfma_f32_32x32x16_bf16 v[64:79], v[56:59], v[244:247], v[64:79]
    s_waitcnt lgkmcnt(2)
    v_mfma_f32_32x32x16_bf16 v[64:79], v[96:99], v[248:251], v[64:79]
    s_waitcnt lgkmcnt(0)
    v_mfma_f32_32x32x16_bf16 v[64:79], v[100:103], v[252:255], v[64:79]
    v_mfma_f32_32x32x16_bf16 v[64:79], v[28:31], v[24:27], v[64:79]
    s_setprio 0
    s_barrier
    v_mul_f32 v32, v80, v80
    v_mul_f32 v33, v81, v81
    v_mul_f32 v34, v82, v82
    v_mul_f32 v35, v83, v83
    v_mul_f32 v6, v84, v84
    v_mul_f32 v16, v85, v85
    v_mul_f32 v22, v86, v86
    v_mul_f32 v23, v87, v87
    v_fma_f32 v32, v32, v15, v14
    v_fma_f32 v33, v33, v15, v14
    v_fma_f32 v34, v34, v15, v14
    v_fma_f32 v35, v35, v15, v14
    v_fma_f32 v6, v6, v15, v14
    v_fma_f32 v16, v16, v15, v14
    v_fma_f32 v22, v22, v15, v14
    v_fma_f32 v23, v23, v15, v14
    v_mul_f32 v32, v32, v80
    v_mul_f32 v33, v33, v81
    v_mul_f32 v34, v34, v82
    v_mul_f32 v35, v35, v83
    v_mul_f32 v6, v6, v84
    v_mul_f32 v16, v16, v85
    v_mul_f32 v22, v22, v86
    v_mul_f32 v23, v23, v87
    v_exp_f32 v32, v32
    v_exp_f32 v33, v33
    v_exp_f32 v34, v34
    v_exp_f32 v35, v35
    v_exp_f32 v6, v6
    v_exp_f32 v16, v16
    v_exp_f32 v22, v22
    v_exp_f32 v23, v23
    v_add_f32 v32, 1.0, v32
    v_add_f32 v33, 1.0, v33
    v_add_f32 v34, 1.0, v34
    v_add_f32 v35, 1.0, v35
    v_add_f32 v6, 1.0, v6
    v_add_f32 v16, 1.0, v16
    v_add_f32 v22, 1.0, v22
    v_add_f32 v23, 1.0, v23
    v_rcp_f32 v32, v32
    v_rcp_f32 v33, v33
    v_rcp_f32 v34, v34
    v_rcp_f32 v35, v35
    v_rcp_f32 v6, v6
    v_rcp_f32 v16, v16
    v_rcp_f32 v22, v22
    v_rcp_f32 v23, v23
    s_waitcnt vmcnt(6)
    s_barrier
    v_mul_f32 v80, v80, v32
    v_mul_f32 v81, v81, v33
    v_mul_f32 v82, v82, v34
    v_mul_f32 v83, v83, v35
    v_mul_f32 v84, v84, v6
    v_mul_f32 v85, v85, v16
    v_mul_f32 v86, v86, v22
    v_mul_f32 v87, v87, v23
    v_cvt_pk_bf16_f32 v36, v80, v81
    v_cvt_pk_bf16_f32 v37, v82, v83
    v_cvt_pk_bf16_f32 v38, v84, v85
    v_cvt_pk_bf16_f32 v39, v86, v87
    v_add_f32 v61, v61, v80
    v_fmac_f32 v62, v80, v80
    v_add_f32 v7, v7, v81
    v_fmac_f32 v8, v81, v81
    v_add_f32 v61, v61, v82
    v_fmac_f32 v62, v82, v82
    v_add_f32 v7, v7, v83
    v_fmac_f32 v8, v83, v83
    v_add_f32 v61, v61, v84
    v_fmac_f32 v62, v84, v84
    v_add_f32 v7, v7, v85
    v_fmac_f32 v8, v85, v85
    v_add_f32 v61, v61, v86
    v_fmac_f32 v62, v86, v86
    v_add_f32 v7, v7, v87
    v_fmac_f32 v8, v87, v87
    v_mul_f32 v32, v88, v88
    v_mul_f32 v33, v89, v89
    v_mul_f32 v34, v90, v90
    v_mul_f32 v35, v91, v91
    v_mul_f32 v6, v92, v92
    v_mul_f32 v16, v93, v93
    v_mul_f32 v22, v94, v94
    v_mul_f32 v23, v95, v95
    v_fma_f32 v32, v32, v15, v14
    v_fma_f32 v33, v33, v15, v14
    v_fma_f32 v34, v34, v15, v14
    v_fma_f32 v35, v35, v15, v14
    v_fma_f32 v6, v6, v15, v14
    v_fma_f32 v16, v16, v15, v14
    v_fma_f32 v22, v22, v15, v14
    v_fma_f32 v23, v23, v15, v14
    v_mul_f32 v32, v32, v88
    v_mul_f32 v33, v33, v89
    v_mul_f32 v34, v34, v90
    v_mul_f32 v35, v35, v91
    v_mul_f32 v6, v6, v92
    v_mul_f32 v16, v16, v93
    v_mul_f32 v22, v22, v94
    v_mul_f32 v23, v23, v95
    v_exp_f32 v32, v32
    v_exp_f32 v33, v33
    v_exp_f32 v34, v34
    v_exp_f32 v35, v35
    v_exp_f32 v6, v6
    v_exp_f32 v16, v16
    s_waitcnt vmcnt(0)
    s_barrier
    v_exp_f32 v22, v22
    v_exp_f32 v23, v23
    v_add_f32 v32, 1.0, v32
    v_add_f32 v33, 1.0, v33
    v_add_f32 v34, 1.0, v34
    v_add_f32 v35, 1.0, v35
    v_add_f32 v6, 1.0, v6
    v_add_f32 v16, 1.0, v16
    v_add_f32 v22, 1.0, v22
    v_add_f32 v23, 1.0, v23
    v_rcp_f32 v32, v32
    v_rcp_f32 v33, v33
    v_rcp_f32 v34, v34
    v_rcp_f32 v35, v35
    v_rcp_f32 v6, v6
    v_rcp_f32 v16, v16
    v_rcp_f32 v22, v22
    v_rcp_f32 v23, v23
    v_mul_f32 v88, v88, v32
    v_mul_f32 v89, v89, v33
    v_mul_f32 v90, v90, v34
    v_mul_f32 v91, v91, v35
    v_mul_f32 v92, v92, v6
    v_mul_f32 v93, v93, v16
    v_mul_f32 v94, v94, v22
    v_mul_f32 v95, v95, v23
    v_cvt_pk_bf16_f32 v40, v88, v89
    v_cvt_pk_bf16_f32 v41, v90, v91
    v_cvt_pk_bf16_f32 v42, v92, v93
    v_cvt_pk_bf16_f32 v43, v94, v95
    v_add_f32 v61, v61, v88
    v_fmac_f32 v62, v88, v88
    v_add_f32 v7, v7, v89
    v_fmac_f32 v8, v89, v89
    v_add_f32 v61, v61, v90
    v_fmac_f32 v62, v90, v90
    v_add_f32 v7, v7, v91
    v_fmac_f32 v8, v91, v91
    v_add_f32 v61, v61, v92
    v_fmac_f32 v62, v92, v92
    v_add_f32 v7, v7, v93
    v_fmac_f32 v8, v93, v93
    v_add_f32 v61, v61, v94
    v_fmac_f32 v62, v94, v94
    v_add_f32 v7, v7, v95
    v_fmac_f32 v8, v95, v95
    ds_read_b64_tr_b16 v[44:45], v1 offset:24576
    ds_read_b64_tr_b16 v[46:47], v1 offset:25088
    ds_read_b64_tr_b16 v[48:49], v1 offset:26624
    ds_read_b64_tr_b16 v[50:51], v1 offset:27136
    ds_read_b64_tr_b16 v[52:53], v1 offset:28672
    ds_read_b64_tr_b16 v[54:55], v1 offset:29184
    s_barrier
    s_setprio 1
    s_waitcnt lgkmcnt(4)
    ds_read_b64_tr_b16 v[56:57], v1 offset:30720
    ds_read_b64_tr_b16 v[58:59], v1 offset:31232
    v_mfma_f32_32x32x16_bf16 v[80:95], v[44:47], v[112:115], 0
    s_waitcnt lgkmcnt(4)
    ds_read_b64_tr_b16 v[96:97], v1 offset:32768
    ds_read_b64_tr_b16 v[98:99], v1 offset:33280
    v_mfma_f32_32x32x16_bf16 v[80:95], v[48:51], v[116:119], v[80:95]
    s_waitcnt lgkmcnt(4)
    ds_read_b64_tr_b16 v[100:101], v1 offset:34816
    ds_read_b64_tr_b16 v[102:103], v1 offset:35328
    v_mfma_f32_32x32x16_bf16 v[80:95], v[52:55], v[120:123], v[80:95]
    ds_write_b128 v19, v[36:39] offset:64
    s_waitcnt lgkmcnt(5)
    ds_read_b64_tr_b16 v[44:45], v1 offset:36864
    ds_read_b64_tr_b16 v[46:47], v1 offset:37376
    v_mfma_f32_32x32x16_bf16 v[80:95], v[56:59], v[124:127], v[80:95]
    s_waitcnt lgkmcnt(5)
    ds_read_b64_tr_b16 v[48:49], v1 offset:38912
    ds_read_b64_tr_b16 v[50:51], v1 offset:39424
    v_mfma_f32_32x32x16_bf16 v[80:95], v[96:99], v[128:131], v[80:95]
    ds_write_b128 v19, v[40:43] offset:96
    s_waitcnt lgkmcnt(6)
    ds_read_b64_tr_b16 v[52:53], v1 offset:40960
    ds_read_b64_tr_b16 v[54:55], v1 offset:41472
    v_mfma_f32_32x32x16_bf16 v[80:95], v[100:103], v[132:135], v[80:95]
    s_waitcnt lgkmcnt(5)
    ds_read_b64_tr_b16 v[56:57], v1 offset:43008
    ds_read_b64_tr_b16 v[58:59], v1 offset:43520
    v_mfma_f32_32x32x16_bf16 v[80:95], v[44:47], v[136:139], v[80:95]
    s_waitcnt lgkmcnt(5)
    ds_read_b64_tr_b16 v[96:97], v1 offset:45056
    ds_read_b64_tr_b16 v[98:99], v1 offset:45568
    v_mfma_f32_32x32x16_bf16 v[80:95], v[48:51], v[140:143], v[80:95]
    s_waitcnt lgkmcnt(4)
    ds_read_b64_tr_b16 v[100:101], v1 offset:47104
    ds_read_b64_tr_b16 v[102:103], v1 offset:47616
    v_mfma_f32_32x32x16_bf16 v[80:95], v[52:55], v[144:147], v[80:95]
    s_waitcnt lgkmcnt(4)
    v_mfma_f32_32x32x16_bf16 v[80:95], v[56:59], v[148:151], v[80:95]
    s_waitcnt lgkmcnt(0)
    s_barrier
    ds_read_b64_tr_b16 v[44:45], v3 offset:0
    ds_read_b64_tr_b16 v[46:47], v3 offset:512
    ds_read_b64_tr_b16 v[48:49], v3 offset:2048
    ds_read_b64_tr_b16 v[50:51], v3 offset:2560
    v_mfma_f32_32x32x16_bf16 v[80:95], v[96:99], v[152:155], v[80:95]
    s_add_u32 m0, s42, 24576
    s_add_u32 s46, s40, 1764992
    buffer_load_dwordx4 v5, s[12:15], s46 offen lds
    ds_read_b64_tr_b16 v[52:53], v3 offset:4096
    ds_read_b64_tr_b16 v[54:55], v3 offset:4608
    v_mfma_f32_32x32x16_bf16 v[80:95], v[100:103], v[156:159], v[80:95]
    s_waitcnt lgkmcnt(4)
    ds_read_b64_tr_b16 v[56:57], v3 offset:6144
    ds_read_b64_tr_b16 v[58:59], v3 offset:6656
    v_mfma_f32_32x32x16_bf16 v[80:95], v[44:47], v[160:163], v[80:95]
    buffer_load_dwordx4 v104, s[12:15], s46 offen offset:1024 lds
    s_waitcnt lgkmcnt(4)
    ds_read_b64_tr_b16 v[96:97], v3 offset:8192
    ds_read_b64_tr_b16 v[98:99], v3 offset:8704
    v_mfma_f32_32x32x16_bf16 v[80:95], v[48:51], v[164:167], v[80:95]
    s_waitcnt lgkmcnt(4)
    ds_read_b64_tr_b16 v[100:101], v3 offset:10240
    ds_read_b64_tr_b16 v[102:103], v3 offset:10752
    v_mfma_f32_32x32x16_bf16 v[80:95], v[52:55], v[168:171], v[80:95]
    s_add_u32 m0, s42, 32768
    s_add_u32 s46, s40, 2354816
    buffer_load_dwordx4 v5, s[12:15], s46 offen lds
    s_waitcnt lgkmcnt(4)
    ds_read_b64_tr_b16 v[44:45], v3 offset:12288
    ds_read_b64_tr_b16 v[46:47], v3 offset:12800
    v_mfma_f32_32x32x16_bf16 v[80:95], v[56:59], v[172:175], v[80:95]
    s_waitcnt lgkmcnt(4)
    ds_read_b64_tr_b16 v[48:49], v3 offset:14336
    ds_read_b64_tr_b16 v[50:51], v3 offset:14848
    v_mfma_f32_32x32x16_bf16 v[80:95], v[96:99], v[176:179], v[80:95]
    buffer_load_dwordx4 v104, s[12:15], s46 offen offset:1024 lds
    s_waitcnt lgkmcnt(4)
    ds_read_b64_tr_b16 v[52:53], v3 offset:16384
    ds_read_b64_tr_b16 v[54:55], v3 offset:16896
    v_mfma_f32_32x32x16_bf16 v[80:95], v[100:103], v[180:183], v[80:95]
    s_waitcnt lgkmcnt(4)
    ds_read_b64_tr_b16 v[56:57], v3 offset:18432
    ds_read_b64_tr_b16 v[58:59], v3 offset:18944
    v_mfma_f32_32x32x16_bf16 v[80:95], v[44:47], v[184:187], v[80:95]
    s_add_u32 m0, s42, 40960
    s_add_u32 s46, s40, 2944640
    buffer_load_dwordx4 v5, s[12:15], s46 offen lds
    s_waitcnt lgkmcnt(4)
    ds_read_b64_tr_b16 v[96:97], v3 offset:20480
    ds_read_b64_tr_b16 v[98:99], v3 offset:20992
    v_mfma_f32_32x32x16_bf16 v[80:95], v[48:51], v[188:191], v[80:95]
    s_waitcnt lgkmcnt(4)
    ds_read_b64_tr_b16 v[100:101], v3 offset:22528
    ds_read_b64_tr_b16 v[102:103], v3 offset:23040
    v_mfma_f32_32x32x16_bf16 v[80:95], v[52:55], v[192:195], v[80:95]
    buffer_load_dwordx4 v104, s[12:15], s46 offen offset:1024 lds
    s_waitcnt lgkmcnt(4)
    v_mfma_f32_32x32x16_bf16 v[80:95], v[56:59], v[196:199], v[80:95]
    s_waitcnt lgkmcnt(0)
    s_barrier
    ds_read_b64_tr_b16 v[44:45], v3 offset:24576
    ds_read_b64_tr_b16 v[46:47], v3 offset:25088
    ds_read_b64_tr_b16 v[48:49], v3 offset:26624
    ds_read_b64_tr_b16 v[50:51], v3 offset:27136
    v_mfma_f32_32x32x16_bf16 v[80:95], v[96:99], v[200:203], v[80:95]
    s_add_u32 m0, s42, 49152
    s_add_u32 s46, s40, 3534464
    buffer_load_dwordx4 v5, s[12:15], s46 offen lds
    ds_read_b64_tr_b16 v[52:53], v3 offset:28672
    ds_read_b64_tr_b16 v[54:55], v3 offset:29184
    v_mfma_f32_32x32x16_bf16 v[80:95], v[100:103], v[204:207], v[80:95]
    s_waitcnt lgkmcnt(4)
    ds_read_b64_tr_b16 v[56:57], v3 offset:30720
    ds_read_b64_tr_b16 v[58:59], v3 offset:31232
    v_mfma_f32_32x32x16_bf16 v[80:95], v[44:47], v[208:211], v[80:95]
    buffer_load_dwordx4 v104, s[12:15], s46 offen offset:1024 lds
    s_waitcnt lgkmcnt(4)
    ds_read_b64_tr_b16 v[96:97], v3 offset:32768
    ds_read_b64_tr_b16 v[98:99], v3 offset:33280
    v_mfma_f32_32x32x16_bf16 v[80:95], v[48:51], v[212:215], v[80:95]
    s_waitcnt lgkmcnt(4)
    ds_read_b64_tr_b16 v[100:101], v3 offset:34816
    ds_read_b64_tr_b16 v[102:103], v3 offset:35328
    v_mfma_f32_32x32x16_bf16 v[80:95], v[52:55], v[216:219], v[80:95]
    s_add_u32 m0, s42, 57344
    s_add_u32 s46, s40, 4124288
    buffer_load_dwordx4 v5, s[12:15], s46 offen lds
    s_waitcnt lgkmcnt(4)
    ds_read_b64_tr_b16 v[44:45], v3 offset:36864
    ds_read_b64_tr_b16 v[46:47], v3 offset:37376
    v_mfma_f32_32x32x16_bf16 v[80:95], v[56:59], v[220:223], v[80:95]
    s_waitcnt lgkmcnt(4)
    ds_read_b64_tr_b16 v[48:49], v3 offset:38912
    ds_read_b64_tr_b16 v[50:51], v3 offset:39424
    v_mfma_f32_32x32x16_bf16 v[80:95], v[96:99], v[224:227], v[80:95]
    buffer_load_dwordx4 v104, s[12:15], s46 offen offset:1024 lds
    s_waitcnt lgkmcnt(4)
    ds_read_b64_tr_b16 v[52:53], v3 offset:40960
    ds_read_b64_tr_b16 v[54:55], v3 offset:41472
    v_mfma_f32_32x32x16_bf16 v[80:95], v[100:103], v[228:231], v[80:95]
    s_waitcnt lgkmcnt(4)
    ds_read_b64_tr_b16 v[56:57], v3 offset:43008
    ds_read_b64_tr_b16 v[58:59], v3 offset:43520
    v_mfma_f32_32x32x16_bf16 v[80:95], v[44:47], v[232:235], v[80:95]
    s_add_u32 m0, s42, 65536
    s_add_u32 s46, s40, 4714112
    buffer_load_dwordx4 v5, s[12:15], s46 offen lds
    ds_read_b64 v[28:29], v17 offset:1536
    s_waitcnt lgkmcnt(5)
    ds_read_b64_tr_b16 v[96:97], v3 offset:45056
    ds_read_b64_tr_b16 v[98:99], v3 offset:45568
    v_mfma_f32_32x32x16_bf16 v[80:95], v[48:51], v[236:239], v[80:95]
    s_waitcnt lgkmcnt(5)
    ds_read_b64_tr_b16 v[100:101], v3 offset:47104
    ds_read_b64_tr_b16 v[102:103], v3 offset:47616
    v_mfma_f32_32x32x16_bf16 v[80:95], v[52:55], v[240:243], v[80:95]
    buffer_load_dwordx4 v104, s[12:15], s46 offen offset:1024 lds
    s_waitcnt lgkmcnt(5)
    v_mfma_f32_32x32x16_bf16 v[80:95], v[56:59], v[244:247], v[80:95]
    s_waitcnt lgkmcnt(2)
    v_mfma_f32_32x32x16_bf16 v[80:95], v[96:99], v[248:251], v[80:95]
    s_waitcnt lgkmcnt(0)
    v_mfma_f32_32x32x16_bf16 v[80:95], v[100:103], v[252:255], v[80:95]
    v_mfma_f32_32x32x16_bf16 v[80:95], v[28:31], v[24:27], v[80:95]
    s_setprio 0
    s_barrier
    v_mul_f32 v32, v64, v64
    v_mul_f32 v33, v65, v65
    v_mul_f32 v34, v66, v66
    v_mul_f32 v35, v67, v67
    v_mul_f32 v6, v68, v68
    v_mul_f32 v16, v69, v69
    v_mul_f32 v22, v70, v70
    v_mul_f32 v23, v71, v71
    v_fma_f32 v32, v32, v15, v14
    v_fma_f32 v33, v33, v15, v14
    v_fma_f32 v34, v34, v15, v14
    v_fma_f32 v35, v35, v15, v14
    v_fma_f32 v6, v6, v15, v14
    v_fma_f32 v16, v16, v15, v14
    v_fma_f32 v22, v22, v15, v14
    v_fma_f32 v23, v23, v15, v14
    v_mul_f32 v32, v32, v64
    v_mul_f32 v33, v33, v65
    v_mul_f32 v34, v34, v66
    v_mul_f32 v35, v35, v67
    v_mul_f32 v6, v6, v68
    v_mul_f32 v16, v16, v69
    v_mul_f32 v22, v22, v70
    v_mul_f32 v23, v23, v71
    v_exp_f32 v32, v32
    v_exp_f32 v33, v33
    v_exp_f32 v34, v34
    v_exp_f32 v35, v35
    v_exp_f32 v6, v6
    v_exp_f32 v16, v16
    v_exp_f32 v22, v22
    v_exp_f32 v23, v23
    v_add_f32 v32, 1.0, v32
    v_add_f32 v33, 1.0, v33
    v_add_f32 v34, 1.0, v34
    v_add_f32 v35, 1.0, v35
    v_add_f32 v6, 1.0, v6
    v_add_f32 v16, 1.0, v16
    v_add_f32 v22, 1.0, v22
    v_add_f32 v23, 1.0, v23
    v_rcp_f32 v32, v32
    v_rcp_f32 v33, v33
    v_rcp_f32 v34, v34
    v_rcp_f32 v35, v35
    v_rcp_f32 v6, v6
    v_rcp_f32 v16, v16
    v_rcp_f32 v22, v22
    v_rcp_f32 v23, v23
    v_mul_f32 v64, v64, v32
    v_mul_f32 v65, v65, v33
    v_mul_f32 v66, v66, v34
    v_mul_f32 v67, v67, v35
    v_mul_f32 v68, v68, v6
    v_mul_f32 v69, v69, v16
    v_mul_f32 v70, v70, v22
    s_waitcnt vmcnt(6)
    s_barrier
    v_mul_f32 v71, v71, v23
    v_cvt_pk_bf16_f32 v36, v64, v65
    v_cvt_pk_bf16_f32 v37, v66, v67
    v_cvt_pk_bf16_f32 v38, v68, v69
    v_cvt_pk_bf16_f32 v39, v70, v71
    v_add_f32 v61, v61, v64
    v_fmac_f32 v62, v64, v64
    v_add_f32 v7, v7, v65
    v_fmac_f32 v8, v65, v65
    v_add_f32 v61, v61, v66
    v_fmac_f32 v62, v66, v66
    v_add_f32 v7, v7, v67
    v_fmac_f32 v8, v67, v67
    v_add_f32 v61, v61, v68
    v_fmac_f32 v62, v68, v68
    v_add_f32 v7, v7, v69
    v_fmac_f32 v8, v69, v69
    v_add_f32 v61, v61, v70
    v_fmac_f32 v62, v70, v70
    v_add_f32 v7, v7, v71
    v_fmac_f32 v8, v71, v71
    v_mul_f32 v32, v72, v72
    v_mul_f32 v33, v73, v73
    v_mul_f32 v34, v74, v74
    v_mul_f32 v35, v75, v75
    v_mul_f32 v6, v76, v76
    v_mul_f32 v16, v77, v77
    v_mul_f32 v22, v78, v78
    v_mul_f32 v23, v79, v79
    v_fma_f32 v32, v32, v15, v14
    v_fma_f32 v33, v33, v15, v14
    v_fma_f32 v34, v34, v15, v14
    v_fma_f32 v35, v35, v15, v14
    v_fma_f32 v6, v6, v15, v14
    v_fma_f32 v16, v16, v15, v14
    v_fma_f32 v22, v22, v15, v14
    v_fma_f32 v23, v23, v15, v14
    v_mul_f32 v32, v32, v72
    v_mul_f32 v33, v33, v73
    v_mul_f32 v34, v34, v74
    v_mul_f32 v35, v35, v75
    v_mul_f32 v6, v6, v76
    v_mul_f32 v16, v16, v77
    v_mul_f32 v22, v22, v78
    v_mul_f32 v23, v23, v79
    v_exp_f32 v32, v32
    v_exp_f32 v33, v33
    v_exp_f32 v34, v34
    v_exp_f32 v35, v35
    v_exp_f32 v6, v6
    v_exp_f32 v16, v16
    v_exp_f32 v22, v22
    v_exp_f32 v23, v23
    v_add_f32 v32, 1.0, v32
    v_add_f32 v33, 1.0, v33
    v_add_f32 v34, 1.0, v34
    v_add_f32 v35, 1.0, v35
    v_add_f32 v6, 1.0, v6
    v_add_f32 v16, 1.0, v16
    v_add_f32 v22, 1.0, v22
    v_add_f32 v23, 1.0, v23
    v_rcp_f32 v32, v32
    s_waitcnt vmcnt(0)
    s_barrier
    v_rcp_f32 v33, v33
    v_rcp_f32 v34, v34
    v_rcp_f32 v35, v35
    v_rcp_f32 v6, v6
    v_rcp_f32 v16, v16
    v_rcp_f32 v22, v22
    v_rcp_f32 v23, v23
    v_mul_f32 v72, v72, v32
    v_mul_f32 v73, v73, v33
    v_mul_f32 v74, v74, v34
    v_mul_f32 v75, v75, v35
    v_mul_f32 v76, v76, v6
    v_mul_f32 v77, v77, v16
    v_mul_f32 v78, v78, v22
    v_mul_f32 v79, v79, v23
    v_cvt_pk_bf16_f32 v40, v72, v73
    v_cvt_pk_bf16_f32 v41, v74, v75
    v_cvt_pk_bf16_f32 v42, v76, v77
    v_cvt_pk_bf16_f32 v43, v78, v79
    v_add_f32 v61, v61, v72
    v_fmac_f32 v62, v72, v72
    v_add_f32 v7, v7, v73
    v_fmac_f32 v8, v73, v73
    v_add_f32 v61, v61, v74
    v_fmac_f32 v62, v74, v74
    v_add_f32 v7, v7, v75
    v_fmac_f32 v8, v75, v75
    v_add_f32 v61, v61, v76
    v_fmac_f32 v62, v76, v76
    v_add_f32 v7, v7, v77
    v_fmac_f32 v8, v77, v77
    v_add_f32 v61, v61, v78
    v_fmac_f32 v62, v78, v78
    v_add_f32 v7, v7, v79
    v_fmac_f32 v8, v79, v79
    v_add_f32 v61, v61, v7
    v_add_f32 v62, v62, v8
    v_mov_b32 v7, v61
    v_mov_b32 v8, v62
    s_nop 1
    v_permlane32_swap_b32 v61, v7
    v_permlane32_swap_b32 v62, v8
    s_nop 1
    v_add_f32 v8, v62, v8
    v_add_f32 v7, v61, v7
    v_mul_f32 v10, v12, v8
    v_mul_f32 v8, v12, v7
    v_mul_f32 v10, v12, v10
    s_lshl_b32 s39, s36, 8
    s_add_u32 s39, s39, 156672
    v_lshrrev_b32 v63, 1, v21
    v_add_u32 v63, s39, v63
    ds_read_b64 v[106:107], v63 offset:256
    v_mov_b32 v9, v60
    v_mov_b32 v11, v60
    s_waitcnt lgkmcnt(0)
    v_add_f32 v8, v8, v106
    v_add_f32 v10, v10, v107
    buffer_store_dwordx4 v[8:11], v21, s[20:23], s56 offen sc1
    ds_read_b64_tr_b16 v[44:45], v1 offset:0
    ds_read_b64_tr_b16 v[46:47], v1 offset:512
    ds_read_b64_tr_b16 v[48:49], v1 offset:2048
    ds_read_b64_tr_b16 v[50:51], v1 offset:2560
    ds_read_b64_tr_b16 v[52:53], v1 offset:4096
    ds_read_b64_tr_b16 v[54:55], v1 offset:4608
    s_barrier
    s_setprio 1
    s_waitcnt lgkmcnt(4)
    ds_read_b64_tr_b16 v[56:57], v1 offset:6144
    ds_read_b64_tr_b16 v[58:59], v1 offset:6656
    v_mfma_f32_32x32x16_bf16 v[64:79], v[44:47], v[112:115], 0
    s_waitcnt lgkmcnt(4)
    ds_read_b64_tr_b16 v[96:97], v1 offset:8192
    ds_read_b64_tr_b16 v[98:99], v1 offset:8704
    v_mfma_f32_32x32x16_bf16 v[64:79], v[48:51], v[116:119], v[64:79]
    s_waitcnt lgkmcnt(4)
    ds_read_b64_tr_b16 v[100:101], v1 offset:10240
    ds_read_b64_tr_b16 v[102:103], v1 offset:10752
    v_mfma_f32_32x32x16_bf16 v[64:79], v[52:55], v[120:123], v[64:79]
    ds_write_b128 v19, v[36:39] offset:128
    s_waitcnt lgkmcnt(5)
    ds_read_b64_tr_b16 v[44:45], v1 offset:12288
    ds_read_b64_tr_b16 v[46:47], v1 offset:12800
    v_mfma_f32_32x32x16_bf16 v[64:79], v[56:59], v[124:127], v[64:79]
    s_waitcnt lgkmcnt(5)
    ds_read_b64_tr_b16 v[48:49], v1 offset:14336
    ds_read_b64_tr_b16 v[50:51], v1 offset:14848
    v_mfma_f32_32x32x16_bf16 v[64:79], v[96:99], v[128:131], v[64:79]
    ds_write_b128 v19, v[40:43] offset:160
    s_waitcnt lgkmcnt(6)
    ds_read_b64_tr_b16 v[52:53], v1 offset:16384
    ds_read_b64_tr_b16 v[54:55], v1 offset:16896
    v_mfma_f32_32x32x16_bf16 v[64:79], v[100:103], v[132:135], v[64:79]
    s_waitcnt lgkmcnt(5)
    ds_read_b64_tr_b16 v[56:57], v1 offset:18432
    ds_read_b64_tr_b16 v[58:59], v1 offset:18944
    v_mfma_f32_32x32x16_bf16 v[64:79], v[44:47], v[136:139], v[64:79]
    s_waitcnt lgkmcnt(5)
    ds_read_b64_tr_b16 v[96:97], v1 offset:20480
    ds_read_b64_tr_b16 v[98:99], v1 offset:20992
    v_mfma_f32_32x32x16_bf16 v[64:79], v[48:51], v[140:143], v[64:79]
    s_waitcnt lgkmcnt(4)
    ds_read_b64_tr_b16 v[100:101], v1 offset:22528
    ds_read_b64_tr_b16 v[102:103], v1 offset:23040
    v_mfma_f32_32x32x16_bf16 v[64:79], v[52:55], v[144:147], v[64:79]
    s_waitcnt lgkmcnt(4)
    v_mfma_f32_32x32x16_bf16 v[64:79], v[56:59], v[148:151], v[64:79]
    s_waitcnt lgkmcnt(0)
    s_barrier
    ds_read_b64_tr_b16 v[44:45], v1 offset:24576
    ds_read_b64_tr_b16 v[46:47], v1 offset:25088
    ds_read_b64_tr_b16 v[48:49], v1 offset:26624
    ds_read_b64_tr_b16 v[50:51], v1 offset:27136
    v_mfma_f32_32x32x16_bf16 v[64:79], v[96:99], v[152:155], v[64:79]
    s_add_u32 m0, s42, 0
    s_add_u32 s46, s40, 1765120
    buffer_load_dwordx4 v5, s[12:15], s46 offen lds
    ds_read_b64_tr_b16 v[52:53], v1 offset:28672
    ds_read_b64_tr_b16 v[54:55], v1 offset:29184
    v_mfma_f32_32x32x16_bf16 v[64:79], v[100:103], v[156:159], v[64:79]
    s_waitcnt lgkmcnt(4)
    ds_read_b64_tr_b16 v[56:57], v1 offset:30720
    ds_read_b64_tr_b16 v[58:59], v1 offset:31232
    v_mfma_f32_32x32x16_bf16 v[64:79], v[44:47], v[160:163], v[64:79]
    buffer_load_dwordx4 v104, s[12:15], s46 offen offset:1024 lds
    s_waitcnt lgkmcnt(4)
    ds_read_b64_tr_b16 v[96:97], v1 offset:32768
    ds_read_b64_tr_b16 v[98:99], v1 offset:33280
    v_mfma_f32_32x32x16_bf16 v[64:79], v[48:51], v[164:167], v[64:79]
    s_waitcnt lgkmcnt(4)
    ds_read_b64_tr_b16 v[100:101], v1 offset:34816
    ds_read_b64_tr_b16 v[102:103], v1 offset:35328
    v_mfma_f32_32x32x16_bf16 v[64:79], v[52:55], v[168:171], v[64:79]
    s_add_u32 m0, s42, 8192
    s_add_u32 s46, s40, 2354944
    buffer_load_dwordx4 v5, s[12:15], s46 offen lds
    s_waitcnt lgkmcnt(4)
    ds_read_b64_tr_b16 v[44:45], v1 offset:36864
    ds_read_b64_tr_b16 v[46:47], v1 offset:37376
    v_mfma_f32_32x32x16_bf16 v[64:79], v[56:59], v[172:175], v[64:79]
    s_waitcnt lgkmcnt(4)
    ds_read_b64_tr_b16 v[48:49], v1 offset:38912
    ds_read_b64_tr_b16 v[50:51], v1 offset:39424
    v_mfma_f32_32x32x16_bf16 v[64:79], v[96:99], v[176:179], v[64:79]
    buffer_load_dwordx4 v104, s[12:15], s46 offen offset:1024 lds
    s_waitcnt lgkmcnt(4)
    ds_read_b64_tr_b16 v[52:53], v1 offset:40960
    ds_read_b64_tr_b16 v[54:55], v1 offset:41472
    v_mfma_f32_32x32x16_bf16 v[64:79], v[100:103], v[180:183], v[64:79]
    s_waitcnt lgkmcnt(4)
    ds_read_b64_tr_b16 v[56:57], v1 offset:43008
    ds_read_b64_tr_b16 v[58:59], v1 offset:43520
    v_mfma_f32_32x32x16_bf16 v[64:79], v[44:47], v[184:187], v[64:79]
    s_add_u32 m0, s42, 16384
    s_add_u32 s46, s40, 2944768
    buffer_load_dwordx4 v5, s[12:15], s46 offen lds
    s_waitcnt lgkmcnt(4)
    ds_read_b64_tr_b16 v[96:97], v1 offset:45056
    ds_read_b64_tr_b16 v[98:99], v1 offset:45568
    v_mfma_f32_32x32x16_bf16 v[64:79], v[48:51], v[188:191], v[64:79]
    s_waitcnt lgkmcnt(4)
    ds_read_b64_tr_b16 v[100:101], v1 offset:47104
    ds_read_b64_tr_b16 v[102:103], v1 offset:47616
    v_mfma_f32_32x32x16_bf16 v[64:79], v[52:55], v[192:195], v[64:79]
    buffer_load_dwordx4 v104, s[12:15], s46 offen offset:1024 lds
    s_waitcnt lgkmcnt(4)
    v_mfma_f32_32x32x16_bf16 v[64:79], v[56:59], v[196:199], v[64:79]
    s_waitcnt lgkmcnt(0)
    s_barrier
    ds_read_b64_tr_b16 v[44:45], v3 offset:0
    ds_read_b64_tr_b16 v[46:47], v3 offset:512
    ds_read_b64_tr_b16 v[48:49], v3 offset:2048
    ds_read_b64_tr_b16 v[50:51], v3 offset:2560
    v_mfma_f32_32x32x16_bf16 v[64:79], v[96:99], v[200:203], v[64:79]
    s_add_u32 m0, s42, 24576
    s_add_u32 s46, s40, 3534592
    buffer_load_dwordx4 v5, s[12:15], s46 offen lds
    ds_read_b64_tr_b16 v[52:53], v3 offset:4096
    ds_read_b64_tr_b16 v[54:55], v3 offset:4608
    v_mfma_f32_32x32x16_bf16 v[64:79], v[100:103], v[204:207], v[64:79]
    s_waitcnt lgkmcnt(4)
    ds_read_b64_tr_b16 v[56:57], v3 offset:6144
    ds_read_b64_tr_b16 v[58:59], v3 offset:6656
    v_mfma_f32_32x32x16_bf16 v[64:79], v[44:47], v[208:211], v[64:79]
    buffer_load_dwordx4 v104, s[12:15], s46 offen offset:1024 lds
    s_waitcnt lgkmcnt(4)
    ds_read_b64_tr_b16 v[96:97], v3 offset:8192
    ds_read_b64_tr_b16 v[98:99], v3 offset:8704
    v_mfma_f32_32x32x16_bf16 v[64:79], v[48:51], v[212:215], v[64:79]
    s_waitcnt lgkmcnt(4)
    ds_read_b64_tr_b16 v[100:101], v3 offset:10240
    ds_read_b64_tr_b16 v[102:103], v3 offset:10752
    v_mfma_f32_32x32x16_bf16 v[64:79], v[52:55], v[216:219], v[64:79]
    s_add_u32 m0, s42, 32768
    s_add_u32 s46, s40, 4124416
    buffer_load_dwordx4 v5, s[12:15], s46 offen lds
    s_waitcnt lgkmcnt(4)
    ds_read_b64_tr_b16 v[44:45], v3 offset:12288
    ds_read_b64_tr_b16 v[46:47], v3 offset:12800
    v_mfma_f32_32x32x16_bf16 v[64:79], v[56:59], v[220:223], v[64:79]
    s_waitcnt lgkmcnt(4)
    ds_read_b64_tr_b16 v[48:49], v3 offset:14336
    ds_read_b64_tr_b16 v[50:51], v3 offset:14848
    v_mfma_f32_32x32x16_bf16 v[64:79], v[96:99], v[224:227], v[64:79]
    buffer_load_dwordx4 v104, s[12:15], s46 offen offset:1024 lds
    s_waitcnt lgkmcnt(4)
    ds_read_b64_tr_b16 v[52:53], v3 offset:16384
    ds_read_b64_tr_b16 v[54:55], v3 offset:16896
    v_mfma_f32_32x32x16_bf16 v[64:79], v[100:103], v[228:231], v[64:79]
    s_waitcnt lgkmcnt(4)
    ds_read_b64_tr_b16 v[56:57], v3 offset:18432
    ds_read_b64_tr_b16 v[58:59], v3 offset:18944
    v_mfma_f32_32x32x16_bf16 v[64:79], v[44:47], v[232:235], v[64:79]
    s_add_u32 m0, s42, 40960
    s_add_u32 s46, s40, 4714240
    buffer_load_dwordx4 v5, s[12:15], s46 offen lds
    ds_read_b64 v[28:29], v17 offset:2048
    s_waitcnt lgkmcnt(5)
    ds_read_b64_tr_b16 v[96:97], v3 offset:20480
    ds_read_b64_tr_b16 v[98:99], v3 offset:20992
    v_mfma_f32_32x32x16_bf16 v[64:79], v[48:51], v[236:239], v[64:79]
    s_waitcnt lgkmcnt(5)
    ds_read_b64_tr_b16 v[100:101], v3 offset:22528
    ds_read_b64_tr_b16 v[102:103], v3 offset:23040
    v_mfma_f32_32x32x16_bf16 v[64:79], v[52:55], v[240:243], v[64:79]
    buffer_load_dwordx4 v104, s[12:15], s46 offen offset:1024 lds
    s_waitcnt lgkmcnt(5)
    v_mfma_f32_32x32x16_bf16 v[64:79], v[56:59], v[244:247], v[64:79]
    s_waitcnt lgkmcnt(2)
    v_mfma_f32_32x32x16_bf16 v[64:79], v[96:99], v[248:251], v[64:79]
    s_waitcnt lgkmcnt(0)
    v_mfma_f32_32x32x16_bf16 v[64:79], v[100:103], v[252:255], v[64:79]
    v_mfma_f32_32x32x16_bf16 v[64:79], v[28:31], v[24:27], v[64:79]
    s_setprio 0
    s_barrier
    v_lshrrev_b32 v63, 9, v0
    v_mul_u32_u24 v63, 12288, v63
    v_add_u32 v63, v63, v21
    s_add_u32 s45, s55, 0
    buffer_load_dwordx4 v[44:47], v63, s[20:23], s45 offen offset:0
    buffer_load_dwordx4 v[48:51], v63, s[20:23], s45 offen offset:2048
    s_add_u32 s45, s45, 4096
    buffer_load_dwordx4 v[52:55], v63, s[20:23], s45 offen offset:0
    buffer_load_dwordx4 v[56:59], v63, s[20:23], s45 offen offset:2048
    s_add_u32 s45, s45, 4096
    buffer_load_dwordx4 v[96:99], v63, s[20:23], s45 offen offset:0
    buffer_load_dwordx4 v[100:103], v63, s[20:23], s45 offen offset:2048
    v_mul_f32 v32, v80, v80
    v_mul_f32 v33, v81, v81
    v_mul_f32 v34, v82, v82
    v_mul_f32 v35, v83, v83
    v_mul_f32 v6, v84, v84
    v_mul_f32 v16, v85, v85
    v_mul_f32 v22, v86, v86
    v_mul_f32 v23, v87, v87
    v_fma_f32 v32, v32, v15, v14
    v_fma_f32 v33, v33, v15, v14
    v_fma_f32 v34, v34, v15, v14
    v_fma_f32 v35, v35, v15, v14
    v_fma_f32 v6, v6, v15, v14
    v_fma_f32 v16, v16, v15, v14
    v_fma_f32 v22, v22, v15, v14
    v_fma_f32 v23, v23, v15, v14
    v_mul_f32 v32, v32, v80
    v_mul_f32 v33, v33, v81
    v_mul_f32 v34, v34, v82
    v_mul_f32 v35, v35, v83
    v_mul_f32 v6, v6, v84
    v_mul_f32 v16, v16, v85
    v_mul_f32 v22, v22, v86
    v_mul_f32 v23, v23, v87
    v_exp_f32 v32, v32
    v_exp_f32 v33, v33
    v_exp_f32 v34, v34
    v_exp_f32 v35, v35
    v_exp_f32 v6, v6
    v_exp_f32 v16, v16
    v_exp_f32 v22, v22
    v_exp_f32 v23, v23
    v_add_f32 v32, 1.0, v32
    v_add_f32 v33, 1.0, v33
    v_add_f32 v34, 1.0, v34
    v_add_f32 v35, 1.0, v35
    v_add_f32 v6, 1.0, v6
    v_add_f32 v16, 1.0, v16
    v_add_f32 v22, 1.0, v22
    v_add_f32 v23, 1.0, v23
    v_rcp_f32 v32, v32
    v_rcp_f32 v33, v33
    v_rcp_f32 v34, v34
    v_rcp_f32 v35, v35
    v_rcp_f32 v6, v6
    v_rcp_f32 v16, v16
    v_rcp_f32 v22, v22
    s_waitcnt vmcnt(12)
    s_barrier
    v_rcp_f32 v23, v23
    v_mul_f32 v80, v80, v32
    v_mul_f32 v81, v81, v33
    v_mul_f32 v82, v82, v34
    v_mul_f32 v83, v83, v35
    v_mul_f32 v84, v84, v6
    v_mul_f32 v85, v85, v16
    v_mul_f32 v86, v86, v22
    v_mul_f32 v87, v87, v23
    v_cvt_pk_bf16_f32 v36, v80, v81
    v_cvt_pk_bf16_f32 v37, v82, v83
    v_cvt_pk_bf16_f32 v40, v84, v85
    v_cvt_pk_bf16_f32 v41, v86, v87
    v_mul_f32 v32, v88, v88
    v_mul_f32 v33, v89, v89
    v_mul_f32 v34, v90, v90
    v_mul_f32 v35, v91, v91
    v_mul_f32 v6, v92, v92
    v_mul_f32 v16, v93, v93
    v_mul_f32 v22, v94, v94
    v_mul_f32 v23, v95, v95
    v_fma_f32 v32, v32, v15, v14
    v_fma_f32 v33, v33, v15, v14
    v_fma_f32 v34, v34, v15, v14
    v_fma_f32 v35, v35, v15, v14
    v_fma_f32 v6, v6, v15, v14
    v_fma_f32 v16, v16, v15, v14
    v_fma_f32 v22, v22, v15, v14
    v_fma_f32 v23, v23, v15, v14
    v_mul_f32 v32, v32, v88
    v_mul_f32 v33, v33, v89
    v_mul_f32 v34, v34, v90
    v_mul_f32 v35, v35, v91
    v_mul_f32 v6, v6, v92
    v_mul_f32 v16, v16, v93
    v_mul_f32 v22, v22, v94
    v_mul_f32 v23, v23, v95
    v_exp_f32 v32, v32
    v_exp_f32 v33, v33
    v_exp_f32 v34, v34
    v_exp_f32 v35, v35
    v_exp_f32 v6, v6
    v_exp_f32 v16, v16
    v_exp_f32 v22, v22
    v_exp_f32 v23, v23
    v_add_f32 v32, 1.0, v32
    v_add_f32 v33, 1.0, v33
    v_add_f32 v34, 1.0, v34
    v_add_f32 v35, 1.0, v35
    v_add_f32 v6, 1.0, v6
    v_add_f32 v16, 1.0, v16
    v_add_f32 v22, 1.0, v22
    s_waitcnt vmcnt(6)
    s_barrier
    v_add_f32 v23, 1.0, v23
    v_rcp_f32 v32, v32
    v_rcp_f32 v33, v33
    v_rcp_f32 v34, v34
    v_rcp_f32 v35, v35
    v_rcp_f32 v6, v6
    v_rcp_f32 v16, v16
    v_rcp_f32 v22, v22
    v_rcp_f32 v23, v23
    v_mul_f32 v88, v88, v32
    v_mul_f32 v89, v89, v33
    v_mul_f32 v90, v90, v34
    v_mul_f32 v91, v91, v35
    v_mul_f32 v92, v92, v6
    v_mul_f32 v93, v93, v16
    v_mul_f32 v94, v94, v22
    v_mul_f32 v95, v95, v23
    v_cvt_pk_bf16_f32 v38, v88, v89
    v_cvt_pk_bf16_f32 v39, v90, v91
    v_cvt_pk_bf16_f32 v42, v92, v93
    v_cvt_pk_bf16_f32 v43, v94, v95
    s_waitcnt vmcnt(0)
    s_mov_b32 s58, 100000
parallel_sum__linear_kernel_hedgehog__mixer_gmlp__prompt_kernel_tg_205:
    v_min3_u32 v106, v45, v47, v49
    v_max3_u32 v107, v45, v47, v49
    v_min3_u32 v106, v106, v51, v53
    v_max3_u32 v107, v107, v51, v53
    v_min3_u32 v106, v106, v55, v57
    v_max3_u32 v107, v107, v55, v57
    v_min3_u32 v106, v106, v59, v97
    v_max3_u32 v107, v107, v59, v97
    v_min3_u32 v106, v106, v99, v101
    v_max3_u32 v107, v107, v99, v101
    v_min3_u32 v106, v106, v103, v103
    v_max3_u32 v107, v107, v103, v103
    v_xor_b32 v106, v106, v60
    v_xor_b32 v107, v107, v60
    v_or_b32 v106, v106, v107
    v_cmp_ne_u32 vcc, 0, v106
    s_sub_u32 s58, s58, 1
    s_cmp_eq_u32 s58, 0
    s_cbranch_scc1 parallel_sum__linear_kernel_hedgehog__mixer_gmlp__prompt_kernel_tk_206
    s_cmp_eq_u64 vcc, 0
    s_cbranch_scc1 parallel_sum__linear_kernel_hedgehog__mixer_gmlp__prompt_kernel_tk_206
    s_sleep 8
    s_add_u32 s45, s55, 0
    buffer_load_dwordx4 v[44:47], v63, s[20:23], s45 offen offset:0 sc1
    buffer_load_dwordx4 v[48:51], v63, s[20:23], s45 offen offset:2048 sc1
    s_add_u32 s45, s45, 4096
    buffer_load_dwordx4 v[52:55], v63, s[20:23], s45 offen offset:0 sc1
    buffer_load_dwordx4 v[56:59], v63, s[20:23], s45 offen offset:2048 sc1
    s_add_u32 s45, s45, 4096
    buffer_load_dwordx4 v[96:99], v63, s[20:23], s45 offen offset:0 sc1
    buffer_load_dwordx4 v[100:103], v63, s[20:23], s45 offen offset:2048 sc1
    s_waitcnt vmcnt(0)
    s_branch parallel_sum__linear_kernel_hedgehog__mixer_gmlp__prompt_kernel_tg_205
parallel_sum__linear_kernel_hedgehog__mixer_gmlp__prompt_kernel_tk_206:
    v_mov_b32 v61, v44
    v_mov_b32 v62, v46
    v_add_f32 v61, v61, v48
    v_add_f32 v62, v62, v50
    v_add_f32 v61, v61, v52
    v_add_f32 v62, v62, v54
    v_add_f32 v61, v61, v56
    v_add_f32 v62, v62, v58
    v_add_f32 v61, v61, v96
    v_add_f32 v62, v62, v98
    v_add_f32 v61, v61, v100
    v_add_f32 v62, v62, v102
    v_mov_b32 v106, v61
    v_mov_b32 v107, v62
    s_lshl_b32 s39, s36, 8
    s_add_u32 s39, s39, 155904
    v_permlane32_swap_b32 v61, v106
    v_permlane32_swap_b32 v62, v107
    v_lshrrev_b32 v63, 2, v21
    v_add_u32 v63, s39, v63
    v_add_f32 v61, v61, v106
    v_add_f32 v62, v62, v107
    v_mul_f32 v61, 971214393, v61
    v_mul_f32 v62, 971214393, v62
    v_fma_f32 v62, -v61, v61, v62
    v_max_f32 v62, 0, v62
    v_add_f32 v62, 925353388, v62
    v_rsq_f32 v62, v62
    s_nop 0
    v_mul_f32 v106, v12, v62
    v_mul_f32 v107, -v61, v62
    ds_write_b32 v63, v106
    ds_write_b32 v63, v107 offset:128
    ds_read_b64_tr_b16 v[44:45], v3 offset:24576
    ds_read_b64_tr_b16 v[46:47], v3 offset:25088
    ds_read_b64_tr_b16 v[48:49], v3 offset:26624
    ds_read_b64_tr_b16 v[50:51], v3 offset:27136
    ds_read_b64_tr_b16 v[52:53], v3 offset:28672
    ds_read_b64_tr_b16 v[54:55], v3 offset:29184
    s_waitcnt lgkmcnt(6)
    s_barrier
    s_cmp_eq_u32 s18, 0
    s_cbranch_scc1 parallel_sum__linear_kernel_hedgehog__mixer_gmlp__prompt_kernel_noq1
    s_setprio 1
    s_waitcnt lgkmcnt(4)
    ds_read_b64_tr_b16 v[56:57], v3 offset:30720
    ds_read_b64_tr_b16 v[58:59], v3 offset:31232
    v_mfma_f32_32x32x16_bf16 v[80:95], v[44:47], v[112:115], 0
    s_waitcnt lgkmcnt(4)
    ds_read_b64_tr_b16 v[96:97], v3 offset:32768
    ds_read_b64_tr_b16 v[98:99], v3 offset:33280
    v_mfma_f32_32x32x16_bf16 v[80:95], v[48:51], v[116:119], v[80:95]
    s_waitcnt lgkmcnt(4)
    ds_read_b64_tr_b16 v[100:101], v3 offset:34816
    ds_read_b64_tr_b16 v[102:103], v3 offset:35328
    v_mfma_f32_32x32x16_bf16 v[80:95], v[52:55], v[120:123], v[80:95]
    buffer_store_dwordx4 v[36:39], v20, s[20:23], s50 offen offset:0 sc1
    s_waitcnt lgkmcnt(4)
    ds_read_b64_tr_b16 v[44:45], v3 offset:36864
    ds_read_b64_tr_b16 v[46:47], v3 offset:37376
    v_mfma_f32_32x32x16_bf16 v[80:95], v[56:59], v[124:127], v[80:95]
    s_waitcnt lgkmcnt(4)
    ds_read_b64_tr_b16 v[48:49], v3 offset:38912
    ds_read_b64_tr_b16 v[50:51], v3 offset:39424
    v_mfma_f32_32x32x16_bf16 v[80:95], v[96:99], v[128:131], v[80:95]
    buffer_store_dwordx4 v[40:43], v20, s[20:23], s50 offen offset:512 sc1
    s_waitcnt lgkmcnt(4)
    ds_read_b64_tr_b16 v[52:53], v3 offset:40960
    ds_read_b64_tr_b16 v[54:55], v3 offset:41472
    v_mfma_f32_32x32x16_bf16 v[80:95], v[100:103], v[132:135], v[80:95]
    s_waitcnt lgkmcnt(4)
    ds_read_b64_tr_b16 v[56:57], v3 offset:43008
    ds_read_b64_tr_b16 v[58:59], v3 offset:43520
    v_mfma_f32_32x32x16_bf16 v[80:95], v[44:47], v[136:139], v[80:95]
    s_waitcnt lgkmcnt(4)
    ds_read_b64_tr_b16 v[96:97], v3 offset:45056
    ds_read_b64_tr_b16 v[98:99], v3 offset:45568
    v_mfma_f32_32x32x16_bf16 v[80:95], v[48:51], v[140:143], v[80:95]
    s_waitcnt lgkmcnt(4)
    ds_read_b64_tr_b16 v[100:101], v3 offset:47104
    ds_read_b64_tr_b16 v[102:103], v3 offset:47616
    v_mfma_f32_32x32x16_bf16 v[80:95], v[52:55], v[144:147], v[80:95]
    s_waitcnt lgkmcnt(4)
    v_mfma_f32_32x32x16_bf16 v[80:95], v[56:59], v[148:151], v[80:95]
    s_waitcnt lgkmcnt(0)
    s_barrier
    ds_read_b64_tr_b16 v[44:45], v1 offset:0
    ds_read_b64_tr_b16 v[46:47], v1 offset:512
    ds_read_b64_tr_b16 v[48:49], v1 offset:2048
    ds_read_b64_tr_b16 v[50:51], v1 offset:2560
    v_mfma_f32_32x32x16_bf16 v[80:95], v[96:99], v[152:155], v[80:95]
    s_add_u32 m0, s42, 73728
    s_add_u32 s46, s41, 663552
    buffer_load_dwordx4 v13, s[16:19], s46 offen lds
    ds_read_b64_tr_b16 v[52:53], v1 offset:4096
    ds_read_b64_tr_b16 v[54:55], v1 offset:4608
    v_mfma_f32_32x32x16_bf16 v[80:95], v[100:103], v[156:159], v[80:95]
    s_waitcnt lgkmcnt(4)
    ds_read_b64_tr_b16 v[56:57], v1 offset:6144
    ds_read_b64_tr_b16 v[58:59], v1 offset:6656
    v_mfma_f32_32x32x16_bf16 v[80:95], v[44:47], v[160:163], v[80:95]
    buffer_load_dwordx4 v105, s[16:19], s46 offen offset:1024 lds
    s_waitcnt lgkmcnt(4)
    ds_read_b64_tr_b16 v[96:97], v1 offset:8192
    ds_read_b64_tr_b16 v[98:99], v1 offset:8704
    v_mfma_f32_32x32x16_bf16 v[80:95], v[48:51], v[164:167], v[80:95]
    s_waitcnt lgkmcnt(4)
    ds_read_b64_tr_b16 v[100:101], v1 offset:10240
    ds_read_b64_tr_b16 v[102:103], v1 offset:10752
    v_mfma_f32_32x32x16_bf16 v[80:95], v[52:55], v[168:171], v[80:95]
    s_add_u32 m0, s42, 81920
    s_add_u32 s46, s41, 884736
    buffer_load_dwordx4 v13, s[16:19], s46 offen lds
    s_waitcnt lgkmcnt(4)
    ds_read_b64_tr_b16 v[44:45], v1 offset:12288
    ds_read_b64_tr_b16 v[46:47], v1 offset:12800
    v_mfma_f32_32x32x16_bf16 v[80:95], v[56:59], v[172:175], v[80:95]
    s_waitcnt lgkmcnt(4)
    ds_read_b64_tr_b16 v[48:49], v1 offset:14336
    ds_read_b64_tr_b16 v[50:51], v1 offset:14848
    v_mfma_f32_32x32x16_bf16 v[80:95], v[96:99], v[176:179], v[80:95]
    buffer_load_dwordx4 v105, s[16:19], s46 offen offset:1024 lds
    s_waitcnt lgkmcnt(4)
    ds_read_b64_tr_b16 v[52:53], v1 offset:16384
    ds_read_b64_tr_b16 v[54:55], v1 offset:16896
    v_mfma_f32_32x32x16_bf16 v[80:95], v[100:103], v[180:183], v[80:95]
    s_waitcnt lgkmcnt(4)
    ds_read_b64_tr_b16 v[56:57], v1 offset:18432
    ds_read_b64_tr_b16 v[58:59], v1 offset:18944
    v_mfma_f32_32x32x16_bf16 v[80:95], v[44:47], v[184:187], v[80:95]
    s_add_u32 m0, s42, 90112
    s_add_u32 s46, s41, 1105920
    buffer_load_dwordx4 v13, s[16:19], s46 offen lds
    s_waitcnt lgkmcnt(4)
    ds_read_b64_tr_b16 v[96:97], v1 offset:20480
    ds_read_b64_tr_b16 v[98:99], v1 offset:20992
    v_mfma_f32_32x32x16_bf16 v[80:95], v[48:51], v[188:191], v[80:95]
    s_waitcnt lgkmcnt(4)
    ds_read_b64_tr_b16 v[100:101], v1 offset:22528
    ds_read_b64_tr_b16 v[102:103], v1 offset:23040
    v_mfma_f32_32x32x16_bf16 v[80:95], v[52:55], v[192:195], v[80:95]
    buffer_load_dwordx4 v105, s[16:19], s46 offen offset:1024 lds
    s_waitcnt lgkmcnt(4)
    v_mfma_f32_32x32x16_bf16 v[80:95], v[56:59], v[196:199], v[80:95]
    s_waitcnt lgkmcnt(0)
    s_barrier
    ds_read_b64_tr_b16 v[44:45], v1 offset:24576
    ds_read_b64_tr_b16 v[46:47], v1 offset:25088
    ds_read_b64_tr_b16 v[48:49], v1 offset:26624
    ds_read_b64_tr_b16 v[50:51], v1 offset:27136
    v_mfma_f32_32x32x16_bf16 v[80:95], v[96:99], v[200:203], v[80:95]
    s_add_u32 m0, s42, 0
    s_add_u32 s46, s41, 1327104
    buffer_load_dwordx4 v13, s[16:19], s46 offen lds
    ds_read_b64_tr_b16 v[52:53], v1 offset:28672
    ds_read_b64_tr_b16 v[54:55], v1 offset:29184
    v_mfma_f32_32x32x16_bf16 v[80:95], v[100:103], v[204:207], v[80:95]
    s_waitcnt lgkmcnt(4)
    ds_read_b64_tr_b16 v[56:57], v1 offset:30720
    ds_read_b64_tr_b16 v[58:59], v1 offset:31232
    v_mfma_f32_32x32x16_bf16 v[80:95], v[44:47], v[208:211], v[80:95]
    buffer_load_dwordx4 v105, s[16:19], s46 offen offset:1024 lds
    s_waitcnt lgkmcnt(4)
    ds_read_b64_tr_b16 v[96:97], v1 offset:32768
    ds_read_b64_tr_b16 v[98:99], v1 offset:33280
    v_mfma_f32_32x32x16_bf16 v[80:95], v[48:51], v[212:215], v[80:95]
    s_waitcnt lgkmcnt(4)
    ds_read_b64_tr_b16 v[100:101], v1 offset:34816
    ds_read_b64_tr_b16 v[102:103], v1 offset:35328
    v_mfma_f32_32x32x16_bf16 v[80:95], v[52:55], v[216:219], v[80:95]
    s_add_u32 m0, s42, 8192
    s_add_u32 s46, s41, 1548288
    buffer_load_dwordx4 v13, s[16:19], s46 offen lds
    s_waitcnt lgkmcnt(4)
    ds_read_b64_tr_b16 v[44:45], v1 offset:36864
    ds_read_b64_tr_b16 v[46:47], v1 offset:37376
    v_mfma_f32_32x32x16_bf16 v[80:95], v[56:59], v[220:223], v[80:95]
    s_waitcnt lgkmcnt(4)
    ds_read_b64_tr_b16 v[48:49], v1 offset:38912
    ds_read_b64_tr_b16 v[50:51], v1 offset:39424
    v_mfma_f32_32x32x16_bf16 v[80:95], v[96:99], v[224:227], v[80:95]
    buffer_load_dwordx4 v105, s[16:19], s46 offen offset:1024 lds
    s_waitcnt lgkmcnt(4)
    ds_read_b64_tr_b16 v[52:53], v1 offset:40960
    ds_read_b64_tr_b16 v[54:55], v1 offset:41472
    v_mfma_f32_32x32x16_bf16 v[80:95], v[100:103], v[228:231], v[80:95]
    s_waitcnt lgkmcnt(4)
    ds_read_b64_tr_b16 v[56:57], v1 offset:43008
    ds_read_b64_tr_b16 v[58:59], v1 offset:43520
    v_mfma_f32_32x32x16_bf16 v[80:95], v[44:47], v[232:235], v[80:95]
    s_add_u32 m0, s42, 16384
    s_add_u32 s46, s41, 1769472
    buffer_load_dwordx4 v13, s[16:19], s46 offen lds
    ds_read_b64 v[28:29], v17 offset:2560
    s_waitcnt lgkmcnt(5)
    ds_read_b64_tr_b16 v[96:97], v1 offset:45056
    ds_read_b64_tr_b16 v[98:99], v1 offset:45568
    v_mfma_f32_32x32x16_bf16 v[80:95], v[48:51], v[236:239], v[80:95]
    s_waitcnt lgkmcnt(5)
    ds_read_b64_tr_b16 v[100:101], v1 offset:47104
    ds_read_b64_tr_b16 v[102:103], v1 offset:47616
    v_mfma_f32_32x32x16_bf16 v[80:95], v[52:55], v[240:243], v[80:95]
    buffer_load_dwordx4 v105, s[16:19], s46 offen offset:1024 lds
    s_waitcnt lgkmcnt(5)
    v_mfma_f32_32x32x16_bf16 v[80:95], v[56:59], v[244:247], v[80:95]
    s_waitcnt lgkmcnt(2)
    v_mfma_f32_32x32x16_bf16 v[80:95], v[96:99], v[248:251], v[80:95]
    s_waitcnt lgkmcnt(0)
    v_mfma_f32_32x32x16_bf16 v[80:95], v[100:103], v[252:255], v[80:95]
    v_mfma_f32_32x32x16_bf16 v[80:95], v[28:31], v[24:27], v[80:95]
    s_setprio 0
    s_barrier
    v_lshrrev_b32 v106, 8, v0
    v_bfe_u32 v63, v0, 6, 2
    s_lshl_b32 s39, s36, 8
    s_add_u32 s39, s39, 155904
    v_lshl_add_u32 v107, v106, 5, s39
    ds_read_b128 v[44:47], v107 offset:0
    ds_read_b128 v[48:51], v107 offset:16
    ds_read_b128 v[52:55], v107 offset:128
    ds_read_b128 v[56:59], v107 offset:144
    v_lshl_add_u32 v63, v106, 3, v63
    v_mul_u32_u24 v63, 208, v63
    v_bfe_u32 v106, v0, 4, 1
    v_lshl_add_u32 v63, v106, 4, v63
    v_bfe_u32 v106, v0, 5, 1
    v_lshl_add_u32 v63, v106, 3, v63
    s_mul_i32 s39, s3, 6656
    s_add_u32 s39, s39, 98304
    v_add_u32 v63, s39, v63
    ds_read_b64_tr_b16 v[96:97], v63 offset:0
    ds_read_b64_tr_b16 v[98:99], v63 offset:832
    ds_read_b64_tr_b16 v[100:101], v63 offset:32
    ds_read_b64_tr_b16 v[102:103], v63 offset:864
    s_waitcnt lgkmcnt(2)
    v_lshlrev_b32 v106, 16, v96
    v_and_b32 v107, 0xffff0000, v96
    v_fma_f32 v106, v106, v44, v52
    v_fma_f32 v107, v107, v45, v53
    v_cvt_pk_bf16_f32 v96, v106, v107
    v_lshlrev_b32 v8, 16, v97
    v_and_b32 v9, 0xffff0000, v97
    v_fma_f32 v8, v8, v46, v54
    v_fma_f32 v9, v9, v47, v55
    v_cvt_pk_bf16_f32 v97, v8, v9
    ds_read_b64_tr_b16 v[108:109], v63 offset:64
    ds_read_b64_tr_b16 v[110:111], v63 offset:896
    v_lshlrev_b32 v106, 16, v98
    v_and_b32 v107, 0xffff0000, v98
    v_fma_f32 v106, v106, v48, v56
    v_fma_f32 v107, v107, v49, v57
    v_cvt_pk_bf16_f32 v98, v106, v107
    v_lshlrev_b32 v8, 16, v99
    v_and_b32 v9, 0xffff0000, v99
    v_fma_f32 v8, v8, v50, v58
    v_fma_f32 v9, v9, v51, v59
    v_cvt_pk_bf16_f32 v99, v8, v9
    buffer_store_dwordx4 v[96:99], v0, s[20:23], s54 offen offset:0 sc1
    s_waitcnt lgkmcnt(2)
    v_lshlrev_b32 v106, 16, v100
    v_and_b32 v107, 0xffff0000, v100
    v_fma_f32 v106, v106, v44, v52
    v_fma_f32 v107, v107, v45, v53
    v_cvt_pk_bf16_f32 v100, v106, v107
    v_lshlrev_b32 v8, 16, v101
    v_and_b32 v9, 0xffff0000, v101
    v_fma_f32 v8, v8, v46, v54
    v_fma_f32 v9, v9, v47, v55
    v_cvt_pk_bf16_f32 v101, v8, v9
    ds_read_b64_tr_b16 v[96:97], v63 offset:96
    ds_read_b64_tr_b16 v[98:99], v63 offset:928
    v_lshlrev_b32 v106, 16, v102
    v_and_b32 v107, 0xffff0000, v102
    v_fma_f32 v106, v106, v48, v56
    v_fma_f32 v107, v107, v49, v57
    v_cvt_pk_bf16_f32 v102, v106, v107
    v_lshlrev_b32 v8, 16, v103
    v_and_b32 v9, 0xffff0000, v103
    v_fma_f32 v8, v8, v50, v58
    v_fma_f32 v9, v9, v51, v59
    v_cvt_pk_bf16_f32 v103, v8, v9
    buffer_store_dwordx4 v[100:103], v0, s[20:23], s54 offen offset:1024 sc1
    s_waitcnt lgkmcnt(2)
    v_lshlrev_b32 v106, 16, v108
    v_and_b32 v107, 0xffff0000, v108
    v_fma_f32 v106, v106, v44, v52
    v_fma_f32 v107, v107, v45, v53
    v_cvt_pk_bf16_f32 v108, v106, v107
    v_lshlrev_b32 v8, 16, v109
    v_and_b32 v9, 0xffff0000, v109
    v_fma_f32 v8, v8, v46, v54
    v_fma_f32 v9, v9, v47, v55
    v_cvt_pk_bf16_f32 v109, v8, v9
    ds_read_b64_tr_b16 v[100:101], v63 offset:128
    ds_read_b64_tr_b16 v[102:103], v63 offset:960
    v_lshlrev_b32 v106, 16, v110
    v_and_b32 v107, 0xffff0000, v110
    v_fma_f32 v106, v106, v48, v56
    v_fma_f32 v107, v107, v49, v57
    v_cvt_pk_bf16_f32 v110, v106, v107
    v_lshlrev_b32 v8, 16, v111
    v_and_b32 v9, 0xffff0000, v111
    v_fma_f32 v8, v8, v50, v58
    v_fma_f32 v9, v9, v51, v59
    v_cvt_pk_bf16_f32 v111, v8, v9
    s_add_u32 s54, s54, 4096
    buffer_store_dwordx4 v[108:111], v0, s[20:23], s54 offen offset:0 sc1
    s_waitcnt lgkmcnt(2)
    v_lshlrev_b32 v106, 16, v96
    v_and_b32 v107, 0xffff0000, v96
    v_fma_f32 v106, v106, v44, v52
    v_fma_f32 v107, v107, v45, v53
    v_cvt_pk_bf16_f32 v96, v106, v107
    v_lshlrev_b32 v8, 16, v97
    v_and_b32 v9, 0xffff0000, v97
    v_fma_f32 v8, v8, v46, v54
    v_fma_f32 v9, v9, v47, v55
    v_cvt_pk_bf16_f32 v97, v8, v9
    ds_read_b64_tr_b16 v[108:109], v63 offset:160
    ds_read_b64_tr_b16 v[110:111], v63 offset:992
    v_lshlrev_b32 v106, 16, v98
    v_and_b32 v107, 0xffff0000, v98
    v_fma_f32 v106, v106, v48, v56
    v_fma_f32 v107, v107, v49, v57
    v_cvt_pk_bf16_f32 v98, v106, v107
    v_lshlrev_b32 v8, 16, v99
    v_and_b32 v9, 0xffff0000, v99
    v_fma_f32 v8, v8, v50, v58
    v_fma_f32 v9, v9, v51, v59
    v_cvt_pk_bf16_f32 v99, v8, v9
    buffer_store_dwordx4 v[96:99], v0, s[20:23], s54 offen offset:1024 sc1
    s_waitcnt lgkmcnt(2)
    v_lshlrev_b32 v106, 16, v100
    v_and_b32 v107, 0xffff0000, v100
    v_fma_f32 v106, v106, v44, v52
    v_fma_f32 v107, v107, v45, v53
    s_waitcnt vmcnt(10)
    s_barrier
    v_cvt_pk_bf16_f32 v100, v106, v107
    v_lshlrev_b32 v8, 16, v101
    v_and_b32 v9, 0xffff0000, v101
    v_fma_f32 v8, v8, v46, v54
    v_fma_f32 v9, v9, v47, v55
    v_cvt_pk_bf16_f32 v101, v8, v9
    v_lshlrev_b32 v106, 16, v102
    v_and_b32 v107, 0xffff0000, v102
    v_fma_f32 v106, v106, v48, v56
    v_fma_f32 v107, v107, v49, v57
    v_cvt_pk_bf16_f32 v102, v106, v107
    v_lshlrev_b32 v8, 16, v103
    v_and_b32 v9, 0xffff0000, v103
    v_fma_f32 v8, v8, v50, v58
    v_fma_f32 v9, v9, v51, v59
    v_cvt_pk_bf16_f32 v103, v8, v9
    s_add_u32 s54, s54, 4096
    buffer_store_dwordx4 v[100:103], v0, s[20:23], s54 offen offset:0 sc1
    s_waitcnt lgkmcnt(0)
    v_lshlrev_b32 v106, 16, v108
    v_and_b32 v107, 0xffff0000, v108
    v_fma_f32 v106, v106, v44, v52
    v_fma_f32 v107, v107, v45, v53
    v_cvt_pk_bf16_f32 v108, v106, v107
    v_lshlrev_b32 v8, 16, v109
    v_and_b32 v9, 0xffff0000, v109
    v_fma_f32 v8, v8, v46, v54
    v_fma_f32 v9, v9, v47, v55
    v_cvt_pk_bf16_f32 v109, v8, v9
    v_lshlrev_b32 v106, 16, v110
    v_and_b32 v107, 0xffff0000, v110
    v_fma_f32 v106, v106, v48, v56
    v_fma_f32 v107, v107, v49, v57
    v_cvt_pk_bf16_f32 v110, v106, v107
    v_lshlrev_b32 v8, 16, v111
    v_and_b32 v9, 0xffff0000, v111
    v_fma_f32 v8, v8, v50, v58
    v_fma_f32 v9, v9, v51, v59
    v_cvt_pk_bf16_f32 v111, v8, v9
    buffer_store_dwordx4 v[108:111], v0, s[20:23], s54 offen offset:1024 sc1
    v_mul_f32 v32, v64, v64
    v_mul_f32 v33, v65, v65
    v_mul_f32 v34, v66, v66
    v_mul_f32 v35, v67, v67
    v_mul_f32 v6, v68, v68
    v_mul_f32 v16, v69, v69
    v_mul_f32 v22, v70, v70
    v_mul_f32 v23, v71, v71
    v_fma_f32 v32, v32, v15, v14
    v_fma_f32 v33, v33, v15, v14
    v_fma_f32 v34, v34, v15, v14
    v_fma_f32 v35, v35, v15, v14
    v_fma_f32 v6, v6, v15, v14
    v_fma_f32 v16, v16, v15, v14
    v_fma_f32 v22, v22, v15, v14
    v_fma_f32 v23, v23, v15, v14
    v_mul_f32 v32, v32, v64
    v_mul_f32 v33, v33, v65
    v_mul_f32 v34, v34, v66
    v_mul_f32 v35, v35, v67
    v_mul_f32 v6, v6, v68
    v_mul_f32 v16, v16, v69
    v_mul_f32 v22, v22, v70
    v_mul_f32 v23, v23, v71
    v_exp_f32 v32, v32
    v_exp_f32 v33, v33
    v_exp_f32 v34, v34
    v_exp_f32 v35, v35
    v_exp_f32 v6, v6
    v_exp_f32 v16, v16
    v_exp_f32 v22, v22
    v_exp_f32 v23, v23
    v_add_f32 v32, 1.0, v32
    v_add_f32 v33, 1.0, v33
    v_add_f32 v34, 1.0, v34
    v_add_f32 v35, 1.0, v35
    v_add_f32 v6, 1.0, v6
    v_add_f32 v16, 1.0, v16
    v_add_f32 v22, 1.0, v22
    v_add_f32 v23, 1.0, v23
    v_rcp_f32 v32, v32
    v_rcp_f32 v33, v33
    v_rcp_f32 v34, v34
    v_rcp_f32 v35, v35
    v_rcp_f32 v6, v6
    v_rcp_f32 v16, v16
    v_rcp_f32 v22, v22
    s_waitcnt vmcnt(6)
    s_barrier
    v_rcp_f32 v23, v23
    v_mul_f32 v64, v64, v32
    v_mul_f32 v65, v65, v33
    v_mul_f32 v66, v66, v34
    v_mul_f32 v67, v67, v35
    v_mul_f32 v68, v68, v6
    v_mul_f32 v69, v69, v16
    v_mul_f32 v70, v70, v22
    v_mul_f32 v71, v71, v23
    v_cvt_pk_bf16_f32 v36, v64, v65
    v_cvt_pk_bf16_f32 v37, v66, v67
    v_cvt_pk_bf16_f32 v40, v68, v69
    v_cvt_pk_bf16_f32 v41, v70, v71
    v_mul_f32 v32, v72, v72
    v_mul_f32 v33, v73, v73
    v_mul_f32 v34, v74, v74
    v_mul_f32 v35, v75, v75
    v_mul_f32 v6, v76, v76
    v_mul_f32 v16, v77, v77
    v_mul_f32 v22, v78, v78
    v_mul_f32 v23, v79, v79
    v_fma_f32 v32, v32, v15, v14
    v_fma_f32 v33, v33, v15, v14
    v_fma_f32 v34, v34, v15, v14
    v_fma_f32 v35, v35, v15, v14
    v_fma_f32 v6, v6, v15, v14
    v_fma_f32 v16, v16, v15, v14
    v_fma_f32 v22, v22, v15, v14
    v_fma_f32 v23, v23, v15, v14
    v_mul_f32 v32, v32, v72
    v_mul_f32 v33, v33, v73
    v_mul_f32 v34, v34, v74
    v_mul_f32 v35, v35, v75
    v_mul_f32 v6, v6, v76
    v_mul_f32 v16, v16, v77
    v_mul_f32 v22, v22, v78
    v_mul_f32 v23, v23, v79
    v_exp_f32 v32, v32
    v_exp_f32 v33, v33
    v_exp_f32 v34, v34
    v_exp_f32 v35, v35
    v_exp_f32 v6, v6
    v_exp_f32 v16, v16
    v_exp_f32 v22, v22
    v_exp_f32 v23, v23
    v_add_f32 v32, 1.0, v32
    v_add_f32 v33, 1.0, v33
    v_add_f32 v34, 1.0, v34
    v_add_f32 v35, 1.0, v35
    v_add_f32 v6, 1.0, v6
    v_add_f32 v16, 1.0, v16
    v_add_f32 v22, 1.0, v22
    v_add_f32 v23, 1.0, v23
    v_rcp_f32 v32, v32
    v_rcp_f32 v33, v33
    v_rcp_f32 v34, v34
    v_rcp_f32 v35, v35
    v_rcp_f32 v6, v6
    v_rcp_f32 v16, v16
    v_rcp_f32 v22, v22
    v_rcp_f32 v23, v23
    v_mul_f32 v72, v72, v32
    v_mul_f32 v73, v73, v33
    v_mul_f32 v74, v74, v34
    v_mul_f32 v75, v75, v35
    v_mul_f32 v76, v76, v6
    v_mul_f32 v77, v77, v16
    v_mul_f32 v78, v78, v22
    v_mul_f32 v79, v79, v23
    v_cvt_pk_bf16_f32 v38, v72, v73
    v_cvt_pk_bf16_f32 v39, v74, v75
    v_cvt_pk_bf16_f32 v42, v76, v77
    v_cvt_pk_bf16_f32 v43, v78, v79
    ds_read_b64_tr_b16 v[44:45], v3 offset:0
    ds_read_b64_tr_b16 v[46:47], v3 offset:512
    ds_read_b64_tr_b16 v[48:49], v3 offset:2048
    ds_read_b64_tr_b16 v[50:51], v3 offset:2560
    ds_read_b64_tr_b16 v[52:53], v3 offset:4096
    ds_read_b64_tr_b16 v[54:55], v3 offset:4608
    s_barrier
    s_setprio 1
    s_waitcnt lgkmcnt(4)
    ds_read_b64_tr_b16 v[56:57], v3 offset:6144
    ds_read_b64_tr_b16 v[58:59], v3 offset:6656
    v_mfma_f32_32x32x16_bf16 v[64:79], v[44:47], v[112:115], 0
    s_waitcnt lgkmcnt(4)
    ds_read_b64_tr_b16 v[96:97], v3 offset:8192
    ds_read_b64_tr_b16 v[98:99], v3 offset:8704
    v_mfma_f32_32x32x16_bf16 v[64:79], v[48:51], v[116:119], v[64:79]
    s_waitcnt lgkmcnt(4)
    ds_read_b64_tr_b16 v[100:101], v3 offset:10240
    ds_read_b64_tr_b16 v[102:103], v3 offset:10752
    v_mfma_f32_32x32x16_bf16 v[64:79], v[52:55], v[120:123], v[64:79]
    buffer_store_dwordx4 v[36:39], v20, s[20:23], s51 offen offset:0 sc1
    s_waitcnt lgkmcnt(4)
    ds_read_b64_tr_b16 v[44:45], v3 offset:12288
    ds_read_b64_tr_b16 v[46:47], v3 offset:12800
    v_mfma_f32_32x32x16_bf16 v[64:79], v[56:59], v[124:127], v[64:79]
    s_waitcnt lgkmcnt(4)
    ds_read_b64_tr_b16 v[48:49], v3 offset:14336
    ds_read_b64_tr_b16 v[50:51], v3 offset:14848
    v_mfma_f32_32x32x16_bf16 v[64:79], v[96:99], v[128:131], v[64:79]
    buffer_store_dwordx4 v[40:43], v20, s[20:23], s51 offen offset:512 sc1
    s_waitcnt lgkmcnt(4)
    ds_read_b64_tr_b16 v[52:53], v3 offset:16384
    ds_read_b64_tr_b16 v[54:55], v3 offset:16896
    v_mfma_f32_32x32x16_bf16 v[64:79], v[100:103], v[132:135], v[64:79]
    s_waitcnt lgkmcnt(4)
    ds_read_b64_tr_b16 v[56:57], v3 offset:18432
    ds_read_b64_tr_b16 v[58:59], v3 offset:18944
    v_mfma_f32_32x32x16_bf16 v[64:79], v[44:47], v[136:139], v[64:79]
    s_waitcnt lgkmcnt(4)
    ds_read_b64_tr_b16 v[96:97], v3 offset:20480
    ds_read_b64_tr_b16 v[98:99], v3 offset:20992
    v_mfma_f32_32x32x16_bf16 v[64:79], v[48:51], v[140:143], v[64:79]
    s_waitcnt lgkmcnt(4)
    ds_read_b64_tr_b16 v[100:101], v3 offset:22528
    ds_read_b64_tr_b16 v[102:103], v3 offset:23040
    v_mfma_f32_32x32x16_bf16 v[64:79], v[52:55], v[144:147], v[64:79]
    s_waitcnt lgkmcnt(4)
    v_mfma_f32_32x32x16_bf16 v[64:79], v[56:59], v[148:151], v[64:79]
    s_waitcnt lgkmcnt(0)
    s_barrier
    ds_read_b64_tr_b16 v[44:45], v3 offset:24576
    ds_read_b64_tr_b16 v[46:47], v3 offset:25088
    ds_read_b64_tr_b16 v[48:49], v3 offset:26624
    ds_read_b64_tr_b16 v[50:51], v3 offset:27136
    v_mfma_f32_32x32x16_bf16 v[64:79], v[96:99], v[152:155], v[64:79]
    ds_read_b64_tr_b16 v[52:53], v3 offset:28672
    ds_read_b64_tr_b16 v[54:55], v3 offset:29184
    v_mfma_f32_32x32x16_bf16 v[64:79], v[100:103], v[156:159], v[64:79]
    s_waitcnt lgkmcnt(4)
    ds_read_b64_tr_b16 v[56:57], v3 offset:30720
    ds_read_b64_tr_b16 v[58:59], v3 offset:31232
    v_mfma_f32_32x32x16_bf16 v[64:79], v[44:47], v[160:163], v[64:79]
    s_waitcnt lgkmcnt(4)
    ds_read_b64_tr_b16 v[96:97], v3 offset:32768
    ds_read_b64_tr_b16 v[98:99], v3 offset:33280
    v_mfma_f32_32x32x16_bf16 v[64:79], v[48:51], v[164:167], v[64:79]
    s_waitcnt lgkmcnt(4)
    ds_read_b64_tr_b16 v[100:101], v3 offset:34816
    ds_read_b64_tr_b16 v[102:103], v3 offset:35328
    v_mfma_f32_32x32x16_bf16 v[64:79], v[52:55], v[168:171], v[64:79]
    s_waitcnt lgkmcnt(4)
    ds_read_b64_tr_b16 v[44:45], v3 offset:36864
    ds_read_b64_tr_b16 v[46:47], v3 offset:37376
    v_mfma_f32_32x32x16_bf16 v[64:79], v[56:59], v[172:175], v[64:79]
    s_waitcnt lgkmcnt(4)
    ds_read_b64_tr_b16 v[48:49], v3 offset:38912
    ds_read_b64_tr_b16 v[50:51], v3 offset:39424
    v_mfma_f32_32x32x16_bf16 v[64:79], v[96:99], v[176:179], v[64:79]
    s_waitcnt lgkmcnt(4)
    ds_read_b64_tr_b16 v[52:53], v3 offset:40960
    ds_read_b64_tr_b16 v[54:55], v3 offset:41472
    v_mfma_f32_32x32x16_bf16 v[64:79], v[100:103], v[180:183], v[64:79]
    s_waitcnt lgkmcnt(4)
    ds_read_b64_tr_b16 v[56:57], v3 offset:43008
    ds_read_b64_tr_b16 v[58:59], v3 offset:43520
    v_mfma_f32_32x32x16_bf16 v[64:79], v[44:47], v[184:187], v[64:79]
    s_waitcnt lgkmcnt(4)
    ds_read_b64_tr_b16 v[96:97], v3 offset:45056
    ds_read_b64_tr_b16 v[98:99], v3 offset:45568
    v_mfma_f32_32x32x16_bf16 v[64:79], v[48:51], v[188:191], v[64:79]
    s_waitcnt lgkmcnt(4)
    ds_read_b64_tr_b16 v[100:101], v3 offset:47104
    ds_read_b64_tr_b16 v[102:103], v3 offset:47616
    v_mfma_f32_32x32x16_bf16 v[64:79], v[52:55], v[192:195], v[64:79]
    s_waitcnt lgkmcnt(4)
    v_mfma_f32_32x32x16_bf16 v[64:79], v[56:59], v[196:199], v[64:79]
    s_waitcnt vmcnt(2)
    s_waitcnt lgkmcnt(0)
    s_barrier
    s_cmp_eq_u32 s3, 4
    s_cbranch_scc0 parallel_sum__linear_kernel_hedgehog__mixer_gmlp__prompt_kernel_zf_207
    s_lshl_b32 s39, s33, 4
    s_add_u32 s39, s39, s32
    s_lshl_b32 s39, s39, 7
    s_add_u32 s39, s39, 45023232
    v_mov_b32 v8, v60
    v_mov_b32 v9, v60
    v_mov_b32 v10, v60
    v_mov_b32 v11, v60
    s_mov_b64 exec, 0xff
    buffer_store_dwordx4 v[8:11], v0, s[20:23], s39 offen sc1
    s_mov_b64 exec, -1
parallel_sum__linear_kernel_hedgehog__mixer_gmlp__prompt_kernel_zf_207:
    ds_read_b64_tr_b16 v[44:45], v1 offset:0
    ds_read_b64_tr_b16 v[46:47], v1 offset:512
    ds_read_b64_tr_b16 v[48:49], v1 offset:2048
    ds_read_b64_tr_b16 v[50:51], v1 offset:2560
    v_mfma_f32_32x32x16_bf16 v[64:79], v[96:99], v[200:203], v[64:79]
    ds_read_b64_tr_b16 v[52:53], v1 offset:4096
    ds_read_b64_tr_b16 v[54:55], v1 offset:4608
    v_mfma_f32_32x32x16_bf16 v[64:79], v[100:103], v[204:207], v[64:79]
    s_waitcnt lgkmcnt(4)
    ds_read_b64_tr_b16 v[56:57], v1 offset:6144
    ds_read_b64_tr_b16 v[58:59], v1 offset:6656
    v_mfma_f32_32x32x16_bf16 v[64:79], v[44:47], v[208:211], v[64:79]
    s_waitcnt lgkmcnt(4)
    ds_read_b64_tr_b16 v[96:97], v1 offset:8192
    ds_read_b64_tr_b16 v[98:99], v1 offset:8704
    v_mfma_f32_32x32x16_bf16 v[64:79], v[48:51], v[212:215], v[64:79]
    s_waitcnt lgkmcnt(4)
    ds_read_b64_tr_b16 v[100:101], v1 offset:10240
    ds_read_b64_tr_b16 v[102:103], v1 offset:10752
    v_mfma_f32_32x32x16_bf16 v[64:79], v[52:55], v[216:219], v[64:79]
    s_waitcnt lgkmcnt(4)
    ds_read_b64_tr_b16 v[44:45], v1 offset:12288
    ds_read_b64_tr_b16 v[46:47], v1 offset:12800
    v_mfma_f32_32x32x16_bf16 v[64:79], v[56:59], v[220:223], v[64:79]
    s_waitcnt lgkmcnt(4)
    ds_read_b64_tr_b16 v[48:49], v1 offset:14336
    ds_read_b64_tr_b16 v[50:51], v1 offset:14848
    v_mfma_f32_32x32x16_bf16 v[64:79], v[96:99], v[224:227], v[64:79]
    s_waitcnt lgkmcnt(4)
    ds_read_b64_tr_b16 v[52:53], v1 offset:16384
    ds_read_b64_tr_b16 v[54:55], v1 offset:16896
    v_mfma_f32_32x32x16_bf16 v[64:79], v[100:103], v[228:231], v[64:79]
    s_waitcnt lgkmcnt(4)
    ds_read_b64_tr_b16 v[56:57], v1 offset:18432
    ds_read_b64_tr_b16 v[58:59], v1 offset:18944
    v_mfma_f32_32x32x16_bf16 v[64:79], v[44:47], v[232:235], v[64:79]
    ds_read_b64 v[28:29], v17 offset:3072
    s_waitcnt lgkmcnt(5)
    ds_read_b64_tr_b16 v[96:97], v1 offset:20480
    ds_read_b64_tr_b16 v[98:99], v1 offset:20992
    v_mfma_f32_32x32x16_bf16 v[64:79], v[48:51], v[236:239], v[64:79]
    s_waitcnt lgkmcnt(5)
    ds_read_b64_tr_b16 v[100:101], v1 offset:22528
    ds_read_b64_tr_b16 v[102:103], v1 offset:23040
    v_mfma_f32_32x32x16_bf16 v[64:79], v[52:55], v[240:243], v[64:79]
    s_waitcnt lgkmcnt(5)
    v_mfma_f32_32x32x16_bf16 v[64:79], v[56:59], v[244:247], v[64:79]
    s_waitcnt lgkmcnt(2)
    v_mfma_f32_32x32x16_bf16 v[64:79], v[96:99], v[248:251], v[64:79]
    s_waitcnt lgkmcnt(0)
    v_mfma_f32_32x32x16_bf16 v[64:79], v[100:103], v[252:255], v[64:79]
    v_mfma_f32_32x32x16_bf16 v[64:79], v[28:31], v[24:27], v[64:79]
    s_setprio 0
    s_barrier
    s_nop 7
    v_mul_f32 v32, v80, v80
    v_mul_f32 v33, v81, v81
    v_mul_f32 v34, v82, v82
    v_mul_f32 v35, v83, v83
    v_mul_f32 v6, v84, v84
    v_mul_f32 v16, v85, v85
    v_mul_f32 v22, v86, v86
    v_mul_f32 v23, v87, v87
    v_fma_f32 v32, v32, v15, v14
    v_fma_f32 v33, v33, v15, v14
    v_fma_f32 v34, v34, v15, v14
    v_fma_f32 v35, v35, v15, v14
    v_fma_f32 v6, v6, v15, v14
    v_fma_f32 v16, v16, v15, v14
    v_fma_f32 v22, v22, v15, v14
    v_fma_f32 v23, v23, v15, v14
    v_mul_f32 v32, v32, v80
    v_mul_f32 v33, v33, v81
    v_mul_f32 v34, v34, v82
    v_mul_f32 v35, v35, v83
    v_mul_f32 v6, v6, v84
    v_mul_f32 v16, v16, v85
    v_mul_f32 v22, v22, v86
    v_mul_f32 v23, v23, v87
    v_exp_f32 v32, v32
    v_exp_f32 v33, v33
    v_exp_f32 v34, v34
    v_exp_f32 v35, v35
    v_exp_f32 v6, v6
    v_exp_f32 v16, v16
    v_exp_f32 v22, v22
    v_exp_f32 v23, v23
    v_add_f32 v32, 1.0, v32
    v_add_f32 v33, 1.0, v33
    v_add_f32 v34, 1.0, v34
    v_add_f32 v35, 1.0, v35
    v_add_f32 v6, 1.0, v6
    v_add_f32 v16, 1.0, v16
    v_add_f32 v22, 1.0, v22
    v_add_f32 v23, 1.0, v23
    v_rcp_f32 v32, v32
    v_rcp_f32 v33, v33
    v_rcp_f32 v34, v34
    v_rcp_f32 v35, v35
    v_rcp_f32 v6, v6
    v_rcp_f32 v16, v16
    v_rcp_f32 v22, v22
    v_rcp_f32 v23, v23
    v_mul_f32 v80, v80, v32
    v_mul_f32 v81, v81, v33
    v_mul_f32 v82, v82, v34
    v_mul_f32 v83, v83, v35
    v_mul_f32 v84, v84, v6
    v_mul_f32 v85, v85, v16
    v_mul_f32 v86, v86, v22
    v_mul_f32 v87, v87, v23
    v_cvt_pk_bf16_f32 v36, v80, v81
    v_cvt_pk_bf16_f32 v37, v82, v83
    v_cvt_pk_bf16_f32 v40, v84, v85
    v_cvt_pk_bf16_f32 v41, v86, v87
    v_mul_f32 v32, v88, v88
    v_mul_f32 v33, v89, v89
    v_mul_f32 v34, v90, v90
    v_mul_f32 v35, v91, v91
    v_mul_f32 v6, v92, v92
    v_mul_f32 v16, v93, v93
    v_mul_f32 v22, v94, v94
    v_mul_f32 v23, v95, v95
    v_fma_f32 v32, v32, v15, v14
    v_fma_f32 v33, v33, v15, v14
    v_fma_f32 v34, v34, v15, v14
    v_fma_f32 v35, v35, v15, v14
    v_fma_f32 v6, v6, v15, v14
    v_fma_f32 v16, v16, v15, v14
    v_fma_f32 v22, v22, v15, v14
    v_fma_f32 v23, v23, v15, v14
    v_mul_f32 v32, v32, v88
    v_mul_f32 v33, v33, v89
    v_mul_f32 v34, v34, v90
    v_mul_f32 v35, v35, v91
    v_mul_f32 v6, v6, v92
    v_mul_f32 v16, v16, v93
    v_mul_f32 v22, v22, v94
    v_mul_f32 v23, v23, v95
    v_exp_f32 v32, v32
    v_exp_f32 v33, v33
    v_exp_f32 v34, v34
    v_exp_f32 v35, v35
    v_exp_f32 v6, v6
    v_exp_f32 v16, v16
    v_exp_f32 v22, v22
    v_exp_f32 v23, v23
    v_add_f32 v32, 1.0, v32
    v_add_f32 v33, 1.0, v33
    v_add_f32 v34, 1.0, v34
    v_add_f32 v35, 1.0, v35
    v_add_f32 v6, 1.0, v6
    v_add_f32 v16, 1.0, v16
    v_add_f32 v22, 1.0, v22
    v_add_f32 v23, 1.0, v23
    v_rcp_f32 v32, v32
    v_rcp_f32 v33, v33
    v_rcp_f32 v34, v34
    v_rcp_f32 v35, v35
    v_rcp_f32 v6, v6
    v_rcp_f32 v16, v16
    v_rcp_f32 v22, v22
    v_rcp_f32 v23, v23
    v_mul_f32 v88, v88, v32
    v_mul_f32 v89, v89, v33
    v_mul_f32 v90, v90, v34
    v_mul_f32 v91, v91, v35
    v_mul_f32 v92, v92, v6
    v_mul_f32 v93, v93, v16
    v_mul_f32 v94, v94, v22
    v_mul_f32 v95, v95, v23
    v_cvt_pk_bf16_f32 v38, v88, v89
    v_cvt_pk_bf16_f32 v39, v90, v91
    v_cvt_pk_bf16_f32 v42, v92, v93
    v_cvt_pk_bf16_f32 v43, v94, v95
    buffer_store_dwordx4 v[36:39], v20, s[20:23], s52 offen offset:0 sc1
    buffer_store_dwordx4 v[40:43], v20, s[20:23], s52 offen offset:512 sc1
    s_nop 3
    v_mul_f32 v64, v12, v64
    v_mul_f32 v65, v12, v65
    v_mul_f32 v66, v12, v66
    v_mul_f32 v67, v12, v67
    v_mul_f32 v68, v12, v68
    v_mul_f32 v69, v12, v69
    v_mul_f32 v70, v12, v70
    v_mul_f32 v71, v12, v71
    v_cvt_pk_bf16_f32 v36, v64, v65
    v_cvt_pk_bf16_f32 v37, v66, v67
    v_cvt_pk_bf16_f32 v38, v68, v69
    v_cvt_pk_bf16_f32 v39, v70, v71
    v_mul_f32 v72, v12, v72
    v_mul_f32 v73, v12, v73
    v_mul_f32 v74, v12, v74
    v_mul_f32 v75, v12, v75
    v_mul_f32 v76, v12, v76
    v_mul_f32 v77, v12, v77
    v_mul_f32 v78, v12, v78
    v_mul_f32 v79, v12, v79
    v_cvt_pk_bf16_f32 v40, v72, v73
    v_cvt_pk_bf16_f32 v41, v74, v75
    v_cvt_pk_bf16_f32 v42, v76, v77
    v_cvt_pk_bf16_f32 v43, v78, v79
    buffer_store_dwordx4 v[36:39], v0, s[20:23], s53 offen offset:0 sc1
    buffer_store_dwordx4 v[40:43], v0, s[20:23], s53 offen offset:1024 sc1
    s_branch parallel_sum__linear_kernel_hedgehog__mixer_gmlp__prompt_kernel_ztail
parallel_sum__linear_kernel_hedgehog__mixer_gmlp__prompt_kernel_noq1:
    s_setprio 1
    s_waitcnt lgkmcnt(4)
    ds_read_b64_tr_b16 v[56:57], v3 offset:30720
    ds_read_b64_tr_b16 v[58:59], v3 offset:31232
    v_mfma_f32_32x32x16_bf16 v[80:95], v[44:47], v[112:115], 0
    s_waitcnt lgkmcnt(4)
    ds_read_b64_tr_b16 v[96:97], v3 offset:32768
    ds_read_b64_tr_b16 v[98:99], v3 offset:33280
    v_mfma_f32_32x32x16_bf16 v[80:95], v[48:51], v[116:119], v[80:95]
    s_waitcnt lgkmcnt(4)
    ds_read_b64_tr_b16 v[100:101], v3 offset:34816
    ds_read_b64_tr_b16 v[102:103], v3 offset:35328
    v_mfma_f32_32x32x16_bf16 v[80:95], v[52:55], v[120:123], v[80:95]
    buffer_store_dwordx4 v[36:39], v20, s[20:23], s50 offen offset:0 sc1
    s_waitcnt lgkmcnt(4)
    ds_read_b64_tr_b16 v[44:45], v3 offset:36864
    ds_read_b64_tr_b16 v[46:47], v3 offset:37376
    v_mfma_f32_32x32x16_bf16 v[80:95], v[56:59], v[124:127], v[80:95]
    s_waitcnt lgkmcnt(4)
    ds_read_b64_tr_b16 v[48:49], v3 offset:38912
    ds_read_b64_tr_b16 v[50:51], v3 offset:39424
    v_mfma_f32_32x32x16_bf16 v[80:95], v[96:99], v[128:131], v[80:95]
    buffer_store_dwordx4 v[40:43], v20, s[20:23], s50 offen offset:512 sc1
    s_waitcnt lgkmcnt(4)
    ds_read_b64_tr_b16 v[52:53], v3 offset:40960
    ds_read_b64_tr_b16 v[54:55], v3 offset:41472
    v_mfma_f32_32x32x16_bf16 v[80:95], v[100:103], v[132:135], v[80:95]
    s_waitcnt lgkmcnt(4)
    ds_read_b64_tr_b16 v[56:57], v3 offset:43008
    ds_read_b64_tr_b16 v[58:59], v3 offset:43520
    v_mfma_f32_32x32x16_bf16 v[80:95], v[44:47], v[136:139], v[80:95]
    s_waitcnt lgkmcnt(4)
    ds_read_b64_tr_b16 v[96:97], v3 offset:45056
    ds_read_b64_tr_b16 v[98:99], v3 offset:45568
    v_mfma_f32_32x32x16_bf16 v[80:95], v[48:51], v[140:143], v[80:95]
    s_waitcnt lgkmcnt(4)
    ds_read_b64_tr_b16 v[100:101], v3 offset:47104
    ds_read_b64_tr_b16 v[102:103], v3 offset:47616
    v_mfma_f32_32x32x16_bf16 v[80:95], v[52:55], v[144:147], v[80:95]
    s_waitcnt lgkmcnt(4)
    v_mfma_f32_32x32x16_bf16 v[80:95], v[56:59], v[148:151], v[80:95]
    s_waitcnt lgkmcnt(0)
    s_barrier
    ds_read_b64_tr_b16 v[44:45], v1 offset:0
    ds_read_b64_tr_b16 v[46:47], v1 offset:512
    ds_read_b64_tr_b16 v[48:49], v1 offset:2048
    ds_read_b64_tr_b16 v[50:51], v1 offset:2560
    v_mfma_f32_32x32x16_bf16 v[80:95], v[96:99], v[152:155], v[80:95]
    ds_read_b64_tr_b16 v[52:53], v1 offset:4096
    ds_read_b64_tr_b16 v[54:55], v1 offset:4608
    v_mfma_f32_32x32x16_bf16 v[80:95], v[100:103], v[156:159], v[80:95]
    s_waitcnt lgkmcnt(4)
    ds_read_b64_tr_b16 v[56:57], v1 offset:6144
    ds_read_b64_tr_b16 v[58:59], v1 offset:6656
    v_mfma_f32_32x32x16_bf16 v[80:95], v[44:47], v[160:163], v[80:95]
    s_waitcnt lgkmcnt(4)
    ds_read_b64_tr_b16 v[96:97], v1 offset:8192
    ds_read_b64_tr_b16 v[98:99], v1 offset:8704
    v_mfma_f32_32x32x16_bf16 v[80:95], v[48:51], v[164:167], v[80:95]
    s_waitcnt lgkmcnt(4)
    ds_read_b64_tr_b16 v[100:101], v1 offset:10240
    ds_read_b64_tr_b16 v[102:103], v1 offset:10752
    v_mfma_f32_32x32x16_bf16 v[80:95], v[52:55], v[168:171], v[80:95]
    s_waitcnt lgkmcnt(4)
    ds_read_b64_tr_b16 v[44:45], v1 offset:12288
    ds_read_b64_tr_b16 v[46:47], v1 offset:12800
    v_mfma_f32_32x32x16_bf16 v[80:95], v[56:59], v[172:175], v[80:95]
    s_waitcnt lgkmcnt(4)
    ds_read_b64_tr_b16 v[48:49], v1 offset:14336
    ds_read_b64_tr_b16 v[50:51], v1 offset:14848
    v_mfma_f32_32x32x16_bf16 v[80:95], v[96:99], v[176:179], v[80:95]
    s_waitcnt lgkmcnt(4)
    ds_read_b64_tr_b16 v[52:53], v1 offset:16384
    ds_read_b64_tr_b16 v[54:55], v1 offset:16896
    v_mfma_f32_32x32x16_bf16 v[80:95], v[100:103], v[180:183], v[80:95]
    s_waitcnt lgkmcnt(4)
    ds_read_b64_tr_b16 v[56:57], v1 offset:18432
    ds_read_b64_tr_b16 v[58:59], v1 offset:18944
    v_mfma_f32_32x32x16_bf16 v[80:95], v[44:47], v[184:187], v[80:95]
    s_waitcnt lgkmcnt(4)
    ds_read_b64_tr_b16 v[96:97], v1 offset:20480
    ds_read_b64_tr_b16 v[98:99], v1 offset:20992
    v_mfma_f32_32x32x16_bf16 v[80:95], v[48:51], v[188:191], v[80:95]
    s_waitcnt lgkmcnt(4)
    ds_read_b64_tr_b16 v[100:101], v1 offset:22528
    ds_read_b64_tr_b16 v[102:103], v1 offset:23040
    v_mfma_f32_32x32x16_bf16 v[80:95], v[52:55], v[192:195], v[80:95]
    s_waitcnt lgkmcnt(4)
    v_mfma_f32_32x32x16_bf16 v[80:95], v[56:59], v[196:199], v[80:95]
    s_waitcnt lgkmcnt(0)
    s_barrier
    ds_read_b64_tr_b16 v[44:45], v1 offset:24576
    ds_read_b64_tr_b16 v[46:47], v1 offset:25088
    ds_read_b64_tr_b16 v[48:49], v1 offset:26624
    ds_read_b64_tr_b16 v[50:51], v1 offset:27136
    v_mfma_f32_32x32x16_bf16 v[80:95], v[96:99], v[200:203], v[80:95]
    ds_read_b64_tr_b16 v[52:53], v1 offset:28672
    ds_read_b64_tr_b16 v[54:55], v1 offset:29184
    v_mfma_f32_32x32x16_bf16 v[80:95], v[100:103], v[204:207], v[80:95]
    s_waitcnt lgkmcnt(4)
    ds_read_b64_tr_b16 v[56:57], v1 offset:30720
    ds_read_b64_tr_b16 v[58:59], v1 offset:31232
    v_mfma_f32_32x32x16_bf16 v[80:95], v[44:47], v[208:211], v[80:95]
    s_waitcnt lgkmcnt(4)
    ds_read_b64_tr_b16 v[96:97], v1 offset:32768
    ds_read_b64_tr_b16 v[98:99], v1 offset:33280
    v_mfma_f32_32x32x16_bf16 v[80:95], v[48:51], v[212:215], v[80:95]
    s_waitcnt lgkmcnt(4)
    ds_read_b64_tr_b16 v[100:101], v1 offset:34816
    ds_read_b64_tr_b16 v[102:103], v1 offset:35328
    v_mfma_f32_32x32x16_bf16 v[80:95], v[52:55], v[216:219], v[80:95]
    s_waitcnt lgkmcnt(4)
    ds_read_b64_tr_b16 v[44:45], v1 offset:36864
    ds_read_b64_tr_b16 v[46:47], v1 offset:37376
    v_mfma_f32_32x32x16_bf16 v[80:95], v[56:59], v[220:223], v[80:95]
    s_waitcnt lgkmcnt(4)
    ds_read_b64_tr_b16 v[48:49], v1 offset:38912
    ds_read_b64_tr_b16 v[50:51], v1 offset:39424
    v_mfma_f32_32x32x16_bf16 v[80:95], v[96:99], v[224:227], v[80:95]
    s_waitcnt lgkmcnt(4)
    ds_read_b64_tr_b16 v[52:53], v1 offset:40960
    ds_read_b64_tr_b16 v[54:55], v1 offset:41472
    v_mfma_f32_32x32x16_bf16 v[80:95], v[100:103], v[228:231], v[80:95]
    s_waitcnt lgkmcnt(4)
    ds_read_b64_tr_b16 v[56:57], v1 offset:43008
    ds_read_b64_tr_b16 v[58:59], v1 offset:43520
    v_mfma_f32_32x32x16_bf16 v[80:95], v[44:47], v[232:235], v[80:95]
    ds_read_b64 v[28:29], v17 offset:2560
    s_waitcnt lgkmcnt(5)
    ds_read_b64_tr_b16 v[96:97], v1 offset:45056
    ds_read_b64_tr_b16 v[98:99], v1 offset:45568
    v_mfma_f32_32x32x16_bf16 v[80:95], v[48:51], v[236:239], v[80:95]
    s_waitcnt lgkmcnt(5)
    ds_read_b64_tr_b16 v[100:101], v1 offset:47104
    ds_read_b64_tr_b16 v[102:103], v1 offset:47616
    v_mfma_f32_32x32x16_bf16 v[80:95], v[52:55], v[240:243], v[80:95]
    s_waitcnt lgkmcnt(5)
    v_mfma_f32_32x32x16_bf16 v[80:95], v[56:59], v[244:247], v[80:95]
    s_waitcnt lgkmcnt(2)
    v_mfma_f32_32x32x16_bf16 v[80:95], v[96:99], v[248:251], v[80:95]
    s_waitcnt lgkmcnt(0)
    v_mfma_f32_32x32x16_bf16 v[80:95], v[100:103], v[252:255], v[80:95]
    v_mfma_f32_32x32x16_bf16 v[80:95], v[28:31], v[24:27], v[80:95]
    s_setprio 0
    s_barrier
    s_nop 7
    v_lshrrev_b32 v106, 8, v0
    v_bfe_u32 v63, v0, 6, 2
    s_lshl_b32 s39, s36, 8
    s_add_u32 s39, s39, 155904
    v_lshl_add_u32 v107, v106, 5, s39
    ds_read_b128 v[44:47], v107 offset:0
    ds_read_b128 v[48:51], v107 offset:16
    ds_read_b128 v[52:55], v107 offset:128
    ds_read_b128 v[56:59], v107 offset:144
    v_lshl_add_u32 v63, v106, 3, v63
    v_mul_u32_u24 v63, 208, v63
    v_bfe_u32 v106, v0, 4, 1
    v_lshl_add_u32 v63, v106, 4, v63
    v_bfe_u32 v106, v0, 5, 1
    v_lshl_add_u32 v63, v106, 3, v63
    s_mul_i32 s39, s3, 6656
    s_add_u32 s39, s39, 98304
    v_add_u32 v63, s39, v63
    ds_read_b64_tr_b16 v[96:97], v63 offset:0
    ds_read_b64_tr_b16 v[98:99], v63 offset:832
    ds_read_b64_tr_b16 v[100:101], v63 offset:32
    ds_read_b64_tr_b16 v[102:103], v63 offset:864
    s_waitcnt lgkmcnt(2)
    v_lshlrev_b32 v106, 16, v96
    v_and_b32 v107, 0xffff0000, v96
    v_fma_f32 v106, v106, v44, v52
    v_fma_f32 v107, v107, v45, v53
    v_cvt_pk_bf16_f32 v96, v106, v107
    v_lshlrev_b32 v8, 16, v97
    v_and_b32 v9, 0xffff0000, v97
    v_fma_f32 v8, v8, v46, v54
    v_fma_f32 v9, v9, v47, v55
    v_cvt_pk_bf16_f32 v97, v8, v9
    ds_read_b64_tr_b16 v[108:109], v63 offset:64
    ds_read_b64_tr_b16 v[110:111], v63 offset:896
    v_lshlrev_b32 v106, 16, v98
    v_and_b32 v107, 0xffff0000, v98
    v_fma_f32 v106, v106, v48, v56
    v_fma_f32 v107, v107, v49, v57
    v_cvt_pk_bf16_f32 v98, v106, v107
    v_lshlrev_b32 v8, 16, v99
    v_and_b32 v9, 0xffff0000, v99
    v_fma_f32 v8, v8, v50, v58
    v_fma_f32 v9, v9, v51, v59
    v_cvt_pk_bf16_f32 v99, v8, v9
    buffer_store_dwordx4 v[96:99], v0, s[20:23], s54 offen offset:0 sc1
    s_waitcnt lgkmcnt(2)
    v_lshlrev_b32 v106, 16, v100
    v_and_b32 v107, 0xffff0000, v100
    v_fma_f32 v106, v106, v44, v52
    v_fma_f32 v107, v107, v45, v53
    v_cvt_pk_bf16_f32 v100, v106, v107
    v_lshlrev_b32 v8, 16, v101
    v_and_b32 v9, 0xffff0000, v101
    v_fma_f32 v8, v8, v46, v54
    v_fma_f32 v9, v9, v47, v55
    v_cvt_pk_bf16_f32 v101, v8, v9
    ds_read_b64_tr_b16 v[96:97], v63 offset:96
    ds_read_b64_tr_b16 v[98:99], v63 offset:928
    v_lshlrev_b32 v106, 16, v102
    v_and_b32 v107, 0xffff0000, v102
    v_fma_f32 v106, v106, v48, v56
    v_fma_f32 v107, v107, v49, v57
    v_cvt_pk_bf16_f32 v102, v106, v107
    v_lshlrev_b32 v8, 16, v103
    v_and_b32 v9, 0xffff0000, v103
    v_fma_f32 v8, v8, v50, v58
    v_fma_f32 v9, v9, v51, v59
    v_cvt_pk_bf16_f32 v103, v8, v9
    buffer_store_dwordx4 v[100:103], v0, s[20:23], s54 offen offset:1024 sc1
    s_waitcnt lgkmcnt(2)
    v_lshlrev_b32 v106, 16, v108
    v_and_b32 v107, 0xffff0000, v108
    v_fma_f32 v106, v106, v44, v52
    v_fma_f32 v107, v107, v45, v53
    v_cvt_pk_bf16_f32 v108, v106, v107
    v_lshlrev_b32 v8, 16, v109
    v_and_b32 v9, 0xffff0000, v109
    v_fma_f32 v8, v8, v46, v54
    v_fma_f32 v9, v9, v47, v55
    v_cvt_pk_bf16_f32 v109, v8, v9
    ds_read_b64_tr_b16 v[100:101], v63 offset:128
    ds_read_b64_tr_b16 v[102:103], v63 offset:960
    v_lshlrev_b32 v106, 16, v110
    v_and_b32 v107, 0xffff0000, v110
    v_fma_f32 v106, v106, v48, v56
    v_fma_f32 v107, v107, v49, v57
    v_cvt_pk_bf16_f32 v110, v106, v107
    v_lshlrev_b32 v8, 16, v111
    v_and_b32 v9, 0xffff0000, v111
    v_fma_f32 v8, v8, v50, v58
    v_fma_f32 v9, v9, v51, v59
    v_cvt_pk_bf16_f32 v111, v8, v9
    s_add_u32 s54, s54, 4096
    buffer_store_dwordx4 v[108:111], v0, s[20:23], s54 offen offset:0 sc1
    s_waitcnt lgkmcnt(2)
    v_lshlrev_b32 v106, 16, v96
    v_and_b32 v107, 0xffff0000, v96
    v_fma_f32 v106, v106, v44, v52
    v_fma_f32 v107, v107, v45, v53
    v_cvt_pk_bf16_f32 v96, v106, v107
    v_lshlrev_b32 v8, 16, v97
    v_and_b32 v9, 0xffff0000, v97
    v_fma_f32 v8, v8, v46, v54
    v_fma_f32 v9, v9, v47, v55
    v_cvt_pk_bf16_f32 v97, v8, v9
    ds_read_b64_tr_b16 v[108:109], v63 offset:160
    ds_read_b64_tr_b16 v[110:111], v63 offset:992
    v_lshlrev_b32 v106, 16, v98
    v_and_b32 v107, 0xffff0000, v98
    v_fma_f32 v106, v106, v48, v56
    v_fma_f32 v107, v107, v49, v57
    v_cvt_pk_bf16_f32 v98, v106, v107
    v_lshlrev_b32 v8, 16, v99
    v_and_b32 v9, 0xffff0000, v99
    v_fma_f32 v8, v8, v50, v58
    v_fma_f32 v9, v9, v51, v59
    v_cvt_pk_bf16_f32 v99, v8, v9
    buffer_store_dwordx4 v[96:99], v0, s[20:23], s54 offen offset:1024 sc1
    s_waitcnt lgkmcnt(2)
    v_lshlrev_b32 v106, 16, v100
    v_and_b32 v107, 0xffff0000, v100
    v_fma_f32 v106, v106, v44, v52
    v_fma_f32 v107, v107, v45, v53
    v_cvt_pk_bf16_f32 v100, v106, v107
    v_lshlrev_b32 v8, 16, v101
    v_and_b32 v9, 0xffff0000, v101
    v_fma_f32 v8, v8, v46, v54
    v_fma_f32 v9, v9, v47, v55
    v_cvt_pk_bf16_f32 v101, v8, v9
    v_lshlrev_b32 v106, 16, v102
    v_and_b32 v107, 0xffff0000, v102
    v_fma_f32 v106, v106, v48, v56
    v_fma_f32 v107, v107, v49, v57
    v_cvt_pk_bf16_f32 v102, v106, v107
    v_lshlrev_b32 v8, 16, v103
    v_and_b32 v9, 0xffff0000, v103
    v_fma_f32 v8, v8, v50, v58
    v_fma_f32 v9, v9, v51, v59
    v_cvt_pk_bf16_f32 v103, v8, v9
    s_add_u32 s54, s54, 4096
    buffer_store_dwordx4 v[100:103], v0, s[20:23], s54 offen offset:0 sc1
    s_waitcnt lgkmcnt(0)
    v_lshlrev_b32 v106, 16, v108
    v_and_b32 v107, 0xffff0000, v108
    v_fma_f32 v106, v106, v44, v52
    v_fma_f32 v107, v107, v45, v53
    v_cvt_pk_bf16_f32 v108, v106, v107
    v_lshlrev_b32 v8, 16, v109
    v_and_b32 v9, 0xffff0000, v109
    v_fma_f32 v8, v8, v46, v54
    v_fma_f32 v9, v9, v47, v55
    v_cvt_pk_bf16_f32 v109, v8, v9
    v_lshlrev_b32 v106, 16, v110
    v_and_b32 v107, 0xffff0000, v110
    v_fma_f32 v106, v106, v48, v56
    v_fma_f32 v107, v107, v49, v57
    v_cvt_pk_bf16_f32 v110, v106, v107
    v_lshlrev_b32 v8, 16, v111
    v_and_b32 v9, 0xffff0000, v111
    v_fma_f32 v8, v8, v50, v58
    v_fma_f32 v9, v9, v51, v59
    v_cvt_pk_bf16_f32 v111, v8, v9
    buffer_store_dwordx4 v[108:111], v0, s[20:23], s54 offen offset:1024 sc1
    v_mul_f32 v32, v64, v64
    v_mul_f32 v33, v65, v65
    v_mul_f32 v34, v66, v66
    v_mul_f32 v35, v67, v67
    v_mul_f32 v6, v68, v68
    v_mul_f32 v16, v69, v69
    v_mul_f32 v22, v70, v70
    v_mul_f32 v23, v71, v71
    v_fma_f32 v32, v32, v15, v14
    v_fma_f32 v33, v33, v15, v14
    v_fma_f32 v34, v34, v15, v14
    v_fma_f32 v35, v35, v15, v14
    v_fma_f32 v6, v6, v15, v14
    v_fma_f32 v16, v16, v15, v14
    v_fma_f32 v22, v22, v15, v14
    v_fma_f32 v23, v23, v15, v14
    v_mul_f32 v32, v32, v64
    v_mul_f32 v33, v33, v65
    v_mul_f32 v34, v34, v66
    v_mul_f32 v35, v35, v67
    v_mul_f32 v6, v6, v68
    v_mul_f32 v16, v16, v69
    v_mul_f32 v22, v22, v70
    v_mul_f32 v23, v23, v71
    v_exp_f32 v32, v32
    v_exp_f32 v33, v33
    v_exp_f32 v34, v34
    v_exp_f32 v35, v35
    v_exp_f32 v6, v6
    v_exp_f32 v16, v16
    v_exp_f32 v22, v22
    v_exp_f32 v23, v23
    v_add_f32 v32, 1.0, v32
    v_add_f32 v33, 1.0, v33
    v_add_f32 v34, 1.0, v34
    v_add_f32 v35, 1.0, v35
    v_add_f32 v6, 1.0, v6
    v_add_f32 v16, 1.0, v16
    v_add_f32 v22, 1.0, v22
    v_add_f32 v23, 1.0, v23
    v_rcp_f32 v32, v32
    v_rcp_f32 v33, v33
    v_rcp_f32 v34, v34
    v_rcp_f32 v35, v35
    v_rcp_f32 v6, v6
    v_rcp_f32 v16, v16
    v_rcp_f32 v22, v22
    v_rcp_f32 v23, v23
    v_mul_f32 v64, v64, v32
    v_mul_f32 v65, v65, v33
    v_mul_f32 v66, v66, v34
    v_mul_f32 v67, v67, v35
    v_mul_f32 v68, v68, v6
    v_mul_f32 v69, v69, v16
    v_mul_f32 v70, v70, v22
    v_mul_f32 v71, v71, v23
    v_cvt_pk_bf16_f32 v36, v64, v65
    v_cvt_pk_bf16_f32 v37, v66, v67
    v_cvt_pk_bf16_f32 v40, v68, v69
    v_cvt_pk_bf16_f32 v41, v70, v71
    v_mul_f32 v32, v72, v72
    v_mul_f32 v33, v73, v73
    v_mul_f32 v34, v74, v74
    v_mul_f32 v35, v75, v75
    v_mul_f32 v6, v76, v76
    v_mul_f32 v16, v77, v77
    v_mul_f32 v22, v78, v78
    v_mul_f32 v23, v79, v79
    v_fma_f32 v32, v32, v15, v14
    v_fma_f32 v33, v33, v15, v14
    v_fma_f32 v34, v34, v15, v14
    v_fma_f32 v35, v35, v15, v14
    v_fma_f32 v6, v6, v15, v14
    v_fma_f32 v16, v16, v15, v14
    v_fma_f32 v22, v22, v15, v14
    v_fma_f32 v23, v23, v15, v14
    v_mul_f32 v32, v32, v72
    v_mul_f32 v33, v33, v73
    v_mul_f32 v34, v34, v74
    v_mul_f32 v35, v35, v75
    v_mul_f32 v6, v6, v76
    v_mul_f32 v16, v16, v77
    v_mul_f32 v22, v22, v78
    v_mul_f32 v23, v23, v79
    v_exp_f32 v32, v32
    v_exp_f32 v33, v33
    v_exp_f32 v34, v34
    v_exp_f32 v35, v35
    v_exp_f32 v6, v6
    v_exp_f32 v16, v16
    v_exp_f32 v22, v22
    v_exp_f32 v23, v23
    v_add_f32 v32, 1.0, v32
    v_add_f32 v33, 1.0, v33
    v_add_f32 v34, 1.0, v34
    v_add_f32 v35, 1.0, v35
    v_add_f32 v6, 1.0, v6
    v_add_f32 v16, 1.0, v16
    v_add_f32 v22, 1.0, v22
    v_add_f32 v23, 1.0, v23
    v_rcp_f32 v32, v32
    v_rcp_f32 v33, v33
    v_rcp_f32 v34, v34
    v_rcp_f32 v35, v35
    v_rcp_f32 v6, v6
    v_rcp_f32 v16, v16
    v_rcp_f32 v22, v22
    v_rcp_f32 v23, v23
    v_mul_f32 v72, v72, v32
    v_mul_f32 v73, v73, v33
    v_mul_f32 v74, v74, v34
    v_mul_f32 v75, v75, v35
    v_mul_f32 v76, v76, v6
    v_mul_f32 v77, v77, v16
    v_mul_f32 v78, v78, v22
    v_mul_f32 v79, v79, v23
    v_cvt_pk_bf16_f32 v38, v72, v73
    v_cvt_pk_bf16_f32 v39, v74, v75
    v_cvt_pk_bf16_f32 v42, v76, v77
    v_cvt_pk_bf16_f32 v43, v78, v79
    buffer_store_dwordx4 v[36:39], v20, s[20:23], s51 offen offset:0 sc1
    buffer_store_dwordx4 v[40:43], v20, s[20:23], s51 offen offset:512 sc1
    s_nop 3
    v_mul_f32 v32, v80, v80
    v_mul_f32 v33, v81, v81
    v_mul_f32 v34, v82, v82
    v_mul_f32 v35, v83, v83
    v_mul_f32 v6, v84, v84
    v_mul_f32 v16, v85, v85
    v_mul_f32 v22, v86, v86
    v_mul_f32 v23, v87, v87
    v_fma_f32 v32, v32, v15, v14
    v_fma_f32 v33, v33, v15, v14
    v_fma_f32 v34, v34, v15, v14
    v_fma_f32 v35, v35, v15, v14
    v_fma_f32 v6, v6, v15, v14
    v_fma_f32 v16, v16, v15, v14
    v_fma_f32 v22, v22, v15, v14
    v_fma_f32 v23, v23, v15, v14
    v_mul_f32 v32, v32, v80
    v_mul_f32 v33, v33, v81
    v_mul_f32 v34, v34, v82
    v_mul_f32 v35, v35, v83
    v_mul_f32 v6, v6, v84
    v_mul_f32 v16, v16, v85
    v_mul_f32 v22, v22, v86
    v_mul_f32 v23, v23, v87
    v_exp_f32 v32, v32
    v_exp_f32 v33, v33
    v_exp_f32 v34, v34
    v_exp_f32 v35, v35
    v_exp_f32 v6, v6
    v_exp_f32 v16, v16
    v_exp_f32 v22, v22
    v_exp_f32 v23, v23
    v_add_f32 v32, 1.0, v32
    v_add_f32 v33, 1.0, v33
    v_add_f32 v34, 1.0, v34
    v_add_f32 v35, 1.0, v35
    v_add_f32 v6, 1.0, v6
    v_add_f32 v16, 1.0, v16
    v_add_f32 v22, 1.0, v22
    v_add_f32 v23, 1.0, v23
    v_rcp_f32 v32, v32
    v_rcp_f32 v33, v33
    v_rcp_f32 v34, v34
    v_rcp_f32 v35, v35
    v_rcp_f32 v6, v6
    v_rcp_f32 v16, v16
    v_rcp_f32 v22, v22
    v_rcp_f32 v23, v23
    v_mul_f32 v80, v80, v32
    v_mul_f32 v81, v81, v33
    v_mul_f32 v82, v82, v34
    v_mul_f32 v83, v83, v35
    v_mul_f32 v84, v84, v6
    v_mul_f32 v85, v85, v16
    v_mul_f32 v86, v86, v22
    v_mul_f32 v87, v87, v23
    v_cvt_pk_bf16_f32 v36, v80, v81
    v_cvt_pk_bf16_f32 v37, v82, v83
    v_cvt_pk_bf16_f32 v40, v84, v85
    v_cvt_pk_bf16_f32 v41, v86, v87
    v_mul_f32 v32, v88, v88
    v_mul_f32 v33, v89, v89
    v_mul_f32 v34, v90, v90
    v_mul_f32 v35, v91, v91
    v_mul_f32 v6, v92, v92
    v_mul_f32 v16, v93, v93
    v_mul_f32 v22, v94, v94
    v_mul_f32 v23, v95, v95
    v_fma_f32 v32, v32, v15, v14
    v_fma_f32 v33, v33, v15, v14
    v_fma_f32 v34, v34, v15, v14
    v_fma_f32 v35, v35, v15, v14
    v_fma_f32 v6, v6, v15, v14
    v_fma_f32 v16, v16, v15, v14
    v_fma_f32 v22, v22, v15, v14
    v_fma_f32 v23, v23, v15, v14
    v_mul_f32 v32, v32, v88
    v_mul_f32 v33, v33, v89
    v_mul_f32 v34, v34, v90
    v_mul_f32 v35, v35, v91
    v_mul_f32 v6, v6, v92
    v_mul_f32 v16, v16, v93
    v_mul_f32 v22, v22, v94
    v_mul_f32 v23, v23, v95
    v_exp_f32 v32, v32
    v_exp_f32 v33, v33
    v_exp_f32 v34, v34
    v_exp_f32 v35, v35
    v_exp_f32 v6, v6
    v_exp_f32 v16, v16
    v_exp_f32 v22, v22
    v_exp_f32 v23, v23
    v_add_f32 v32, 1.0, v32
    v_add_f32 v33, 1.0, v33
    v_add_f32 v34, 1.0, v34
    v_add_f32 v35, 1.0, v35
    v_add_f32 v6, 1.0, v6
    v_add_f32 v16, 1.0, v16
    v_add_f32 v22, 1.0, v22
    v_add_f32 v23, 1.0, v23
    v_rcp_f32 v32, v32
    v_rcp_f32 v33, v33
    v_rcp_f32 v34, v34
    v_rcp_f32 v35, v35
    v_rcp_f32 v6, v6
    v_rcp_f32 v16, v16
    v_rcp_f32 v22, v22
    v_rcp_f32 v23, v23
    v_mul_f32 v88, v88, v32
    v_mul_f32 v89, v89, v33
    v_mul_f32 v90, v90, v34
    v_mul_f32 v91, v91, v35
    v_mul_f32 v92, v92, v6
    v_mul_f32 v93, v93, v16
    v_mul_f32 v94, v94, v22
    v_mul_f32 v95, v95, v23
    v_cvt_pk_bf16_f32 v38, v88, v89
    v_cvt_pk_bf16_f32 v39, v90, v91
    v_cvt_pk_bf16_f32 v42, v92, v93
    v_cvt_pk_bf16_f32 v43, v94, v95
    buffer_store_dwordx4 v[36:39], v20, s[20:23], s52 offen offset:0 sc1
    buffer_store_dwordx4 v[40:43], v20, s[20:23], s52 offen offset:512 sc1
    s_waitcnt vmcnt(4)
    s_barrier
    s_cmp_eq_u32 s3, 4
    s_cbranch_scc0 parallel_sum__linear_kernel_hedgehog__mixer_gmlp__prompt_kernel_zf_208
    s_lshl_b32 s39, s33, 4
    s_add_u32 s39, s39, s32
    s_lshl_b32 s39, s39, 7
    s_add_u32 s39, s39, 45023232
    v_mov_b32 v8, v60
    v_mov_b32 v9, v60
    v_mov_b32 v10, v60
    v_mov_b32 v11, v60
    s_mov_b64 exec, 0xff
    buffer_store_dwordx4 v[8:11], v0, s[20:23], s39 offen sc1
    s_mov_b64 exec, -1
parallel_sum__linear_kernel_hedgehog__mixer_gmlp__prompt_kernel_zf_208:
parallel_sum__linear_kernel_hedgehog__mixer_gmlp__prompt_kernel_rpk:
    s_lshr_b32 s60, s33, 2
    s_lshl_b32 s60, s60, 4
    s_add_u32 s60, s60, s32
    s_lshl_b32 s60, s60, 3
    s_add_u32 s60, s60, s3
    s_mov_b32 s49, s60
    s_cmp_ge_u32 s60, 720
    s_cbranch_scc1 parallel_sum__linear_kernel_hedgehog__mixer_gmlp__prompt_kernel_rpa
    s_lshr_b32 s61, s60, 3
    s_and_b32 s62, s60, 7
    s_cmp_lt_u32 s61, 72
    s_cselect_b32 s28, s70, s72
    s_cselect_b32 s29, s71, s73
    s_mov_b32 s30, 663552
    s_cselect_b32 s30, 2654208, s30
    s_mov_b32 s31, 0x20000
    s_mov_b32 s63, 9216
    s_cselect_b32 s63, 18432, s63
    s_mov_b32 s64, 2304
    s_mov_b32 s65, 20736
    s_cselect_b32 s65, 9216, s65
    s_mov_b32 s66, 4608
    s_mul_i32 s67, s61, 36864
    s_sub_u32 s68, s61, 72
    s_mul_i32 s68, s68, 41472
    s_cmp_lt_u32 s61, 72
    s_cselect_b32 s67, s67, s68
    s_sub_u32 s68, s61, 88
    s_mul_i32 s68, s68, 331776
    s_add_u32 s68, s68, 18432
    s_cmp_ge_u32 s61, 88
    s_cselect_b32 s67, s68, s67
    s_cselect_b32 s63, 41472, s63
    s_cselect_b32 s64, 20736, s64
    s_cselect_b32 s65, 165888, s65
    s_cselect_b32 s66, 82944, s66
    s_mul_i32 s68, s62, 144
    s_add_u32 s67, s67, s68
    v_lshrrev_b32 v180, 9, v0
    v_mul_lo_u32 v180, v180, s64
    v_bfe_u32 v181, v0, 8, 1
    v_mul_u32_u24 v181, 1152, v181
    v_add_u32 v180, v180, v181
    v_and_b32 v181, 0xf0, v0
    v_add_u32 v180, v180, v181
    v_mov_b32 v182, 1073741824
    v_cmp_gt_u32 vcc, 144, v181
    s_lshl_b32 s48, s3, 13
    s_add_u32 s48, s48, 0
    s_nop 0
    v_cndmask_b32 v180, v182, v180, vcc
    s_add_u32 m0, s48, 0
    s_mov_b32 s68, s67
    buffer_load_dwordx4 v180, s[28:31], s68 offen lds
    s_add_u32 m0, s48, 1024
    s_mov_b32 s68, s67
    s_add_u32 s68, s68, s66
    buffer_load_dwordx4 v180, s[28:31], s68 offen lds
    s_add_u32 m0, s48, 2048
    s_mov_b32 s68, s67
    s_add_u32 s68, s68, s65
    buffer_load_dwordx4 v180, s[28:31], s68 offen lds
    s_add_u32 m0, s48, 3072
    s_mov_b32 s68, s67
    s_add_u32 s68, s68, s65
    s_add_u32 s68, s68, s66
    buffer_load_dwordx4 v180, s[28:31], s68 offen lds
    s_add_u32 m0, s48, 4096
    s_mov_b32 s68, s67
    s_add_u32 s68, s68, s63
    buffer_load_dwordx4 v180, s[28:31], s68 offen lds
    s_add_u32 m0, s48, 5120
    s_mov_b32 s68, s67
    s_add_u32 s68, s68, s63
    s_add_u32 s68, s68, s66
    buffer_load_dwordx4 v180, s[28:31], s68 offen lds
    s_add_u32 m0, s48, 6144
    s_mov_b32 s68, s67
    s_add_u32 s68, s68, s63
    s_add_u32 s68, s68, s65
    buffer_load_dwordx4 v180, s[28:31], s68 offen lds
    s_add_u32 m0, s48, 7168
    s_mov_b32 s68, s67
    s_add_u32 s68, s68, s63
    s_add_u32 s68, s68, s65
    s_add_u32 s68, s68, s66
    buffer_load_dwordx4 v180, s[28:31], s68 offen lds
parallel_sum__linear_kernel_hedgehog__mixer_gmlp__prompt_kernel_rpa:
    s_mov_b32 s50, s61
    s_mov_b32 s51, s62
    s_add_u32 s60, s60, 384
    s_cmp_ge_u32 s60, 720
    s_cbranch_scc1 parallel_sum__linear_kernel_hedgehog__mixer_gmlp__prompt_kernel_rpb
    s_lshr_b32 s61, s60, 3
    s_and_b32 s62, s60, 7
    s_cmp_lt_u32 s61, 72
    s_cselect_b32 s28, s70, s72
    s_cselect_b32 s29, s71, s73
    s_mov_b32 s30, 663552
    s_cselect_b32 s30, 2654208, s30
    s_mov_b32 s31, 0x20000
    s_mov_b32 s63, 9216
    s_cselect_b32 s63, 18432, s63
    s_mov_b32 s64, 2304
    s_mov_b32 s65, 20736
    s_cselect_b32 s65, 9216, s65
    s_mov_b32 s66, 4608
    s_mul_i32 s67, s61, 36864
    s_sub_u32 s68, s61, 72
    s_mul_i32 s68, s68, 41472
    s_cmp_lt_u32 s61, 72
    s_cselect_b32 s67, s67, s68
    s_sub_u32 s68, s61, 88
    s_mul_i32 s68, s68, 331776
    s_add_u32 s68, s68, 18432
    s_cmp_ge_u32 s61, 88
    s_cselect_b32 s67, s68, s67
    s_cselect_b32 s63, 41472, s63
    s_cselect_b32 s64, 20736, s64
    s_cselect_b32 s65, 165888, s65
    s_cselect_b32 s66, 82944, s66
    s_mul_i32 s68, s62, 144
    s_add_u32 s67, s67, s68
    v_lshrrev_b32 v180, 9, v0
    v_mul_lo_u32 v180, v180, s64
    v_bfe_u32 v181, v0, 8, 1
    v_mul_u32_u24 v181, 1152, v181
    v_add_u32 v180, v180, v181
    v_and_b32 v181, 0xf0, v0
    v_add_u32 v180, v180, v181
    v_mov_b32 v182, 1073741824
    v_cmp_gt_u32 vcc, 144, v181
    s_lshl_b32 s48, s3, 13
    s_add_u32 s48, s48, 65536
    s_nop 0
    v_cndmask_b32 v180, v182, v180, vcc
    s_add_u32 m0, s48, 0
    s_mov_b32 s68, s67
    buffer_load_dwordx4 v180, s[28:31], s68 offen lds
    s_add_u32 m0, s48, 1024
    s_mov_b32 s68, s67
    s_add_u32 s68, s68, s66
    buffer_load_dwordx4 v180, s[28:31], s68 offen lds
    s_add_u32 m0, s48, 2048
    s_mov_b32 s68, s67
    s_add_u32 s68, s68, s65
    buffer_load_dwordx4 v180, s[28:31], s68 offen lds
    s_add_u32 m0, s48, 3072
    s_mov_b32 s68, s67
    s_add_u32 s68, s68, s65
    s_add_u32 s68, s68, s66
    buffer_load_dwordx4 v180, s[28:31], s68 offen lds
    s_add_u32 m0, s48, 4096
    s_mov_b32 s68, s67
    s_add_u32 s68, s68, s63
    buffer_load_dwordx4 v180, s[28:31], s68 offen lds
    s_add_u32 m0, s48, 5120
    s_mov_b32 s68, s67
    s_add_u32 s68, s68, s63
    s_add_u32 s68, s68, s66
    buffer_load_dwordx4 v180, s[28:31], s68 offen lds
    s_add_u32 m0, s48, 6144
    s_mov_b32 s68, s67
    s_add_u32 s68, s68, s63
    s_add_u32 s68, s68, s65
    buffer_load_dwordx4 v180, s[28:31], s68 offen lds
    s_add_u32 m0, s48, 7168
    s_mov_b32 s68, s67
    s_add_u32 s68, s68, s63
    s_add_u32 s68, s68, s65
    s_add_u32 s68, s68, s66
    buffer_load_dwordx4 v180, s[28:31], s68 offen lds
parallel_sum__linear_kernel_hedgehog__mixer_gmlp__prompt_kernel_rpb:
    s_mov_b32 s52, s61
    s_mov_b32 s53, s62
    s_mov_b32 s54, s60
    s_mov_b32 s61, s50
    s_mov_b32 s62, s51
    s_mov_b32 s60, s49
    s_lshl_b32 s48, s3, 13
    s_waitcnt vmcnt(0)
    s_cmp_ge_u32 s60, 720
    s_cbranch_scc1 parallel_sum__linear_kernel_hedgehog__mixer_gmlp__prompt_kernel_rpsa
    v_lshrrev_b32 v181, 6, v0
    v_lshlrev_b32 v181, 8, v181
    v_bfe_u32 v182, v0, 4, 2
    v_lshl_add_u32 v181, v182, 3, v181
    v_add_u32 v181, s48, v181
    s_and_b32 s63, s62, 1
    s_lshl_b32 s64, s63, 4
    v_add_u32 v182, s64, v181
    s_lshl_b32 s64, s63, 7
    s_sub_u32 s65, 128, s64
    v_add_u32 v181, s65, v181
    ds_read_b64_tr_b16 v[160:161], v182 offset:0
    ds_read_b64_tr_b16 v[162:163], v182 offset:4096
    ds_read_b64_tr_b16 v[164:165], v182 offset:32
    ds_read_b64_tr_b16 v[166:167], v182 offset:4128
    ds_read_b64_tr_b16 v[168:169], v182 offset:64
    ds_read_b64_tr_b16 v[170:171], v182 offset:4160
    ds_read_b64_tr_b16 v[172:173], v182 offset:96
    ds_read_b64_tr_b16 v[174:175], v182 offset:4192
    ds_read_b64_tr_b16 v[176:177], v181
    ds_read_b64_tr_b16 v[178:179], v181 offset:4096
    s_lshr_b32 s68, s62, 1
    s_mul_i32 s68, s68, 90
    s_add_u32 s68, s68, s61
    s_mul_i32 s68, s68, 9216
    s_add_u32 s68, s68, 33554432
    s_add_u32 s65, s68, s64
    s_add_u32 s65, s65, 4096
    s_mul_i32 s63, s63, 5120
    s_add_u32 s68, s68, s63
    v_and_b32 v182, 0x80, v0
    v_cmp_eq_u32 vcc, 0, v182
    v_mov_b32 v182, 1073741824
    s_nop 0
    v_cndmask_b32 v181, v182, v0, vcc
    s_waitcnt lgkmcnt(0)
    buffer_store_dwordx4 v[160:163], v0, s[20:23], s68 offen offset:0 sc1
    buffer_store_dwordx4 v[164:167], v0, s[20:23], s68 offen offset:1024 sc1
    buffer_store_dwordx4 v[168:171], v0, s[20:23], s68 offen offset:2048 sc1
    buffer_store_dwordx4 v[172:175], v0, s[20:23], s68 offen offset:3072 sc1
    buffer_store_dwordx4 v[176:179], v181, s[20:23], s65 offen sc1
parallel_sum__linear_kernel_hedgehog__mixer_gmlp__prompt_kernel_rpsa:
    s_mov_b32 s61, s52
    s_mov_b32 s62, s53
    s_mov_b32 s60, s54
    s_add_u32 s48, s48, 65536
    s_nop 1
    s_cmp_ge_u32 s60, 720
    s_cbranch_scc1 parallel_sum__linear_kernel_hedgehog__mixer_gmlp__prompt_kernel_rpsb
    v_lshrrev_b32 v181, 6, v0
    v_lshlrev_b32 v181, 8, v181
    v_bfe_u32 v182, v0, 4, 2
    v_lshl_add_u32 v181, v182, 3, v181
    v_add_u32 v181, s48, v181
    s_and_b32 s63, s62, 1
    s_lshl_b32 s64, s63, 4
    v_add_u32 v182, s64, v181
    s_lshl_b32 s64, s63, 7
    s_sub_u32 s65, 128, s64
    v_add_u32 v181, s65, v181
    ds_read_b64_tr_b16 v[160:161], v182 offset:0
    ds_read_b64_tr_b16 v[162:163], v182 offset:4096
    ds_read_b64_tr_b16 v[164:165], v182 offset:32
    ds_read_b64_tr_b16 v[166:167], v182 offset:4128
    ds_read_b64_tr_b16 v[168:169], v182 offset:64
    ds_read_b64_tr_b16 v[170:171], v182 offset:4160
    ds_read_b64_tr_b16 v[172:173], v182 offset:96
    ds_read_b64_tr_b16 v[174:175], v182 offset:4192
    ds_read_b64_tr_b16 v[176:177], v181
    ds_read_b64_tr_b16 v[178:179], v181 offset:4096
    s_lshr_b32 s68, s62, 1
    s_mul_i32 s68, s68, 90
    s_add_u32 s68, s68, s61
    s_mul_i32 s68, s68, 9216
    s_add_u32 s68, s68, 33554432
    s_add_u32 s65, s68, s64
    s_add_u32 s65, s65, 4096
    s_mul_i32 s63, s63, 5120
    s_add_u32 s68, s68, s63
    v_and_b32 v182, 0x80, v0
    v_cmp_eq_u32 vcc, 0, v182
    v_mov_b32 v182, 1073741824
    s_nop 0
    v_cndmask_b32 v181, v182, v0, vcc
    s_waitcnt lgkmcnt(0)
    buffer_store_dwordx4 v[160:163], v0, s[20:23], s68 offen offset:0 sc1
    buffer_store_dwordx4 v[164:167], v0, s[20:23], s68 offen offset:1024 sc1
    buffer_store_dwordx4 v[168:171], v0, s[20:23], s68 offen offset:2048 sc1
    buffer_store_dwordx4 v[172:175], v0, s[20:23], s68 offen offset:3072 sc1
    buffer_store_dwordx4 v[176:179], v181, s[20:23], s65 offen sc1
parallel_sum__linear_kernel_hedgehog__mixer_gmlp__prompt_kernel_rpsb:
parallel_sum__linear_kernel_hedgehog__mixer_gmlp__prompt_kernel_ztail:
    v_readfirstlane_b32 s69, v60
    s_lshl_b32 s68, s33, 4
    s_add_u32 s68, s68, s32
    s_branch parallel_sum__linear_kernel_hedgehog__mixer_gmlp__prompt_kernel_p2
parallel_sum__linear_kernel_hedgehog__mixer_gmlp__prompt_kernel_attn:
    s_sub_u32 s33, s31, 24
    s_lshl_b32 s32, s35, 2
    s_and_b32 s34, s33, 3
    s_add_u32 s32, s32, s34
    s_lshr_b32 s33, s33, 2
    s_lshl_b32 s34, s30, 1
    s_add_u32 s33, s33, s34
    s_and_b32 s34, s33, 1
    s_mul_i32 s36, s33, 144
    s_lshl_b32 s37, s34, 4
    s_sub_u32 s37, s36, s37
    s_add_u32 s37, s37, 1152
    s_add_u32 s36, s36, 2144
    v_lshrrev_b32 v28, 3, v2
    v_and_b32 v29, 7, v2
    v_lshrrev_b32 v31, 4, v2
    v_xor_b32 v31, v31, v29
    v_mul_u32_u24 v8, 1152, v28
    v_lshl_add_u32 v8, v31, 4, v8
    v_xor_b32 v9, 64, v8
    v_add_u32 v10, 16384, v8
    v_add_u32 v11, 24576, v9
    v_add_u32 v9, 8192, v9
    s_lshl_b32 s43, s32, 8
    s_lshl_b32 s44, s3, 5
    s_add_u32 s43, s43, s44
    s_lshl_b32 s59, s43, 4
    s_add_u32 s59, s59, 43909120
    s_mul_i32 s43, s43, 1152
    s_lshl_b32 s44, s3, 12
    v_and_b32 v26, 3, v2
    v_lshrrev_b32 v30, 2, v2
    v_mul_u32_u24 v30, 3456, v30
    s_lshr_b32 s38, s3, 1
    s_lshl_b32 s38, s38, 2
    v_add_u32 v27, s38, v26
    v_cmp_gt_u32 vcc, 10, v27
    v_mov_b32 v5, s36
    v_mov_b32 v29, s37
    v_cndmask_b32 v5, v5, v29, vcc
    v_lshl_add_u32 v5, v27, 4, v5
    v_add_u32 v5, v5, v30
    v_add_u32 v6, 54272, v5
    s_and_b32 s40, s3, 1
    s_mul_i32 s40, s40, 110592
    s_lshl_b32 s42, s3, 11
    s_add_u32 s42, s42, 98304
    s_waitcnt lgkmcnt(0)
    s_mov_b32 s8, s4
    s_mov_b32 s9, s5
    s_mov_b32 s10, 2359296
    s_mov_b32 s11, 0x20000
    s_mov_b32 s16, s6
    s_mov_b32 s17, s7
    s_mov_b32 s18, 1990656
    s_mov_b32 s19, 0x20000
    s_add_u32 m0, s44, 0
    s_add_u32 s46, s43, 0
    buffer_load_dwordx4 v8, s[8:11], s46 offen offset:0 lds
    buffer_load_dwordx4 v9, s[8:11], s46 offen offset:1024 lds
    buffer_load_dwordx4 v10, s[8:11], s46 offen offset:2048 lds
    buffer_load_dwordx4 v11, s[8:11], s46 offen offset:3072 lds
    s_add_u32 m0, s42, 0
    s_add_u32 s46, s40, 0
    buffer_load_dwordx4 v5, s[16:19], s46 offen offset:0 lds
    buffer_load_dwordx4 v6, s[16:19], s46 offen offset:1024 lds
    s_mov_b32 s24, s64
    s_mov_b32 s25, s65
    s_mov_b32 s26, 256
    s_mov_b32 s27, 0x20000
    s_mov_b32 s20, s66
    s_mov_b32 s21, s67
    s_mov_b32 s22, 57671680
    s_mov_b32 s23, 0x20000
    s_load_dwordx4 s[4:7], s[0:1], 48
    s_load_dwordx2 s[88:89], s[0:1], 72
    s_lshl_b32 s38, s3, 2
    v_add_u32 v27, s38, v26
    v_cmp_gt_u32 vcc, 10, v27
    v_mov_b32 v28, s36
    v_mov_b32 v29, s37
    v_cndmask_b32 v28, v28, v29, vcc
    v_lshl_add_u32 v28, v27, 4, v28
    v_add_u32 v28, v28, v30
    v_mov_b32 v31, 1073741824
    s_cmp_lt_u32 s3, 5
    s_cselect_b64 vcc, -1, 0
    v_cndmask_b32 v28, v31, v28, vcc
    v_cmp_gt_u32 vcc, 32, v2
    s_mul_i32 s39, s32, 248832
    s_nop 0
    v_cndmask_b32 v29, v31, v28, vcc
    buffer_load_dwordx4 v[216:219], v28, s[16:19], s39 offen
    s_add_u32 s39, s39, 55296
    buffer_load_dwordx4 v[220:223], v28, s[16:19], s39 offen
    s_add_u32 s39, s39, 55296
    buffer_load_dwordx4 v[224:227], v28, s[16:19], s39 offen
    s_add_u32 s39, s39, 55296
    buffer_load_dwordx4 v[228:231], v28, s[16:19], s39 offen
    s_add_u32 s39, s39, 55296
    buffer_load_dwordx4 v[232:235], v29, s[16:19], s39 offen
    s_mov_b32 s28, s74
    s_mov_b32 s29, s75
    s_mov_b32 s30, 20736
    s_mov_b32 s31, 0x20000
    s_min_u32 s38, s3, 3
    s_lshl_b32 s38, s38, 10
    s_add_u32 m0, s38, 157696
    s_mul_i32 s39, s33, 2592
    s_add_u32 s39, s39, s38
    v_lshlrev_b32 v0, 4, v2
    s_cmp_ge_u32 s3, 3
    s_cselect_b64 vcc, -1, 0
    v_add_u32 v28, s39, v0
    v_cndmask_b32 v28, v28, v31, vcc
    buffer_load_dwordx4 v28, s[28:31], 0 offen lds
    s_cmp_eq_u32 s3, 0
    s_cselect_b32 s38, 0, 1073741824
    v_mov_b32 v4, s38
    s_add_u32 m0, s44, 32768
    s_add_u32 s46, s43, 128
    buffer_load_dwordx4 v8, s[8:11], s46 offen offset:0 lds
    buffer_load_dwordx4 v9, s[8:11], s46 offen offset:1024 lds
    buffer_load_dwordx4 v10, s[8:11], s46 offen offset:2048 lds
    buffer_load_dwordx4 v11, s[8:11], s46 offen offset:3072 lds
    s_add_u32 m0, s42, 16384
    s_add_u32 s46, s40, 221184
    buffer_load_dwordx4 v5, s[16:19], s46 offen offset:0 lds
    buffer_load_dwordx4 v6, s[16:19], s46 offen offset:1024 lds
    buffer_load_dword v14, v4, s[24:27], 0 offen sc1
    v_add_u32 v27, 16, v26
    v_cmp_gt_u32 vcc, 10, v27
    v_mov_b32 v7, s36
    v_mov_b32 v29, s37
    v_cndmask_b32 v7, v7, v29, vcc
    v_lshl_add_u32 v7, v27, 4, v7
    v_add_u32 v7, v7, v30
    s_mul_i32 s41, s3, 55296
    s_lshl_b32 s48, s3, 10
    v_lshrrev_b32 v24, 5, v2
    v_and_b32 v22, 15, v2
    v_lshrrev_b32 v23, 2, v22
    v_and_b32 v22, 3, v22
    v_bfe_u32 v25, v2, 4, 1
    v_lshl_add_u32 v12, v24, 3, v23
    v_lshlrev_b32 v1, 6, v12
    v_lshl_add_u32 v1, v25, 5, v1
    v_lshl_add_u32 v3, v22, 3, v1
    v_add_u32 v1, 98304, v3
    v_and_b32 v32, 31, v2
    v_bfe_u32 v33, v2, 1, 3
    v_xor_b32 v33, v33, v24
    v_lshlrev_b32 v33, 4, v33
    v_lshl_add_u32 v16, v32, 7, v33
    v_add_u32 v16, s44, v16
    v_xor_b32 v17, 32, v16
    v_xor_b32 v18, 64, v16
    v_xor_b32 v19, 96, v16
    v_lshlrev_b32 v21, 3, v32
    s_waitcnt vmcnt(13)
    s_barrier
    ds_read_b128 v[112:115], v16 offset:0
    ds_read_b64_tr_b16 v[24:25], v1 offset:0
    ds_read_b64_tr_b16 v[26:27], v1 offset:256
    ds_read_b64_tr_b16 v[28:29], v1 offset:4096
    ds_read_b64_tr_b16 v[30:31], v1 offset:4352
    ds_read_b64_tr_b16 v[32:33], v1 offset:8192
    ds_read_b64_tr_b16 v[34:35], v1 offset:8448
    s_waitcnt lgkmcnt(4)
    ds_read_b64_tr_b16 v[36:37], v1 offset:12288
    ds_read_b64_tr_b16 v[38:39], v1 offset:12544
    v_mfma_f32_32x32x16_bf16 v[48:63], v[24:27], v[112:115], 0
    s_mul_i32 s57, s33, 10240
    s_add_u32 s57, s57, 44728320
    s_mul_i32 s47, s32, 1280
    s_add_u32 s47, s47, s57
    s_lshl_b32 s50, s3, 8
    s_add_u32 s47, s47, s50
    s_waitcnt lgkmcnt(4)
    ds_read_b128 v[116:119], v17 offset:0
    ds_read_b64_tr_b16 v[24:25], v1 offset:1024
    ds_read_b64_tr_b16 v[26:27], v1 offset:1280
    v_mfma_f32_32x32x16_bf16 v[64:79], v[28:31], v[112:115], 0
    s_add_u32 m0, s44, 65536
    s_add_u32 s46, s43, 256
    buffer_load_dwordx4 v8, s[8:11], s46 offen offset:0 lds
    v_and_b32 v250, 3, v2
    v_lshlrev_b32 v250, 6, v250
    v_lshrrev_b32 v249, 4, v2
    v_lshl_add_u32 v250, v249, 3, v250
    v_and_b32 v249, 12, v2
    v_cmp_eq_u32 vcc, 0, v249
    s_waitcnt lgkmcnt(5)
    ds_read_b64_tr_b16 v[28:29], v1 offset:5120
    ds_read_b64_tr_b16 v[30:31], v1 offset:5376
    v_mfma_f32_32x32x16_bf16 v[80:95], v[32:35], v[112:115], 0
    s_mov_b32 s62, 0x00003f80
    s_mov_b32 s63, 0x3f800000
    v_mov_b32 v249, 1073741824
    s_cmp_ge_u32 s3, 5
    s_cselect_b64 vcc, 0, vcc
    v_cndmask_b32 v250, v249, v250, vcc
    s_waitcnt vmcnt(9)
    v_lshlrev_b32 v236, 16, v216
    s_waitcnt lgkmcnt(5)
    ds_read_b64_tr_b16 v[32:33], v1 offset:9216
    ds_read_b64_tr_b16 v[34:35], v1 offset:9472
    v_mfma_f32_32x32x16_bf16 v[96:111], v[36:39], v[112:115], 0
    buffer_load_dwordx4 v9, s[8:11], s46 offen offset:1024 lds
    v_and_b32 v237, 0xffff0000, v216
    v_lshlrev_b32 v238, 16, v217
    v_and_b32 v239, 0xffff0000, v217
    v_lshlrev_b32 v240, 16, v218
    v_and_b32 v241, 0xffff0000, v218
    v_lshlrev_b32 v242, 16, v219
    s_waitcnt lgkmcnt(4)
    ds_read_b64_tr_b16 v[36:37], v1 offset:13312
    ds_read_b64_tr_b16 v[38:39], v1 offset:13568
    v_mfma_f32_32x32x16_bf16 v[48:63], v[24:27], v[116:119], v[48:63]
    v_and_b32 v243, 0xffff0000, v219
    v_dot2c_f32_bf16 v236, s62, v220
    v_dot2c_f32_bf16 v237, s63, v220
    v_dot2c_f32_bf16 v238, s62, v221
    v_dot2c_f32_bf16 v239, s63, v221
    v_dot2c_f32_bf16 v240, s62, v222
    s_waitcnt lgkmcnt(4)
    ds_read_b128 v[120:123], v18 offset:0
    ds_read_b64_tr_b16 v[24:25], v1 offset:2048
    ds_read_b64_tr_b16 v[26:27], v1 offset:2304
    v_mfma_f32_32x32x16_bf16 v[64:79], v[28:31], v[116:119], v[64:79]
    buffer_load_dwordx4 v10, s[8:11], s46 offen offset:2048 lds
    v_dot2c_f32_bf16 v241, s63, v222
    v_dot2c_f32_bf16 v242, s62, v223
    v_dot2c_f32_bf16 v243, s63, v223
    v_dot2c_f32_bf16 v236, s62, v224
    v_dot2c_f32_bf16 v237, s63, v224
    v_dot2c_f32_bf16 v238, s62, v225
    s_waitcnt lgkmcnt(5)
    ds_read_b64_tr_b16 v[28:29], v1 offset:6144
    ds_read_b64_tr_b16 v[30:31], v1 offset:6400
    v_mfma_f32_32x32x16_bf16 v[80:95], v[32:35], v[116:119], v[80:95]
    v_dot2c_f32_bf16 v239, s63, v225
    v_dot2c_f32_bf16 v240, s62, v226
    v_dot2c_f32_bf16 v241, s63, v226
    v_dot2c_f32_bf16 v242, s62, v227
    v_dot2c_f32_bf16 v243, s63, v227
    v_dot2c_f32_bf16 v236, s62, v228
    s_waitcnt lgkmcnt(5)
    ds_read_b64_tr_b16 v[32:33], v1 offset:10240
    ds_read_b64_tr_b16 v[34:35], v1 offset:10496
    v_mfma_f32_32x32x16_bf16 v[96:111], v[36:39], v[116:119], v[96:111]
    buffer_load_dwordx4 v11, s[8:11], s46 offen offset:3072 lds
    v_dot2c_f32_bf16 v237, s63, v228
    v_dot2c_f32_bf16 v238, s62, v229
    v_dot2c_f32_bf16 v239, s63, v229
    v_dot2c_f32_bf16 v240, s62, v230
    v_dot2c_f32_bf16 v241, s63, v230
    v_dot2c_f32_bf16 v242, s62, v231
    s_waitcnt lgkmcnt(4)
    ds_read_b64_tr_b16 v[36:37], v1 offset:14336
    ds_read_b64_tr_b16 v[38:39], v1 offset:14592
    v_mfma_f32_32x32x16_bf16 v[48:63], v[24:27], v[120:123], v[48:63]
    v_dot2c_f32_bf16 v243, s63, v231
    v_dot2c_f32_bf16 v236, s62, v232
    v_dot2c_f32_bf16 v237, s63, v232
    v_dot2c_f32_bf16 v238, s62, v233
    v_dot2c_f32_bf16 v239, s63, v233
    v_dot2c_f32_bf16 v240, s62, v234
    s_waitcnt lgkmcnt(4)
    ds_read_b128 v[124:127], v19 offset:0
    ds_read_b64_tr_b16 v[24:25], v1 offset:3072
    ds_read_b64_tr_b16 v[26:27], v1 offset:3328
    v_mfma_f32_32x32x16_bf16 v[64:79], v[28:31], v[120:123], v[64:79]
    s_add_u32 m0, s42, 32768
    s_add_u32 s46, s40, 442368
    buffer_load_dwordx4 v5, s[16:19], s46 offen offset:0 lds
    v_dot2c_f32_bf16 v241, s63, v234
    v_dot2c_f32_bf16 v242, s62, v235
    v_dot2c_f32_bf16 v243, s63, v235
    s_nop 2
    v_add_f32_dpp v236, v236, v236 row_ror:4 row_mask:0xf bank_mask:0xf
    v_add_f32_dpp v237, v237, v237 row_ror:4 row_mask:0xf bank_mask:0xf
    s_waitcnt lgkmcnt(5)
    ds_read_b64_tr_b16 v[28:29], v1 offset:7168
    ds_read_b64_tr_b16 v[30:31], v1 offset:7424
    v_mfma_f32_32x32x16_bf16 v[80:95], v[32:35], v[120:123], v[80:95]
    v_add_f32_dpp v238, v238, v238 row_ror:4 row_mask:0xf bank_mask:0xf
    v_add_f32_dpp v239, v239, v239 row_ror:4 row_mask:0xf bank_mask:0xf
    v_add_f32_dpp v240, v240, v240 row_ror:4 row_mask:0xf bank_mask:0xf
    v_add_f32_dpp v241, v241, v241 row_ror:4 row_mask:0xf bank_mask:0xf
    v_add_f32_dpp v242, v242, v242 row_ror:4 row_mask:0xf bank_mask:0xf
    v_add_f32_dpp v243, v243, v243 row_ror:4 row_mask:0xf bank_mask:0xf
    s_waitcnt lgkmcnt(5)
    ds_read_b64_tr_b16 v[32:33], v1 offset:11264
    ds_read_b64_tr_b16 v[34:35], v1 offset:11520
    v_mfma_f32_32x32x16_bf16 v[96:111], v[36:39], v[120:123], v[96:111]
    buffer_load_dwordx4 v6, s[16:19], s46 offen offset:1024 lds
    v_add_f32_dpp v236, v236, v236 row_ror:8 row_mask:0xf bank_mask:0xf
    v_add_f32_dpp v237, v237, v237 row_ror:8 row_mask:0xf bank_mask:0xf
    v_add_f32_dpp v238, v238, v238 row_ror:8 row_mask:0xf bank_mask:0xf
    v_add_f32_dpp v239, v239, v239 row_ror:8 row_mask:0xf bank_mask:0xf
    v_add_f32_dpp v240, v240, v240 row_ror:8 row_mask:0xf bank_mask:0xf
    v_add_f32_dpp v241, v241, v241 row_ror:8 row_mask:0xf bank_mask:0xf
    s_waitcnt lgkmcnt(4)
    ds_read_b64_tr_b16 v[36:37], v1 offset:15360
    ds_read_b64_tr_b16 v[38:39], v1 offset:15616
    v_mfma_f32_32x32x16_bf16 v[48:63], v[24:27], v[124:127], v[48:63]
    v_add_f32_dpp v242, v242, v242 row_ror:8 row_mask:0xf bank_mask:0xf
    v_add_f32_dpp v243, v243, v243 row_ror:8 row_mask:0xf bank_mask:0xf
    s_nop 1
    v_permlane16_swap_b32 v236, v237
    v_permlane16_swap_b32 v238, v239
    v_permlane16_swap_b32 v240, v241
    s_waitcnt lgkmcnt(4)
    s_waitcnt vmcnt(6)
    s_cmp_eq_u32 s3, 0
    s_cbranch_scc0 parallel_sum__linear_kernel_hedgehog__mixer_gmlp__prompt_kernel_es_1001
    v_readfirstlane_b32 s69, v14
    s_mov_b32 s58, 400000
parallel_sum__linear_kernel_hedgehog__mixer_gmlp__prompt_kernel_epl_1002:
    s_cmp_lg_u32 s69, 0
    s_cbranch_scc1 parallel_sum__linear_kernel_hedgehog__mixer_gmlp__prompt_kernel_epk_1003
    s_sub_u32 s58, s58, 1
    s_cmp_eq_u32 s58, 0
    s_cbranch_scc1 parallel_sum__linear_kernel_hedgehog__mixer_gmlp__prompt_kernel_epk_1003
    s_sleep 4
    buffer_load_dword v14, v4, s[24:27], 0 offen sc1
    s_waitcnt vmcnt(0)
    v_readfirstlane_b32 s69, v14
    s_branch parallel_sum__linear_kernel_hedgehog__mixer_gmlp__prompt_kernel_epl_1002
parallel_sum__linear_kernel_hedgehog__mixer_gmlp__prompt_kernel_epk_1003:
    v_mov_b32 v4, 162812
    ds_write_b32 v4, v14
    s_waitcnt lgkmcnt(0)
parallel_sum__linear_kernel_hedgehog__mixer_gmlp__prompt_kernel_es_1001:
    s_waitcnt lgkmcnt(0)
    s_barrier
    v_mov_b32 v4, 162812
    ds_read_b128 v[128:131], v16 offset:32768
    ds_read_b64_tr_b16 v[24:25], v1 offset:16384
    ds_read_b64_tr_b16 v[26:27], v1 offset:16640
    v_mfma_f32_32x32x16_bf16 v[64:79], v[28:31], v[124:127], v[64:79]
    s_add_u32 m0, s44, 0
    s_add_u32 s46, s43, 384
    buffer_load_dwordx4 v8, s[8:11], s46 offen offset:0 lds
    v_permlane16_swap_b32 v242, v243
    s_nop 1
    v_add_f32 v236, v236, v237
    v_add_f32 v238, v238, v239
    v_add_f32 v240, v240, v241
    v_add_f32 v242, v242, v243
    ds_read_b64_tr_b16 v[28:29], v1 offset:20480
    ds_read_b64_tr_b16 v[30:31], v1 offset:20736
    v_mfma_f32_32x32x16_bf16 v[80:95], v[32:35], v[124:127], v[80:95]
    s_nop 1
    v_permlane32_swap_b32 v236, v238
    v_permlane32_swap_b32 v240, v242
    s_nop 1
    v_add_f32 v236, v236, v238
    v_add_f32 v240, v240, v242
    ds_read_b64_tr_b16 v[32:33], v1 offset:24576
    ds_read_b64_tr_b16 v[34:35], v1 offset:24832
    v_mfma_f32_32x32x16_bf16 v[96:111], v[36:39], v[124:127], v[96:111]
    buffer_load_dwordx4 v9, s[8:11], s46 offen offset:1024 lds
    ds_read_b32 v14, v4
    s_waitcnt lgkmcnt(0)
    v_mov_b32 v237, v14
    v_mov_b32 v241, v14
    buffer_store_dwordx2 v[236:237], v250, s[20:23], s47 offen sc1
    buffer_store_dwordx2 v[240:241], v250, s[20:23], s47 offen offset:32 sc1
    s_mul_i32 s50, s3, 160
    v_and_b32 v22, 7, v2
    v_lshrrev_b32 v23, 3, v2
    v_mul_u32_u24 v23, 1280, v23
    ds_read_b64_tr_b16 v[36:37], v1 offset:28672
    ds_read_b64_tr_b16 v[38:39], v1 offset:28928
    v_mfma_f32_32x32x16_bf16 v[48:63], v[24:27], v[128:131], v[48:63]
    v_lshl_add_u32 v23, v22, 3, v23
    v_add_u32 v23, s50, v23
    v_cmp_gt_u32 vcc, 4, v22
    v_mov_b32 v47, 1073741824
    s_lshr_b32 s50, s50, 1
    v_cndmask_b32 v47, v47, v23, vcc
    ds_read_b128 v[132:135], v17 offset:32768
    ds_read_b64_tr_b16 v[24:25], v1 offset:17408
    ds_read_b64_tr_b16 v[26:27], v1 offset:17664
    v_mfma_f32_32x32x16_bf16 v[64:79], v[28:31], v[128:131], v[64:79]
    buffer_load_dwordx4 v10, s[8:11], s46 offen offset:2048 lds
    s_add_u32 s50, s50, 161792
    v_lshl_add_u32 v20, v22, 2, s50
    v_lshlrev_b32 v15, 1, v21
    v_lshrrev_b32 v224, 5, v2
    v_bfe_u32 v225, v2, 3, 2
    v_and_b32 v226, 3, v2
    ds_read_b64_tr_b16 v[28:29], v1 offset:21504
    ds_read_b64_tr_b16 v[30:31], v1 offset:21760
    v_mfma_f32_32x32x16_bf16 v[80:95], v[32:35], v[128:131], v[80:95]
    v_lshl_add_u32 v225, v225, 2, v226
    s_lshr_b32 s50, s3, 1
    s_and_b32 s51, s3, 1
    s_lshl_b32 s51, s51, 4
    s_lshl_b32 s52, s50, 1
    s_sub_u32 s51, s51, s52
    s_waitcnt lgkmcnt(5)
    ds_read_b64_tr_b16 v[32:33], v1 offset:25600
    ds_read_b64_tr_b16 v[34:35], v1 offset:25856
    v_mfma_f32_32x32x16_bf16 v[96:111], v[36:39], v[128:131], v[96:111]
    buffer_load_dwordx4 v11, s[8:11], s46 offen offset:3072 lds
    s_lshl_b32 s52, s34, 3
    s_sub_u32 s51, s51, s52
    v_lshlrev_b32 v227, 2, v224
    v_add_u32 v228, s51, v227
    s_mul_i32 s50, s50, 648
    s_add_u32 s50, s50, 157696
    s_waitcnt lgkmcnt(4)
    ds_read_b64_tr_b16 v[36:37], v1 offset:29696
    ds_read_b64_tr_b16 v[38:39], v1 offset:29952
    v_mfma_f32_32x32x16_bf16 v[48:63], v[24:27], v[132:135], v[48:63]
    v_lshlrev_b32 v229, 1, v225
    v_add_u32 v229, s50, v229
    v_lshrrev_b32 v230, 1, v225
    s_lshl_b32 s53, s3, 4
    s_sub_u32 s53, s53, s52
    v_add_u32 v231, s53, v227
    s_waitcnt lgkmcnt(4)
    ds_read_b128 v[136:139], v18 offset:32768
    ds_read_b64_tr_b16 v[24:25], v1 offset:18432
    ds_read_b64_tr_b16 v[26:27], v1 offset:18688
    v_mfma_f32_32x32x16_bf16 v[64:79], v[28:31], v[132:135], v[64:79]
    s_add_u32 m0, s42, 0
    s_add_u32 s46, s40, 663552
    buffer_load_dwordx4 v5, s[16:19], s46 offen offset:0 lds
    v_mul_u32_u24 v226, 18, v230
    v_sub_u32 v231, v231, v226
    v_cmp_lt_u32 vcc, 7, v225
    v_mov_b32 v227, 1000
    v_mul_u32_u24 v230, 648, v230
    v_cndmask_b32 v231, v231, v227, vcc
    s_waitcnt lgkmcnt(5)
    ds_read_b64_tr_b16 v[28:29], v1 offset:22528
    ds_read_b64_tr_b16 v[30:31], v1 offset:22784
    v_mfma_f32_32x32x16_bf16 v[80:95], v[32:35], v[132:135], v[80:95]
    v_and_b32 v226, 1, v225
    v_lshl_add_u32 v230, v226, 1, v230
    v_add_u32 v230, 157728, v230
    v_mov_b32 v227, 160768
    v_add_u32 v226, 0, v228
    v_cmp_gt_u32 vcc, 18, v226
    s_waitcnt lgkmcnt(5)
    ds_read_b64_tr_b16 v[32:33], v1 offset:26624
    ds_read_b64_tr_b16 v[34:35], v1 offset:26880
    v_mfma_f32_32x32x16_bf16 v[96:111], v[36:39], v[132:135], v[96:111]
    buffer_load_dwordx4 v6, s[16:19], s46 offen offset:1024 lds
    v_mul_u32_u24 v226, 36, v226
    v_add_u32 v226, v226, v229
    v_cndmask_b32 v226, v227, v226, vcc
    ds_read_u16 v232, v226
    v_add_u32 v226, 1, v228
    v_cmp_gt_u32 vcc, 18, v226
    v_mul_u32_u24 v226, 36, v226
    s_waitcnt lgkmcnt(5)
    ds_read_b64_tr_b16 v[36:37], v1 offset:30720
    ds_read_b64_tr_b16 v[38:39], v1 offset:30976
    v_mfma_f32_32x32x16_bf16 v[48:63], v[24:27], v[136:139], v[48:63]
    v_add_u32 v226, v226, v229
    v_cndmask_b32 v226, v227, v226, vcc
    ds_read_u16 v233, v226
    v_add_u32 v226, 2, v228
    v_cmp_gt_u32 vcc, 18, v226
    v_mul_u32_u24 v226, 36, v226
    v_add_u32 v226, v226, v229
    s_waitcnt lgkmcnt(6)
    ds_read_b128 v[140:143], v19 offset:32768
    ds_read_b64_tr_b16 v[24:25], v1 offset:19456
    ds_read_b64_tr_b16 v[26:27], v1 offset:19712
    v_mfma_f32_32x32x16_bf16 v[64:79], v[28:31], v[136:139], v[64:79]
    v_cndmask_b32 v226, v227, v226, vcc
    ds_read_u16 v234, v226
    v_add_u32 v226, 3, v228
    v_cmp_gt_u32 vcc, 18, v226
    v_mul_u32_u24 v226, 36, v226
    v_add_u32 v226, v226, v229
    v_cndmask_b32 v226, v227, v226, vcc
    s_waitcnt lgkmcnt(8)
    ds_read_b64_tr_b16 v[28:29], v1 offset:23552
    ds_read_b64_tr_b16 v[30:31], v1 offset:23808
    v_mfma_f32_32x32x16_bf16 v[80:95], v[32:35], v[136:139], v[80:95]
    ds_read_u16 v235, v226
    v_add_u32 v226, 8, v228
    v_cmp_gt_u32 vcc, 18, v226
    v_mul_u32_u24 v226, 36, v226
    v_add_u32 v226, v226, v229
    v_cndmask_b32 v226, v227, v226, vcc
    ds_read_u16 v236, v226
    v_add_u32 v226, 9, v228
    s_waitcnt lgkmcnt(9)
    ds_read_b64_tr_b16 v[32:33], v1 offset:27648
    ds_read_b64_tr_b16 v[34:35], v1 offset:27904
    v_mfma_f32_32x32x16_bf16 v[96:111], v[36:39], v[136:139], v[96:111]
    v_cmp_gt_u32 vcc, 18, v226
    v_mul_u32_u24 v226, 36, v226
    v_add_u32 v226, v226, v229
    v_cndmask_b32 v226, v227, v226, vcc
    ds_read_u16 v237, v226
    v_add_u32 v226, 10, v228
    v_cmp_gt_u32 vcc, 18, v226
    s_waitcnt lgkmcnt(8)
    ds_read_b64_tr_b16 v[36:37], v1 offset:31744
    ds_read_b64_tr_b16 v[38:39], v1 offset:32000
    v_mfma_f32_32x32x16_bf16 v[48:63], v[24:27], v[140:143], v[48:63]
    v_mul_u32_u24 v226, 36, v226
    v_add_u32 v226, v226, v229
    v_cndmask_b32 v226, v227, v226, vcc
    ds_read_u16 v238, v226
    v_add_u32 v226, 11, v228
    v_cmp_gt_u32 vcc, 18, v226
    v_mul_u32_u24 v226, 36, v226
    s_waitcnt lgkmcnt(8)
    s_waitcnt vmcnt(8) lgkmcnt(0)
    s_barrier
    v_add_u32 v13, 65536, v16
    ds_read_b128 v[144:147], v13
    ds_read_b64_tr_b16 v[24:25], v1 offset:32768
    ds_read_b64_tr_b16 v[26:27], v1 offset:33024
    v_mfma_f32_32x32x16_bf16 v[64:79], v[28:31], v[140:143], v[64:79]
    s_add_u32 m0, s44, 32768
    s_add_u32 s46, s43, 512
    buffer_load_dwordx4 v8, s[8:11], s46 offen offset:0 lds
    v_add_u32 v226, v226, v229
    v_cndmask_b32 v226, v227, v226, vcc
    ds_read_u16 v239, v226
    v_add_u32 v226, 0, v231
    v_cmp_gt_u32 vcc, 18, v226
    v_mul_u32_u24 v226, 36, v226
    v_add_u32 v226, v226, v230
    ds_read_b64_tr_b16 v[28:29], v1 offset:36864
    ds_read_b64_tr_b16 v[30:31], v1 offset:37120
    v_mfma_f32_32x32x16_bf16 v[80:95], v[32:35], v[140:143], v[80:95]
    v_cndmask_b32 v226, v227, v226, vcc
    ds_read_u16 v240, v226
    v_add_u32 v226, 1, v231
    v_cmp_gt_u32 vcc, 18, v226
    v_mul_u32_u24 v226, 36, v226
    v_add_u32 v226, v226, v230
    v_cndmask_b32 v226, v227, v226, vcc
    ds_read_b64_tr_b16 v[32:33], v1 offset:40960
    ds_read_b64_tr_b16 v[34:35], v1 offset:41216
    v_mfma_f32_32x32x16_bf16 v[96:111], v[36:39], v[140:143], v[96:111]
    buffer_load_dwordx4 v9, s[8:11], s46 offen offset:1024 lds
    ds_read_u16 v241, v226
    v_add_u32 v226, 2, v231
    v_cmp_gt_u32 vcc, 18, v226
    v_mul_u32_u24 v226, 36, v226
    v_add_u32 v226, v226, v230
    v_cndmask_b32 v226, v227, v226, vcc
    ds_read_u16 v242, v226
    v_add_u32 v226, 3, v231
    s_waitcnt lgkmcnt(8)
    ds_read_b64_tr_b16 v[36:37], v1 offset:45056
    ds_read_b64_tr_b16 v[38:39], v1 offset:45312
    v_mfma_f32_32x32x16_bf16 v[48:63], v[24:27], v[144:147], v[48:63]
    v_cmp_gt_u32 vcc, 18, v226
    v_mul_u32_u24 v226, 36, v226
    v_add_u32 v226, v226, v230
    v_cndmask_b32 v226, v227, v226, vcc
    ds_read_u16 v243, v226
    v_add_u32 v226, 8, v231
    s_waitcnt lgkmcnt(8)
    v_add_u32 v13, 65536, v17
    ds_read_b128 v[148:151], v13
    ds_read_b64_tr_b16 v[24:25], v1 offset:33792
    ds_read_b64_tr_b16 v[26:27], v1 offset:34048
    v_mfma_f32_32x32x16_bf16 v[64:79], v[28:31], v[144:147], v[64:79]
    buffer_load_dwordx4 v10, s[8:11], s46 offen offset:2048 lds
    v_cmp_gt_u32 vcc, 18, v226
    v_mul_u32_u24 v226, 36, v226
    v_add_u32 v226, v226, v230
    v_cndmask_b32 v226, v227, v226, vcc
    ds_read_u16 v244, v226
    v_add_u32 v226, 9, v231
    s_waitcnt lgkmcnt(9)
    ds_read_b64_tr_b16 v[28:29], v1 offset:37888
    ds_read_b64_tr_b16 v[30:31], v1 offset:38144
    v_mfma_f32_32x32x16_bf16 v[80:95], v[32:35], v[144:147], v[80:95]
    v_cmp_gt_u32 vcc, 18, v226
    v_mul_u32_u24 v226, 36, v226
    v_add_u32 v226, v226, v230
    v_cndmask_b32 v226, v227, v226, vcc
    ds_read_u16 v245, v226
    v_add_u32 v226, 10, v231
    s_waitcnt lgkmcnt(8)
    ds_read_b64_tr_b16 v[32:33], v1 offset:41984
    ds_read_b64_tr_b16 v[34:35], v1 offset:42240
    v_mfma_f32_32x32x16_bf16 v[96:111], v[36:39], v[144:147], v[96:111]
    buffer_load_dwordx4 v11, s[8:11], s46 offen offset:3072 lds
    v_cmp_gt_u32 vcc, 18, v226
    v_mul_u32_u24 v226, 36, v226
    v_add_u32 v226, v226, v230
    v_cndmask_b32 v226, v227, v226, vcc
    ds_read_u16 v246, v226
    v_add_u32 v226, 11, v231
    s_waitcnt lgkmcnt(7)
    ds_read_b64_tr_b16 v[36:37], v1 offset:46080
    ds_read_b64_tr_b16 v[38:39], v1 offset:46336
    v_mfma_f32_32x32x16_bf16 v[48:63], v[24:27], v[148:151], v[48:63]
    v_cmp_gt_u32 vcc, 18, v226
    v_mul_u32_u24 v226, 36, v226
    v_add_u32 v226, v226, v230
    v_cndmask_b32 v226, v227, v226, vcc
    ds_read_u16 v247, v226
    v_bfe_u32 v224, v2, 2, 1
    s_waitcnt lgkmcnt(7)
    v_add_u32 v13, 65536, v18
    ds_read_b128 v[152:155], v13
    ds_read_b64_tr_b16 v[24:25], v1 offset:34816
    ds_read_b64_tr_b16 v[26:27], v1 offset:35072
    v_mfma_f32_32x32x16_bf16 v[64:79], v[28:31], v[148:151], v[64:79]
    s_add_u32 m0, s42, 16384
    s_add_u32 s46, s40, 884736
    buffer_load_dwordx4 v5, s[16:19], s46 offen offset:0 lds
    v_mov_b32 v225, 0x80008000
    v_mul_lo_u32 v224, v224, v225
    s_add_u32 s50, s48, 147456
    v_add_u32 v225, s50, v0
    s_min_u32 s51, s3, 5
    s_waitcnt lgkmcnt(7)
    ds_read_b64_tr_b16 v[28:29], v1 offset:38912
    ds_read_b64_tr_b16 v[30:31], v1 offset:39168
    v_mfma_f32_32x32x16_bf16 v[80:95], v[32:35], v[148:151], v[80:95]
    s_lshl_b32 s51, s51, 10
    s_add_u32 s50, s51, 155648
    v_add_u32 v226, s50, v0
    s_mul_i32 s52, s33, 13312
    s_add_u32 s52, s52, 41943040
    s_waitcnt lgkmcnt(6)
    ds_read_b64_tr_b16 v[32:33], v1 offset:43008
    ds_read_b64_tr_b16 v[34:35], v1 offset:43264
    v_mfma_f32_32x32x16_bf16 v[96:111], v[36:39], v[148:151], v[96:111]
    buffer_load_dwordx4 v6, s[16:19], s46 offen offset:1024 lds
    s_add_u32 s51, s51, s52
    s_add_u32 s51, s51, 8192
    s_add_u32 s52, s52, s48
    v_mov_b32 v227, 1073741824
    s_cmp_eq_u32 s32, 0
    s_cselect_b64 vcc, -1, 0
    s_waitcnt lgkmcnt(4)
    ds_read_b64_tr_b16 v[36:37], v1 offset:47104
    ds_read_b64_tr_b16 v[38:39], v1 offset:47360
    v_mfma_f32_32x32x16_bf16 v[48:63], v[24:27], v[152:155], v[48:63]
    v_cndmask_b32 v228, v227, v0, vcc
    s_cmp_ge_u32 s3, 5
    s_cselect_b64 vcc, 0, vcc
    v_cndmask_b32 v229, v227, v0, vcc
    v_lshl_or_b32 v248, v233, 16, v232
    v_xor_b32 v248, v248, v224
    s_waitcnt lgkmcnt(4)
    v_add_u32 v13, 65536, v19
    ds_read_b128 v[156:159], v13
    ds_read_b64_tr_b16 v[24:25], v1 offset:35840
    ds_read_b64_tr_b16 v[26:27], v1 offset:36096
    v_mfma_f32_32x32x16_bf16 v[64:79], v[28:31], v[152:155], v[64:79]
    v_lshl_or_b32 v249, v235, 16, v234
    v_xor_b32 v249, v249, v224
    v_lshl_or_b32 v250, v237, 16, v236
    v_xor_b32 v250, v250, v224
    v_lshl_or_b32 v251, v239, 16, v238
    s_waitcnt lgkmcnt(5)
    ds_read_b64_tr_b16 v[28:29], v1 offset:39936
    ds_read_b64_tr_b16 v[30:31], v1 offset:40192
    v_mfma_f32_32x32x16_bf16 v[80:95], v[32:35], v[152:155], v[80:95]
    v_xor_b32 v251, v251, v224
    v_lshl_or_b32 v252, v241, 16, v240
    v_xor_b32 v252, v252, v224
    v_lshl_or_b32 v253, v243, 16, v242
    v_xor_b32 v253, v253, v224
    s_waitcnt lgkmcnt(5)
    ds_read_b64_tr_b16 v[32:33], v1 offset:44032
    ds_read_b64_tr_b16 v[34:35], v1 offset:44288
    v_mfma_f32_32x32x16_bf16 v[96:111], v[36:39], v[152:155], v[96:111]
    v_lshl_or_b32 v254, v245, 16, v244
    v_xor_b32 v254, v254, v224
    v_lshl_or_b32 v255, v247, 16, v246
    v_xor_b32 v255, v255, v224
    s_waitcnt lgkmcnt(4)
    ds_read_b64_tr_b16 v[36:37], v1 offset:48128
    ds_read_b64_tr_b16 v[38:39], v1 offset:48384
    v_mfma_f32_32x32x16_bf16 v[48:63], v[24:27], v[156:159], v[48:63]
    s_waitcnt lgkmcnt(4)
    s_waitcnt vmcnt(6) lgkmcnt(0)
    s_barrier
    ds_read_b128 v[160:163], v16 offset:0
    ds_read_b64_tr_b16 v[24:25], v1 offset:0
    ds_read_b64_tr_b16 v[26:27], v1 offset:256
    v_mfma_f32_32x32x16_bf16 v[64:79], v[28:31], v[156:159], v[64:79]
    s_add_u32 m0, s44, 65536
    s_add_u32 s46, s43, 640
    buffer_load_dwordx4 v8, s[8:11], s46 offen offset:0 lds
    ds_write_b128 v225, v[248:251]
    ds_write_b128 v226, v[252:255]
    buffer_store_dwordx4 v[248:251], v228, s[20:23], s52 offen sc1
    buffer_store_dwordx4 v[252:255], v229, s[20:23], s51 offen sc1
    s_nop 1
    ds_read_b64_tr_b16 v[28:29], v1 offset:4096
    ds_read_b64_tr_b16 v[30:31], v1 offset:4352
    v_mfma_f32_32x32x16_bf16 v[80:95], v[32:35], v[156:159], v[80:95]
    ds_read_b64_tr_b16 v[32:33], v1 offset:8192
    ds_read_b64_tr_b16 v[34:35], v1 offset:8448
    v_mfma_f32_32x32x16_bf16 v[96:111], v[36:39], v[156:159], v[96:111]
    buffer_load_dwordx4 v9, s[8:11], s46 offen offset:1024 lds
    s_waitcnt lgkmcnt(6)
    ds_read_b64_tr_b16 v[36:37], v1 offset:12288
    ds_read_b64_tr_b16 v[38:39], v1 offset:12544
    v_mfma_f32_32x32x16_bf16 v[48:63], v[24:27], v[160:163], v[48:63]
    s_waitcnt lgkmcnt(4)
    ds_read_b128 v[164:167], v17 offset:0
    ds_read_b64_tr_b16 v[24:25], v1 offset:1024
    ds_read_b64_tr_b16 v[26:27], v1 offset:1280
    v_mfma_f32_32x32x16_bf16 v[64:79], v[28:31], v[160:163], v[64:79]
    buffer_load_dwordx4 v10, s[8:11], s46 offen offset:2048 lds
    s_waitcnt lgkmcnt(5)
    ds_read_b64_tr_b16 v[28:29], v1 offset:5120
    ds_read_b64_tr_b16 v[30:31], v1 offset:5376
    v_mfma_f32_32x32x16_bf16 v[80:95], v[32:35], v[160:163], v[80:95]
    s_waitcnt lgkmcnt(5)
    ds_read_b64_tr_b16 v[32:33], v1 offset:9216
    ds_read_b64_tr_b16 v[34:35], v1 offset:9472
    v_mfma_f32_32x32x16_bf16 v[96:111], v[36:39], v[160:163], v[96:111]
    buffer_load_dwordx4 v11, s[8:11], s46 offen offset:3072 lds
    s_waitcnt lgkmcnt(4)
    ds_read_b64_tr_b16 v[36:37], v1 offset:13312
    ds_read_b64_tr_b16 v[38:39], v1 offset:13568
    v_mfma_f32_32x32x16_bf16 v[48:63], v[24:27], v[164:167], v[48:63]
    s_waitcnt lgkmcnt(4)
    ds_read_b128 v[168:171], v18 offset:0
    ds_read_b64_tr_b16 v[24:25], v1 offset:2048
    ds_read_b64_tr_b16 v[26:27], v1 offset:2304
    v_mfma_f32_32x32x16_bf16 v[64:79], v[28:31], v[164:167], v[64:79]
    s_add_u32 m0, s42, 32768
    s_add_u32 s46, s40, 1105920
    buffer_load_dwordx4 v5, s[16:19], s46 offen offset:0 lds
    s_waitcnt lgkmcnt(5)
    ds_read_b64_tr_b16 v[28:29], v1 offset:6144
    ds_read_b64_tr_b16 v[30:31], v1 offset:6400
    v_mfma_f32_32x32x16_bf16 v[80:95], v[32:35], v[164:167], v[80:95]
    s_waitcnt lgkmcnt(5)
    ds_read_b64_tr_b16 v[32:33], v1 offset:10240
    ds_read_b64_tr_b16 v[34:35], v1 offset:10496
    v_mfma_f32_32x32x16_bf16 v[96:111], v[36:39], v[164:167], v[96:111]
    buffer_load_dwordx4 v6, s[16:19], s46 offen offset:1024 lds
    s_waitcnt lgkmcnt(4)
    ds_read_b64_tr_b16 v[36:37], v1 offset:14336
    ds_read_b64_tr_b16 v[38:39], v1 offset:14592
    v_mfma_f32_32x32x16_bf16 v[48:63], v[24:27], v[168:171], v[48:63]
    s_waitcnt lgkmcnt(4)
    ds_read_b128 v[172:175], v19 offset:0
    ds_read_b64_tr_b16 v[24:25], v1 offset:3072
    ds_read_b64_tr_b16 v[26:27], v1 offset:3328
    v_mfma_f32_32x32x16_bf16 v[64:79], v[28:31], v[168:171], v[64:79]
    s_waitcnt lgkmcnt(5)
    ds_read_b64_tr_b16 v[28:29], v1 offset:7168
    ds_read_b64_tr_b16 v[30:31], v1 offset:7424
    v_mfma_f32_32x32x16_bf16 v[80:95], v[32:35], v[168:171], v[80:95]
    s_waitcnt lgkmcnt(5)
    ds_read_b64_tr_b16 v[32:33], v1 offset:11264
    ds_read_b64_tr_b16 v[34:35], v1 offset:11520
    v_mfma_f32_32x32x16_bf16 v[96:111], v[36:39], v[168:171], v[96:111]
    s_waitcnt lgkmcnt(4)
    ds_read_b64_tr_b16 v[36:37], v1 offset:15360
    ds_read_b64_tr_b16 v[38:39], v1 offset:15616
    v_mfma_f32_32x32x16_bf16 v[48:63], v[24:27], v[172:175], v[48:63]
    s_waitcnt lgkmcnt(4)
    s_waitcnt vmcnt(8) lgkmcnt(0)
    s_barrier
    ds_read_b128 v[176:179], v16 offset:32768
    ds_read_b64_tr_b16 v[24:25], v1 offset:16384
    ds_read_b64_tr_b16 v[26:27], v1 offset:16640
    v_mfma_f32_32x32x16_bf16 v[64:79], v[28:31], v[172:175], v[64:79]
    s_add_u32 m0, s44, 0
    s_add_u32 s46, s43, 768
    buffer_load_dwordx4 v8, s[8:11], s46 offen offset:0 lds
    ds_read_b64_tr_b16 v[28:29], v1 offset:20480
    ds_read_b64_tr_b16 v[30:31], v1 offset:20736
    v_mfma_f32_32x32x16_bf16 v[80:95], v[32:35], v[172:175], v[80:95]
    ds_read_b64_tr_b16 v[32:33], v1 offset:24576
    ds_read_b64_tr_b16 v[34:35], v1 offset:24832
    v_mfma_f32_32x32x16_bf16 v[96:111], v[36:39], v[172:175], v[96:111]
    buffer_load_dwordx4 v9, s[8:11], s46 offen offset:1024 lds
    s_waitcnt lgkmcnt(4)
    ds_read_b64_tr_b16 v[36:37], v1 offset:28672
    ds_read_b64_tr_b16 v[38:39], v1 offset:28928
    v_mfma_f32_32x32x16_bf16 v[48:63], v[24:27], v[176:179], v[48:63]
    s_waitcnt lgkmcnt(4)
    ds_read_b128 v[180:183], v17 offset:32768
    ds_read_b64_tr_b16 v[24:25], v1 offset:17408
    ds_read_b64_tr_b16 v[26:27], v1 offset:17664
    v_mfma_f32_32x32x16_bf16 v[64:79], v[28:31], v[176:179], v[64:79]
    buffer_load_dwordx4 v10, s[8:11], s46 offen offset:2048 lds
    s_waitcnt lgkmcnt(5)
    ds_read_b64_tr_b16 v[28:29], v1 offset:21504
    ds_read_b64_tr_b16 v[30:31], v1 offset:21760
    v_mfma_f32_32x32x16_bf16 v[80:95], v[32:35], v[176:179], v[80:95]
    s_waitcnt lgkmcnt(5)
    ds_read_b64_tr_b16 v[32:33], v1 offset:25600
    ds_read_b64_tr_b16 v[34:35], v1 offset:25856
    v_mfma_f32_32x32x16_bf16 v[96:111], v[36:39], v[176:179], v[96:111]
    buffer_load_dwordx4 v11, s[8:11], s46 offen offset:3072 lds
    s_waitcnt lgkmcnt(4)
    ds_read_b64_tr_b16 v[36:37], v1 offset:29696
    ds_read_b64_tr_b16 v[38:39], v1 offset:29952
    v_mfma_f32_32x32x16_bf16 v[48:63], v[24:27], v[180:183], v[48:63]
    s_waitcnt lgkmcnt(4)
    ds_read_b128 v[184:187], v18 offset:32768
    ds_read_b64_tr_b16 v[24:25], v1 offset:18432
    ds_read_b64_tr_b16 v[26:27], v1 offset:18688
    v_mfma_f32_32x32x16_bf16 v[64:79], v[28:31], v[180:183], v[64:79]
    s_add_u32 m0, s42, 0
    s_add_u32 s46, s40, 1327104
    buffer_load_dwordx4 v5, s[16:19], s46 offen offset:0 lds
    s_waitcnt lgkmcnt(5)
    ds_read_b64_tr_b16 v[28:29], v1 offset:22528
    ds_read_b64_tr_b16 v[30:31], v1 offset:22784
    v_mfma_f32_32x32x16_bf16 v[80:95], v[32:35], v[180:183], v[80:95]
    s_waitcnt lgkmcnt(5)
    ds_read_b64_tr_b16 v[32:33], v1 offset:26624
    ds_read_b64_tr_b16 v[34:35], v1 offset:26880
    v_mfma_f32_32x32x16_bf16 v[96:111], v[36:39], v[180:183], v[96:111]
    buffer_load_dwordx4 v6, s[16:19], s46 offen offset:1024 lds
    s_waitcnt lgkmcnt(4)
    ds_read_b64_tr_b16 v[36:37], v1 offset:30720
    ds_read_b64_tr_b16 v[38:39], v1 offset:30976
    v_mfma_f32_32x32x16_bf16 v[48:63], v[24:27], v[184:187], v[48:63]
    s_waitcnt lgkmcnt(4)
    ds_read_b128 v[188:191], v19 offset:32768
    ds_read_b64_tr_b16 v[24:25], v1 offset:19456
    ds_read_b64_tr_b16 v[26:27], v1 offset:19712
    v_mfma_f32_32x32x16_bf16 v[64:79], v[28:31], v[184:187], v[64:79]
    s_waitcnt lgkmcnt(5)
    ds_read_b64_tr_b16 v[28:29], v1 offset:23552
    ds_read_b64_tr_b16 v[30:31], v1 offset:23808
    v_mfma_f32_32x32x16_bf16 v[80:95], v[32:35], v[184:187], v[80:95]
    s_waitcnt lgkmcnt(5)
    ds_read_b64_tr_b16 v[32:33], v1 offset:27648
    ds_read_b64_tr_b16 v[34:35], v1 offset:27904
    v_mfma_f32_32x32x16_bf16 v[96:111], v[36:39], v[184:187], v[96:111]
    s_waitcnt lgkmcnt(4)
    ds_read_b64_tr_b16 v[36:37], v1 offset:31744
    ds_read_b64_tr_b16 v[38:39], v1 offset:32000
    v_mfma_f32_32x32x16_bf16 v[48:63], v[24:27], v[188:191], v[48:63]
    s_waitcnt lgkmcnt(4)
    s_waitcnt vmcnt(6) lgkmcnt(0)
    s_barrier
    v_add_u32 v13, 65536, v16
    ds_read_b128 v[192:195], v13
    ds_read_b64_tr_b16 v[24:25], v1 offset:32768
    ds_read_b64_tr_b16 v[26:27], v1 offset:33024
    v_mfma_f32_32x32x16_bf16 v[64:79], v[28:31], v[188:191], v[64:79]
    s_add_u32 m0, s44, 32768
    s_add_u32 s46, s43, 896
    buffer_load_dwordx4 v8, s[8:11], s46 offen offset:0 lds
    ds_read_b64_tr_b16 v[28:29], v1 offset:36864
    ds_read_b64_tr_b16 v[30:31], v1 offset:37120
    v_mfma_f32_32x32x16_bf16 v[80:95], v[32:35], v[188:191], v[80:95]
    ds_read_b64_tr_b16 v[32:33], v1 offset:40960
    ds_read_b64_tr_b16 v[34:35], v1 offset:41216
    v_mfma_f32_32x32x16_bf16 v[96:111], v[36:39], v[188:191], v[96:111]
    buffer_load_dwordx4 v9, s[8:11], s46 offen offset:1024 lds
    s_waitcnt lgkmcnt(4)
    ds_read_b64_tr_b16 v[36:37], v1 offset:45056
    ds_read_b64_tr_b16 v[38:39], v1 offset:45312
    v_mfma_f32_32x32x16_bf16 v[48:63], v[24:27], v[192:195], v[48:63]
    s_waitcnt lgkmcnt(4)
    v_add_u32 v13, 65536, v17
    ds_read_b128 v[196:199], v13
    ds_read_b64_tr_b16 v[24:25], v1 offset:33792
    ds_read_b64_tr_b16 v[26:27], v1 offset:34048
    v_mfma_f32_32x32x16_bf16 v[64:79], v[28:31], v[192:195], v[64:79]
    buffer_load_dwordx4 v10, s[8:11], s46 offen offset:2048 lds
    s_waitcnt lgkmcnt(5)
    ds_read_b64_tr_b16 v[28:29], v1 offset:37888
    ds_read_b64_tr_b16 v[30:31], v1 offset:38144
    v_mfma_f32_32x32x16_bf16 v[80:95], v[32:35], v[192:195], v[80:95]
    s_waitcnt lgkmcnt(5)
    ds_read_b64_tr_b16 v[32:33], v1 offset:41984
    ds_read_b64_tr_b16 v[34:35], v1 offset:42240
    v_mfma_f32_32x32x16_bf16 v[96:111], v[36:39], v[192:195], v[96:111]
    buffer_load_dwordx4 v11, s[8:11], s46 offen offset:3072 lds
    s_waitcnt lgkmcnt(4)
    ds_read_b64_tr_b16 v[36:37], v1 offset:46080
    ds_read_b64_tr_b16 v[38:39], v1 offset:46336
    v_mfma_f32_32x32x16_bf16 v[48:63], v[24:27], v[196:199], v[48:63]
    s_waitcnt lgkmcnt(4)
    v_add_u32 v13, 65536, v18
    ds_read_b128 v[200:203], v13
    ds_read_b64_tr_b16 v[24:25], v1 offset:34816
    ds_read_b64_tr_b16 v[26:27], v1 offset:35072
    v_mfma_f32_32x32x16_bf16 v[64:79], v[28:31], v[196:199], v[64:79]
    s_add_u32 m0, s42, 16384
    s_add_u32 s46, s40, 1548288
    buffer_load_dwordx4 v5, s[16:19], s46 offen offset:0 lds
    s_waitcnt lgkmcnt(5)
    ds_read_b64_tr_b16 v[28:29], v1 offset:38912
    ds_read_b64_tr_b16 v[30:31], v1 offset:39168
    v_mfma_f32_32x32x16_bf16 v[80:95], v[32:35], v[196:199], v[80:95]
    s_waitcnt lgkmcnt(5)
    ds_read_b64_tr_b16 v[32:33], v1 offset:43008
    ds_read_b64_tr_b16 v[34:35], v1 offset:43264
    v_mfma_f32_32x32x16_bf16 v[96:111], v[36:39], v[196:199], v[96:111]
    buffer_load_dwordx4 v6, s[16:19], s46 offen offset:1024 lds
    s_waitcnt lgkmcnt(4)
    ds_read_b64_tr_b16 v[36:37], v1 offset:47104
    ds_read_b64_tr_b16 v[38:39], v1 offset:47360
    v_mfma_f32_32x32x16_bf16 v[48:63], v[24:27], v[200:203], v[48:63]
    s_waitcnt lgkmcnt(4)
    v_add_u32 v13, 65536, v19
    ds_read_b128 v[204:207], v13
    ds_read_b64_tr_b16 v[24:25], v1 offset:35840
    ds_read_b64_tr_b16 v[26:27], v1 offset:36096
    v_mfma_f32_32x32x16_bf16 v[64:79], v[28:31], v[200:203], v[64:79]
    s_waitcnt lgkmcnt(5)
    ds_read_b64_tr_b16 v[28:29], v1 offset:39936
    ds_read_b64_tr_b16 v[30:31], v1 offset:40192
    v_mfma_f32_32x32x16_bf16 v[80:95], v[32:35], v[200:203], v[80:95]
    s_waitcnt lgkmcnt(5)
    ds_read_b64_tr_b16 v[32:33], v1 offset:44032
    ds_read_b64_tr_b16 v[34:35], v1 offset:44288
    v_mfma_f32_32x32x16_bf16 v[96:111], v[36:39], v[200:203], v[96:111]
    s_waitcnt lgkmcnt(4)
    ds_read_b64_tr_b16 v[36:37], v1 offset:48128
    ds_read_b64_tr_b16 v[38:39], v1 offset:48384
    v_mfma_f32_32x32x16_bf16 v[48:63], v[24:27], v[204:207], v[48:63]
    s_waitcnt lgkmcnt(4)
    s_waitcnt vmcnt(6) lgkmcnt(0)
    s_barrier
    ds_read_b128 v[208:211], v16 offset:0
    ds_read_b64_tr_b16 v[24:25], v1 offset:0
    ds_read_b64_tr_b16 v[26:27], v1 offset:256
    v_mfma_f32_32x32x16_bf16 v[64:79], v[28:31], v[204:207], v[64:79]
    s_add_u32 m0, s44, 65536
    s_add_u32 s46, s43, 1024
    buffer_load_dwordx4 v8, s[8:11], s46 offen offset:0 lds
    ds_read_b64_tr_b16 v[28:29], v1 offset:4096
    ds_read_b64_tr_b16 v[30:31], v1 offset:4352
    v_mfma_f32_32x32x16_bf16 v[80:95], v[32:35], v[204:207], v[80:95]
    ds_read_b64_tr_b16 v[32:33], v1 offset:8192
    ds_read_b64_tr_b16 v[34:35], v1 offset:8448
    v_mfma_f32_32x32x16_bf16 v[96:111], v[36:39], v[204:207], v[96:111]
    buffer_load_dwordx4 v9, s[8:11], s46 offen offset:1024 lds
    s_waitcnt lgkmcnt(4)
    ds_read_b64_tr_b16 v[36:37], v1 offset:12288
    ds_read_b64_tr_b16 v[38:39], v1 offset:12544
    v_mfma_f32_32x32x16_bf16 v[48:63], v[24:27], v[208:211], v[48:63]
    s_waitcnt lgkmcnt(4)
    ds_read_b128 v[212:215], v17 offset:0
    ds_read_b64_tr_b16 v[24:25], v1 offset:1024
    ds_read_b64_tr_b16 v[26:27], v1 offset:1280
    v_mfma_f32_32x32x16_bf16 v[64:79], v[28:31], v[208:211], v[64:79]
    buffer_load_dwordx4 v10, s[8:11], s46 offen offset:2048 lds
    s_waitcnt lgkmcnt(5)
    ds_read_b64_tr_b16 v[28:29], v1 offset:5120
    ds_read_b64_tr_b16 v[30:31], v1 offset:5376
    v_mfma_f32_32x32x16_bf16 v[80:95], v[32:35], v[208:211], v[80:95]
    s_waitcnt lgkmcnt(5)
    ds_read_b64_tr_b16 v[32:33], v1 offset:9216
    ds_read_b64_tr_b16 v[34:35], v1 offset:9472
    v_mfma_f32_32x32x16_bf16 v[96:111], v[36:39], v[208:211], v[96:111]
    buffer_load_dwordx4 v11, s[8:11], s46 offen offset:3072 lds
    s_waitcnt lgkmcnt(4)
    ds_read_b64_tr_b16 v[36:37], v1 offset:13312
    ds_read_b64_tr_b16 v[38:39], v1 offset:13568
    v_mfma_f32_32x32x16_bf16 v[48:63], v[24:27], v[212:215], v[48:63]
    s_waitcnt lgkmcnt(4)
    ds_read_b128 v[216:219], v18 offset:0
    ds_read_b64_tr_b16 v[24:25], v1 offset:2048
    ds_read_b64_tr_b16 v[26:27], v1 offset:2304
    v_mfma_f32_32x32x16_bf16 v[64:79], v[28:31], v[212:215], v[64:79]
    s_add_u32 m0, s42, 32768
    s_add_u32 s46, s40, 1769472
    buffer_load_dwordx4 v5, s[16:19], s46 offen offset:0 lds
    s_waitcnt lgkmcnt(5)
    ds_read_b64_tr_b16 v[28:29], v1 offset:6144
    ds_read_b64_tr_b16 v[30:31], v1 offset:6400
    v_mfma_f32_32x32x16_bf16 v[80:95], v[32:35], v[212:215], v[80:95]
    s_waitcnt lgkmcnt(5)
    ds_read_b64_tr_b16 v[32:33], v1 offset:10240
    ds_read_b64_tr_b16 v[34:35], v1 offset:10496
    v_mfma_f32_32x32x16_bf16 v[96:111], v[36:39], v[212:215], v[96:111]
    buffer_load_dwordx4 v6, s[16:19], s46 offen offset:1024 lds
    s_waitcnt lgkmcnt(4)
    ds_read_b64_tr_b16 v[36:37], v1 offset:14336
    ds_read_b64_tr_b16 v[38:39], v1 offset:14592
    v_mfma_f32_32x32x16_bf16 v[48:63], v[24:27], v[216:219], v[48:63]
    s_waitcnt lgkmcnt(4)
    ds_read_b128 v[220:223], v19 offset:0
    ds_read_b64_tr_b16 v[24:25], v1 offset:3072
    ds_read_b64_tr_b16 v[26:27], v1 offset:3328
    v_mfma_f32_32x32x16_bf16 v[64:79], v[28:31], v[216:219], v[64:79]
    s_waitcnt lgkmcnt(5)
    ds_read_b64_tr_b16 v[28:29], v1 offset:7168
    ds_read_b64_tr_b16 v[30:31], v1 offset:7424
    v_mfma_f32_32x32x16_bf16 v[80:95], v[32:35], v[216:219], v[80:95]
    s_waitcnt lgkmcnt(5)
    ds_read_b64_tr_b16 v[32:33], v1 offset:11264
    ds_read_b64_tr_b16 v[34:35], v1 offset:11520
    v_mfma_f32_32x32x16_bf16 v[96:111], v[36:39], v[216:219], v[96:111]
    s_waitcnt lgkmcnt(4)
    ds_read_b64_tr_b16 v[36:37], v1 offset:15360
    ds_read_b64_tr_b16 v[38:39], v1 offset:15616
    v_mfma_f32_32x32x16_bf16 v[48:63], v[24:27], v[220:223], v[48:63]
    s_waitcnt lgkmcnt(4)
    s_waitcnt vmcnt(6) lgkmcnt(0)
    s_barrier
    buffer_load_dwordx4 v[8:11], v15, s[20:23], s59 offen
    buffer_load_dwordx2 v[40:41], v23, s[20:23], s57 offen offset:0
    buffer_load_dwordx2 v[42:43], v23, s[20:23], s57 offen offset:64
    buffer_load_dwordx2 v[44:45], v47, s[20:23], s57 offen offset:128
    ds_read_b128 v[224:227], v16 offset:32768
    ds_read_b64_tr_b16 v[24:25], v1 offset:16384
    ds_read_b64_tr_b16 v[26:27], v1 offset:16640
    v_mfma_f32_32x32x16_bf16 v[64:79], v[28:31], v[220:223], v[64:79]
    s_add_u32 m0, s48, 0
    s_add_u32 s46, s41, 0
    buffer_load_dwordx4 v7, s[16:19], s46 offen lds
    ds_read_b64_tr_b16 v[28:29], v1 offset:20480
    ds_read_b64_tr_b16 v[30:31], v1 offset:20736
    v_mfma_f32_32x32x16_bf16 v[80:95], v[32:35], v[220:223], v[80:95]
    ds_read_b64_tr_b16 v[32:33], v1 offset:24576
    ds_read_b64_tr_b16 v[34:35], v1 offset:24832
    v_mfma_f32_32x32x16_bf16 v[96:111], v[36:39], v[220:223], v[96:111]
    s_add_u32 m0, s48, 8192
    s_add_u32 s46, s41, 442368
    buffer_load_dwordx4 v7, s[16:19], s46 offen lds
    s_waitcnt lgkmcnt(4)
    ds_read_b64_tr_b16 v[36:37], v1 offset:28672
    ds_read_b64_tr_b16 v[38:39], v1 offset:28928
    v_mfma_f32_32x32x16_bf16 v[48:63], v[24:27], v[224:227], v[48:63]
    s_waitcnt lgkmcnt(4)
    ds_read_b128 v[228:231], v17 offset:32768
    ds_read_b64_tr_b16 v[24:25], v1 offset:17408
    ds_read_b64_tr_b16 v[26:27], v1 offset:17664
    v_mfma_f32_32x32x16_bf16 v[64:79], v[28:31], v[224:227], v[64:79]
    s_add_u32 m0, s48, 16384
    s_add_u32 s46, s41, 884736
    buffer_load_dwordx4 v7, s[16:19], s46 offen lds
    s_waitcnt lgkmcnt(5)
    ds_read_b64_tr_b16 v[28:29], v1 offset:21504
    ds_read_b64_tr_b16 v[30:31], v1 offset:21760
    v_mfma_f32_32x32x16_bf16 v[80:95], v[32:35], v[224:227], v[80:95]
    s_waitcnt lgkmcnt(5)
    ds_read_b64_tr_b16 v[32:33], v1 offset:25600
    ds_read_b64_tr_b16 v[34:35], v1 offset:25856
    v_mfma_f32_32x32x16_bf16 v[96:111], v[36:39], v[224:227], v[96:111]
    s_add_u32 m0, s48, 24576
    s_add_u32 s46, s41, 1327104
    buffer_load_dwordx4 v7, s[16:19], s46 offen lds
    s_waitcnt lgkmcnt(4)
    ds_read_b64_tr_b16 v[36:37], v1 offset:29696
    ds_read_b64_tr_b16 v[38:39], v1 offset:29952
    v_mfma_f32_32x32x16_bf16 v[48:63], v[24:27], v[228:231], v[48:63]
    s_waitcnt lgkmcnt(4)
    ds_read_b128 v[232:235], v18 offset:32768
    ds_read_b64_tr_b16 v[24:25], v1 offset:18432
    ds_read_b64_tr_b16 v[26:27], v1 offset:18688
    v_mfma_f32_32x32x16_bf16 v[64:79], v[28:31], v[228:231], v[64:79]
    s_waitcnt lgkmcnt(5)
    ds_read_b64_tr_b16 v[28:29], v1 offset:22528
    ds_read_b64_tr_b16 v[30:31], v1 offset:22784
    v_mfma_f32_32x32x16_bf16 v[80:95], v[32:35], v[228:231], v[80:95]
    s_waitcnt lgkmcnt(5)
    ds_read_b64_tr_b16 v[32:33], v1 offset:26624
    ds_read_b64_tr_b16 v[34:35], v1 offset:26880
    v_mfma_f32_32x32x16_bf16 v[96:111], v[36:39], v[228:231], v[96:111]
    s_waitcnt lgkmcnt(4)
    ds_read_b64_tr_b16 v[36:37], v1 offset:30720
    ds_read_b64_tr_b16 v[38:39], v1 offset:30976
    v_mfma_f32_32x32x16_bf16 v[48:63], v[24:27], v[232:235], v[48:63]
    s_waitcnt lgkmcnt(4)
    ds_read_b128 v[236:239], v19 offset:32768
    ds_read_b64_tr_b16 v[24:25], v1 offset:19456
    ds_read_b64_tr_b16 v[26:27], v1 offset:19712
    v_mfma_f32_32x32x16_bf16 v[64:79], v[28:31], v[232:235], v[64:79]
    s_waitcnt lgkmcnt(5)
    ds_read_b64_tr_b16 v[28:29], v1 offset:23552
    ds_read_b64_tr_b16 v[30:31], v1 offset:23808
    v_mfma_f32_32x32x16_bf16 v[80:95], v[32:35], v[232:235], v[80:95]
    s_waitcnt lgkmcnt(5)
    ds_read_b64_tr_b16 v[32:33], v1 offset:27648
    ds_read_b64_tr_b16 v[34:35], v1 offset:27904
    v_mfma_f32_32x32x16_bf16 v[96:111], v[36:39], v[232:235], v[96:111]
    s_waitcnt lgkmcnt(4)
    ds_read_b64_tr_b16 v[36:37], v1 offset:31744
    ds_read_b64_tr_b16 v[38:39], v1 offset:32000
    v_mfma_f32_32x32x16_bf16 v[48:63], v[24:27], v[236:239], v[48:63]
    s_waitcnt lgkmcnt(4)
    s_waitcnt vmcnt(8) lgkmcnt(0)
    s_barrier
    v_add_u32 v13, 65536, v16
    ds_read_b128 v[240:243], v13
    ds_read_b64_tr_b16 v[24:25], v1 offset:32768
    ds_read_b64_tr_b16 v[26:27], v1 offset:33024
    v_mfma_f32_32x32x16_bf16 v[64:79], v[28:31], v[236:239], v[64:79]
    s_add_u32 m0, s48, 32768
    s_add_u32 s46, s41, 1769472
    v_add_u32 v22, s46, v7
    buffer_load_dwordx4 v22, s[16:19], 0 offen lds
    ds_read_b64_tr_b16 v[28:29], v1 offset:36864
    ds_read_b64_tr_b16 v[30:31], v1 offset:37120
    v_mfma_f32_32x32x16_bf16 v[80:95], v[32:35], v[236:239], v[80:95]
    ds_read_b64_tr_b16 v[32:33], v1 offset:40960
    ds_read_b64_tr_b16 v[34:35], v1 offset:41216
    v_mfma_f32_32x32x16_bf16 v[96:111], v[36:39], v[236:239], v[96:111]
    s_waitcnt lgkmcnt(4)
    ds_read_b64_tr_b16 v[36:37], v1 offset:45056
    ds_read_b64_tr_b16 v[38:39], v1 offset:45312
    v_mfma_f32_32x32x16_bf16 v[48:63], v[24:27], v[240:243], v[48:63]
    s_waitcnt lgkmcnt(4)
    v_add_u32 v13, 65536, v17
    ds_read_b128 v[244:247], v13
    ds_read_b64_tr_b16 v[24:25], v1 offset:33792
    ds_read_b64_tr_b16 v[26:27], v1 offset:34048
    v_mfma_f32_32x32x16_bf16 v[64:79], v[28:31], v[240:243], v[64:79]
    s_waitcnt lgkmcnt(5)
    ds_read_b64_tr_b16 v[28:29], v1 offset:37888
    ds_read_b64_tr_b16 v[30:31], v1 offset:38144
    v_mfma_f32_32x32x16_bf16 v[80:95], v[32:35], v[240:243], v[80:95]
    s_waitcnt lgkmcnt(5)
    ds_read_b64_tr_b16 v[32:33], v1 offset:41984
    ds_read_b64_tr_b16 v[34:35], v1 offset:42240
    v_mfma_f32_32x32x16_bf16 v[96:111], v[36:39], v[240:243], v[96:111]
    s_waitcnt lgkmcnt(4)
    ds_read_b64_tr_b16 v[36:37], v1 offset:46080
    ds_read_b64_tr_b16 v[38:39], v1 offset:46336
    v_mfma_f32_32x32x16_bf16 v[48:63], v[24:27], v[244:247], v[48:63]
    s_waitcnt lgkmcnt(4)
    v_add_u32 v13, 65536, v18
    ds_read_b128 v[248:251], v13
    ds_read_b64_tr_b16 v[24:25], v1 offset:34816
    ds_read_b64_tr_b16 v[26:27], v1 offset:35072
    v_mfma_f32_32x32x16_bf16 v[64:79], v[28:31], v[244:247], v[64:79]
    s_waitcnt lgkmcnt(5)
    ds_read_b64_tr_b16 v[28:29], v1 offset:38912
    ds_read_b64_tr_b16 v[30:31], v1 offset:39168
    v_mfma_f32_32x32x16_bf16 v[80:95], v[32:35], v[244:247], v[80:95]
    s_waitcnt lgkmcnt(5)
    ds_read_b64_tr_b16 v[32:33], v1 offset:43008
    ds_read_b64_tr_b16 v[34:35], v1 offset:43264
    v_mfma_f32_32x32x16_bf16 v[96:111], v[36:39], v[244:247], v[96:111]
    s_waitcnt lgkmcnt(4)
    ds_read_b64_tr_b16 v[36:37], v1 offset:47104
    ds_read_b64_tr_b16 v[38:39], v1 offset:47360
    v_mfma_f32_32x32x16_bf16 v[48:63], v[24:27], v[248:251], v[48:63]
    s_waitcnt lgkmcnt(4)
    v_add_u32 v13, 65536, v19
    ds_read_b128 v[252:255], v13
    ds_read_b64_tr_b16 v[24:25], v1 offset:35840
    ds_read_b64_tr_b16 v[26:27], v1 offset:36096
    v_mfma_f32_32x32x16_bf16 v[64:79], v[28:31], v[248:251], v[64:79]
    s_waitcnt lgkmcnt(5)
    ds_read_b64_tr_b16 v[28:29], v1 offset:39936
    ds_read_b64_tr_b16 v[30:31], v1 offset:40192
    v_mfma_f32_32x32x16_bf16 v[80:95], v[32:35], v[248:251], v[80:95]
    s_waitcnt lgkmcnt(5)
    ds_read_b64_tr_b16 v[32:33], v1 offset:44032
    ds_read_b64_tr_b16 v[34:35], v1 offset:44288
    v_mfma_f32_32x32x16_bf16 v[96:111], v[36:39], v[248:251], v[96:111]
    s_waitcnt lgkmcnt(4)
    ds_read_b64_tr_b16 v[36:37], v1 offset:48128
    ds_read_b64_tr_b16 v[38:39], v1 offset:48384
    v_mfma_f32_32x32x16_bf16 v[48:63], v[24:27], v[252:255], v[48:63]
    s_waitcnt lgkmcnt(4)
    v_mfma_f32_32x32x16_bf16 v[64:79], v[28:31], v[252:255], v[64:79]
    s_waitcnt lgkmcnt(2)
    v_mfma_f32_32x32x16_bf16 v[80:95], v[32:35], v[252:255], v[80:95]
    s_waitcnt lgkmcnt(0)
    v_mfma_f32_32x32x16_bf16 v[96:111], v[36:39], v[252:255], v[96:111]
    s_waitcnt vmcnt(5)
    s_mov_b32 s58, 100000
parallel_sum__linear_kernel_hedgehog__mixer_gmlp__prompt_kernel_tg_1004:
    v_min3_u32 v4, v41, v43, v9
    v_max3_u32 v5, v41, v43, v9
    v_min3_u32 v4, v4, v11, v11
    v_max3_u32 v5, v5, v11, v11
    v_xor_b32 v4, v4, v14
    v_xor_b32 v5, v5, v14
    v_or_b32 v4, v4, v5
    v_cmp_ne_u32 vcc, 0, v4
    s_sub_u32 s58, s58, 1
    s_cmp_eq_u32 s58, 0
    s_cbranch_scc1 parallel_sum__linear_kernel_hedgehog__mixer_gmlp__prompt_kernel_tk_1005
    s_cmp_eq_u64 vcc, 0
    s_cbranch_scc1 parallel_sum__linear_kernel_hedgehog__mixer_gmlp__prompt_kernel_tk_1005
    s_sleep 8
    buffer_load_dwordx4 v[8:11], v15, s[20:23], s59 offen sc1
    buffer_load_dwordx2 v[40:41], v23, s[20:23], s57 offen offset:0 sc1
    buffer_load_dwordx2 v[42:43], v23, s[20:23], s57 offen offset:64 sc1
    buffer_load_dwordx2 v[44:45], v47, s[20:23], s57 offen offset:128 sc1
    s_waitcnt vmcnt(0)
    s_branch parallel_sum__linear_kernel_hedgehog__mixer_gmlp__prompt_kernel_tg_1004
parallel_sum__linear_kernel_hedgehog__mixer_gmlp__prompt_kernel_tk_1005:
    s_mov_b32 s58, 100000
parallel_sum__linear_kernel_hedgehog__mixer_gmlp__prompt_kernel_tg_1006:
    v_min3_u32 v4, v45, v45, v45
    v_max3_u32 v5, v45, v45, v45
    v_xor_b32 v4, v4, v14
    v_xor_b32 v5, v5, v14
    v_or_b32 v4, v4, v5
    v_lshrrev_b32 v5, 30, v47
    v_subrev_u32 v5, 1, v5
    v_and_b32 v4, v4, v5
    v_cmp_ne_u32 vcc, 0, v4
    s_sub_u32 s58, s58, 1
    s_cmp_eq_u32 s58, 0
    s_cbranch_scc1 parallel_sum__linear_kernel_hedgehog__mixer_gmlp__prompt_kernel_tk_1007
    s_cmp_eq_u64 vcc, 0
    s_cbranch_scc1 parallel_sum__linear_kernel_hedgehog__mixer_gmlp__prompt_kernel_tk_1007
    s_sleep 8
    buffer_load_dwordx4 v[8:11], v15, s[20:23], s59 offen sc1
    buffer_load_dwordx2 v[40:41], v23, s[20:23], s57 offen offset:0 sc1
    buffer_load_dwordx2 v[42:43], v23, s[20:23], s57 offen offset:64 sc1
    buffer_load_dwordx2 v[44:45], v47, s[20:23], s57 offen offset:128 sc1
    s_waitcnt vmcnt(0)
    s_branch parallel_sum__linear_kernel_hedgehog__mixer_gmlp__prompt_kernel_tg_1006
parallel_sum__linear_kernel_hedgehog__mixer_gmlp__prompt_kernel_tk_1007:
    v_mov_b32 v41, v42
    v_mov_b32 v42, v44
    s_nop 1
    v_add_f32_dpp v40, v40, v40 row_ror:8 row_mask:0xf bank_mask:0xf
    v_add_f32_dpp v41, v41, v41 row_ror:8 row_mask:0xf bank_mask:0xf
    v_add_f32_dpp v42, v42, v42 row_ror:8 row_mask:0xf bank_mask:0xf
    v_mov_b32 v44, v40
    v_mov_b32 v45, v41
    v_mov_b32 v46, v42
    s_nop 1
    v_permlane16_swap_b32 v40, v44
    v_permlane16_swap_b32 v41, v45
    v_permlane16_swap_b32 v42, v46
    s_nop 1
    v_add_f32 v40, v40, v44
    v_add_f32 v41, v41, v45
    v_add_f32 v42, v42, v46
    v_mov_b32 v44, v40
    v_mov_b32 v45, v41
    v_mov_b32 v46, v42
    s_nop 1
    v_permlane32_swap_b32 v40, v44
    v_permlane32_swap_b32 v41, v45
    v_permlane32_swap_b32 v42, v46
    s_nop 1
    v_add_f32 v40, v40, v44
    v_add_f32 v41, v41, v45
    v_add_f32 v42, v42, v46
    ds_write_b32 v20, v40
    ds_write_b32 v20, v41 offset:32
    v_cmp_gt_u32 vcc, 1073741824, v47
    v_mov_b32 v43, 162728
    s_nop 0
    v_cndmask_b32 v20, v43, v20, vcc
    ds_write_b32 v20, v42 offset:64
    s_waitcnt vmcnt(0) lgkmcnt(0)
    s_barrier
    v_lshrrev_b32 v4, 9, v0
    v_lshlrev_b32 v4, 4, v4
    v_add_u32 v4, 161792, v4
    v_add_u32 v5, 147456, v0
    v_lshrrev_b32 v6, 3, v21
    s_lshl_b32 s38, s3, 5
    v_add_u32 v6, s38, v6
    v_lshrrev_b32 v9, 9, v0
    v_mul_u32_u24 v7, 152, v6
    v_lshl_add_u32 v7, v9, 3, v7
    v_mul_u32_u24 v6, 328, v6
    v_mul_u32_u24 v9, 40, v9
    v_add_u32 v6, v6, v9
    v_add_u32 v6, 40960, v6
    s_load_dwordx2 s[62:63], s[0:1], 48
    s_lshl_b32 s38, s32, 3
    s_add_u32 s38, s38, s33
    s_lshl_b32 s38, s38, 3
    s_add_u32 s38, s38, s3
    s_sub_u32 s39, s38, 324
    s_cmp_lt_u32 s38, 324
    s_cselect_b32 s28, s70, s72
    s_cselect_b32 s29, s71, s73
    s_mov_b32 s30, 663552
    s_cselect_b32 s30, 2654208, s30
    s_cselect_b32 s39, s38, s39
    s_mov_b32 s31, 0x20000
    s_lshl_b32 s39, s39, 13
    v_lshlrev_b32 v22, 3, v0
    v_add_u32 v23, s39, v22
    buffer_load_dword v23, v23, s[28:31], 0 offen
    s_waitcnt lgkmcnt(0)
    s_mov_b32 s28, s62
    s_mov_b32 s29, s63
    s_mov_b32 s30, 8388608
    s_lshl_b32 s39, s38, 14
    buffer_load_dword v13, v22, s[28:31], s39 offen
    s_add_u32 s39, s39, 8192
    buffer_load_dword v13, v22, s[28:31], s39 offen
    ds_read_b64_tr_b16 v[24:25], v3 offset:0
    ds_read_b64_tr_b16 v[26:27], v3 offset:256
    ds_read_b64_tr_b16 v[28:29], v3 offset:1024
    ds_read_b64_tr_b16 v[30:31], v3 offset:1280
    ds_read_b128 v[16:19], v4 offset:384
    s_waitcnt lgkmcnt(0)
    v_fmac_f32 v96, v8, v16
    v_fmac_f32 v97, v8, v17
    v_fmac_f32 v98, v8, v18
    v_fmac_f32 v99, v8, v19
    v_mul_f32 v96, v10, v96
    v_mul_f32 v97, v10, v97
    v_mul_f32 v98, v10, v98
    v_mul_f32 v99, v10, v99
    v_cvt_pk_bf16_f32 v96, v96, v97
    v_cvt_pk_bf16_f32 v97, v98, v99
    ds_read_b128 v[16:19], v4 offset:416
    s_waitcnt lgkmcnt(0)
    v_fmac_f32 v100, v8, v16
    v_fmac_f32 v101, v8, v17
    v_fmac_f32 v102, v8, v18
    v_fmac_f32 v103, v8, v19
    v_mul_f32 v100, v10, v100
    v_mul_f32 v101, v10, v101
    v_mul_f32 v102, v10, v102
    v_mul_f32 v103, v10, v103
    v_cvt_pk_bf16_f32 v98, v100, v101
    v_cvt_pk_bf16_f32 v99, v102, v103
    ds_read_b128 v[16:19], v4 offset:448
    s_waitcnt lgkmcnt(0)
    v_fmac_f32 v104, v8, v16
    v_fmac_f32 v105, v8, v17
    v_fmac_f32 v106, v8, v18
    v_fmac_f32 v107, v8, v19
    v_mul_f32 v104, v10, v104
    v_mul_f32 v105, v10, v105
    v_mul_f32 v106, v10, v106
    v_mul_f32 v107, v10, v107
    v_cvt_pk_bf16_f32 v100, v104, v105
    v_cvt_pk_bf16_f32 v101, v106, v107
    ds_read_b128 v[16:19], v4 offset:480
    s_waitcnt lgkmcnt(0)
    v_fmac_f32 v108, v8, v16
    v_fmac_f32 v109, v8, v17
    v_fmac_f32 v110, v8, v18
    v_fmac_f32 v111, v8, v19
    v_mul_f32 v108, v10, v108
    v_mul_f32 v109, v10, v109
    v_mul_f32 v110, v10, v110
    v_mul_f32 v111, v10, v111
    v_cvt_pk_bf16_f32 v102, v108, v109
    v_cvt_pk_bf16_f32 v103, v110, v111
    v_mov_b32 v40, v96
    v_mov_b32 v41, v97
    v_mov_b32 v42, v98
    v_mov_b32 v43, v99
    v_mov_b32 v44, v100
    v_mov_b32 v45, v101
    v_mov_b32 v46, v102
    v_mov_b32 v47, v103
    ds_read_b64_tr_b16 v[32:33], v3 offset:2048
    ds_read_b64_tr_b16 v[34:35], v3 offset:2304
    s_setprio 1
    v_mfma_f32_32x32x16_bf16 v[96:111], v[24:27], v[112:115], 0
    s_setprio 0
    ds_read_b128 v[16:19], v4 offset:0
    s_waitcnt lgkmcnt(0)
    v_fmac_f32 v48, v8, v16
    v_fmac_f32 v49, v8, v17
    v_fmac_f32 v50, v8, v18
    v_fmac_f32 v51, v8, v19
    v_mul_f32 v48, v10, v48
    v_mul_f32 v49, v10, v49
    ds_read_b64_tr_b16 v[36:37], v3 offset:3072
    ds_read_b64_tr_b16 v[38:39], v3 offset:3328
    s_setprio 1
    v_mfma_f32_32x32x16_bf16 v[96:111], v[28:31], v[116:119], v[96:111]
    s_setprio 0
    v_mul_f32 v50, v10, v50
    v_mul_f32 v51, v10, v51
    v_cvt_pk_bf16_f32 v48, v48, v49
    v_cvt_pk_bf16_f32 v49, v50, v51
    ds_read_b128 v[16:19], v4 offset:32
    s_waitcnt lgkmcnt(0)
    v_fmac_f32 v52, v8, v16
    v_fmac_f32 v53, v8, v17
    ds_read_b64_tr_b16 v[24:25], v3 offset:4096
    ds_read_b64_tr_b16 v[26:27], v3 offset:4352
    s_setprio 1
    v_mfma_f32_32x32x16_bf16 v[96:111], v[32:35], v[120:123], v[96:111]
    s_setprio 0
    v_fmac_f32 v54, v8, v18
    v_fmac_f32 v55, v8, v19
    v_mul_f32 v52, v10, v52
    v_mul_f32 v53, v10, v53
    v_mul_f32 v54, v10, v54
    v_mul_f32 v55, v10, v55
    ds_read_b64_tr_b16 v[28:29], v3 offset:5120
    ds_read_b64_tr_b16 v[30:31], v3 offset:5376
    s_setprio 1
    v_mfma_f32_32x32x16_bf16 v[96:111], v[36:39], v[124:127], v[96:111]
    s_setprio 0
    v_cvt_pk_bf16_f32 v50, v52, v53
    v_cvt_pk_bf16_f32 v51, v54, v55
    ds_read_b128 v[16:19], v4 offset:64
    s_waitcnt lgkmcnt(0)
    v_fmac_f32 v56, v8, v16
    v_fmac_f32 v57, v8, v17
    v_fmac_f32 v58, v8, v18
    v_fmac_f32 v59, v8, v19
    ds_read_b64_tr_b16 v[32:33], v3 offset:6144
    ds_read_b64_tr_b16 v[34:35], v3 offset:6400
    s_setprio 1
    v_mfma_f32_32x32x16_bf16 v[96:111], v[24:27], v[128:131], v[96:111]
    s_setprio 0
    v_mul_f32 v56, v10, v56
    v_mul_f32 v57, v10, v57
    v_mul_f32 v58, v10, v58
    v_mul_f32 v59, v10, v59
    v_cvt_pk_bf16_f32 v52, v56, v57
    v_cvt_pk_bf16_f32 v53, v58, v59
    ds_read_b64_tr_b16 v[36:37], v3 offset:7168
    ds_read_b64_tr_b16 v[38:39], v3 offset:7424
    s_setprio 1
    v_mfma_f32_32x32x16_bf16 v[96:111], v[28:31], v[132:135], v[96:111]
    s_setprio 0
    ds_read_b128 v[16:19], v4 offset:96
    s_waitcnt lgkmcnt(0)
    v_fmac_f32 v60, v8, v16
    v_fmac_f32 v61, v8, v17
    v_fmac_f32 v62, v8, v18
    v_fmac_f32 v63, v8, v19
    v_mul_f32 v60, v10, v60
    v_mul_f32 v61, v10, v61
    ds_read_b64_tr_b16 v[24:25], v3 offset:8192
    ds_read_b64_tr_b16 v[26:27], v3 offset:8448
    s_setprio 1
    v_mfma_f32_32x32x16_bf16 v[96:111], v[32:35], v[136:139], v[96:111]
    s_setprio 0
    v_mul_f32 v62, v10, v62
    v_mul_f32 v63, v10, v63
    v_cvt_pk_bf16_f32 v54, v60, v61
    v_cvt_pk_bf16_f32 v55, v62, v63
    ds_read_b128 v[16:19], v4 offset:128
    s_waitcnt lgkmcnt(0)
    v_fmac_f32 v64, v8, v16
    v_fmac_f32 v65, v8, v17
    ds_read_b64_tr_b16 v[28:29], v3 offset:9216
    ds_read_b64_tr_b16 v[30:31], v3 offset:9472
    s_setprio 1
    v_mfma_f32_32x32x16_bf16 v[96:111], v[36:39], v[140:143], v[96:111]
    s_setprio 0
    v_fmac_f32 v66, v8, v18
    v_fmac_f32 v67, v8, v19
    v_mul_f32 v64, v10, v64
    v_mul_f32 v65, v10, v65
    v_mul_f32 v66, v10, v66
    v_mul_f32 v67, v10, v67
    ds_read_b64_tr_b16 v[32:33], v3 offset:10240
    ds_read_b64_tr_b16 v[34:35], v3 offset:10496
    s_setprio 1
    v_mfma_f32_32x32x16_bf16 v[96:111], v[24:27], v[144:147], v[96:111]
    s_setprio 0
    v_cvt_pk_bf16_f32 v64, v64, v65
    v_cvt_pk_bf16_f32 v65, v66, v67
    ds_read_b128 v[16:19], v4 offset:160
    s_waitcnt lgkmcnt(0)
    v_fmac_f32 v68, v8, v16
    v_fmac_f32 v69, v8, v17
    v_fmac_f32 v70, v8, v18
    v_fmac_f32 v71, v8, v19
    ds_read_b64_tr_b16 v[36:37], v3 offset:11264
    ds_read_b64_tr_b16 v[38:39], v3 offset:11520
    s_setprio 1
    v_mfma_f32_32x32x16_bf16 v[96:111], v[28:31], v[148:151], v[96:111]
    s_setprio 0
    v_mul_f32 v68, v10, v68
    v_mul_f32 v69, v10, v69
    v_mul_f32 v70, v10, v70
    v_mul_f32 v71, v10, v71
    v_cvt_pk_bf16_f32 v66, v68, v69
    v_cvt_pk_bf16_f32 v67, v70, v71
    ds_read_b64_tr_b16 v[24:25], v3 offset:12288
    ds_read_b64_tr_b16 v[26:27], v3 offset:12544
    s_setprio 1
    v_mfma_f32_32x32x16_bf16 v[96:111], v[32:35], v[152:155], v[96:111]
    s_setprio 0
    ds_read_b128 v[16:19], v4 offset:192
    s_waitcnt lgkmcnt(0)
    v_fmac_f32 v72, v8, v16
    v_fmac_f32 v73, v8, v17
    v_fmac_f32 v74, v8, v18
    v_fmac_f32 v75, v8, v19
    v_mul_f32 v72, v10, v72
    v_mul_f32 v73, v10, v73
    ds_read_b64_tr_b16 v[28:29], v3 offset:13312
    ds_read_b64_tr_b16 v[30:31], v3 offset:13568
    s_setprio 1
    v_mfma_f32_32x32x16_bf16 v[96:111], v[36:39], v[156:159], v[96:111]
    s_setprio 0
    v_mul_f32 v74, v10, v74
    v_mul_f32 v75, v10, v75
    v_cvt_pk_bf16_f32 v68, v72, v73
    v_cvt_pk_bf16_f32 v69, v74, v75
    ds_read_b128 v[16:19], v4 offset:224
    s_waitcnt lgkmcnt(0)
    v_fmac_f32 v76, v8, v16
    v_fmac_f32 v77, v8, v17
    ds_read_b64_tr_b16 v[32:33], v3 offset:14336
    ds_read_b64_tr_b16 v[34:35], v3 offset:14592
    s_setprio 1
    v_mfma_f32_32x32x16_bf16 v[96:111], v[24:27], v[160:163], v[96:111]
    s_setprio 0
    v_fmac_f32 v78, v8, v18
    v_fmac_f32 v79, v8, v19
    v_mul_f32 v76, v10, v76
    v_mul_f32 v77, v10, v77
    v_mul_f32 v78, v10, v78
    v_mul_f32 v79, v10, v79
    ds_read_b64_tr_b16 v[36:37], v3 offset:15360
    ds_read_b64_tr_b16 v[38:39], v3 offset:15616
    s_setprio 1
    v_mfma_f32_32x32x16_bf16 v[96:111], v[28:31], v[164:167], v[96:111]
    s_setprio 0
    v_cvt_pk_bf16_f32 v70, v76, v77
    v_cvt_pk_bf16_f32 v71, v78, v79
    ds_read_b128 v[16:19], v4 offset:256
    s_waitcnt lgkmcnt(0)
    v_fmac_f32 v80, v8, v16
    v_fmac_f32 v81, v8, v17
    v_fmac_f32 v82, v8, v18
    v_fmac_f32 v83, v8, v19
    ds_read_b64_tr_b16 v[24:25], v3 offset:16384
    ds_read_b64_tr_b16 v[26:27], v3 offset:16640
    s_setprio 1
    v_mfma_f32_32x32x16_bf16 v[96:111], v[32:35], v[168:171], v[96:111]
    s_setprio 0
    v_mul_f32 v80, v10, v80
    v_mul_f32 v81, v10, v81
    v_mul_f32 v82, v10, v82
    v_mul_f32 v83, v10, v83
    v_cvt_pk_bf16_f32 v80, v80, v81
    v_cvt_pk_bf16_f32 v81, v82, v83
    ds_read_b64_tr_b16 v[28:29], v3 offset:17408
    ds_read_b64_tr_b16 v[30:31], v3 offset:17664
    s_setprio 1
    v_mfma_f32_32x32x16_bf16 v[96:111], v[36:39], v[172:175], v[96:111]
    s_setprio 0
    ds_read_b128 v[16:19], v4 offset:288
    s_waitcnt lgkmcnt(0)
    v_fmac_f32 v84, v8, v16
    v_fmac_f32 v85, v8, v17
    v_fmac_f32 v86, v8, v18
    v_fmac_f32 v87, v8, v19
    v_mul_f32 v84, v10, v84
    v_mul_f32 v85, v10, v85
    ds_read_b64_tr_b16 v[32:33], v3 offset:18432
    ds_read_b64_tr_b16 v[34:35], v3 offset:18688
    s_setprio 1
    v_mfma_f32_32x32x16_bf16 v[96:111], v[24:27], v[176:179], v[96:111]
    s_setprio 0
    v_mul_f32 v86, v10, v86
    v_mul_f32 v87, v10, v87
    v_cvt_pk_bf16_f32 v82, v84, v85
    v_cvt_pk_bf16_f32 v83, v86, v87
    ds_read_b128 v[16:19], v4 offset:320
    s_waitcnt lgkmcnt(0)
    v_fmac_f32 v88, v8, v16
    v_fmac_f32 v89, v8, v17
    ds_read_b64_tr_b16 v[36:37], v3 offset:19456
    ds_read_b64_tr_b16 v[38:39], v3 offset:19712
    s_setprio 1
    v_mfma_f32_32x32x16_bf16 v[96:111], v[28:31], v[180:183], v[96:111]
    s_setprio 0
    v_fmac_f32 v90, v8, v18
    v_fmac_f32 v91, v8, v19
    v_mul_f32 v88, v10, v88
    v_mul_f32 v89, v10, v89
    v_mul_f32 v90, v10, v90
    v_mul_f32 v91, v10, v91
    ds_read_b64_tr_b16 v[24:25], v3 offset:20480
    ds_read_b64_tr_b16 v[26:27], v3 offset:20736
    s_setprio 1
    v_mfma_f32_32x32x16_bf16 v[96:111], v[32:35], v[184:187], v[96:111]
    s_setprio 0
    v_cvt_pk_bf16_f32 v84, v88, v89
    v_cvt_pk_bf16_f32 v85, v90, v91
    ds_read_b128 v[16:19], v4 offset:352
    s_waitcnt lgkmcnt(0)
    v_fmac_f32 v92, v8, v16
    v_fmac_f32 v93, v8, v17
    v_fmac_f32 v94, v8, v18
    v_fmac_f32 v95, v8, v19
    ds_read_b64_tr_b16 v[28:29], v3 offset:21504
    ds_read_b64_tr_b16 v[30:31], v3 offset:21760
    s_setprio 1
    v_mfma_f32_32x32x16_bf16 v[96:111], v[36:39], v[188:191], v[96:111]
    s_setprio 0
    v_mul_f32 v92, v10, v92
    v_mul_f32 v93, v10, v93
    v_mul_f32 v94, v10, v94
    v_mul_f32 v95, v10, v95
    v_cvt_pk_bf16_f32 v86, v92, v93
    v_cvt_pk_bf16_f32 v87, v94, v95
    ds_read_b64_tr_b16 v[32:33], v3 offset:22528
    ds_read_b64_tr_b16 v[34:35], v3 offset:22784
    s_setprio 1
    v_mfma_f32_32x32x16_bf16 v[96:111], v[24:27], v[192:195], v[96:111]
    s_setprio 0
    s_waitcnt lgkmcnt(2)
    ds_read_b64_tr_b16 v[36:37], v3 offset:23552
    ds_read_b64_tr_b16 v[38:39], v3 offset:23808
    s_setprio 1
    v_mfma_f32_32x32x16_bf16 v[96:111], v[28:31], v[196:199], v[96:111]
    s_setprio 0
    s_waitcnt lgkmcnt(2)
    ds_read_b64_tr_b16 v[24:25], v3 offset:24576
    ds_read_b64_tr_b16 v[26:27], v3 offset:24832
    s_setprio 1
    v_mfma_f32_32x32x16_bf16 v[96:111], v[32:35], v[200:203], v[96:111]
    s_setprio 0
    s_waitcnt lgkmcnt(2)
    ds_read_b64_tr_b16 v[28:29], v3 offset:25600
    ds_read_b64_tr_b16 v[30:31], v3 offset:25856
    s_setprio 1
    v_mfma_f32_32x32x16_bf16 v[96:111], v[36:39], v[204:207], v[96:111]
    s_setprio 0
    s_waitcnt lgkmcnt(2)
    ds_read_b64_tr_b16 v[32:33], v3 offset:26624
    ds_read_b64_tr_b16 v[34:35], v3 offset:26880
    s_setprio 1
    v_mfma_f32_32x32x16_bf16 v[96:111], v[24:27], v[208:211], v[96:111]
    s_setprio 0
    s_waitcnt lgkmcnt(2)
    ds_read_b64_tr_b16 v[36:37], v3 offset:27648
    ds_read_b64_tr_b16 v[38:39], v3 offset:27904
    s_setprio 1
    v_mfma_f32_32x32x16_bf16 v[96:111], v[28:31], v[212:215], v[96:111]
    s_setprio 0
    s_waitcnt lgkmcnt(2)
    ds_read_b64_tr_b16 v[24:25], v3 offset:28672
    ds_read_b64_tr_b16 v[26:27], v3 offset:28928
    s_setprio 1
    v_mfma_f32_32x32x16_bf16 v[96:111], v[32:35], v[216:219], v[96:111]
    s_setprio 0
    s_waitcnt lgkmcnt(2)
    ds_read_b64_tr_b16 v[28:29], v3 offset:29696
    ds_read_b64_tr_b16 v[30:31], v3 offset:29952
    s_setprio 1
    v_mfma_f32_32x32x16_bf16 v[96:111], v[36:39], v[220:223], v[96:111]
    s_setprio 0
    s_waitcnt lgkmcnt(2)
    ds_read_b64_tr_b16 v[32:33], v3 offset:30720
    ds_read_b64_tr_b16 v[34:35], v3 offset:30976
    s_setprio 1
    v_mfma_f32_32x32x16_bf16 v[96:111], v[24:27], v[224:227], v[96:111]
    s_setprio 0
    s_waitcnt lgkmcnt(2)
    ds_read_b64_tr_b16 v[36:37], v3 offset:31744
    ds_read_b64_tr_b16 v[38:39], v3 offset:32000
    s_setprio 1
    v_mfma_f32_32x32x16_bf16 v[96:111], v[28:31], v[228:231], v[96:111]
    s_setprio 0
    s_waitcnt lgkmcnt(2)
    ds_read_b64_tr_b16 v[24:25], v3 offset:32768
    ds_read_b64_tr_b16 v[26:27], v3 offset:33024
    s_setprio 1
    v_mfma_f32_32x32x16_bf16 v[96:111], v[32:35], v[232:235], v[96:111]
    s_setprio 0
    s_waitcnt lgkmcnt(2)
    ds_read_b64_tr_b16 v[28:29], v3 offset:33792
    ds_read_b64_tr_b16 v[30:31], v3 offset:34048
    s_setprio 1
    v_mfma_f32_32x32x16_bf16 v[96:111], v[36:39], v[236:239], v[96:111]
    s_setprio 0
    s_waitcnt lgkmcnt(2)
    ds_read_b64_tr_b16 v[32:33], v3 offset:34816
    ds_read_b64_tr_b16 v[34:35], v3 offset:35072
    s_setprio 1
    v_mfma_f32_32x32x16_bf16 v[96:111], v[24:27], v[240:243], v[96:111]
    s_setprio 0
    s_waitcnt lgkmcnt(2)
    ds_read_b64_tr_b16 v[36:37], v3 offset:35840
    ds_read_b64_tr_b16 v[38:39], v3 offset:36096
    s_setprio 1
    v_mfma_f32_32x32x16_bf16 v[96:111], v[28:31], v[244:247], v[96:111]
    s_setprio 0
    s_waitcnt lgkmcnt(2)
    s_setprio 1
    v_mfma_f32_32x32x16_bf16 v[96:111], v[32:35], v[248:251], v[96:111]
    s_setprio 0
    s_waitcnt lgkmcnt(0)
    s_setprio 1
    v_mfma_f32_32x32x16_bf16 v[96:111], v[36:39], v[252:255], v[96:111]
    s_setprio 0
    ds_read_b128 v[112:115], v5 offset:0
    ds_read_b128 v[116:119], v5 offset:1024
    ds_read_b128 v[120:123], v5 offset:2048
    ds_read_b128 v[124:127], v5 offset:3072
    ds_read_b128 v[128:131], v5 offset:4096
    ds_read_b128 v[132:135], v5 offset:5120
    ds_read_b128 v[136:139], v5 offset:6144
    ds_read_b128 v[140:143], v5 offset:7168
    ds_read_b128 v[144:147], v5 offset:8192
    ds_read_b128 v[148:151], v5 offset:9216
    ds_read_b128 v[152:155], v5 offset:10240
    ds_read_b128 v[156:159], v5 offset:11264
    ds_read_b128 v[160:163], v5 offset:12288
    s_waitcnt lgkmcnt(4)
    v_mfma_f32_32x32x16_bf16 v[228:243], v[144:147], v[48:51], 0
    s_waitcnt lgkmcnt(3)
    v_mfma_f32_32x32x16_bf16 v[228:243], v[148:151], v[52:55], v[228:243]
    s_waitcnt lgkmcnt(2)
    v_mfma_f32_32x32x16_bf16 v[228:243], v[152:155], v[64:67], v[228:243]
    s_waitcnt lgkmcnt(1)
    v_mfma_f32_32x32x16_bf16 v[228:243], v[156:159], v[68:71], v[228:243]
    s_waitcnt lgkmcnt(0)
    v_mfma_f32_32x32x16_bf16 v[228:243], v[160:163], v[80:83], v[228:243]
    v_mfma_f32_32x32x16_bf16 v[164:179], v[112:115], v[48:51], 0
    v_mfma_f32_32x32x16_bf16 v[164:179], v[116:119], v[52:55], v[164:179]
    v_mfma_f32_32x32x16_bf16 v[180:195], v[120:123], v[52:55], 0
    v_mfma_f32_32x32x16_bf16 v[180:195], v[124:127], v[64:67], v[180:195]
    v_mfma_f32_32x32x16_bf16 v[196:211], v[128:131], v[64:67], 0
    v_mfma_f32_32x32x16_bf16 v[196:211], v[132:135], v[68:71], v[196:211]
    v_mfma_f32_32x32x16_bf16 v[212:227], v[136:139], v[68:71], 0
    v_mfma_f32_32x32x16_bf16 v[212:227], v[140:143], v[80:83], v[212:227]
    ds_read_b128 v[16:19], v4 offset:512
    s_waitcnt lgkmcnt(0)
    v_fmac_f32 v96, v8, v16
    v_fmac_f32 v97, v8, v17
    v_fmac_f32 v98, v8, v18
    v_fmac_f32 v99, v8, v19
    v_mul_f32 v96, v10, v96
    v_mul_f32 v97, v10, v97
    v_mul_f32 v98, v10, v98
    v_mul_f32 v99, v10, v99
    v_cvt_pk_bf16_f32 v96, v96, v97
    v_cvt_pk_bf16_f32 v97, v98, v99
    ds_read_b128 v[16:19], v4 offset:544
    s_waitcnt lgkmcnt(0)
    v_fmac_f32 v100, v8, v16
    v_fmac_f32 v101, v8, v17
    v_fmac_f32 v102, v8, v18
    v_fmac_f32 v103, v8, v19
    v_mul_f32 v100, v10, v100
    v_mul_f32 v101, v10, v101
    v_mul_f32 v102, v10, v102
    v_mul_f32 v103, v10, v103
    v_cvt_pk_bf16_f32 v98, v100, v101
    v_cvt_pk_bf16_f32 v99, v102, v103
    ds_read_b128 v[16:19], v4 offset:576
    s_waitcnt lgkmcnt(0)
    v_fmac_f32 v104, v8, v16
    v_fmac_f32 v105, v8, v17
    v_fmac_f32 v106, v8, v18
    v_fmac_f32 v107, v8, v19
    v_mul_f32 v104, v10, v104
    v_mul_f32 v105, v10, v105
    v_mul_f32 v106, v10, v106
    v_mul_f32 v107, v10, v107
    v_cvt_pk_bf16_f32 v100, v104, v105
    v_cvt_pk_bf16_f32 v101, v106, v107
    ds_read_b128 v[16:19], v4 offset:608
    s_waitcnt lgkmcnt(0)
    v_fmac_f32 v108, v8, v16
    v_fmac_f32 v109, v8, v17
    v_fmac_f32 v110, v8, v18
    v_fmac_f32 v111, v8, v19
    v_mul_f32 v108, v10, v108
    v_mul_f32 v109, v10, v109
    v_mul_f32 v110, v10, v110
    v_mul_f32 v111, v10, v111
    v_cvt_pk_bf16_f32 v102, v108, v109
    v_cvt_pk_bf16_f32 v103, v110, v111
    s_mov_b32 s45, 1069066811
    v_max3_f32 v24, v164, v165, v166
    v_max3_f32 v25, v167, v168, v169
    v_max3_f32 v24, v24, v170, v171
    v_max3_f32 v25, v25, v172, v173
    v_max3_f32 v24, v24, v174, v175
    v_max3_f32 v25, v25, v176, v177
    v_max3_f32 v24, v24, v178, v179
    v_max3_f32 v25, v25, v228, v229
    v_max_f32 v24, v24, v25
    v_mul_f32 v24, s45, v24
    v_fma_f32 v164, v164, s45, -v24
    v_fma_f32 v165, v165, s45, -v24
    v_fma_f32 v166, v166, s45, -v24
    v_fma_f32 v167, v167, s45, -v24
    v_fma_f32 v168, v168, s45, -v24
    v_fma_f32 v169, v169, s45, -v24
    v_fma_f32 v170, v170, s45, -v24
    v_fma_f32 v171, v171, s45, -v24
    v_fma_f32 v172, v172, s45, -v24
    v_fma_f32 v173, v173, s45, -v24
    v_fma_f32 v174, v174, s45, -v24
    v_fma_f32 v175, v175, s45, -v24
    v_fma_f32 v176, v176, s45, -v24
    v_fma_f32 v177, v177, s45, -v24
    v_fma_f32 v178, v178, s45, -v24
    v_fma_f32 v179, v179, s45, -v24
    v_fma_f32 v228, v228, s45, -v24
    v_fma_f32 v229, v229, s45, -v24
    v_exp_f32 v164, v164
    v_exp_f32 v165, v165
    v_exp_f32 v166, v166
    v_exp_f32 v167, v167
    v_exp_f32 v168, v168
    v_exp_f32 v169, v169
    v_exp_f32 v170, v170
    v_exp_f32 v171, v171
    v_exp_f32 v172, v172
    v_exp_f32 v173, v173
    v_exp_f32 v174, v174
    v_exp_f32 v175, v175
    v_exp_f32 v176, v176
    v_exp_f32 v177, v177
    v_exp_f32 v178, v178
    v_exp_f32 v179, v179
    v_exp_f32 v228, v228
    v_exp_f32 v229, v229
    v_add_f32 v25, v164, v165
    v_add_f32 v26, v166, v167
    v_add_f32 v25, v25, v168
    v_add_f32 v26, v26, v169
    v_add_f32 v25, v25, v170
    v_add_f32 v26, v26, v171
    v_add_f32 v25, v25, v172
    v_add_f32 v26, v26, v173
    v_add_f32 v25, v25, v174
    v_add_f32 v26, v26, v175
    v_add_f32 v25, v25, v176
    v_add_f32 v26, v26, v177
    v_add_f32 v25, v25, v178
    v_add_f32 v26, v26, v179
    v_add_f32 v25, v25, v228
    v_add_f32 v26, v26, v229
    v_add_f32 v25, v25, v26
    v_rcp_f32 v25, v25
    s_nop 0
    v_mul_f32 v164, v164, v25
    v_mul_f32 v165, v165, v25
    v_mul_f32 v166, v166, v25
    v_mul_f32 v167, v167, v25
    v_mul_f32 v168, v168, v25
    v_mul_f32 v169, v169, v25
    v_mul_f32 v170, v170, v25
    v_mul_f32 v171, v171, v25
    v_mul_f32 v172, v172, v25
    v_mul_f32 v173, v173, v25
    v_mul_f32 v174, v174, v25
    v_mul_f32 v175, v175, v25
    v_mul_f32 v176, v176, v25
    v_mul_f32 v177, v177, v25
    v_mul_f32 v178, v178, v25
    v_mul_f32 v179, v179, v25
    v_mul_f32 v228, v228, v25
    v_mul_f32 v229, v229, v25
    v_cvt_pk_bf16_f32 v28, v164, v165
    v_cvt_pk_bf16_f32 v29, v166, v167
    v_cvt_pk_bf16_f32 v30, v168, v169
    v_cvt_pk_bf16_f32 v31, v170, v171
    v_cvt_pk_bf16_f32 v32, v172, v173
    v_cvt_pk_bf16_f32 v33, v174, v175
    v_cvt_pk_bf16_f32 v34, v176, v177
    v_cvt_pk_bf16_f32 v35, v178, v179
    v_cvt_pk_bf16_f32 v36, v228, v229
    ds_write_b64 v6, v[28:29] offset:0
    ds_write_b64 v6, v[30:31] offset:8
    ds_write_b64 v6, v[32:33] offset:16
    ds_write_b64 v6, v[34:35] offset:24
    ds_write_b32 v6, v36 offset:32
    v_max3_f32 v24, v180, v181, v182
    v_max3_f32 v25, v183, v184, v185
    v_max3_f32 v24, v24, v186, v187
    v_max3_f32 v25, v25, v188, v189
    v_max3_f32 v24, v24, v190, v191
    v_max3_f32 v25, v25, v192, v193
    v_max3_f32 v24, v24, v194, v195
    v_max3_f32 v25, v25, v230, v231
    v_max_f32 v24, v24, v25
    v_mul_f32 v24, s45, v24
    v_fma_f32 v180, v180, s45, -v24
    v_fma_f32 v181, v181, s45, -v24
    v_fma_f32 v182, v182, s45, -v24
    v_fma_f32 v183, v183, s45, -v24
    v_fma_f32 v184, v184, s45, -v24
    v_fma_f32 v185, v185, s45, -v24
    v_fma_f32 v186, v186, s45, -v24
    v_fma_f32 v187, v187, s45, -v24
    v_fma_f32 v188, v188, s45, -v24
    v_fma_f32 v189, v189, s45, -v24
    v_fma_f32 v190, v190, s45, -v24
    v_fma_f32 v191, v191, s45, -v24
    v_fma_f32 v192, v192, s45, -v24
    v_fma_f32 v193, v193, s45, -v24
    v_fma_f32 v194, v194, s45, -v24
    v_fma_f32 v195, v195, s45, -v24
    v_fma_f32 v230, v230, s45, -v24
    v_fma_f32 v231, v231, s45, -v24
    v_exp_f32 v180, v180
    v_exp_f32 v181, v181
    v_exp_f32 v182, v182
    v_exp_f32 v183, v183
    v_exp_f32 v184, v184
    v_exp_f32 v185, v185
    v_exp_f32 v186, v186
    v_exp_f32 v187, v187
    v_exp_f32 v188, v188
    v_exp_f32 v189, v189
    v_exp_f32 v190, v190
    v_exp_f32 v191, v191
    v_exp_f32 v192, v192
    v_exp_f32 v193, v193
    v_exp_f32 v194, v194
    v_exp_f32 v195, v195
    v_exp_f32 v230, v230
    v_exp_f32 v231, v231
    v_add_f32 v25, v180, v181
    v_add_f32 v26, v182, v183
    v_add_f32 v25, v25, v184
    v_add_f32 v26, v26, v185
    v_add_f32 v25, v25, v186
    v_add_f32 v26, v26, v187
    v_add_f32 v25, v25, v188
    v_add_f32 v26, v26, v189
    v_add_f32 v25, v25, v190
    v_add_f32 v26, v26, v191
    v_add_f32 v25, v25, v192
    v_add_f32 v26, v26, v193
    v_add_f32 v25, v25, v194
    v_add_f32 v26, v26, v195
    v_add_f32 v25, v25, v230
    v_add_f32 v26, v26, v231
    v_add_f32 v25, v25, v26
    v_rcp_f32 v25, v25
    s_nop 0
    v_mul_f32 v180, v180, v25
    v_mul_f32 v181, v181, v25
    v_mul_f32 v182, v182, v25
    v_mul_f32 v183, v183, v25
    v_mul_f32 v184, v184, v25
    v_mul_f32 v185, v185, v25
    v_mul_f32 v186, v186, v25
    v_mul_f32 v187, v187, v25
    v_mul_f32 v188, v188, v25
    v_mul_f32 v189, v189, v25
    v_mul_f32 v190, v190, v25
    v_mul_f32 v191, v191, v25
    v_mul_f32 v192, v192, v25
    v_mul_f32 v193, v193, v25
    v_mul_f32 v194, v194, v25
    v_mul_f32 v195, v195, v25
    v_mul_f32 v230, v230, v25
    v_mul_f32 v231, v231, v25
    v_cvt_pk_bf16_f32 v28, v180, v181
    v_cvt_pk_bf16_f32 v29, v182, v183
    v_cvt_pk_bf16_f32 v30, v184, v185
    v_cvt_pk_bf16_f32 v31, v186, v187
    v_cvt_pk_bf16_f32 v32, v188, v189
    v_cvt_pk_bf16_f32 v33, v190, v191
    v_cvt_pk_bf16_f32 v34, v192, v193
    v_cvt_pk_bf16_f32 v35, v194, v195
    v_cvt_pk_bf16_f32 v36, v230, v231
    ds_write_b64 v6, v[28:29] offset:80
    ds_write_b64 v6, v[30:31] offset:88
    ds_write_b64 v6, v[32:33] offset:96
    ds_write_b64 v6, v[34:35] offset:104
    ds_write_b32 v6, v36 offset:112
    v_max3_f32 v24, v196, v197, v198
    v_max3_f32 v25, v199, v200, v201
    v_max3_f32 v24, v24, v202, v203
    v_max3_f32 v25, v25, v204, v205
    v_max3_f32 v24, v24, v206, v207
    v_max3_f32 v25, v25, v208, v209
    v_max3_f32 v24, v24, v210, v211
    v_max3_f32 v25, v25, v232, v233
    v_max_f32 v24, v24, v25
    v_mul_f32 v24, s45, v24
    v_fma_f32 v196, v196, s45, -v24
    v_fma_f32 v197, v197, s45, -v24
    v_fma_f32 v198, v198, s45, -v24
    v_fma_f32 v199, v199, s45, -v24
    v_fma_f32 v200, v200, s45, -v24
    v_fma_f32 v201, v201, s45, -v24
    v_fma_f32 v202, v202, s45, -v24
    v_fma_f32 v203, v203, s45, -v24
    v_fma_f32 v204, v204, s45, -v24
    v_fma_f32 v205, v205, s45, -v24
    v_fma_f32 v206, v206, s45, -v24
    v_fma_f32 v207, v207, s45, -v24
    v_fma_f32 v208, v208, s45, -v24
    v_fma_f32 v209, v209, s45, -v24
    v_fma_f32 v210, v210, s45, -v24
    v_fma_f32 v211, v211, s45, -v24
    v_fma_f32 v232, v232, s45, -v24
    v_fma_f32 v233, v233, s45, -v24
    v_exp_f32 v196, v196
    v_exp_f32 v197, v197
    v_exp_f32 v198, v198
    v_exp_f32 v199, v199
    v_exp_f32 v200, v200
    v_exp_f32 v201, v201
    v_exp_f32 v202, v202
    v_exp_f32 v203, v203
    v_exp_f32 v204, v204
    v_exp_f32 v205, v205
    v_exp_f32 v206, v206
    v_exp_f32 v207, v207
    v_exp_f32 v208, v208
    v_exp_f32 v209, v209
    v_exp_f32 v210, v210
    v_exp_f32 v211, v211
    v_exp_f32 v232, v232
    v_exp_f32 v233, v233
    v_add_f32 v25, v196, v197
    v_add_f32 v26, v198, v199
    v_add_f32 v25, v25, v200
    v_add_f32 v26, v26, v201
    v_add_f32 v25, v25, v202
    v_add_f32 v26, v26, v203
    v_add_f32 v25, v25, v204
    v_add_f32 v26, v26, v205
    v_add_f32 v25, v25, v206
    v_add_f32 v26, v26, v207
    v_add_f32 v25, v25, v208
    v_add_f32 v26, v26, v209
    v_add_f32 v25, v25, v210
    v_add_f32 v26, v26, v211
    v_add_f32 v25, v25, v232
    v_add_f32 v26, v26, v233
    v_add_f32 v25, v25, v26
    v_rcp_f32 v25, v25
    s_nop 0
    v_mul_f32 v196, v196, v25
    v_mul_f32 v197, v197, v25
    v_mul_f32 v198, v198, v25
    v_mul_f32 v199, v199, v25
    v_mul_f32 v200, v200, v25
    v_mul_f32 v201, v201, v25
    v_mul_f32 v202, v202, v25
    v_mul_f32 v203, v203, v25
    v_mul_f32 v204, v204, v25
    v_mul_f32 v205, v205, v25
    v_mul_f32 v206, v206, v25
    v_mul_f32 v207, v207, v25
    v_mul_f32 v208, v208, v25
    v_mul_f32 v209, v209, v25
    v_mul_f32 v210, v210, v25
    v_mul_f32 v211, v211, v25
    v_mul_f32 v232, v232, v25
    v_mul_f32 v233, v233, v25
    v_cvt_pk_bf16_f32 v28, v196, v197
    v_cvt_pk_bf16_f32 v29, v198, v199
    v_cvt_pk_bf16_f32 v30, v200, v201
    v_cvt_pk_bf16_f32 v31, v202, v203
    v_cvt_pk_bf16_f32 v32, v204, v205
    v_cvt_pk_bf16_f32 v33, v206, v207
    v_cvt_pk_bf16_f32 v34, v208, v209
    v_cvt_pk_bf16_f32 v35, v210, v211
    v_cvt_pk_bf16_f32 v36, v232, v233
    ds_write_b64 v6, v[28:29] offset:160
    ds_write_b64 v6, v[30:31] offset:168
    ds_write_b64 v6, v[32:33] offset:176
    ds_write_b64 v6, v[34:35] offset:184
    ds_write_b32 v6, v36 offset:192
    v_max3_f32 v24, v212, v213, v214
    v_max3_f32 v25, v215, v216, v217
    v_max3_f32 v24, v24, v218, v219
    v_max3_f32 v25, v25, v220, v221
    v_max3_f32 v24, v24, v222, v223
    v_max3_f32 v25, v25, v224, v225
    v_max3_f32 v24, v24, v226, v227
    v_max3_f32 v25, v25, v234, v235
    v_max_f32 v24, v24, v25
    v_mul_f32 v24, s45, v24
    v_fma_f32 v212, v212, s45, -v24
    v_fma_f32 v213, v213, s45, -v24
    v_fma_f32 v214, v214, s45, -v24
    v_fma_f32 v215, v215, s45, -v24
    v_fma_f32 v216, v216, s45, -v24
    v_fma_f32 v217, v217, s45, -v24
    v_fma_f32 v218, v218, s45, -v24
    v_fma_f32 v219, v219, s45, -v24
    v_fma_f32 v220, v220, s45, -v24
    v_fma_f32 v221, v221, s45, -v24
    v_fma_f32 v222, v222, s45, -v24
    v_fma_f32 v223, v223, s45, -v24
    v_fma_f32 v224, v224, s45, -v24
    v_fma_f32 v225, v225, s45, -v24
    v_fma_f32 v226, v226, s45, -v24
    v_fma_f32 v227, v227, s45, -v24
    v_fma_f32 v234, v234, s45, -v24
    v_fma_f32 v235, v235, s45, -v24
    v_exp_f32 v212, v212
    v_exp_f32 v213, v213
    v_exp_f32 v214, v214
    v_exp_f32 v215, v215
    v_exp_f32 v216, v216
    v_exp_f32 v217, v217
    v_exp_f32 v218, v218
    v_exp_f32 v219, v219
    v_exp_f32 v220, v220
    v_exp_f32 v221, v221
    v_exp_f32 v222, v222
    v_exp_f32 v223, v223
    v_exp_f32 v224, v224
    v_exp_f32 v225, v225
    v_exp_f32 v226, v226
    v_exp_f32 v227, v227
    v_exp_f32 v234, v234
    v_exp_f32 v235, v235
    v_add_f32 v25, v212, v213
    v_add_f32 v26, v214, v215
    v_add_f32 v25, v25, v216
    v_add_f32 v26, v26, v217
    v_add_f32 v25, v25, v218
    v_add_f32 v26, v26, v219
    v_add_f32 v25, v25, v220
    v_add_f32 v26, v26, v221
    v_add_f32 v25, v25, v222
    v_add_f32 v26, v26, v223
    v_add_f32 v25, v25, v224
    v_add_f32 v26, v26, v225
    v_add_f32 v25, v25, v226
    v_add_f32 v26, v26, v227
    v_add_f32 v25, v25, v234
    v_add_f32 v26, v26, v235
    v_add_f32 v25, v25, v26
    v_rcp_f32 v25, v25
    s_nop 0
    v_mul_f32 v212, v212, v25
    v_mul_f32 v213, v213, v25
    v_mul_f32 v214, v214, v25
    v_mul_f32 v215, v215, v25
    v_mul_f32 v216, v216, v25
    v_mul_f32 v217, v217, v25
    v_mul_f32 v218, v218, v25
    v_mul_f32 v219, v219, v25
    v_mul_f32 v220, v220, v25
    v_mul_f32 v221, v221, v25
    v_mul_f32 v222, v222, v25
    v_mul_f32 v223, v223, v25
    v_mul_f32 v224, v224, v25
    v_mul_f32 v225, v225, v25
    v_mul_f32 v226, v226, v25
    v_mul_f32 v227, v227, v25
    v_mul_f32 v234, v234, v25
    v_mul_f32 v235, v235, v25
    v_cvt_pk_bf16_f32 v28, v212, v213
    v_cvt_pk_bf16_f32 v29, v214, v215
    v_cvt_pk_bf16_f32 v30, v216, v217
    v_cvt_pk_bf16_f32 v31, v218, v219
    v_cvt_pk_bf16_f32 v32, v220, v221
    v_cvt_pk_bf16_f32 v33, v222, v223
    v_cvt_pk_bf16_f32 v34, v224, v225
    v_cvt_pk_bf16_f32 v35, v226, v227
    v_cvt_pk_bf16_f32 v36, v234, v235
    ds_write_b64 v6, v[28:29] offset:240
    ds_write_b64 v6, v[30:31] offset:248
    ds_write_b64 v6, v[32:33] offset:256
    ds_write_b64 v6, v[34:35] offset:264
    ds_write_b32 v6, v36 offset:272
    s_waitcnt lgkmcnt(0)
    s_barrier
    ds_write_b64 v7, v[84:85] offset:0
    ds_write_b64 v7, v[86:87] offset:16
    ds_write_b64 v7, v[40:41] offset:32
    ds_write_b64 v7, v[42:43] offset:48
    ds_write_b64 v7, v[44:45] offset:64
    ds_write_b64 v7, v[46:47] offset:80
    ds_write_b64 v7, v[96:97] offset:96
    ds_write_b64 v7, v[98:99] offset:112
    ds_write_b64 v7, v[100:101] offset:128
    v_mov_b32 v24, 1065369472
    v_mov_b32 v25, 1065369472
    v_lshrrev_b32 v26, 9, v0
    v_lshlrev_b32 v26, 3, v26
    v_sub_u32 v26, v7, v26
    ds_write_b64 v26, v[24:25] offset:144
    s_lshr_b32 s38, s3, 1
    s_and_b32 s39, s38, 1
    s_mul_i32 s40, s38, 36
    s_lshl_b32 s39, s39, 2
    s_sub_u32 s40, s40, s39
    v_bfe_u32 v24, v0, 4, 2
    v_bfe_u32 v25, v0, 8, 1
    v_lshlrev_b32 v26, 3, v24
    v_lshl_add_u32 v26, v25, 5, v26
    v_add_u32 v27, s40, v26
    v_cmp_eq_u32 vcc, 40, v26
    v_mov_b32 v28, 144
    v_mul_u32_u24 v29, 152, v12
    v_cndmask_b32 v27, v27, v28, vcc
    v_add_u32 v27, v27, v29
    v_mul_u32_u24 v29, 328, v12
    v_add_u32 v29, v29, v26
    s_mul_i32 s41, s3, 40
    s_add_u32 s41, s41, 40960
    v_add_u32 v29, s41, v29
    v_add_u32 v30, 41984, v29
    s_waitcnt lgkmcnt(0)
    s_barrier
    ds_read_b64_tr_b16 v[112:113], v27 offset:0
    ds_read_b64_tr_b16 v[114:115], v27 offset:608
    ds_read_b64_tr_b16 v[116:117], v29 offset:0
    ds_read_b64_tr_b16 v[118:119], v29 offset:1312
    ds_read_b64_tr_b16 v[120:121], v27 offset:2432
    ds_read_b64_tr_b16 v[122:123], v27 offset:3040
    ds_read_b64_tr_b16 v[124:125], v29 offset:5248
    ds_read_b64_tr_b16 v[126:127], v29 offset:6560
    ds_read_b64_tr_b16 v[128:129], v27 offset:4864
    ds_read_b64_tr_b16 v[130:131], v27 offset:5472
    ds_read_b64_tr_b16 v[132:133], v29 offset:10496
    ds_read_b64_tr_b16 v[134:135], v29 offset:11808
    s_waitcnt lgkmcnt(8)
    v_mfma_f32_32x32x16_bf16 v[48:63], v[112:115], v[116:119], 0
    ds_read_b64_tr_b16 v[136:137], v27 offset:7296
    ds_read_b64_tr_b16 v[138:139], v27 offset:7904
    ds_read_b64_tr_b16 v[140:141], v29 offset:15744
    ds_read_b64_tr_b16 v[142:143], v29 offset:17056
    s_waitcnt lgkmcnt(8)
    v_mfma_f32_32x32x16_bf16 v[48:63], v[120:123], v[124:127], v[48:63]
    ds_read_b64_tr_b16 v[144:145], v27 offset:9728
    ds_read_b64_tr_b16 v[146:147], v27 offset:10336
    ds_read_b64_tr_b16 v[148:149], v29 offset:20992
    ds_read_b64_tr_b16 v[150:151], v29 offset:22304
    s_waitcnt lgkmcnt(8)
    v_mfma_f32_32x32x16_bf16 v[48:63], v[128:131], v[132:135], v[48:63]
    ds_read_b64_tr_b16 v[152:153], v27 offset:12160
    ds_read_b64_tr_b16 v[154:155], v27 offset:12768
    ds_read_b64_tr_b16 v[156:157], v29 offset:26240
    ds_read_b64_tr_b16 v[158:159], v29 offset:27552
    s_waitcnt lgkmcnt(8)
    v_mfma_f32_32x32x16_bf16 v[48:63], v[136:139], v[140:143], v[48:63]
    ds_read_b64_tr_b16 v[160:161], v27 offset:14592
    ds_read_b64_tr_b16 v[162:163], v27 offset:15200
    ds_read_b64_tr_b16 v[164:165], v29 offset:31488
    ds_read_b64_tr_b16 v[166:167], v29 offset:32800
    s_waitcnt lgkmcnt(8)
    v_mfma_f32_32x32x16_bf16 v[48:63], v[144:147], v[148:151], v[48:63]
    ds_read_b64_tr_b16 v[168:169], v27 offset:17024
    ds_read_b64_tr_b16 v[170:171], v27 offset:17632
    ds_read_b64_tr_b16 v[172:173], v29 offset:36736
    ds_read_b64_tr_b16 v[174:175], v29 offset:38048
    s_waitcnt lgkmcnt(8)
    v_mfma_f32_32x32x16_bf16 v[48:63], v[152:155], v[156:159], v[48:63]
    ds_read_b64_tr_b16 v[176:177], v27 offset:19456
    ds_read_b64_tr_b16 v[178:179], v27 offset:20064
    ds_read_b64_tr_b16 v[180:181], v30 offset:0
    ds_read_b64_tr_b16 v[182:183], v30 offset:1312
    s_waitcnt lgkmcnt(8)
    v_mfma_f32_32x32x16_bf16 v[48:63], v[160:163], v[164:167], v[48:63]
    ds_read_b64_tr_b16 v[184:185], v27 offset:21888
    ds_read_b64_tr_b16 v[186:187], v27 offset:22496
    ds_read_b64_tr_b16 v[188:189], v30 offset:5248
    ds_read_b64_tr_b16 v[190:191], v30 offset:6560
    s_waitcnt lgkmcnt(8)
    v_mfma_f32_32x32x16_bf16 v[48:63], v[168:171], v[172:175], v[48:63]
    ds_read_b64_tr_b16 v[192:193], v27 offset:24320
    ds_read_b64_tr_b16 v[194:195], v27 offset:24928
    ds_read_b64_tr_b16 v[196:197], v30 offset:10496
    ds_read_b64_tr_b16 v[198:199], v30 offset:11808
    s_waitcnt lgkmcnt(8)
    v_mfma_f32_32x32x16_bf16 v[48:63], v[176:179], v[180:183], v[48:63]
    ds_read_b64_tr_b16 v[200:201], v27 offset:26752
    ds_read_b64_tr_b16 v[202:203], v27 offset:27360
    ds_read_b64_tr_b16 v[204:205], v30 offset:15744
    ds_read_b64_tr_b16 v[206:207], v30 offset:17056
    s_waitcnt lgkmcnt(8)
    v_mfma_f32_32x32x16_bf16 v[48:63], v[184:187], v[188:191], v[48:63]
    ds_read_b64_tr_b16 v[208:209], v27 offset:29184
    ds_read_b64_tr_b16 v[210:211], v27 offset:29792
    ds_read_b64_tr_b16 v[212:213], v30 offset:20992
    ds_read_b64_tr_b16 v[214:215], v30 offset:22304
    s_waitcnt lgkmcnt(8)
    v_mfma_f32_32x32x16_bf16 v[48:63], v[192:195], v[196:199], v[48:63]
    ds_read_b64_tr_b16 v[216:217], v27 offset:31616
    ds_read_b64_tr_b16 v[218:219], v27 offset:32224
    ds_read_b64_tr_b16 v[220:221], v30 offset:26240
    ds_read_b64_tr_b16 v[222:223], v30 offset:27552
    s_waitcnt lgkmcnt(8)
    v_mfma_f32_32x32x16_bf16 v[48:63], v[200:203], v[204:207], v[48:63]
    ds_read_b64_tr_b16 v[224:225], v27 offset:34048
    ds_read_b64_tr_b16 v[226:227], v27 offset:34656
    ds_read_b64_tr_b16 v[228:229], v30 offset:31488
    ds_read_b64_tr_b16 v[230:231], v30 offset:32800
    s_waitcnt lgkmcnt(8)
    v_mfma_f32_32x32x16_bf16 v[48:63], v[208:211], v[212:215], v[48:63]
    ds_read_b64_tr_b16 v[232:233], v27 offset:36480
    ds_read_b64_tr_b16 v[234:235], v27 offset:37088
    ds_read_b64_tr_b16 v[236:237], v30 offset:36736
    ds_read_b64_tr_b16 v[238:239], v30 offset:38048
    s_waitcnt lgkmcnt(8)
    v_mfma_f32_32x32x16_bf16 v[48:63], v[216:219], v[220:223], v[48:63]
    s_waitcnt lgkmcnt(4)
    v_mfma_f32_32x32x16_bf16 v[48:63], v[224:227], v[228:231], v[48:63]
    s_waitcnt lgkmcnt(0)
    v_mfma_f32_32x32x16_bf16 v[48:63], v[232:235], v[236:239], v[48:63]
    s_lshl_b32 s38, s32, 6
    s_lshl_b32 s39, s33, 3
    s_add_u32 s38, s38, s39
    s_add_u32 s38, s38, s3
    s_mul_i32 s38, s38, 1920
    s_add_u32 s38, s38, 40894464
    v_lshrrev_b32 v24, 9, v0
    v_mul_u32_u24 v24, 320, v24
    v_lshrrev_b32 v25, 1, v21
    v_add_u32 v24, v24, v25
    v_cmp_gt_u32 vcc, 80, v25
    v_mov_b32 v26, 1073741824
    s_nop 0
    v_cndmask_b32 v24, v26, v24, vcc
    s_nop 7
    buffer_store_dword v48, v24, s[20:23], s38 offen offset:0 sc1
    buffer_store_dword v49, v24, s[20:23], s38 offen offset:80 sc1
    buffer_store_dword v50, v24, s[20:23], s38 offen offset:160 sc1
    buffer_store_dword v51, v24, s[20:23], s38 offen offset:240 sc1
    buffer_store_dword v52, v24, s[20:23], s38 offen offset:640 sc1
    buffer_store_dword v53, v24, s[20:23], s38 offen offset:720 sc1
    buffer_store_dword v54, v24, s[20:23], s38 offen offset:800 sc1
    buffer_store_dword v55, v24, s[20:23], s38 offen offset:880 sc1
    buffer_store_dword v56, v24, s[20:23], s38 offen offset:1280 sc1
    buffer_store_dword v57, v24, s[20:23], s38 offen offset:1360 sc1
    buffer_store_dword v58, v24, s[20:23], s38 offen offset:1440 sc1
    buffer_store_dword v59, v24, s[20:23], s38 offen offset:1520 sc1
    s_waitcnt vmcnt(12)
    v_readfirstlane_b32 s69, v14
    s_lshl_b32 s68, s33, 3
    s_add_u32 s68, s68, s32
    s_add_u32 s68, s68, 192
    s_branch parallel_sum__linear_kernel_hedgehog__mixer_gmlp__prompt_kernel_p2
parallel_sum__linear_kernel_hedgehog__mixer_gmlp__prompt_kernel_p2:
    s_mov_b32 s100, s8
    s_mov_b32 s101, s9
    v_mbcnt_lo_u32_b32 v2, -1, 0
    v_mbcnt_hi_u32_b32 v2, -1, v2
    s_lshl_b32 s10, s3, 6
    v_add_u32 v0, s10, v2
    s_and_b32 s10, s2, 7
    s_lshr_b32 s11, s2, 3
    s_and_b32 s32, s10, 1
    s_lshl_b32 s32, s32, 3
    s_and_b32 s33, s11, 7
    s_add_u32 s32, s32, s33
    s_lshr_b32 s33, s10, 1
    s_lshl_b32 s33, s33, 2
    s_lshr_b32 s34, s11, 3
    s_add_u32 s33, s33, s34
    v_lshlrev_b32 v3, 4, v2
    s_waitcnt lgkmcnt(0)
    s_barrier
    s_mov_b32 s12, s4
    s_mov_b32 s13, s5
    s_mov_b32 s14, 8388608
    s_mov_b32 s15, 0x20000
    s_mov_b32 s8, s6
    s_mov_b32 s9, s7
    s_mov_b32 s4, s20
    s_mov_b32 s5, s21
    s_mov_b32 s16, s4
    s_mov_b32 s17, s5
    s_mov_b32 s18, 9437184
    s_mov_b32 s19, 0x20000
    s_mov_b32 s20, s4
    s_mov_b32 s21, s5
    s_mov_b32 s22, 57671680
    s_mov_b32 s23, 0x20000
    s_cmp_lt_u32 s3, 4
    s_cbranch_scc1 parallel_sum__linear_kernel_hedgehog__mixer_gmlp__prompt_kernel_compute
    s_sub_u32 s3, s3, 4
    v_lshrrev_b32 v8, 3, v2
    v_and_b32 v9, 7, v2
    v_lshrrev_b32 v10, 4, v2
    v_xor_b32 v9, v9, v10
    v_lshlrev_b32 v8, 12, v8
    v_lshl_add_u32 v4, v9, 4, v8
    v_xor_b32 v9, 4, v9
    v_lshl_add_u32 v5, v9, 4, v8
    v_add_u32 v6, 63488, v4
    v_add_u32 v7, 95232, v5
    v_add_u32 v5, 31744, v5
    s_lshl_b32 s36, s32, 7
    s_lshl_b32 s37, s3, 5
    s_add_u32 s36, s36, s37
    s_lshl_b32 s36, s36, 12
    s_waitcnt lgkmcnt(0)
    s_cmp_ge_u32 s3, 2
    s_cbranch_scc1 parallel_sum__linear_kernel_hedgehog__mixer_gmlp__prompt_kernel_ldhi
    s_add_u32 s62, s32, s33
    s_and_b32 s62, s62, 3
    s_and_b32 s42, s3, 1
    s_mul_i32 s43, s33, 9
    s_and_b32 s44, s33, 1
    s_add_u32 s45, s43, s44
    s_mul_i32 s46, s42, 144
    s_add_u32 s37, s45, s46
    s_add_u32 s37, s37, 0
    s_lshl_b32 s37, s37, 10
    s_add_u32 s38, s37, 4096
    s_mul_i32 s40, s42, 9216
    s_add_u32 s41, s40, 4096
    s_add_u32 s40, s40, 0
    s_lshl_b32 s39, s3, 12
    s_add_u32 s39, s39, 18432
    s_mul_i32 s58, s33, 3
    s_add_u32 s59, s58, 2
    s_lshr_b32 s58, s58, 2
    s_lshr_b32 s59, s59, 2
    s_sub_u32 s59, s59, s58
    v_bfe_u32 v20, v2, 4, 1
    v_mul_lo_u32 v20, v20, s59
    v_add_u32 v20, s58, v20
    v_and_b32 v21, 15, v2
    v_lshl_add_u32 v20, v20, 4, v21
    v_lshlrev_b32 v20, 7, v20
    v_add_u32 v20, 45023232, v20
    buffer_load_dword v22, v20, s[20:23], 0 offen sc1
    s_cmp_eq_u32 s62, 0
    s_cselect_b32 s63, 4, 0
    s_lshl_b32 s64, s63, 7
    s_add_u32 s64, s64, s36
    s_add_u32 m0, s39, 0
    s_mul_i32 s63, s63, 294912
    buffer_load_dwordx4 v4, s[12:15], s64 offen offset:0 lds
    buffer_load_dwordx4 v5, s[12:15], s64 offen offset:1024 lds
    buffer_load_dwordx4 v6, s[12:15], s64 offen offset:2048 lds
    buffer_load_dwordx4 v7, s[12:15], s64 offen offset:3072 lds
    s_cmp_eq_u32 s62, 1
    s_cselect_b32 s63, 5, 1
    s_lshl_b32 s64, s63, 7
    s_add_u32 s64, s64, s36
    s_add_u32 m0, s39, 34816
    s_mul_i32 s63, s63, 294912
    buffer_load_dwordx4 v4, s[12:15], s64 offen offset:0 lds
    buffer_load_dwordx4 v5, s[12:15], s64 offen offset:1024 lds
    buffer_load_dwordx4 v6, s[12:15], s64 offen offset:2048 lds
    buffer_load_dwordx4 v7, s[12:15], s64 offen offset:3072 lds
    s_cmp_eq_u32 s62, 2
    s_cselect_b32 s63, 6, 2
    s_lshl_b32 s64, s63, 7
    s_add_u32 s64, s64, s36
    s_add_u32 m0, s39, 69632
    s_mul_i32 s63, s63, 294912
    buffer_load_dwordx4 v4, s[12:15], s64 offen offset:0 lds
    buffer_load_dwordx4 v5, s[12:15], s64 offen offset:1024 lds
    buffer_load_dwordx4 v6, s[12:15], s64 offen offset:2048 lds
    buffer_load_dwordx4 v7, s[12:15], s64 offen offset:3072 lds
    s_cmp_eq_u32 s3, 1
    s_cbranch_scc0 parallel_sum__linear_kernel_hedgehog__mixer_gmlp__prompt_kernel_e1_501
    s_waitcnt vmcnt(12)
    s_mov_b32 s58, 200000
parallel_sum__linear_kernel_hedgehog__mixer_gmlp__prompt_kernel_fl_502:
    v_cmp_ne_u32 vcc, s69, v22
    s_sub_u32 s58, s58, 1
    s_cmp_eq_u32 s58, 0
    s_cbranch_scc1 parallel_sum__linear_kernel_hedgehog__mixer_gmlp__prompt_kernel_fk_503
    s_cmp_eq_u64 vcc, 0
    s_cbranch_scc1 parallel_sum__linear_kernel_hedgehog__mixer_gmlp__prompt_kernel_fk_503
    s_sleep 6
    buffer_load_dword v22, v20, s[20:23], 0 offen sc1
    s_waitcnt vmcnt(0)
    s_branch parallel_sum__linear_kernel_hedgehog__mixer_gmlp__prompt_kernel_fl_502
parallel_sum__linear_kernel_hedgehog__mixer_gmlp__prompt_kernel_fk_503:
parallel_sum__linear_kernel_hedgehog__mixer_gmlp__prompt_kernel_e1_501:
    s_barrier
    s_cmp_eq_u32 s62, 0
    s_cselect_b32 s63, 4, 0
    s_lshl_b32 s64, s63, 7
    s_add_u32 s64, s64, s36
    s_add_u32 m0, s39, 0
    s_mul_i32 s63, s63, 294912
    s_add_u32 m0, s40, 0
    s_add_u32 s64, s63, s37
    buffer_load_dwordx4 v3, s[16:19], s64 offen offset:0 lds
    buffer_load_dwordx4 v3, s[16:19], s64 offen offset:1024 lds
    buffer_load_dwordx4 v3, s[16:19], s64 offen offset:2048 lds
    buffer_load_dwordx4 v3, s[16:19], s64 offen offset:3072 lds
    s_add_u32 m0, s41, 0
    s_add_u32 s64, s63, s38
    buffer_load_dwordx4 v3, s[16:19], s64 offen lds
    s_cmp_eq_u32 s62, 1
    s_cselect_b32 s63, 5, 1
    s_lshl_b32 s64, s63, 7
    s_add_u32 s64, s64, s36
    s_add_u32 m0, s39, 34816
    s_mul_i32 s63, s63, 294912
    s_add_u32 m0, s40, 34816
    s_add_u32 s64, s63, s37
    buffer_load_dwordx4 v3, s[16:19], s64 offen offset:0 lds
    buffer_load_dwordx4 v3, s[16:19], s64 offen offset:1024 lds
    buffer_load_dwordx4 v3, s[16:19], s64 offen offset:2048 lds
    buffer_load_dwordx4 v3, s[16:19], s64 offen offset:3072 lds
    s_add_u32 m0, s41, 34816
    s_add_u32 s64, s63, s38
    buffer_load_dwordx4 v3, s[16:19], s64 offen lds
    s_cmp_eq_u32 s62, 2
    s_cselect_b32 s63, 6, 2
    s_lshl_b32 s64, s63, 7
    s_add_u32 s64, s64, s36
    s_add_u32 m0, s39, 69632
    s_mul_i32 s63, s63, 294912
    s_add_u32 m0, s40, 69632
    s_add_u32 s64, s63, s37
    buffer_load_dwordx4 v3, s[16:19], s64 offen offset:0 lds
    buffer_load_dwordx4 v3, s[16:19], s64 offen offset:1024 lds
    buffer_load_dwordx4 v3, s[16:19], s64 offen offset:2048 lds
    buffer_load_dwordx4 v3, s[16:19], s64 offen offset:3072 lds
    s_add_u32 m0, s41, 69632
    s_add_u32 s64, s63, s38
    buffer_load_dwordx4 v3, s[16:19], s64 offen lds
    s_waitcnt vmcnt(10)
    s_barrier
    s_cmp_eq_u32 s62, 3
    s_cselect_b32 s63, 7, 3
    s_lshl_b32 s64, s63, 7
    s_add_u32 s64, s64, s36
    s_add_u32 m0, s39, 104448
    s_mul_i32 s63, s63, 294912
    buffer_load_dwordx4 v4, s[12:15], s64 offen offset:0 lds
    buffer_load_dwordx4 v5, s[12:15], s64 offen offset:1024 lds
    buffer_load_dwordx4 v6, s[12:15], s64 offen offset:2048 lds
    buffer_load_dwordx4 v7, s[12:15], s64 offen offset:3072 lds
    s_add_u32 m0, s40, 104448
    s_add_u32 s64, s63, s37
    buffer_load_dwordx4 v3, s[16:19], s64 offen offset:0 lds
    buffer_load_dwordx4 v3, s[16:19], s64 offen offset:1024 lds
    buffer_load_dwordx4 v3, s[16:19], s64 offen offset:2048 lds
    buffer_load_dwordx4 v3, s[16:19], s64 offen offset:3072 lds
    s_add_u32 m0, s41, 104448
    s_add_u32 s64, s63, s38
    buffer_load_dwordx4 v3, s[16:19], s64 offen lds
    s_waitcnt vmcnt(14)
    s_barrier
    s_cmp_eq_u32 s3, 0
    s_cbranch_scc0 parallel_sum__linear_kernel_hedgehog__mixer_gmlp__prompt_kernel_fs_504
    s_lshl_b32 s58, s68, 7
    s_add_u32 s58, s58, 44990464
    v_mov_b32 v12, s69
    v_mov_b32 v13, s69
    v_mov_b32 v14, s69
    v_mov_b32 v15, s69
    s_mov_b64 exec, 0xff
    buffer_store_dwordx4 v[12:15], v3, s[20:23], s58 offen sc1
    s_mov_b64 exec, -1
parallel_sum__linear_kernel_hedgehog__mixer_gmlp__prompt_kernel_fs_504:
    s_cmp_eq_u32 s62, 0
    s_cselect_b32 s63, 8, 4
    s_lshl_b32 s64, s63, 7
    s_add_u32 s64, s64, s36
    s_add_u32 m0, s39, 0
    s_mul_i32 s63, s63, 294912
    buffer_load_dwordx4 v4, s[12:15], s64 offen offset:0 lds
    buffer_load_dwordx4 v5, s[12:15], s64 offen offset:1024 lds
    buffer_load_dwordx4 v6, s[12:15], s64 offen offset:2048 lds
    buffer_load_dwordx4 v7, s[12:15], s64 offen offset:3072 lds
    s_add_u32 m0, s40, 0
    s_add_u32 s64, s63, s37
    buffer_load_dwordx4 v3, s[16:19], s64 offen offset:0 lds
    buffer_load_dwordx4 v3, s[16:19], s64 offen offset:1024 lds
    buffer_load_dwordx4 v3, s[16:19], s64 offen offset:2048 lds
    buffer_load_dwordx4 v3, s[16:19], s64 offen offset:3072 lds
    s_add_u32 m0, s41, 0
    s_add_u32 s64, s63, s38
    buffer_load_dwordx4 v3, s[16:19], s64 offen lds
    s_waitcnt vmcnt(18)
    s_barrier
    s_cmp_eq_u32 s62, 1
    s_cselect_b32 s63, 9, 5
    s_lshl_b32 s64, s63, 7
    s_add_u32 s64, s64, s36
    s_add_u32 m0, s39, 34816
    s_mul_i32 s63, s63, 294912
    buffer_load_dwordx4 v4, s[12:15], s64 offen offset:0 lds
    buffer_load_dwordx4 v5, s[12:15], s64 offen offset:1024 lds
    buffer_load_dwordx4 v6, s[12:15], s64 offen offset:2048 lds
    buffer_load_dwordx4 v7, s[12:15], s64 offen offset:3072 lds
    s_add_u32 m0, s40, 34816
    s_add_u32 s64, s63, s37
    buffer_load_dwordx4 v3, s[16:19], s64 offen offset:0 lds
    buffer_load_dwordx4 v3, s[16:19], s64 offen offset:1024 lds
    buffer_load_dwordx4 v3, s[16:19], s64 offen offset:2048 lds
    buffer_load_dwordx4 v3, s[16:19], s64 offen offset:3072 lds
    s_add_u32 m0, s41, 34816
    s_add_u32 s64, s63, s38
    buffer_load_dwordx4 v3, s[16:19], s64 offen lds
    s_waitcnt vmcnt(18)
    s_barrier
    s_cmp_eq_u32 s62, 2
    s_cselect_b32 s63, 10, 6
    s_lshl_b32 s64, s63, 7
    s_add_u32 s64, s64, s36
    s_add_u32 m0, s39, 69632
    s_mul_i32 s63, s63, 294912
    buffer_load_dwordx4 v4, s[12:15], s64 offen offset:0 lds
    buffer_load_dwordx4 v5, s[12:15], s64 offen offset:1024 lds
    buffer_load_dwordx4 v6, s[12:15], s64 offen offset:2048 lds
    buffer_load_dwordx4 v7, s[12:15], s64 offen offset:3072 lds
    s_add_u32 m0, s40, 69632
    s_add_u32 s64, s63, s37
    buffer_load_dwordx4 v3, s[16:19], s64 offen offset:0 lds
    buffer_load_dwordx4 v3, s[16:19], s64 offen offset:1024 lds
    buffer_load_dwordx4 v3, s[16:19], s64 offen offset:2048 lds
    buffer_load_dwordx4 v3, s[16:19], s64 offen offset:3072 lds
    s_add_u32 m0, s41, 69632
    s_add_u32 s64, s63, s38
    buffer_load_dwordx4 v3, s[16:19], s64 offen lds
    s_lshr_b32 s50, s2, 5
    s_and_b32 s51, s2, 7
    s_lshl_b32 s51, s51, 2
    s_bfe_u32 s59, s2, 0x20003
    s_add_u32 s51, s51, s59
    s_lshr_b32 s52, s51, 3
    s_add_u32 s52, s52, s51
    s_add_u32 s53, s52, 1
    s_lshr_b32 s52, s52, 2
    s_lshr_b32 s53, s53, 2
    s_mul_i32 s54, s52, 43
    s_lshr_b32 s54, s54, 7
    s_add_u32 s52, s52, s54
    s_mul_i32 s54, s53, 43
    s_lshr_b32 s54, s54, 7
    s_add_u32 s53, s53, s54
    s_lshl_b32 s54, s50, 1
    s_lshl_b32 s52, s52, 4
    s_lshl_b32 s53, s53, 4
    s_add_u32 s52, s52, s54
    s_add_u32 s53, s53, s54
    s_lshr_b32 s54, s51, 2
    s_lshl_b32 s54, s54, 3
    s_add_u32 s54, s54, 192
    v_and_b32 v26, 7, v2
    v_add_u32 v26, s54, v26
    v_writelane_b32 v26, s52, 8
    v_writelane_b32 v26, s53, 9
    s_add_u32 s52, s52, 1
    s_add_u32 s53, s53, 1
    v_writelane_b32 v26, s52, 10
    v_writelane_b32 v26, s53, 11
    s_mul_i32 s52, s33, 3
    s_add_u32 s53, s52, 2
    s_lshr_b32 s52, s52, 2
    s_lshr_b32 s53, s53, 2
    s_lshl_b32 s52, s52, 4
    s_lshl_b32 s53, s53, 4
    s_add_u32 s52, s52, s32
    s_add_u32 s53, s53, s32
    v_writelane_b32 v26, s52, 12
    v_writelane_b32 v26, s53, 13
    v_lshlrev_b32 v26, 7, v26
    v_add_u32 v26, 44990464, v26
    buffer_load_dword v27, v26, s[20:23], 0 offen sc1
    s_waitcnt vmcnt(19)
    s_barrier
    s_cmp_eq_u32 s62, 3
    s_cselect_b32 s63, 11, 7
    s_lshl_b32 s64, s63, 7
    s_add_u32 s64, s64, s36
    s_add_u32 m0, s39, 104448
    s_mul_i32 s63, s63, 294912
    buffer_load_dwordx4 v4, s[12:15], s64 offen offset:0 lds
    buffer_load_dwordx4 v5, s[12:15], s64 offen offset:1024 lds
    buffer_load_dwordx4 v6, s[12:15], s64 offen offset:2048 lds
    buffer_load_dwordx4 v7, s[12:15], s64 offen offset:3072 lds
    s_add_u32 m0, s40, 104448
    s_add_u32 s64, s63, s37
    buffer_load_dwordx4 v3, s[16:19], s64 offen offset:0 lds
    buffer_load_dwordx4 v3, s[16:19], s64 offen offset:1024 lds
    buffer_load_dwordx4 v3, s[16:19], s64 offen offset:2048 lds
    buffer_load_dwordx4 v3, s[16:19], s64 offen offset:3072 lds
    s_add_u32 m0, s41, 104448
    s_add_u32 s64, s63, s38
    buffer_load_dwordx4 v3, s[16:19], s64 offen lds
    s_waitcnt vmcnt(19)
    s_barrier
    s_cmp_eq_u32 s62, 0
    s_cselect_b32 s63, 12, 8
    s_lshl_b32 s64, s63, 7
    s_add_u32 s64, s64, s36
    s_add_u32 m0, s39, 0
    s_mul_i32 s63, s63, 294912
    buffer_load_dwordx4 v4, s[12:15], s64 offen offset:0 lds
    buffer_load_dwordx4 v5, s[12:15], s64 offen offset:1024 lds
    buffer_load_dwordx4 v6, s[12:15], s64 offen offset:2048 lds
    buffer_load_dwordx4 v7, s[12:15], s64 offen offset:3072 lds
    s_add_u32 m0, s40, 0
    s_add_u32 s64, s63, s37
    buffer_load_dwordx4 v3, s[16:19], s64 offen offset:0 lds
    buffer_load_dwordx4 v3, s[16:19], s64 offen offset:1024 lds
    buffer_load_dwordx4 v3, s[16:19], s64 offen offset:2048 lds
    buffer_load_dwordx4 v3, s[16:19], s64 offen offset:3072 lds
    s_add_u32 m0, s41, 0
    s_add_u32 s64, s63, s38
    buffer_load_dwordx4 v3, s[16:19], s64 offen lds
    s_waitcnt vmcnt(18)
    s_mov_b32 s58, 200000
parallel_sum__linear_kernel_hedgehog__mixer_gmlp__prompt_kernel_fl_505:
    v_cmp_ne_u32 vcc, s69, v27
    s_sub_u32 s58, s58, 1
    s_cmp_eq_u32 s58, 0
    s_cbranch_scc1 parallel_sum__linear_kernel_hedgehog__mixer_gmlp__prompt_kernel_fk_506
    s_cmp_eq_u64 vcc, 0
    s_cbranch_scc1 parallel_sum__linear_kernel_hedgehog__mixer_gmlp__prompt_kernel_fk_506
    s_sleep 6
    buffer_load_dword v27, v26, s[20:23], 0 offen sc1
    s_waitcnt vmcnt(0)
    s_branch parallel_sum__linear_kernel_hedgehog__mixer_gmlp__prompt_kernel_fl_505
parallel_sum__linear_kernel_hedgehog__mixer_gmlp__prompt_kernel_fk_506:
    s_lshr_b32 s50, s2, 5
    s_and_b32 s51, s2, 7
    s_lshl_b32 s51, s51, 2
    s_bfe_u32 s59, s2, 0x20003
    s_add_u32 s51, s51, s59
    s_mul_i32 s52, s51, 3840
    s_add_u32 s52, s52, 40894464
    v_lshlrev_b32 v28, 4, v0
    v_subrev_u32 v28, 4096, v28
    v_cmp_gt_u32 vcc, 3840, v28
    v_mov_b32 v29, 1073741824
    s_lshr_b32 s53, s51, 2
    s_mul_i32 s53, s53, 13
    v_cndmask_b32 v29, v29, v28, vcc
    buffer_load_dwordx4 v[32:35], v29, s[20:23], s52 offen
    s_add_u32 s52, s52, 122880
    buffer_load_dwordx4 v[36:39], v29, s[20:23], s52 offen
    s_add_u32 s52, s52, 122880
    buffer_load_dwordx4 v[40:43], v29, s[20:23], s52 offen
    s_add_u32 s52, s52, 122880
    buffer_load_dwordx4 v[44:47], v29, s[20:23], s52 offen
    s_add_u32 s52, s52, 122880
    buffer_load_dwordx4 v[48:51], v29, s[20:23], s52 offen
    s_add_u32 s52, s52, 122880
    buffer_load_dwordx4 v[52:55], v29, s[20:23], s52 offen
    s_add_u32 s52, s52, 122880
    buffer_load_dwordx4 v[56:59], v29, s[20:23], s52 offen
    s_add_u32 s52, s52, 122880
    buffer_load_dwordx4 v[60:63], v29, s[20:23], s52 offen
    s_and_b32 s54, s51, 3
    s_lshl_b32 s55, s54, 1
    s_add_u32 s56, s54, 6
    s_cmp_lt_u32 s3, 2
    s_cselect_b32 s55, s55, s56
    s_add_u32 s55, s55, s3
    s_add_u32 s55, s55, s53
    s_lshl_b32 s55, s55, 10
    s_add_u32 s55, s55, 41943040
    s_lshl_b32 s56, s3, 10
    s_add_u32 m0, s56, 157696
    s_lshl_b32 s57, s50, 3
    buffer_load_dwordx4 v3, s[20:23], s55 offen lds
    s_lshl_b32 s58, s3, 1
    s_add_u32 s57, s57, s58
    s_mul_i32 s58, s57, 36
    s_lshr_b32 s59, s51, 3
    s_add_u32 s59, s59, s51
    s_add_u32 s58, s58, s59
    s_lshl_b32 s58, s58, 10
    s_add_u32 s58, s58, 37748736
    s_lshl_b32 s56, s3, 12
    s_add_u32 m0, s56, 141312
    v_add_u32 v30, 34816, v3
    buffer_load_dwordx4 v3, s[20:23], s58 offen offset:0 lds
    buffer_load_dwordx4 v3, s[20:23], s58 offen offset:1024 lds
    buffer_load_dwordx4 v30, s[20:23], s58 offen offset:2048 lds
    buffer_load_dwordx4 v30, s[20:23], s58 offen offset:3072 lds
    s_barrier
    s_cmp_eq_u32 s62, 1
    s_cselect_b32 s63, 13, 9
    s_lshl_b32 s64, s63, 7
    s_add_u32 s64, s64, s36
    s_add_u32 m0, s39, 34816
    s_mul_i32 s63, s63, 294912
    buffer_load_dwordx4 v4, s[12:15], s64 offen offset:0 lds
    buffer_load_dwordx4 v5, s[12:15], s64 offen offset:1024 lds
    buffer_load_dwordx4 v6, s[12:15], s64 offen offset:2048 lds
    buffer_load_dwordx4 v7, s[12:15], s64 offen offset:3072 lds
    s_add_u32 m0, s40, 34816
    s_add_u32 s64, s63, s37
    buffer_load_dwordx4 v3, s[16:19], s64 offen offset:0 lds
    buffer_load_dwordx4 v3, s[16:19], s64 offen offset:1024 lds
    buffer_load_dwordx4 v3, s[16:19], s64 offen offset:2048 lds
    buffer_load_dwordx4 v3, s[16:19], s64 offen offset:3072 lds
    s_add_u32 m0, s41, 34816
    s_add_u32 s64, s63, s38
    buffer_load_dwordx4 v3, s[16:19], s64 offen lds
    s_waitcnt vmcnt(31)
    s_barrier
    s_cmp_eq_u32 s62, 2
    s_cselect_b32 s63, 14, 10
    s_lshl_b32 s64, s63, 7
    s_add_u32 s64, s64, s36
    s_add_u32 m0, s39, 69632
    s_mul_i32 s63, s63, 294912
    buffer_load_dwordx4 v4, s[12:15], s64 offen offset:0 lds
    buffer_load_dwordx4 v5, s[12:15], s64 offen offset:1024 lds
    buffer_load_dwordx4 v6, s[12:15], s64 offen offset:2048 lds
    buffer_load_dwordx4 v7, s[12:15], s64 offen offset:3072 lds
    s_add_u32 m0, s40, 69632
    s_add_u32 s64, s63, s37
    buffer_load_dwordx4 v3, s[16:19], s64 offen offset:0 lds
    buffer_load_dwordx4 v3, s[16:19], s64 offen offset:1024 lds
    buffer_load_dwordx4 v3, s[16:19], s64 offen offset:2048 lds
    buffer_load_dwordx4 v3, s[16:19], s64 offen offset:3072 lds
    s_add_u32 m0, s41, 69632
    s_add_u32 s64, s63, s38
    buffer_load_dwordx4 v3, s[16:19], s64 offen lds
    s_waitcnt vmcnt(31)
    s_barrier
    s_cmp_eq_u32 s62, 3
    s_cselect_b32 s63, 15, 11
    s_lshl_b32 s64, s63, 7
    s_add_u32 s64, s64, s36
    s_add_u32 m0, s39, 104448
    s_mul_i32 s63, s63, 294912
    buffer_load_dwordx4 v4, s[12:15], s64 offen offset:0 lds
    buffer_load_dwordx4 v5, s[12:15], s64 offen offset:1024 lds
    buffer_load_dwordx4 v6, s[12:15], s64 offen offset:2048 lds
    buffer_load_dwordx4 v7, s[12:15], s64 offen offset:3072 lds
    s_add_u32 m0, s40, 104448
    s_add_u32 s64, s63, s37
    buffer_load_dwordx4 v3, s[16:19], s64 offen offset:0 lds
    buffer_load_dwordx4 v3, s[16:19], s64 offen offset:1024 lds
    buffer_load_dwordx4 v3, s[16:19], s64 offen offset:2048 lds
    buffer_load_dwordx4 v3, s[16:19], s64 offen offset:3072 lds
    s_add_u32 m0, s41, 104448
    s_add_u32 s64, s63, s38
    buffer_load_dwordx4 v3, s[16:19], s64 offen lds
    s_waitcnt vmcnt(27)
    v_add_f32 v32, v32, v36
    v_add_f32 v33, v33, v37
    v_add_f32 v34, v34, v38
    v_add_f32 v35, v35, v39
    v_add_f32 v32, v32, v40
    v_add_f32 v33, v33, v41
    v_add_f32 v34, v34, v42
    v_add_f32 v35, v35, v43
    v_add_f32 v32, v32, v44
    v_add_f32 v33, v33, v45
    v_add_f32 v34, v34, v46
    v_add_f32 v35, v35, v47
    v_add_f32 v32, v32, v48
    v_add_f32 v33, v33, v49
    v_add_f32 v34, v34, v50
    v_add_f32 v35, v35, v51
    v_add_f32 v32, v32, v52
    v_add_f32 v33, v33, v53
    v_add_f32 v34, v34, v54
    v_add_f32 v35, v35, v55
    v_add_f32 v32, v32, v56
    v_add_f32 v33, v33, v57
    v_add_f32 v34, v34, v58
    v_add_f32 v35, v35, v59
    v_add_f32 v32, v32, v60
    v_add_f32 v33, v33, v61
    v_add_f32 v34, v34, v62
    v_add_f32 v35, v35, v63
    v_cvt_pk_bf16_f32 v32, v32, v33
    v_cvt_pk_bf16_f32 v33, v34, v35
    v_lshrrev_b32 v28, 1, v28
    v_add_u32 v28, 139264, v28
    ds_write_b64 v28, v[32:33]
    s_waitcnt lgkmcnt(0)
    s_waitcnt vmcnt(18)
    s_barrier
    s_cmp_eq_u32 s62, 0
    s_cselect_b32 s63, 16, 12
    s_lshl_b32 s64, s63, 7
    s_add_u32 s64, s64, s36
    s_add_u32 m0, s39, 0
    s_mul_i32 s63, s63, 294912
    buffer_load_dwordx4 v4, s[12:15], s64 offen offset:0 lds
    buffer_load_dwordx4 v5, s[12:15], s64 offen offset:1024 lds
    buffer_load_dwordx4 v6, s[12:15], s64 offen offset:2048 lds
    buffer_load_dwordx4 v7, s[12:15], s64 offen offset:3072 lds
    s_add_u32 m0, s40, 0
    s_add_u32 s64, s63, s37
    buffer_load_dwordx4 v3, s[16:19], s64 offen offset:0 lds
    buffer_load_dwordx4 v3, s[16:19], s64 offen offset:1024 lds
    buffer_load_dwordx4 v3, s[16:19], s64 offen offset:2048 lds
    buffer_load_dwordx4 v3, s[16:19], s64 offen offset:3072 lds
    s_add_u32 m0, s41, 0
    s_add_u32 s64, s63, s38
    buffer_load_dwordx4 v3, s[16:19], s64 offen lds
    s_waitcnt vmcnt(18)
    s_barrier
    s_cmp_eq_u32 s62, 1
    s_cselect_b32 s63, 17, 13
    s_lshl_b32 s64, s63, 7
    s_add_u32 s64, s64, s36
    s_add_u32 m0, s39, 34816
    s_mul_i32 s63, s63, 294912
    buffer_load_dwordx4 v4, s[12:15], s64 offen offset:0 lds
    buffer_load_dwordx4 v5, s[12:15], s64 offen offset:1024 lds
    buffer_load_dwordx4 v6, s[12:15], s64 offen offset:2048 lds
    buffer_load_dwordx4 v7, s[12:15], s64 offen offset:3072 lds
    s_add_u32 m0, s40, 34816
    s_add_u32 s64, s63, s37
    buffer_load_dwordx4 v3, s[16:19], s64 offen offset:0 lds
    buffer_load_dwordx4 v3, s[16:19], s64 offen offset:1024 lds
    buffer_load_dwordx4 v3, s[16:19], s64 offen offset:2048 lds
    buffer_load_dwordx4 v3, s[16:19], s64 offen offset:3072 lds
    s_add_u32 m0, s41, 34816
    s_add_u32 s64, s63, s38
    buffer_load_dwordx4 v3, s[16:19], s64 offen lds
    s_waitcnt vmcnt(18)
    s_barrier
    s_cmp_eq_u32 s62, 2
    s_cselect_b32 s63, 18, 14
    s_lshl_b32 s64, s63, 7
    s_add_u32 s64, s64, s36
    s_add_u32 m0, s39, 69632
    s_mul_i32 s63, s63, 294912
    buffer_load_dwordx4 v4, s[12:15], s64 offen offset:0 lds
    buffer_load_dwordx4 v5, s[12:15], s64 offen offset:1024 lds
    buffer_load_dwordx4 v6, s[12:15], s64 offen offset:2048 lds
    buffer_load_dwordx4 v7, s[12:15], s64 offen offset:3072 lds
    s_add_u32 m0, s40, 69632
    s_add_u32 s64, s63, s37
    buffer_load_dwordx4 v3, s[16:19], s64 offen offset:0 lds
    buffer_load_dwordx4 v3, s[16:19], s64 offen offset:1024 lds
    buffer_load_dwordx4 v3, s[16:19], s64 offen offset:2048 lds
    buffer_load_dwordx4 v3, s[16:19], s64 offen offset:3072 lds
    s_add_u32 m0, s41, 69632
    s_add_u32 s64, s63, s38
    buffer_load_dwordx4 v3, s[16:19], s64 offen lds
    s_waitcnt vmcnt(18)
    s_barrier
    s_cmp_eq_u32 s62, 3
    s_cselect_b32 s63, 19, 15
    s_lshl_b32 s64, s63, 7
    s_add_u32 s64, s64, s36
    s_add_u32 m0, s39, 104448
    s_mul_i32 s63, s63, 294912
    buffer_load_dwordx4 v4, s[12:15], s64 offen offset:0 lds
    buffer_load_dwordx4 v5, s[12:15], s64 offen offset:1024 lds
    buffer_load_dwordx4 v6, s[12:15], s64 offen offset:2048 lds
    buffer_load_dwordx4 v7, s[12:15], s64 offen offset:3072 lds
    s_add_u32 m0, s40, 104448
    s_add_u32 s64, s63, s37
    buffer_load_dwordx4 v3, s[16:19], s64 offen offset:0 lds
    buffer_load_dwordx4 v3, s[16:19], s64 offen offset:1024 lds
    buffer_load_dwordx4 v3, s[16:19], s64 offen offset:2048 lds
    buffer_load_dwordx4 v3, s[16:19], s64 offen offset:3072 lds
    s_add_u32 m0, s41, 104448
    s_add_u32 s64, s63, s38
    buffer_load_dwordx4 v3, s[16:19], s64 offen lds
    s_waitcnt vmcnt(18)
    s_barrier
    s_cmp_eq_u32 s62, 0
    s_cselect_b32 s63, 20, 16
    s_lshl_b32 s64, s63, 7
    s_add_u32 s64, s64, s36
    s_add_u32 m0, s39, 0
    s_mul_i32 s63, s63, 294912
    buffer_load_dwordx4 v4, s[12:15], s64 offen offset:0 lds
    buffer_load_dwordx4 v5, s[12:15], s64 offen offset:1024 lds
    buffer_load_dwordx4 v6, s[12:15], s64 offen offset:2048 lds
    buffer_load_dwordx4 v7, s[12:15], s64 offen offset:3072 lds
    s_add_u32 m0, s40, 0
    s_add_u32 s64, s63, s37
    buffer_load_dwordx4 v3, s[16:19], s64 offen offset:0 lds
    buffer_load_dwordx4 v3, s[16:19], s64 offen offset:1024 lds
    buffer_load_dwordx4 v3, s[16:19], s64 offen offset:2048 lds
    buffer_load_dwordx4 v3, s[16:19], s64 offen offset:3072 lds
    s_add_u32 m0, s41, 0
    s_add_u32 s64, s63, s38
    buffer_load_dwordx4 v3, s[16:19], s64 offen lds
    s_waitcnt vmcnt(18)
    s_barrier
    s_cmp_eq_u32 s62, 1
    s_cselect_b32 s63, 21, 17
    s_lshl_b32 s64, s63, 7
    s_add_u32 s64, s64, s36
    s_add_u32 m0, s39, 34816
    s_mul_i32 s63, s63, 294912
    buffer_load_dwordx4 v4, s[12:15], s64 offen offset:0 lds
    buffer_load_dwordx4 v5, s[12:15], s64 offen offset:1024 lds
    buffer_load_dwordx4 v6, s[12:15], s64 offen offset:2048 lds
    buffer_load_dwordx4 v7, s[12:15], s64 offen offset:3072 lds
    s_add_u32 m0, s40, 34816
    s_add_u32 s64, s63, s37
    buffer_load_dwordx4 v3, s[16:19], s64 offen offset:0 lds
    buffer_load_dwordx4 v3, s[16:19], s64 offen offset:1024 lds
    buffer_load_dwordx4 v3, s[16:19], s64 offen offset:2048 lds
    buffer_load_dwordx4 v3, s[16:19], s64 offen offset:3072 lds
    s_add_u32 m0, s41, 34816
    s_add_u32 s64, s63, s38
    buffer_load_dwordx4 v3, s[16:19], s64 offen lds
    s_waitcnt vmcnt(18)
    s_barrier
    s_cmp_eq_u32 s62, 2
    s_cselect_b32 s63, 22, 18
    s_lshl_b32 s64, s63, 7
    s_add_u32 s64, s64, s36
    s_add_u32 m0, s39, 69632
    s_mul_i32 s63, s63, 294912
    buffer_load_dwordx4 v4, s[12:15], s64 offen offset:0 lds
    buffer_load_dwordx4 v5, s[12:15], s64 offen offset:1024 lds
    buffer_load_dwordx4 v6, s[12:15], s64 offen offset:2048 lds
    buffer_load_dwordx4 v7, s[12:15], s64 offen offset:3072 lds
    s_add_u32 m0, s40, 69632
    s_add_u32 s64, s63, s37
    buffer_load_dwordx4 v3, s[16:19], s64 offen offset:0 lds
    buffer_load_dwordx4 v3, s[16:19], s64 offen offset:1024 lds
    buffer_load_dwordx4 v3, s[16:19], s64 offen offset:2048 lds
    buffer_load_dwordx4 v3, s[16:19], s64 offen offset:3072 lds
    s_add_u32 m0, s41, 69632
    s_add_u32 s64, s63, s38
    buffer_load_dwordx4 v3, s[16:19], s64 offen lds
    s_waitcnt vmcnt(18)
    s_barrier
    s_cmp_eq_u32 s62, 3
    s_cselect_b32 s63, 23, 19
    s_lshl_b32 s64, s63, 7
    s_add_u32 s64, s64, s36
    s_add_u32 m0, s39, 104448
    s_mul_i32 s63, s63, 294912
    buffer_load_dwordx4 v4, s[12:15], s64 offen offset:0 lds
    buffer_load_dwordx4 v5, s[12:15], s64 offen offset:1024 lds
    buffer_load_dwordx4 v6, s[12:15], s64 offen offset:2048 lds
    buffer_load_dwordx4 v7, s[12:15], s64 offen offset:3072 lds
    s_add_u32 m0, s40, 104448
    s_add_u32 s64, s63, s37
    buffer_load_dwordx4 v3, s[16:19], s64 offen offset:0 lds
    buffer_load_dwordx4 v3, s[16:19], s64 offen offset:1024 lds
    buffer_load_dwordx4 v3, s[16:19], s64 offen offset:2048 lds
    buffer_load_dwordx4 v3, s[16:19], s64 offen offset:3072 lds
    s_add_u32 m0, s41, 104448
    s_add_u32 s64, s63, s38
    buffer_load_dwordx4 v3, s[16:19], s64 offen lds
    s_waitcnt vmcnt(18)
    s_barrier
    s_cmp_eq_u32 s62, 0
    s_cselect_b32 s63, 24, 20
    s_lshl_b32 s64, s63, 7
    s_add_u32 s64, s64, s36
    s_add_u32 m0, s39, 0
    s_mul_i32 s63, s63, 294912
    buffer_load_dwordx4 v4, s[12:15], s64 offen offset:0 lds
    buffer_load_dwordx4 v5, s[12:15], s64 offen offset:1024 lds
    buffer_load_dwordx4 v6, s[12:15], s64 offen offset:2048 lds
    buffer_load_dwordx4 v7, s[12:15], s64 offen offset:3072 lds
    s_add_u32 m0, s40, 0
    s_add_u32 s64, s63, s37
    buffer_load_dwordx4 v3, s[16:19], s64 offen offset:0 lds
    buffer_load_dwordx4 v3, s[16:19], s64 offen offset:1024 lds
    buffer_load_dwordx4 v3, s[16:19], s64 offen offset:2048 lds
    buffer_load_dwordx4 v3, s[16:19], s64 offen offset:3072 lds
    s_add_u32 m0, s41, 0
    s_add_u32 s64, s63, s38
    buffer_load_dwordx4 v3, s[16:19], s64 offen lds
    s_waitcnt vmcnt(18)
    s_barrier
    s_cmp_eq_u32 s62, 1
    s_cselect_b32 s63, 25, 21
    s_lshl_b32 s64, s63, 7
    s_add_u32 s64, s64, s36
    s_add_u32 m0, s39, 34816
    s_mul_i32 s63, s63, 294912
    buffer_load_dwordx4 v4, s[12:15], s64 offen offset:0 lds
    buffer_load_dwordx4 v5, s[12:15], s64 offen offset:1024 lds
    buffer_load_dwordx4 v6, s[12:15], s64 offen offset:2048 lds
    buffer_load_dwordx4 v7, s[12:15], s64 offen offset:3072 lds
    s_add_u32 m0, s40, 34816
    s_add_u32 s64, s63, s37
    buffer_load_dwordx4 v3, s[16:19], s64 offen offset:0 lds
    buffer_load_dwordx4 v3, s[16:19], s64 offen offset:1024 lds
    buffer_load_dwordx4 v3, s[16:19], s64 offen offset:2048 lds
    buffer_load_dwordx4 v3, s[16:19], s64 offen offset:3072 lds
    s_add_u32 m0, s41, 34816
    s_add_u32 s64, s63, s38
    buffer_load_dwordx4 v3, s[16:19], s64 offen lds
    s_waitcnt vmcnt(18)
    s_barrier
    s_cmp_eq_u32 s62, 2
    s_cselect_b32 s63, 26, 22
    s_lshl_b32 s64, s63, 7
    s_add_u32 s64, s64, s36
    s_add_u32 m0, s39, 69632
    s_mul_i32 s63, s63, 294912
    buffer_load_dwordx4 v4, s[12:15], s64 offen offset:0 lds
    buffer_load_dwordx4 v5, s[12:15], s64 offen offset:1024 lds
    buffer_load_dwordx4 v6, s[12:15], s64 offen offset:2048 lds
    buffer_load_dwordx4 v7, s[12:15], s64 offen offset:3072 lds
    s_add_u32 m0, s40, 69632
    s_add_u32 s64, s63, s37
    buffer_load_dwordx4 v3, s[16:19], s64 offen offset:0 lds
    buffer_load_dwordx4 v3, s[16:19], s64 offen offset:1024 lds
    buffer_load_dwordx4 v3, s[16:19], s64 offen offset:2048 lds
    buffer_load_dwordx4 v3, s[16:19], s64 offen offset:3072 lds
    s_add_u32 m0, s41, 69632
    s_add_u32 s64, s63, s38
    buffer_load_dwordx4 v3, s[16:19], s64 offen lds
    s_waitcnt vmcnt(18)
    s_barrier
    s_cmp_eq_u32 s62, 3
    s_cselect_b32 s63, 27, 23
    s_lshl_b32 s64, s63, 7
    s_add_u32 s64, s64, s36
    s_add_u32 m0, s39, 104448
    s_mul_i32 s63, s63, 294912
    buffer_load_dwordx4 v4, s[12:15], s64 offen offset:0 lds
    buffer_load_dwordx4 v5, s[12:15], s64 offen offset:1024 lds
    buffer_load_dwordx4 v6, s[12:15], s64 offen offset:2048 lds
    buffer_load_dwordx4 v7, s[12:15], s64 offen offset:3072 lds
    s_add_u32 m0, s40, 104448
    s_add_u32 s64, s63, s37
    buffer_load_dwordx4 v3, s[16:19], s64 offen offset:0 lds
    buffer_load_dwordx4 v3, s[16:19], s64 offen offset:1024 lds
    buffer_load_dwordx4 v3, s[16:19], s64 offen offset:2048 lds
    buffer_load_dwordx4 v3, s[16:19], s64 offen offset:3072 lds
    s_add_u32 m0, s41, 104448
    s_add_u32 s64, s63, s38
    buffer_load_dwordx4 v3, s[16:19], s64 offen lds
    s_waitcnt vmcnt(18)
    s_barrier
    s_cmp_eq_u32 s62, 0
    s_cselect_b32 s63, 28, 24
    s_lshl_b32 s64, s63, 7
    s_add_u32 s64, s64, s36
    s_add_u32 m0, s39, 0
    s_mul_i32 s63, s63, 294912
    buffer_load_dwordx4 v4, s[12:15], s64 offen offset:0 lds
    buffer_load_dwordx4 v5, s[12:15], s64 offen offset:1024 lds
    buffer_load_dwordx4 v6, s[12:15], s64 offen offset:2048 lds
    buffer_load_dwordx4 v7, s[12:15], s64 offen offset:3072 lds
    s_add_u32 m0, s40, 0
    s_add_u32 s64, s63, s37
    buffer_load_dwordx4 v3, s[16:19], s64 offen offset:0 lds
    buffer_load_dwordx4 v3, s[16:19], s64 offen offset:1024 lds
    buffer_load_dwordx4 v3, s[16:19], s64 offen offset:2048 lds
    buffer_load_dwordx4 v3, s[16:19], s64 offen offset:3072 lds
    s_add_u32 m0, s41, 0
    s_add_u32 s64, s63, s38
    buffer_load_dwordx4 v3, s[16:19], s64 offen lds
    s_waitcnt vmcnt(18)
    s_barrier
    s_cmp_eq_u32 s62, 1
    s_cselect_b32 s63, 29, 25
    s_lshl_b32 s64, s63, 7
    s_add_u32 s64, s64, s36
    s_add_u32 m0, s39, 34816
    s_mul_i32 s63, s63, 294912
    buffer_load_dwordx4 v4, s[12:15], s64 offen offset:0 lds
    buffer_load_dwordx4 v5, s[12:15], s64 offen offset:1024 lds
    buffer_load_dwordx4 v6, s[12:15], s64 offen offset:2048 lds
    buffer_load_dwordx4 v7, s[12:15], s64 offen offset:3072 lds
    s_add_u32 m0, s40, 34816
    s_add_u32 s64, s63, s37
    buffer_load_dwordx4 v3, s[16:19], s64 offen offset:0 lds
    buffer_load_dwordx4 v3, s[16:19], s64 offen offset:1024 lds
    buffer_load_dwordx4 v3, s[16:19], s64 offen offset:2048 lds
    buffer_load_dwordx4 v3, s[16:19], s64 offen offset:3072 lds
    s_add_u32 m0, s41, 34816
    s_add_u32 s64, s63, s38
    buffer_load_dwordx4 v3, s[16:19], s64 offen lds
    s_waitcnt vmcnt(18)
    s_barrier
    s_cmp_eq_u32 s62, 2
    s_cselect_b32 s63, 30, 26
    s_lshl_b32 s64, s63, 7
    s_add_u32 s64, s64, s36
    s_add_u32 m0, s39, 69632
    s_mul_i32 s63, s63, 294912
    buffer_load_dwordx4 v4, s[12:15], s64 offen offset:0 lds
    buffer_load_dwordx4 v5, s[12:15], s64 offen offset:1024 lds
    buffer_load_dwordx4 v6, s[12:15], s64 offen offset:2048 lds
    buffer_load_dwordx4 v7, s[12:15], s64 offen offset:3072 lds
    s_add_u32 m0, s40, 69632
    s_add_u32 s64, s63, s37
    buffer_load_dwordx4 v3, s[16:19], s64 offen offset:0 lds
    buffer_load_dwordx4 v3, s[16:19], s64 offen offset:1024 lds
    buffer_load_dwordx4 v3, s[16:19], s64 offen offset:2048 lds
    buffer_load_dwordx4 v3, s[16:19], s64 offen offset:3072 lds
    s_add_u32 m0, s41, 69632
    s_add_u32 s64, s63, s38
    buffer_load_dwordx4 v3, s[16:19], s64 offen lds
    s_waitcnt vmcnt(18)
    s_barrier
    s_lshl_b32 s59, s50, 5
    s_add_u32 s59, s59, s51
    s_cmp_eq_u32 s3, 0
    s_cbranch_scc0 parallel_sum__linear_kernel_hedgehog__mixer_gmlp__prompt_kernel_fs_507
    s_lshl_b32 s58, s59, 7
    s_add_u32 s58, s58, 44924928
    v_mov_b32 v12, s69
    v_mov_b32 v13, s69
    v_mov_b32 v14, s69
    v_mov_b32 v15, s69
    s_mov_b64 exec, 0xff
    buffer_store_dwordx4 v[12:15], v3, s[20:23], s58 offen sc1
    s_mov_b64 exec, -1
parallel_sum__linear_kernel_hedgehog__mixer_gmlp__prompt_kernel_fs_507:
    s_cmp_eq_u32 s62, 3
    s_cselect_b32 s63, 31, 27
    s_lshl_b32 s64, s63, 7
    s_add_u32 s64, s64, s36
    s_add_u32 m0, s39, 104448
    s_mul_i32 s63, s63, 294912
    buffer_load_dwordx4 v4, s[12:15], s64 offen offset:0 lds
    buffer_load_dwordx4 v5, s[12:15], s64 offen offset:1024 lds
    buffer_load_dwordx4 v6, s[12:15], s64 offen offset:2048 lds
    buffer_load_dwordx4 v7, s[12:15], s64 offen offset:3072 lds
    s_add_u32 m0, s40, 104448
    s_add_u32 s64, s63, s37
    buffer_load_dwordx4 v3, s[16:19], s64 offen offset:0 lds
    buffer_load_dwordx4 v3, s[16:19], s64 offen offset:1024 lds
    buffer_load_dwordx4 v3, s[16:19], s64 offen offset:2048 lds
    buffer_load_dwordx4 v3, s[16:19], s64 offen offset:3072 lds
    s_add_u32 m0, s41, 104448
    s_add_u32 s64, s63, s38
    buffer_load_dwordx4 v3, s[16:19], s64 offen lds
    s_lshr_b32 s70, s33, 2
    s_and_b32 s71, s33, 3
    s_mul_i32 s72, s33, 9
    s_and_b32 s73, s33, 1
    s_add_u32 s72, s72, s73
    s_lshr_b32 s72, s72, 1
    s_mul_i32 s73, s70, 18
    s_sub_u32 s74, s72, s73
    s_mul_i32 s75, s70, 5
    s_cmp_eq_u32 s70, 3
    s_cselect_b32 s75, 14, s75
    s_add_u32 s75, s75, 72
    s_mul_i32 s76, s71, 829440
    s_add_u32 s76, s76, 33554432
    s_lshl_b32 s77, s32, 3
    s_add_u32 s77, s77, 0
    s_mul_i32 s77, s77, 92160
    s_add_u32 s77, s77, 20971520
    s_lshl_b32 s78, s42, 10
    s_add_u32 s78, s78, 18432
    v_add_u32 v16, 90112, v3
    v_add_u32 v17, 184320, v3
    v_add_u32 v18, 274432, v3
    v_and_b32 v20, 31, v2
    v_lshlrev_b32 v20, 7, v20
    s_lshr_b32 s58, s32, 1
    s_lshl_b32 s58, s58, 12
    s_add_u32 s58, s58, 44924928
    v_add_u32 v20, s58, v20
    v_and_b32 v21, 3, v2
    v_lshlrev_b32 v21, 13, v21
    s_and_b32 s58, s2, 63
    s_lshl_b32 s58, s58, 7
    s_add_u32 s58, s58, 44892160
    v_add_u32 v21, s58, v21
    v_subrev_u32 v23, 32, v2
    v_add_u32 v24, s73, v23
    v_subrev_u32 v25, 18, v23
    v_add_u32 v25, s75, v25
    v_cmp_gt_u32 vcc, 18, v23
    v_min_u32 v25, 89, v25
    s_nop 0
    v_cndmask_b32 v24, v25, v24, vcc
    v_subrev_u32 v25, 48, v24
    v_min_u32 v24, v24, v25
    v_lshrrev_b32 v25, 4, v24
    v_mul_u32_u24 v25, 48, v25
    v_add3_u32 v24, v24, v25, 48
    v_lshlrev_b32 v24, 7, v24
    v_add_u32 v24, 44990464, v24
    v_cmp_gt_u32 vcc, 32, v2
    s_nop 1
    v_cndmask_b32 v20, v24, v20, vcc
    s_waitcnt vmcnt(18)
    s_barrier
    s_cmp_eq_u32 s62, 0
    s_cselect_b32 s63, 0, 28
    s_lshl_b32 s64, s63, 7
    s_add_u32 s64, s64, s36
    s_add_u32 m0, s39, 0
    s_mul_i32 s63, s63, 294912
    buffer_load_dwordx4 v4, s[12:15], s64 offen offset:0 lds
    buffer_load_dwordx4 v5, s[12:15], s64 offen offset:1024 lds
    buffer_load_dwordx4 v6, s[12:15], s64 offen offset:2048 lds
    buffer_load_dwordx4 v7, s[12:15], s64 offen offset:3072 lds
    s_add_u32 m0, s40, 0
    s_add_u32 s64, s63, s37
    buffer_load_dwordx4 v3, s[16:19], s64 offen offset:0 lds
    buffer_load_dwordx4 v3, s[16:19], s64 offen offset:1024 lds
    buffer_load_dwordx4 v3, s[16:19], s64 offen offset:2048 lds
    buffer_load_dwordx4 v3, s[16:19], s64 offen offset:3072 lds
    s_add_u32 m0, s41, 0
    s_add_u32 s64, s63, s38
    buffer_load_dwordx4 v3, s[16:19], s64 offen lds
    s_waitcnt vmcnt(18)
    s_barrier
    s_cmp_eq_u32 s62, 1
    s_cselect_b32 s63, 1, 29
    s_lshl_b32 s64, s63, 7
    s_add_u32 s64, s64, s36
    s_add_u32 m0, s39, 34816
    s_mul_i32 s63, s63, 294912
    buffer_load_dwordx4 v4, s[12:15], s64 offen offset:0 lds
    buffer_load_dwordx4 v5, s[12:15], s64 offen offset:1024 lds
    buffer_load_dwordx4 v6, s[12:15], s64 offen offset:2048 lds
    buffer_load_dwordx4 v7, s[12:15], s64 offen offset:3072 lds
    s_add_u32 m0, s40, 34816
    s_add_u32 s64, s63, s37
    buffer_load_dwordx4 v3, s[16:19], s64 offen offset:0 lds
    buffer_load_dwordx4 v3, s[16:19], s64 offen offset:1024 lds
    buffer_load_dwordx4 v3, s[16:19], s64 offen offset:2048 lds
    buffer_load_dwordx4 v3, s[16:19], s64 offen offset:3072 lds
    s_add_u32 m0, s41, 34816
    s_add_u32 s64, s63, s38
    buffer_load_dwordx4 v3, s[16:19], s64 offen lds
    s_waitcnt vmcnt(18)
    s_barrier
    s_cmp_eq_u32 s62, 2
    s_cselect_b32 s63, 2, 30
    s_lshl_b32 s64, s63, 7
    s_add_u32 s64, s64, s36
    s_add_u32 m0, s39, 69632
    s_mul_i32 s63, s63, 294912
    buffer_load_dwordx4 v4, s[12:15], s64 offen offset:0 lds
    buffer_load_dwordx4 v5, s[12:15], s64 offen offset:1024 lds
    buffer_load_dwordx4 v6, s[12:15], s64 offen offset:2048 lds
    buffer_load_dwordx4 v7, s[12:15], s64 offen offset:3072 lds
    s_add_u32 m0, s40, 69632
    s_add_u32 s64, s63, s37
    buffer_load_dwordx4 v3, s[16:19], s64 offen offset:0 lds
    buffer_load_dwordx4 v3, s[16:19], s64 offen offset:1024 lds
    buffer_load_dwordx4 v3, s[16:19], s64 offen offset:2048 lds
    buffer_load_dwordx4 v3, s[16:19], s64 offen offset:3072 lds
    s_add_u32 m0, s41, 69632
    s_add_u32 s64, s63, s38
    buffer_load_dwordx4 v3, s[16:19], s64 offen lds
    s_waitcnt vmcnt(18)
    s_barrier
    s_cmp_eq_u32 s62, 3
    s_cselect_b32 s63, 3, 31
    s_lshl_b32 s64, s63, 7
    s_add_u32 s64, s64, s36
    s_add_u32 m0, s39, 104448
    s_mul_i32 s63, s63, 294912
    buffer_load_dwordx4 v4, s[12:15], s64 offen offset:0 lds
    buffer_load_dwordx4 v5, s[12:15], s64 offen offset:1024 lds
    buffer_load_dwordx4 v6, s[12:15], s64 offen offset:2048 lds
    buffer_load_dwordx4 v7, s[12:15], s64 offen offset:3072 lds
    s_add_u32 m0, s40, 104448
    s_add_u32 s64, s63, s37
    buffer_load_dwordx4 v3, s[16:19], s64 offen offset:0 lds
    buffer_load_dwordx4 v3, s[16:19], s64 offen offset:1024 lds
    buffer_load_dwordx4 v3, s[16:19], s64 offen offset:2048 lds
    buffer_load_dwordx4 v3, s[16:19], s64 offen offset:3072 lds
    s_add_u32 m0, s41, 104448
    s_add_u32 s64, s63, s38
    buffer_load_dwordx4 v3, s[16:19], s64 offen lds
    s_waitcnt vmcnt(18)
    s_barrier
    buffer_load_dword v22, v20, s[20:23], 0 offen sc1
    s_waitcnt vmcnt(10)
    s_barrier
    s_waitcnt vmcnt(0)
    s_barrier
parallel_sum__linear_kernel_hedgehog__mixer_gmlp__prompt_kernel_l3:
    s_mov_b32 s24, s20
    s_mov_b32 s25, s21
    s_mov_b32 s27, 0x20000
    s_mov_b32 s58, 200000
parallel_sum__linear_kernel_hedgehog__mixer_gmlp__prompt_kernel_fl_508:
    v_cmp_ne_u32 vcc, s69, v22
    s_sub_u32 s58, s58, 1
    s_cmp_eq_u32 s58, 0
    s_cbranch_scc1 parallel_sum__linear_kernel_hedgehog__mixer_gmlp__prompt_kernel_fk_509
    s_cmp_eq_u64 vcc, 0
    s_cbranch_scc1 parallel_sum__linear_kernel_hedgehog__mixer_gmlp__prompt_kernel_fk_509
    s_sleep 6
    buffer_load_dword v22, v20, s[20:23], 0 offen sc1
    s_waitcnt vmcnt(0)
    s_branch parallel_sum__linear_kernel_hedgehog__mixer_gmlp__prompt_kernel_fl_508
parallel_sum__linear_kernel_hedgehog__mixer_gmlp__prompt_kernel_fk_509:
    s_add_u32 s63, s72, 0
    s_add_u32 s65, s72, 1
    s_cmp_eq_u32 s42, 0
    s_cselect_b32 s63, s63, s65
    s_mul_i32 s64, s63, 9216
    s_add_u32 s64, s64, s76
    s_add_u32 m0, s40, 0
    s_nop 0
    buffer_load_dwordx4 v3, s[20:23], s64 offen offset:0 lds
    buffer_load_dwordx4 v3, s[20:23], s64 offen offset:1024 lds
    buffer_load_dwordx4 v3, s[20:23], s64 offen offset:2048 lds
    buffer_load_dwordx4 v3, s[20:23], s64 offen offset:3072 lds
    s_add_u32 m0, s41, 0
    s_add_u32 s64, s64, 4096
    buffer_load_dwordx4 v3, s[20:23], s64 offen lds
    s_add_u32 s63, s72, 2
    s_add_u32 s65, s72, 3
    s_cmp_eq_u32 s42, 0
    s_cselect_b32 s63, s63, s65
    s_mul_i32 s64, s63, 9216
    s_add_u32 s64, s64, s76
    s_add_u32 m0, s40, 34816
    s_nop 0
    buffer_load_dwordx4 v3, s[20:23], s64 offen offset:0 lds
    buffer_load_dwordx4 v3, s[20:23], s64 offen offset:1024 lds
    buffer_load_dwordx4 v3, s[20:23], s64 offen offset:2048 lds
    buffer_load_dwordx4 v3, s[20:23], s64 offen offset:3072 lds
    s_add_u32 m0, s41, 34816
    s_add_u32 s64, s64, 4096
    buffer_load_dwordx4 v3, s[20:23], s64 offen lds
    s_add_u32 s63, s75, 0
    s_add_u32 s65, s75, 1
    s_cmp_eq_u32 s42, 0
    s_cselect_b32 s63, s63, s65
    s_mul_i32 s64, s63, 9216
    s_add_u32 s64, s64, s76
    s_add_u32 m0, s40, 69632
    s_nop 0
    buffer_load_dwordx4 v3, s[20:23], s64 offen offset:0 lds
    buffer_load_dwordx4 v3, s[20:23], s64 offen offset:1024 lds
    buffer_load_dwordx4 v3, s[20:23], s64 offen offset:2048 lds
    buffer_load_dwordx4 v3, s[20:23], s64 offen offset:3072 lds
    s_add_u32 m0, s41, 69632
    s_add_u32 s64, s64, 4096
    buffer_load_dwordx4 v3, s[20:23], s64 offen lds
    s_add_u32 s63, s75, 0
    s_add_u32 s65, s75, 1
    s_cmp_eq_u32 s42, 0
    s_cselect_b32 s63, s63, s65
    s_lshl_b32 s64, s63, 10
    s_add_u32 s64, s64, s77
    s_add_u32 m0, s78, 69632
    s_nop 0
    buffer_load_dwordx4 v3, s[20:23], s64 offen lds
    buffer_load_dwordx4 v16, s[20:23], s64 offen offset:2048 lds
    s_add_u32 m0, s78, 73728
    s_nop 0
    buffer_load_dwordx4 v17, s[20:23], s64 offen lds
    buffer_load_dwordx4 v18, s[20:23], s64 offen offset:2048 lds
    s_waitcnt vmcnt(14)
    s_barrier
    s_add_u32 s63, s75, 2
    s_add_u32 s65, s75, 3
    s_cmp_eq_u32 s42, 0
    s_cselect_b32 s63, s63, s65
    s_mul_i32 s64, s63, 9216
    s_add_u32 s64, s64, s76
    s_add_u32 m0, s40, 104448
    s_nop 0
    buffer_load_dwordx4 v3, s[20:23], s64 offen offset:0 lds
    buffer_load_dwordx4 v3, s[20:23], s64 offen offset:1024 lds
    buffer_load_dwordx4 v3, s[20:23], s64 offen offset:2048 lds
    buffer_load_dwordx4 v3, s[20:23], s64 offen offset:3072 lds
    s_add_u32 m0, s41, 104448
    s_add_u32 s64, s64, 4096
    buffer_load_dwordx4 v3, s[20:23], s64 offen lds
    s_add_u32 s63, s75, 2
    s_add_u32 s65, s75, 3
    s_cmp_eq_u32 s42, 0
    s_cselect_b32 s63, s63, s65
    s_lshl_b32 s64, s63, 10
    s_add_u32 s64, s64, s77
    s_add_u32 m0, s78, 104448
    s_nop 0
    buffer_load_dwordx4 v3, s[20:23], s64 offen lds
    buffer_load_dwordx4 v16, s[20:23], s64 offen offset:2048 lds
    s_add_u32 m0, s78, 108544
    s_nop 0
    buffer_load_dwordx4 v17, s[20:23], s64 offen lds
    buffer_load_dwordx4 v18, s[20:23], s64 offen offset:2048 lds
    s_waitcnt vmcnt(18)
    s_barrier
    s_add_u32 s63, s75, 4
    s_cmp_lt_u32 s70, 2
    s_cselect_b32 s63, s63, 100
    s_cmp_le_u32 s74, 0
    s_cselect_b32 s65, 4, 0
    s_add_u32 s65, s65, s73
    s_cmp_eq_u32 s42, 0
    s_cselect_b32 s63, s63, s65
    s_cmp_lt_u32 s63, 90
    s_cselect_b32 s26, 57671680, 0
    s_cselect_b32 s63, s63, 0
    s_mul_i32 s64, s63, 9216
    s_add_u32 s64, s64, s76
    s_add_u32 m0, s40, 0
    s_nop 0
    buffer_load_dwordx4 v3, s[24:27], s64 offen offset:0 lds
    buffer_load_dwordx4 v3, s[24:27], s64 offen offset:1024 lds
    buffer_load_dwordx4 v3, s[24:27], s64 offen offset:2048 lds
    buffer_load_dwordx4 v3, s[24:27], s64 offen offset:3072 lds
    s_add_u32 m0, s41, 0
    s_add_u32 s64, s64, 4096
    buffer_load_dwordx4 v3, s[24:27], s64 offen lds
    s_waitcnt vmcnt(14)
    s_barrier
    s_cmp_eq_u32 s3, 0
    s_cbranch_scc0 parallel_sum__linear_kernel_hedgehog__mixer_gmlp__prompt_kernel_fs_510
    s_lshl_b32 s58, s2, 7
    s_add_u32 s58, s58, 44892160
    v_mov_b32 v12, s69
    v_mov_b32 v13, s69
    v_mov_b32 v14, s69
    v_mov_b32 v15, s69
    s_mov_b64 exec, 0xff
    buffer_store_dwordx4 v[12:15], v3, s[20:23], s58 offen sc1
    s_mov_b64 exec, -1
parallel_sum__linear_kernel_hedgehog__mixer_gmlp__prompt_kernel_fs_510:
    s_cmp_le_u32 s74, 1
    s_cselect_b32 s63, 5, 1
    s_add_u32 s63, s63, s73
    s_cmp_le_u32 s74, 2
    s_cselect_b32 s65, 6, 2
    s_add_u32 s65, s65, s73
    s_cmp_eq_u32 s42, 0
    s_cselect_b32 s63, s63, s65
    s_mul_i32 s64, s63, 9216
    s_add_u32 s64, s64, s76
    s_add_u32 m0, s40, 34816
    s_nop 0
    buffer_load_dwordx4 v3, s[20:23], s64 offen offset:0 lds
    buffer_load_dwordx4 v3, s[20:23], s64 offen offset:1024 lds
    buffer_load_dwordx4 v3, s[20:23], s64 offen offset:2048 lds
    buffer_load_dwordx4 v3, s[20:23], s64 offen offset:3072 lds
    s_add_u32 m0, s41, 34816
    s_add_u32 s64, s64, 4096
    buffer_load_dwordx4 v3, s[20:23], s64 offen lds
    s_waitcnt vmcnt(10)
    s_barrier
    s_cmp_le_u32 s74, 3
    s_cselect_b32 s63, 7, 3
    s_add_u32 s63, s63, s73
    s_cmp_le_u32 s74, 4
    s_cselect_b32 s65, 8, 4
    s_add_u32 s65, s65, s73
    s_cmp_eq_u32 s42, 0
    s_cselect_b32 s63, s63, s65
    s_mul_i32 s64, s63, 9216
    s_add_u32 s64, s64, s76
    s_add_u32 m0, s40, 69632
    s_nop 0
    buffer_load_dwordx4 v3, s[20:23], s64 offen offset:0 lds
    buffer_load_dwordx4 v3, s[20:23], s64 offen offset:1024 lds
    buffer_load_dwordx4 v3, s[20:23], s64 offen offset:2048 lds
    buffer_load_dwordx4 v3, s[20:23], s64 offen offset:3072 lds
    s_add_u32 m0, s41, 69632
    s_add_u32 s64, s64, 4096
    buffer_load_dwordx4 v3, s[20:23], s64 offen lds
    s_cmp_eq_u32 s3, 1
    s_cbranch_scc0 parallel_sum__linear_kernel_hedgehog__mixer_gmlp__prompt_kernel_y_511
    buffer_load_dword v22, v21, s[20:23], 0 offen sc1
    s_waitcnt vmcnt(0)
    s_mov_b32 s58, 200000
parallel_sum__linear_kernel_hedgehog__mixer_gmlp__prompt_kernel_fl_512:
    v_cmp_ne_u32 vcc, s69, v22
    s_sub_u32 s58, s58, 1
    s_cmp_eq_u32 s58, 0
    s_cbranch_scc1 parallel_sum__linear_kernel_hedgehog__mixer_gmlp__prompt_kernel_fk_513
    s_cmp_eq_u64 vcc, 0
    s_cbranch_scc1 parallel_sum__linear_kernel_hedgehog__mixer_gmlp__prompt_kernel_fk_513
    s_sleep 6
    buffer_load_dword v22, v21, s[20:23], 0 offen sc1
    s_waitcnt vmcnt(0)
    s_branch parallel_sum__linear_kernel_hedgehog__mixer_gmlp__prompt_kernel_fl_512
parallel_sum__linear_kernel_hedgehog__mixer_gmlp__prompt_kernel_fk_513:
parallel_sum__linear_kernel_hedgehog__mixer_gmlp__prompt_kernel_y_511:
    s_barrier
    s_add_u32 s63, s75, 4
    s_cmp_lt_u32 s70, 2
    s_cselect_b32 s63, s63, 100
    s_cmp_le_u32 s74, 0
    s_cselect_b32 s65, 4, 0
    s_add_u32 s65, s65, s73
    s_cmp_eq_u32 s42, 0
    s_cselect_b32 s63, s63, s65
    s_cmp_lt_u32 s63, 90
    s_cselect_b32 s26, 57671680, 0
    s_cselect_b32 s63, s63, 0
    s_lshl_b32 s64, s63, 10
    s_add_u32 s64, s64, s77
    s_add_u32 m0, s78, 0
    s_nop 0
    buffer_load_dwordx4 v3, s[24:27], s64 offen lds
    buffer_load_dwordx4 v16, s[24:27], s64 offen offset:2048 lds
    s_add_u32 m0, s78, 4096
    s_nop 0
    buffer_load_dwordx4 v17, s[24:27], s64 offen lds
    buffer_load_dwordx4 v18, s[24:27], s64 offen offset:2048 lds
    s_cmp_le_u32 s74, 1
    s_cselect_b32 s63, 5, 1
    s_add_u32 s63, s63, s73
    s_cmp_le_u32 s74, 2
    s_cselect_b32 s65, 6, 2
    s_add_u32 s65, s65, s73
    s_cmp_eq_u32 s42, 0
    s_cselect_b32 s63, s63, s65
    s_lshl_b32 s64, s63, 10
    s_add_u32 s64, s64, s77
    s_add_u32 m0, s78, 34816
    s_nop 0
    buffer_load_dwordx4 v3, s[20:23], s64 offen lds
    buffer_load_dwordx4 v16, s[20:23], s64 offen offset:2048 lds
    s_add_u32 m0, s78, 38912
    s_nop 0
    buffer_load_dwordx4 v17, s[20:23], s64 offen lds
    buffer_load_dwordx4 v18, s[20:23], s64 offen offset:2048 lds
    s_cmp_le_u32 s74, 3
    s_cselect_b32 s63, 7, 3
    s_add_u32 s63, s63, s73
    s_cmp_le_u32 s74, 4
    s_cselect_b32 s65, 8, 4
    s_add_u32 s65, s65, s73
    s_cmp_eq_u32 s42, 0
    s_cselect_b32 s63, s63, s65
    s_lshl_b32 s64, s63, 10
    s_add_u32 s64, s64, s77
    s_add_u32 m0, s78, 69632
    s_nop 0
    buffer_load_dwordx4 v3, s[20:23], s64 offen lds
    buffer_load_dwordx4 v16, s[20:23], s64 offen offset:2048 lds
    s_add_u32 m0, s78, 73728
    s_nop 0
    buffer_load_dwordx4 v17, s[20:23], s64 offen lds
    buffer_load_dwordx4 v18, s[20:23], s64 offen offset:2048 lds
    s_waitcnt vmcnt(8)
    s_barrier
    s_cmp_le_u32 s74, 5
    s_cselect_b32 s63, 9, 5
    s_add_u32 s63, s63, s73
    s_cmp_le_u32 s74, 6
    s_cselect_b32 s65, 10, 6
    s_add_u32 s65, s65, s73
    s_cmp_eq_u32 s42, 0
    s_cselect_b32 s63, s63, s65
    s_mul_i32 s64, s63, 9216
    s_add_u32 s64, s64, s76
    s_add_u32 m0, s40, 104448
    s_nop 0
    buffer_load_dwordx4 v3, s[20:23], s64 offen offset:0 lds
    buffer_load_dwordx4 v3, s[20:23], s64 offen offset:1024 lds
    buffer_load_dwordx4 v3, s[20:23], s64 offen offset:2048 lds
    buffer_load_dwordx4 v3, s[20:23], s64 offen offset:3072 lds
    s_add_u32 m0, s41, 104448
    s_add_u32 s64, s64, 4096
    buffer_load_dwordx4 v3, s[20:23], s64 offen lds
    s_cmp_le_u32 s74, 5
    s_cselect_b32 s63, 9, 5
    s_add_u32 s63, s63, s73
    s_cmp_le_u32 s74, 6
    s_cselect_b32 s65, 10, 6
    s_add_u32 s65, s65, s73
    s_cmp_eq_u32 s42, 0
    s_cselect_b32 s63, s63, s65
    s_lshl_b32 s64, s63, 10
    s_add_u32 s64, s64, s77
    s_add_u32 m0, s78, 104448
    s_nop 0
    buffer_load_dwordx4 v3, s[20:23], s64 offen lds
    buffer_load_dwordx4 v16, s[20:23], s64 offen offset:2048 lds
    s_add_u32 m0, s78, 108544
    s_nop 0
    buffer_load_dwordx4 v17, s[20:23], s64 offen lds
    buffer_load_dwordx4 v18, s[20:23], s64 offen offset:2048 lds
    s_waitcnt vmcnt(13)
    s_barrier
    s_cmp_le_u32 s74, 7
    s_cselect_b32 s63, 11, 7
    s_add_u32 s63, s63, s73
    s_cmp_le_u32 s74, 8
    s_cselect_b32 s65, 12, 8
    s_add_u32 s65, s65, s73
    s_cmp_eq_u32 s42, 0
    s_cselect_b32 s63, s63, s65
    s_mul_i32 s64, s63, 9216
    s_add_u32 s64, s64, s76
    s_add_u32 m0, s40, 0
    s_nop 0
    buffer_load_dwordx4 v3, s[20:23], s64 offen offset:0 lds
    buffer_load_dwordx4 v3, s[20:23], s64 offen offset:1024 lds
    buffer_load_dwordx4 v3, s[20:23], s64 offen offset:2048 lds
    buffer_load_dwordx4 v3, s[20:23], s64 offen offset:3072 lds
    s_add_u32 m0, s41, 0
    s_add_u32 s64, s64, 4096
    buffer_load_dwordx4 v3, s[20:23], s64 offen lds
    s_cmp_le_u32 s74, 7
    s_cselect_b32 s63, 11, 7
    s_add_u32 s63, s63, s73
    s_cmp_le_u32 s74, 8
    s_cselect_b32 s65, 12, 8
    s_add_u32 s65, s65, s73
    s_cmp_eq_u32 s42, 0
    s_cselect_b32 s63, s63, s65
    s_lshl_b32 s64, s63, 10
    s_add_u32 s64, s64, s77
    s_add_u32 m0, s78, 0
    s_nop 0
    buffer_load_dwordx4 v3, s[20:23], s64 offen lds
    buffer_load_dwordx4 v16, s[20:23], s64 offen offset:2048 lds
    s_add_u32 m0, s78, 4096
    s_nop 0
    buffer_load_dwordx4 v17, s[20:23], s64 offen lds
    buffer_load_dwordx4 v18, s[20:23], s64 offen offset:2048 lds
    s_waitcnt vmcnt(18)
    s_barrier
    s_cmp_le_u32 s74, 9
    s_cselect_b32 s63, 13, 9
    s_add_u32 s63, s63, s73
    s_cmp_le_u32 s74, 10
    s_cselect_b32 s65, 14, 10
    s_add_u32 s65, s65, s73
    s_cmp_eq_u32 s42, 0
    s_cselect_b32 s63, s63, s65
    s_mul_i32 s64, s63, 9216
    s_add_u32 s64, s64, s76
    s_add_u32 m0, s40, 34816
    s_nop 0
    buffer_load_dwordx4 v3, s[20:23], s64 offen offset:0 lds
    buffer_load_dwordx4 v3, s[20:23], s64 offen offset:1024 lds
    buffer_load_dwordx4 v3, s[20:23], s64 offen offset:2048 lds
    buffer_load_dwordx4 v3, s[20:23], s64 offen offset:3072 lds
    s_add_u32 m0, s41, 34816
    s_add_u32 s64, s64, 4096
    buffer_load_dwordx4 v3, s[20:23], s64 offen lds
    s_cmp_le_u32 s74, 9
    s_cselect_b32 s63, 13, 9
    s_add_u32 s63, s63, s73
    s_cmp_le_u32 s74, 10
    s_cselect_b32 s65, 14, 10
    s_add_u32 s65, s65, s73
    s_cmp_eq_u32 s42, 0
    s_cselect_b32 s63, s63, s65
    s_lshl_b32 s64, s63, 10
    s_add_u32 s64, s64, s77
    s_add_u32 m0, s78, 34816
    s_nop 0
    buffer_load_dwordx4 v3, s[20:23], s64 offen lds
    buffer_load_dwordx4 v16, s[20:23], s64 offen offset:2048 lds
    s_add_u32 m0, s78, 38912
    s_nop 0
    buffer_load_dwordx4 v17, s[20:23], s64 offen lds
    buffer_load_dwordx4 v18, s[20:23], s64 offen offset:2048 lds
    s_waitcnt vmcnt(18)
    s_barrier
    s_cmp_le_u32 s74, 11
    s_cselect_b32 s63, 15, 11
    s_add_u32 s63, s63, s73
    s_cmp_le_u32 s74, 12
    s_cselect_b32 s65, 16, 12
    s_add_u32 s65, s65, s73
    s_cmp_eq_u32 s42, 0
    s_cselect_b32 s63, s63, s65
    s_mul_i32 s64, s63, 9216
    s_add_u32 s64, s64, s76
    s_add_u32 m0, s40, 69632
    s_nop 0
    buffer_load_dwordx4 v3, s[20:23], s64 offen offset:0 lds
    buffer_load_dwordx4 v3, s[20:23], s64 offen offset:1024 lds
    buffer_load_dwordx4 v3, s[20:23], s64 offen offset:2048 lds
    buffer_load_dwordx4 v3, s[20:23], s64 offen offset:3072 lds
    s_add_u32 m0, s41, 69632
    s_add_u32 s64, s64, 4096
    buffer_load_dwordx4 v3, s[20:23], s64 offen lds
    s_cmp_le_u32 s74, 11
    s_cselect_b32 s63, 15, 11
    s_add_u32 s63, s63, s73
    s_cmp_le_u32 s74, 12
    s_cselect_b32 s65, 16, 12
    s_add_u32 s65, s65, s73
    s_cmp_eq_u32 s42, 0
    s_cselect_b32 s63, s63, s65
    s_lshl_b32 s64, s63, 10
    s_add_u32 s64, s64, s77
    s_add_u32 m0, s78, 69632
    s_nop 0
    buffer_load_dwordx4 v3, s[20:23], s64 offen lds
    buffer_load_dwordx4 v16, s[20:23], s64 offen offset:2048 lds
    s_add_u32 m0, s78, 73728
    s_nop 0
    buffer_load_dwordx4 v17, s[20:23], s64 offen lds
    buffer_load_dwordx4 v18, s[20:23], s64 offen offset:2048 lds
    s_waitcnt vmcnt(18)
    s_barrier
    s_cmp_le_u32 s74, 13
    s_cselect_b32 s63, 17, 13
    s_add_u32 s63, s63, s73
    s_mov_b32 s65, 100
    s_cmp_eq_u32 s42, 0
    s_cselect_b32 s63, s63, s65
    s_cmp_lt_u32 s63, 90
    s_cselect_b32 s26, 57671680, 0
    s_cselect_b32 s63, s63, 0
    s_mul_i32 s64, s63, 9216
    s_add_u32 s64, s64, s76
    s_add_u32 m0, s40, 104448
    s_nop 0
    buffer_load_dwordx4 v3, s[24:27], s64 offen offset:0 lds
    buffer_load_dwordx4 v3, s[24:27], s64 offen offset:1024 lds
    buffer_load_dwordx4 v3, s[24:27], s64 offen offset:2048 lds
    buffer_load_dwordx4 v3, s[24:27], s64 offen offset:3072 lds
    s_add_u32 m0, s41, 104448
    s_add_u32 s64, s64, 4096
    buffer_load_dwordx4 v3, s[24:27], s64 offen lds
    s_cmp_le_u32 s74, 13
    s_cselect_b32 s63, 17, 13
    s_add_u32 s63, s63, s73
    s_mov_b32 s65, 100
    s_cmp_eq_u32 s42, 0
    s_cselect_b32 s63, s63, s65
    s_cmp_lt_u32 s63, 90
    s_cselect_b32 s26, 57671680, 0
    s_cselect_b32 s63, s63, 0
    s_lshl_b32 s64, s63, 10
    s_add_u32 s64, s64, s77
    s_add_u32 m0, s78, 104448
    s_nop 0
    buffer_load_dwordx4 v3, s[24:27], s64 offen lds
    buffer_load_dwordx4 v16, s[24:27], s64 offen offset:2048 lds
    s_add_u32 m0, s78, 108544
    s_nop 0
    buffer_load_dwordx4 v17, s[24:27], s64 offen lds
    buffer_load_dwordx4 v18, s[24:27], s64 offen offset:2048 lds
    s_waitcnt vmcnt(18)
    s_barrier
    s_waitcnt vmcnt(9)
    s_barrier
    s_waitcnt vmcnt(0)
    s_barrier
    s_add_u32 s3, s3, 4
    s_branch parallel_sum__linear_kernel_hedgehog__mixer_gmlp__prompt_kernel_final
parallel_sum__linear_kernel_hedgehog__mixer_gmlp__prompt_kernel_ldhi:
    s_add_u32 s62, s32, s33
    s_and_b32 s62, s62, 3
    s_and_b32 s42, s3, 1
    s_mul_i32 s43, s33, 9
    s_and_b32 s44, s33, 1
    s_add_u32 s45, s43, s44
    s_mul_i32 s46, s42, 144
    s_add_u32 s37, s45, s46
    s_add_u32 s37, s37, 5
    s_lshl_b32 s37, s37, 10
    s_cmp_eq_u32 s44, 0
    s_cselect_b32 s47, 8, 0
    s_add_u32 s38, s43, s47
    s_add_u32 s38, s38, s46
    s_lshl_b32 s38, s38, 10
    s_mul_i32 s40, s42, 9216
    s_add_u32 s41, s40, 8192
    s_add_u32 s40, s40, 5120
    s_lshl_b32 s39, s3, 12
    s_add_u32 s39, s39, 18432
    s_mul_i32 s58, s33, 3
    s_add_u32 s59, s58, 2
    s_lshr_b32 s58, s58, 2
    s_lshr_b32 s59, s59, 2
    s_sub_u32 s59, s59, s58
    v_bfe_u32 v20, v2, 4, 1
    v_mul_lo_u32 v20, v20, s59
    v_add_u32 v20, s58, v20
    v_and_b32 v21, 15, v2
    v_lshl_add_u32 v20, v20, 4, v21
    v_lshlrev_b32 v20, 7, v20
    v_add_u32 v20, 45023232, v20
    buffer_load_dword v22, v20, s[20:23], 0 offen sc1
    s_cmp_eq_u32 s62, 0
    s_cselect_b32 s63, 4, 0
    s_lshl_b32 s64, s63, 7
    s_add_u32 s64, s64, s36
    s_add_u32 m0, s39, 0
    s_mul_i32 s63, s63, 294912
    buffer_load_dwordx4 v4, s[12:15], s64 offen offset:0 lds
    buffer_load_dwordx4 v5, s[12:15], s64 offen offset:1024 lds
    buffer_load_dwordx4 v6, s[12:15], s64 offen offset:2048 lds
    buffer_load_dwordx4 v7, s[12:15], s64 offen offset:3072 lds
    s_cmp_eq_u32 s62, 1
    s_cselect_b32 s63, 5, 1
    s_lshl_b32 s64, s63, 7
    s_add_u32 s64, s64, s36
    s_add_u32 m0, s39, 34816
    s_mul_i32 s63, s63, 294912
    buffer_load_dwordx4 v4, s[12:15], s64 offen offset:0 lds
    buffer_load_dwordx4 v5, s[12:15], s64 offen offset:1024 lds
    buffer_load_dwordx4 v6, s[12:15], s64 offen offset:2048 lds
    buffer_load_dwordx4 v7, s[12:15], s64 offen offset:3072 lds
    s_cmp_eq_u32 s62, 2
    s_cselect_b32 s63, 6, 2
    s_lshl_b32 s64, s63, 7
    s_add_u32 s64, s64, s36
    s_add_u32 m0, s39, 69632
    s_mul_i32 s63, s63, 294912
    buffer_load_dwordx4 v4, s[12:15], s64 offen offset:0 lds
    buffer_load_dwordx4 v5, s[12:15], s64 offen offset:1024 lds
    buffer_load_dwordx4 v6, s[12:15], s64 offen offset:2048 lds
    buffer_load_dwordx4 v7, s[12:15], s64 offen offset:3072 lds
    s_cmp_eq_u32 s3, 1
    s_cbranch_scc0 parallel_sum__linear_kernel_hedgehog__mixer_gmlp__prompt_kernel_e1_601
    s_waitcnt vmcnt(12)
    s_mov_b32 s58, 200000
parallel_sum__linear_kernel_hedgehog__mixer_gmlp__prompt_kernel_fl_602:
    v_cmp_ne_u32 vcc, s69, v22
    s_sub_u32 s58, s58, 1
    s_cmp_eq_u32 s58, 0
    s_cbranch_scc1 parallel_sum__linear_kernel_hedgehog__mixer_gmlp__prompt_kernel_fk_603
    s_cmp_eq_u64 vcc, 0
    s_cbranch_scc1 parallel_sum__linear_kernel_hedgehog__mixer_gmlp__prompt_kernel_fk_603
    s_sleep 6
    buffer_load_dword v22, v20, s[20:23], 0 offen sc1
    s_waitcnt vmcnt(0)
    s_branch parallel_sum__linear_kernel_hedgehog__mixer_gmlp__prompt_kernel_fl_602
parallel_sum__linear_kernel_hedgehog__mixer_gmlp__prompt_kernel_fk_603:
parallel_sum__linear_kernel_hedgehog__mixer_gmlp__prompt_kernel_e1_601:
    s_barrier
    s_cmp_eq_u32 s62, 0
    s_cselect_b32 s63, 4, 0
    s_lshl_b32 s64, s63, 7
    s_add_u32 s64, s64, s36
    s_add_u32 m0, s39, 0
    s_mul_i32 s63, s63, 294912
    s_add_u32 m0, s40, 0
    s_add_u32 s64, s63, s37
    buffer_load_dwordx4 v3, s[16:19], s64 offen offset:0 lds
    buffer_load_dwordx4 v3, s[16:19], s64 offen offset:1024 lds
    buffer_load_dwordx4 v3, s[16:19], s64 offen offset:2048 lds
    s_add_u32 m0, s41, 0
    s_add_u32 s64, s63, s38
    buffer_load_dwordx4 v3, s[16:19], s64 offen lds
    s_cmp_eq_u32 s62, 1
    s_cselect_b32 s63, 5, 1
    s_lshl_b32 s64, s63, 7
    s_add_u32 s64, s64, s36
    s_add_u32 m0, s39, 34816
    s_mul_i32 s63, s63, 294912
    s_add_u32 m0, s40, 34816
    s_add_u32 s64, s63, s37
    buffer_load_dwordx4 v3, s[16:19], s64 offen offset:0 lds
    buffer_load_dwordx4 v3, s[16:19], s64 offen offset:1024 lds
    buffer_load_dwordx4 v3, s[16:19], s64 offen offset:2048 lds
    s_add_u32 m0, s41, 34816
    s_add_u32 s64, s63, s38
    buffer_load_dwordx4 v3, s[16:19], s64 offen lds
    s_cmp_eq_u32 s62, 2
    s_cselect_b32 s63, 6, 2
    s_lshl_b32 s64, s63, 7
    s_add_u32 s64, s64, s36
    s_add_u32 m0, s39, 69632
    s_mul_i32 s63, s63, 294912
    s_add_u32 m0, s40, 69632
    s_add_u32 s64, s63, s37
    buffer_load_dwordx4 v3, s[16:19], s64 offen offset:0 lds
    buffer_load_dwordx4 v3, s[16:19], s64 offen offset:1024 lds
    buffer_load_dwordx4 v3, s[16:19], s64 offen offset:2048 lds
    s_add_u32 m0, s41, 69632
    s_add_u32 s64, s63, s38
    buffer_load_dwordx4 v3, s[16:19], s64 offen lds
    s_waitcnt vmcnt(8)
    s_barrier
    s_cmp_eq_u32 s62, 3
    s_cselect_b32 s63, 7, 3
    s_lshl_b32 s64, s63, 7
    s_add_u32 s64, s64, s36
    s_add_u32 m0, s39, 104448
    s_mul_i32 s63, s63, 294912
    buffer_load_dwordx4 v4, s[12:15], s64 offen offset:0 lds
    buffer_load_dwordx4 v5, s[12:15], s64 offen offset:1024 lds
    buffer_load_dwordx4 v6, s[12:15], s64 offen offset:2048 lds
    buffer_load_dwordx4 v7, s[12:15], s64 offen offset:3072 lds
    s_add_u32 m0, s40, 104448
    s_add_u32 s64, s63, s37
    buffer_load_dwordx4 v3, s[16:19], s64 offen offset:0 lds
    buffer_load_dwordx4 v3, s[16:19], s64 offen offset:1024 lds
    buffer_load_dwordx4 v3, s[16:19], s64 offen offset:2048 lds
    s_add_u32 m0, s41, 104448
    s_add_u32 s64, s63, s38
    buffer_load_dwordx4 v3, s[16:19], s64 offen lds
    s_waitcnt vmcnt(12)
    s_barrier
    s_cmp_eq_u32 s3, 0
    s_cbranch_scc0 parallel_sum__linear_kernel_hedgehog__mixer_gmlp__prompt_kernel_fs_604
    s_lshl_b32 s58, s68, 7
    s_add_u32 s58, s58, 44990464
    v_mov_b32 v12, s69
    v_mov_b32 v13, s69
    v_mov_b32 v14, s69
    v_mov_b32 v15, s69
    s_mov_b64 exec, 0xff
    buffer_store_dwordx4 v[12:15], v3, s[20:23], s58 offen sc1
    s_mov_b64 exec, -1
parallel_sum__linear_kernel_hedgehog__mixer_gmlp__prompt_kernel_fs_604:
    s_cmp_eq_u32 s62, 0
    s_cselect_b32 s63, 8, 4
    s_lshl_b32 s64, s63, 7
    s_add_u32 s64, s64, s36
    s_add_u32 m0, s39, 0
    s_mul_i32 s63, s63, 294912
    buffer_load_dwordx4 v4, s[12:15], s64 offen offset:0 lds
    buffer_load_dwordx4 v5, s[12:15], s64 offen offset:1024 lds
    buffer_load_dwordx4 v6, s[12:15], s64 offen offset:2048 lds
    buffer_load_dwordx4 v7, s[12:15], s64 offen offset:3072 lds
    s_add_u32 m0, s40, 0
    s_add_u32 s64, s63, s37
    buffer_load_dwordx4 v3, s[16:19], s64 offen offset:0 lds
    buffer_load_dwordx4 v3, s[16:19], s64 offen offset:1024 lds
    buffer_load_dwordx4 v3, s[16:19], s64 offen offset:2048 lds
    s_add_u32 m0, s41, 0
    s_add_u32 s64, s63, s38
    buffer_load_dwordx4 v3, s[16:19], s64 offen lds
    s_waitcnt vmcnt(16)
    s_barrier
    s_cmp_eq_u32 s62, 1
    s_cselect_b32 s63, 9, 5
    s_lshl_b32 s64, s63, 7
    s_add_u32 s64, s64, s36
    s_add_u32 m0, s39, 34816
    s_mul_i32 s63, s63, 294912
    buffer_load_dwordx4 v4, s[12:15], s64 offen offset:0 lds
    buffer_load_dwordx4 v5, s[12:15], s64 offen offset:1024 lds
    buffer_load_dwordx4 v6, s[12:15], s64 offen offset:2048 lds
    buffer_load_dwordx4 v7, s[12:15], s64 offen offset:3072 lds
    s_add_u32 m0, s40, 34816
    s_add_u32 s64, s63, s37
    buffer_load_dwordx4 v3, s[16:19], s64 offen offset:0 lds
    buffer_load_dwordx4 v3, s[16:19], s64 offen offset:1024 lds
    buffer_load_dwordx4 v3, s[16:19], s64 offen offset:2048 lds
    s_add_u32 m0, s41, 34816
    s_add_u32 s64, s63, s38
    buffer_load_dwordx4 v3, s[16:19], s64 offen lds
    s_waitcnt vmcnt(16)
    s_barrier
    s_cmp_eq_u32 s62, 2
    s_cselect_b32 s63, 10, 6
    s_lshl_b32 s64, s63, 7
    s_add_u32 s64, s64, s36
    s_add_u32 m0, s39, 69632
    s_mul_i32 s63, s63, 294912
    buffer_load_dwordx4 v4, s[12:15], s64 offen offset:0 lds
    buffer_load_dwordx4 v5, s[12:15], s64 offen offset:1024 lds
    buffer_load_dwordx4 v6, s[12:15], s64 offen offset:2048 lds
    buffer_load_dwordx4 v7, s[12:15], s64 offen offset:3072 lds
    s_add_u32 m0, s40, 69632
    s_add_u32 s64, s63, s37
    buffer_load_dwordx4 v3, s[16:19], s64 offen offset:0 lds
    buffer_load_dwordx4 v3, s[16:19], s64 offen offset:1024 lds
    buffer_load_dwordx4 v3, s[16:19], s64 offen offset:2048 lds
    s_add_u32 m0, s41, 69632
    s_add_u32 s64, s63, s38
    buffer_load_dwordx4 v3, s[16:19], s64 offen lds
    s_lshr_b32 s50, s2, 5
    s_and_b32 s51, s2, 7
    s_lshl_b32 s51, s51, 2
    s_bfe_u32 s59, s2, 0x20003
    s_add_u32 s51, s51, s59
    s_lshr_b32 s52, s51, 3
    s_add_u32 s52, s52, s51
    s_add_u32 s53, s52, 1
    s_lshr_b32 s52, s52, 2
    s_lshr_b32 s53, s53, 2
    s_mul_i32 s54, s52, 43
    s_lshr_b32 s54, s54, 7
    s_add_u32 s52, s52, s54
    s_mul_i32 s54, s53, 43
    s_lshr_b32 s54, s54, 7
    s_add_u32 s53, s53, s54
    s_lshl_b32 s54, s50, 1
    s_lshl_b32 s52, s52, 4
    s_lshl_b32 s53, s53, 4
    s_add_u32 s52, s52, s54
    s_add_u32 s53, s53, s54
    s_lshr_b32 s54, s51, 2
    s_lshl_b32 s54, s54, 3
    s_add_u32 s54, s54, 192
    v_and_b32 v26, 7, v2
    v_add_u32 v26, s54, v26
    v_writelane_b32 v26, s52, 8
    v_writelane_b32 v26, s53, 9
    s_add_u32 s52, s52, 1
    s_add_u32 s53, s53, 1
    v_writelane_b32 v26, s52, 10
    v_writelane_b32 v26, s53, 11
    s_mul_i32 s52, s33, 3
    s_add_u32 s53, s52, 2
    s_lshr_b32 s52, s52, 2
    s_lshr_b32 s53, s53, 2
    s_lshl_b32 s52, s52, 4
    s_lshl_b32 s53, s53, 4
    s_add_u32 s52, s52, s32
    s_add_u32 s53, s53, s32
    v_writelane_b32 v26, s52, 12
    v_writelane_b32 v26, s53, 13
    v_lshlrev_b32 v26, 7, v26
    v_add_u32 v26, 44990464, v26
    buffer_load_dword v27, v26, s[20:23], 0 offen sc1
    s_waitcnt vmcnt(17)
    s_barrier
    s_cmp_eq_u32 s62, 3
    s_cselect_b32 s63, 11, 7
    s_lshl_b32 s64, s63, 7
    s_add_u32 s64, s64, s36
    s_add_u32 m0, s39, 104448
    s_mul_i32 s63, s63, 294912
    buffer_load_dwordx4 v4, s[12:15], s64 offen offset:0 lds
    buffer_load_dwordx4 v5, s[12:15], s64 offen offset:1024 lds
    buffer_load_dwordx4 v6, s[12:15], s64 offen offset:2048 lds
    buffer_load_dwordx4 v7, s[12:15], s64 offen offset:3072 lds
    s_add_u32 m0, s40, 104448
    s_add_u32 s64, s63, s37
    buffer_load_dwordx4 v3, s[16:19], s64 offen offset:0 lds
    buffer_load_dwordx4 v3, s[16:19], s64 offen offset:1024 lds
    buffer_load_dwordx4 v3, s[16:19], s64 offen offset:2048 lds
    s_add_u32 m0, s41, 104448
    s_add_u32 s64, s63, s38
    buffer_load_dwordx4 v3, s[16:19], s64 offen lds
    s_waitcnt vmcnt(17)
    s_barrier
    s_cmp_eq_u32 s62, 0
    s_cselect_b32 s63, 12, 8
    s_lshl_b32 s64, s63, 7
    s_add_u32 s64, s64, s36
    s_add_u32 m0, s39, 0
    s_mul_i32 s63, s63, 294912
    buffer_load_dwordx4 v4, s[12:15], s64 offen offset:0 lds
    buffer_load_dwordx4 v5, s[12:15], s64 offen offset:1024 lds
    buffer_load_dwordx4 v6, s[12:15], s64 offen offset:2048 lds
    buffer_load_dwordx4 v7, s[12:15], s64 offen offset:3072 lds
    s_add_u32 m0, s40, 0
    s_add_u32 s64, s63, s37
    buffer_load_dwordx4 v3, s[16:19], s64 offen offset:0 lds
    buffer_load_dwordx4 v3, s[16:19], s64 offen offset:1024 lds
    buffer_load_dwordx4 v3, s[16:19], s64 offen offset:2048 lds
    s_add_u32 m0, s41, 0
    s_add_u32 s64, s63, s38
    buffer_load_dwordx4 v3, s[16:19], s64 offen lds
    s_waitcnt vmcnt(16)
    s_mov_b32 s58, 200000
parallel_sum__linear_kernel_hedgehog__mixer_gmlp__prompt_kernel_fl_605:
    v_cmp_ne_u32 vcc, s69, v27
    s_sub_u32 s58, s58, 1
    s_cmp_eq_u32 s58, 0
    s_cbranch_scc1 parallel_sum__linear_kernel_hedgehog__mixer_gmlp__prompt_kernel_fk_606
    s_cmp_eq_u64 vcc, 0
    s_cbranch_scc1 parallel_sum__linear_kernel_hedgehog__mixer_gmlp__prompt_kernel_fk_606
    s_sleep 6
    buffer_load_dword v27, v26, s[20:23], 0 offen sc1
    s_waitcnt vmcnt(0)
    s_branch parallel_sum__linear_kernel_hedgehog__mixer_gmlp__prompt_kernel_fl_605
parallel_sum__linear_kernel_hedgehog__mixer_gmlp__prompt_kernel_fk_606:
    s_lshr_b32 s50, s2, 5
    s_and_b32 s51, s2, 7
    s_lshl_b32 s51, s51, 2
    s_bfe_u32 s59, s2, 0x20003
    s_add_u32 s51, s51, s59
    s_mul_i32 s52, s51, 3840
    s_add_u32 s52, s52, 40894464
    v_lshlrev_b32 v28, 4, v0
    v_subrev_u32 v28, 4096, v28
    v_cmp_gt_u32 vcc, 3840, v28
    v_mov_b32 v29, 1073741824
    s_lshr_b32 s53, s51, 2
    s_mul_i32 s53, s53, 13
    v_cndmask_b32 v29, v29, v28, vcc
    buffer_load_dwordx4 v[32:35], v29, s[20:23], s52 offen
    s_add_u32 s52, s52, 122880
    buffer_load_dwordx4 v[36:39], v29, s[20:23], s52 offen
    s_add_u32 s52, s52, 122880
    buffer_load_dwordx4 v[40:43], v29, s[20:23], s52 offen
    s_add_u32 s52, s52, 122880
    buffer_load_dwordx4 v[44:47], v29, s[20:23], s52 offen
    s_add_u32 s52, s52, 122880
    buffer_load_dwordx4 v[48:51], v29, s[20:23], s52 offen
    s_add_u32 s52, s52, 122880
    buffer_load_dwordx4 v[52:55], v29, s[20:23], s52 offen
    s_add_u32 s52, s52, 122880
    buffer_load_dwordx4 v[56:59], v29, s[20:23], s52 offen
    s_add_u32 s52, s52, 122880
    buffer_load_dwordx4 v[60:63], v29, s[20:23], s52 offen
    s_and_b32 s54, s51, 3
    s_lshl_b32 s55, s54, 1
    s_add_u32 s56, s54, 6
    s_cmp_lt_u32 s3, 2
    s_cselect_b32 s55, s55, s56
    s_add_u32 s55, s55, s3
    s_add_u32 s55, s55, s53
    s_lshl_b32 s55, s55, 10
    s_add_u32 s55, s55, 41943040
    s_lshl_b32 s56, s3, 10
    s_add_u32 m0, s56, 157696
    s_lshl_b32 s57, s50, 3
    buffer_load_dwordx4 v3, s[20:23], s55 offen lds
    s_lshl_b32 s58, s3, 1
    s_add_u32 s57, s57, s58
    s_mul_i32 s58, s57, 36
    s_lshr_b32 s59, s51, 3
    s_add_u32 s59, s59, s51
    s_add_u32 s58, s58, s59
    s_lshl_b32 s58, s58, 10
    s_add_u32 s58, s58, 37748736
    s_lshl_b32 s56, s3, 12
    s_add_u32 m0, s56, 141312
    v_add_u32 v30, 34816, v3
    buffer_load_dwordx4 v3, s[20:23], s58 offen offset:0 lds
    buffer_load_dwordx4 v3, s[20:23], s58 offen offset:1024 lds
    buffer_load_dwordx4 v30, s[20:23], s58 offen offset:2048 lds
    buffer_load_dwordx4 v30, s[20:23], s58 offen offset:3072 lds
    s_barrier
    s_cmp_eq_u32 s62, 1
    s_cselect_b32 s63, 13, 9
    s_lshl_b32 s64, s63, 7
    s_add_u32 s64, s64, s36
    s_add_u32 m0, s39, 34816
    s_mul_i32 s63, s63, 294912
    buffer_load_dwordx4 v4, s[12:15], s64 offen offset:0 lds
    buffer_load_dwordx4 v5, s[12:15], s64 offen offset:1024 lds
    buffer_load_dwordx4 v6, s[12:15], s64 offen offset:2048 lds
    buffer_load_dwordx4 v7, s[12:15], s64 offen offset:3072 lds
    s_add_u32 m0, s40, 34816
    s_add_u32 s64, s63, s37
    buffer_load_dwordx4 v3, s[16:19], s64 offen offset:0 lds
    buffer_load_dwordx4 v3, s[16:19], s64 offen offset:1024 lds
    buffer_load_dwordx4 v3, s[16:19], s64 offen offset:2048 lds
    s_add_u32 m0, s41, 34816
    s_add_u32 s64, s63, s38
    buffer_load_dwordx4 v3, s[16:19], s64 offen lds
    s_waitcnt vmcnt(29)
    s_barrier
    s_cmp_eq_u32 s62, 2
    s_cselect_b32 s63, 14, 10
    s_lshl_b32 s64, s63, 7
    s_add_u32 s64, s64, s36
    s_add_u32 m0, s39, 69632
    s_mul_i32 s63, s63, 294912
    buffer_load_dwordx4 v4, s[12:15], s64 offen offset:0 lds
    buffer_load_dwordx4 v5, s[12:15], s64 offen offset:1024 lds
    buffer_load_dwordx4 v6, s[12:15], s64 offen offset:2048 lds
    buffer_load_dwordx4 v7, s[12:15], s64 offen offset:3072 lds
    s_add_u32 m0, s40, 69632
    s_add_u32 s64, s63, s37
    buffer_load_dwordx4 v3, s[16:19], s64 offen offset:0 lds
    buffer_load_dwordx4 v3, s[16:19], s64 offen offset:1024 lds
    buffer_load_dwordx4 v3, s[16:19], s64 offen offset:2048 lds
    s_add_u32 m0, s41, 69632
    s_add_u32 s64, s63, s38
    buffer_load_dwordx4 v3, s[16:19], s64 offen lds
    s_waitcnt vmcnt(29)
    s_barrier
    s_cmp_eq_u32 s62, 3
    s_cselect_b32 s63, 15, 11
    s_lshl_b32 s64, s63, 7
    s_add_u32 s64, s64, s36
    s_add_u32 m0, s39, 104448
    s_mul_i32 s63, s63, 294912
    buffer_load_dwordx4 v4, s[12:15], s64 offen offset:0 lds
    buffer_load_dwordx4 v5, s[12:15], s64 offen offset:1024 lds
    buffer_load_dwordx4 v6, s[12:15], s64 offen offset:2048 lds
    buffer_load_dwordx4 v7, s[12:15], s64 offen offset:3072 lds
    s_add_u32 m0, s40, 104448
    s_add_u32 s64, s63, s37
    buffer_load_dwordx4 v3, s[16:19], s64 offen offset:0 lds
    buffer_load_dwordx4 v3, s[16:19], s64 offen offset:1024 lds
    buffer_load_dwordx4 v3, s[16:19], s64 offen offset:2048 lds
    s_add_u32 m0, s41, 104448
    s_add_u32 s64, s63, s38
    buffer_load_dwordx4 v3, s[16:19], s64 offen lds
    s_waitcnt vmcnt(24)
    v_add_f32 v32, v32, v36
    v_add_f32 v33, v33, v37
    v_add_f32 v34, v34, v38
    v_add_f32 v35, v35, v39
    v_add_f32 v32, v32, v40
    v_add_f32 v33, v33, v41
    v_add_f32 v34, v34, v42
    v_add_f32 v35, v35, v43
    v_add_f32 v32, v32, v44
    v_add_f32 v33, v33, v45
    v_add_f32 v34, v34, v46
    v_add_f32 v35, v35, v47
    v_add_f32 v32, v32, v48
    v_add_f32 v33, v33, v49
    v_add_f32 v34, v34, v50
    v_add_f32 v35, v35, v51
    v_add_f32 v32, v32, v52
    v_add_f32 v33, v33, v53
    v_add_f32 v34, v34, v54
    v_add_f32 v35, v35, v55
    v_add_f32 v32, v32, v56
    v_add_f32 v33, v33, v57
    v_add_f32 v34, v34, v58
    v_add_f32 v35, v35, v59
    v_add_f32 v32, v32, v60
    v_add_f32 v33, v33, v61
    v_add_f32 v34, v34, v62
    v_add_f32 v35, v35, v63
    v_cvt_pk_bf16_f32 v32, v32, v33
    v_cvt_pk_bf16_f32 v33, v34, v35
    v_lshrrev_b32 v28, 1, v28
    v_add_u32 v28, 139264, v28
    ds_write_b64 v28, v[32:33]
    s_waitcnt lgkmcnt(0)
    s_waitcnt vmcnt(16)
    s_barrier
    s_cmp_eq_u32 s62, 0
    s_cselect_b32 s63, 16, 12
    s_lshl_b32 s64, s63, 7
    s_add_u32 s64, s64, s36
    s_add_u32 m0, s39, 0
    s_mul_i32 s63, s63, 294912
    buffer_load_dwordx4 v4, s[12:15], s64 offen offset:0 lds
    buffer_load_dwordx4 v5, s[12:15], s64 offen offset:1024 lds
    buffer_load_dwordx4 v6, s[12:15], s64 offen offset:2048 lds
    buffer_load_dwordx4 v7, s[12:15], s64 offen offset:3072 lds
    s_add_u32 m0, s40, 0
    s_add_u32 s64, s63, s37
    buffer_load_dwordx4 v3, s[16:19], s64 offen offset:0 lds
    buffer_load_dwordx4 v3, s[16:19], s64 offen offset:1024 lds
    buffer_load_dwordx4 v3, s[16:19], s64 offen offset:2048 lds
    s_add_u32 m0, s41, 0
    s_add_u32 s64, s63, s38
    buffer_load_dwordx4 v3, s[16:19], s64 offen lds
    s_waitcnt vmcnt(16)
    s_barrier
    s_cmp_eq_u32 s62, 1
    s_cselect_b32 s63, 17, 13
    s_lshl_b32 s64, s63, 7
    s_add_u32 s64, s64, s36
    s_add_u32 m0, s39, 34816
    s_mul_i32 s63, s63, 294912
    buffer_load_dwordx4 v4, s[12:15], s64 offen offset:0 lds
    buffer_load_dwordx4 v5, s[12:15], s64 offen offset:1024 lds
    buffer_load_dwordx4 v6, s[12:15], s64 offen offset:2048 lds
    buffer_load_dwordx4 v7, s[12:15], s64 offen offset:3072 lds
    s_add_u32 m0, s40, 34816
    s_add_u32 s64, s63, s37
    buffer_load_dwordx4 v3, s[16:19], s64 offen offset:0 lds
    buffer_load_dwordx4 v3, s[16:19], s64 offen offset:1024 lds
    buffer_load_dwordx4 v3, s[16:19], s64 offen offset:2048 lds
    s_add_u32 m0, s41, 34816
    s_add_u32 s64, s63, s38
    buffer_load_dwordx4 v3, s[16:19], s64 offen lds
    s_waitcnt vmcnt(16)
    s_barrier
    s_cmp_eq_u32 s62, 2
    s_cselect_b32 s63, 18, 14
    s_lshl_b32 s64, s63, 7
    s_add_u32 s64, s64, s36
    s_add_u32 m0, s39, 69632
    s_mul_i32 s63, s63, 294912
    buffer_load_dwordx4 v4, s[12:15], s64 offen offset:0 lds
    buffer_load_dwordx4 v5, s[12:15], s64 offen offset:1024 lds
    buffer_load_dwordx4 v6, s[12:15], s64 offen offset:2048 lds
    buffer_load_dwordx4 v7, s[12:15], s64 offen offset:3072 lds
    s_add_u32 m0, s40, 69632
    s_add_u32 s64, s63, s37
    buffer_load_dwordx4 v3, s[16:19], s64 offen offset:0 lds
    buffer_load_dwordx4 v3, s[16:19], s64 offen offset:1024 lds
    buffer_load_dwordx4 v3, s[16:19], s64 offen offset:2048 lds
    s_add_u32 m0, s41, 69632
    s_add_u32 s64, s63, s38
    buffer_load_dwordx4 v3, s[16:19], s64 offen lds
    s_waitcnt vmcnt(16)
    s_barrier
    s_cmp_eq_u32 s62, 3
    s_cselect_b32 s63, 19, 15
    s_lshl_b32 s64, s63, 7
    s_add_u32 s64, s64, s36
    s_add_u32 m0, s39, 104448
    s_mul_i32 s63, s63, 294912
    buffer_load_dwordx4 v4, s[12:15], s64 offen offset:0 lds
    buffer_load_dwordx4 v5, s[12:15], s64 offen offset:1024 lds
    buffer_load_dwordx4 v6, s[12:15], s64 offen offset:2048 lds
    buffer_load_dwordx4 v7, s[12:15], s64 offen offset:3072 lds
    s_add_u32 m0, s40, 104448
    s_add_u32 s64, s63, s37
    buffer_load_dwordx4 v3, s[16:19], s64 offen offset:0 lds
    buffer_load_dwordx4 v3, s[16:19], s64 offen offset:1024 lds
    buffer_load_dwordx4 v3, s[16:19], s64 offen offset:2048 lds
    s_add_u32 m0, s41, 104448
    s_add_u32 s64, s63, s38
    buffer_load_dwordx4 v3, s[16:19], s64 offen lds
    s_waitcnt vmcnt(16)
    s_barrier
    s_cmp_eq_u32 s62, 0
    s_cselect_b32 s63, 20, 16
    s_lshl_b32 s64, s63, 7
    s_add_u32 s64, s64, s36
    s_add_u32 m0, s39, 0
    s_mul_i32 s63, s63, 294912
    buffer_load_dwordx4 v4, s[12:15], s64 offen offset:0 lds
    buffer_load_dwordx4 v5, s[12:15], s64 offen offset:1024 lds
    buffer_load_dwordx4 v6, s[12:15], s64 offen offset:2048 lds
    buffer_load_dwordx4 v7, s[12:15], s64 offen offset:3072 lds
    s_add_u32 m0, s40, 0
    s_add_u32 s64, s63, s37
    buffer_load_dwordx4 v3, s[16:19], s64 offen offset:0 lds
    buffer_load_dwordx4 v3, s[16:19], s64 offen offset:1024 lds
    buffer_load_dwordx4 v3, s[16:19], s64 offen offset:2048 lds
    s_add_u32 m0, s41, 0
    s_add_u32 s64, s63, s38
    buffer_load_dwordx4 v3, s[16:19], s64 offen lds
    s_waitcnt vmcnt(16)
    s_barrier
    s_cmp_eq_u32 s62, 1
    s_cselect_b32 s63, 21, 17
    s_lshl_b32 s64, s63, 7
    s_add_u32 s64, s64, s36
    s_add_u32 m0, s39, 34816
    s_mul_i32 s63, s63, 294912
    buffer_load_dwordx4 v4, s[12:15], s64 offen offset:0 lds
    buffer_load_dwordx4 v5, s[12:15], s64 offen offset:1024 lds
    buffer_load_dwordx4 v6, s[12:15], s64 offen offset:2048 lds
    buffer_load_dwordx4 v7, s[12:15], s64 offen offset:3072 lds
    s_add_u32 m0, s40, 34816
    s_add_u32 s64, s63, s37
    buffer_load_dwordx4 v3, s[16:19], s64 offen offset:0 lds
    buffer_load_dwordx4 v3, s[16:19], s64 offen offset:1024 lds
    buffer_load_dwordx4 v3, s[16:19], s64 offen offset:2048 lds
    s_add_u32 m0, s41, 34816
    s_add_u32 s64, s63, s38
    buffer_load_dwordx4 v3, s[16:19], s64 offen lds
    s_waitcnt vmcnt(16)
    s_barrier
    s_cmp_eq_u32 s62, 2
    s_cselect_b32 s63, 22, 18
    s_lshl_b32 s64, s63, 7
    s_add_u32 s64, s64, s36
    s_add_u32 m0, s39, 69632
    s_mul_i32 s63, s63, 294912
    buffer_load_dwordx4 v4, s[12:15], s64 offen offset:0 lds
    buffer_load_dwordx4 v5, s[12:15], s64 offen offset:1024 lds
    buffer_load_dwordx4 v6, s[12:15], s64 offen offset:2048 lds
    buffer_load_dwordx4 v7, s[12:15], s64 offen offset:3072 lds
    s_add_u32 m0, s40, 69632
    s_add_u32 s64, s63, s37
    buffer_load_dwordx4 v3, s[16:19], s64 offen offset:0 lds
    buffer_load_dwordx4 v3, s[16:19], s64 offen offset:1024 lds
    buffer_load_dwordx4 v3, s[16:19], s64 offen offset:2048 lds
    s_add_u32 m0, s41, 69632
    s_add_u32 s64, s63, s38
    buffer_load_dwordx4 v3, s[16:19], s64 offen lds
    s_waitcnt vmcnt(16)
    s_barrier
    s_cmp_eq_u32 s62, 3
    s_cselect_b32 s63, 23, 19
    s_lshl_b32 s64, s63, 7
    s_add_u32 s64, s64, s36
    s_add_u32 m0, s39, 104448
    s_mul_i32 s63, s63, 294912
    buffer_load_dwordx4 v4, s[12:15], s64 offen offset:0 lds
    buffer_load_dwordx4 v5, s[12:15], s64 offen offset:1024 lds
    buffer_load_dwordx4 v6, s[12:15], s64 offen offset:2048 lds
    buffer_load_dwordx4 v7, s[12:15], s64 offen offset:3072 lds
    s_add_u32 m0, s40, 104448
    s_add_u32 s64, s63, s37
    buffer_load_dwordx4 v3, s[16:19], s64 offen offset:0 lds
    buffer_load_dwordx4 v3, s[16:19], s64 offen offset:1024 lds
    buffer_load_dwordx4 v3, s[16:19], s64 offen offset:2048 lds
    s_add_u32 m0, s41, 104448
    s_add_u32 s64, s63, s38
    buffer_load_dwordx4 v3, s[16:19], s64 offen lds
    s_waitcnt vmcnt(16)
    s_barrier
    s_cmp_eq_u32 s62, 0
    s_cselect_b32 s63, 24, 20
    s_lshl_b32 s64, s63, 7
    s_add_u32 s64, s64, s36
    s_add_u32 m0, s39, 0
    s_mul_i32 s63, s63, 294912
    buffer_load_dwordx4 v4, s[12:15], s64 offen offset:0 lds
    buffer_load_dwordx4 v5, s[12:15], s64 offen offset:1024 lds
    buffer_load_dwordx4 v6, s[12:15], s64 offen offset:2048 lds
    buffer_load_dwordx4 v7, s[12:15], s64 offen offset:3072 lds
    s_add_u32 m0, s40, 0
    s_add_u32 s64, s63, s37
    buffer_load_dwordx4 v3, s[16:19], s64 offen offset:0 lds
    buffer_load_dwordx4 v3, s[16:19], s64 offen offset:1024 lds
    buffer_load_dwordx4 v3, s[16:19], s64 offen offset:2048 lds
    s_add_u32 m0, s41, 0
    s_add_u32 s64, s63, s38
    buffer_load_dwordx4 v3, s[16:19], s64 offen lds
    s_waitcnt vmcnt(16)
    s_barrier
    s_cmp_eq_u32 s62, 1
    s_cselect_b32 s63, 25, 21
    s_lshl_b32 s64, s63, 7
    s_add_u32 s64, s64, s36
    s_add_u32 m0, s39, 34816
    s_mul_i32 s63, s63, 294912
    buffer_load_dwordx4 v4, s[12:15], s64 offen offset:0 lds
    buffer_load_dwordx4 v5, s[12:15], s64 offen offset:1024 lds
    buffer_load_dwordx4 v6, s[12:15], s64 offen offset:2048 lds
    buffer_load_dwordx4 v7, s[12:15], s64 offen offset:3072 lds
    s_add_u32 m0, s40, 34816
    s_add_u32 s64, s63, s37
    buffer_load_dwordx4 v3, s[16:19], s64 offen offset:0 lds
    buffer_load_dwordx4 v3, s[16:19], s64 offen offset:1024 lds
    buffer_load_dwordx4 v3, s[16:19], s64 offen offset:2048 lds
    s_add_u32 m0, s41, 34816
    s_add_u32 s64, s63, s38
    buffer_load_dwordx4 v3, s[16:19], s64 offen lds
    s_waitcnt vmcnt(16)
    s_barrier
    s_cmp_eq_u32 s62, 2
    s_cselect_b32 s63, 26, 22
    s_lshl_b32 s64, s63, 7
    s_add_u32 s64, s64, s36
    s_add_u32 m0, s39, 69632
    s_mul_i32 s63, s63, 294912
    buffer_load_dwordx4 v4, s[12:15], s64 offen offset:0 lds
    buffer_load_dwordx4 v5, s[12:15], s64 offen offset:1024 lds
    buffer_load_dwordx4 v6, s[12:15], s64 offen offset:2048 lds
    buffer_load_dwordx4 v7, s[12:15], s64 offen offset:3072 lds
    s_add_u32 m0, s40, 69632
    s_add_u32 s64, s63, s37
    buffer_load_dwordx4 v3, s[16:19], s64 offen offset:0 lds
    buffer_load_dwordx4 v3, s[16:19], s64 offen offset:1024 lds
    buffer_load_dwordx4 v3, s[16:19], s64 offen offset:2048 lds
    s_add_u32 m0, s41, 69632
    s_add_u32 s64, s63, s38
    buffer_load_dwordx4 v3, s[16:19], s64 offen lds
    s_waitcnt vmcnt(16)
    s_barrier
    s_cmp_eq_u32 s62, 3
    s_cselect_b32 s63, 27, 23
    s_lshl_b32 s64, s63, 7
    s_add_u32 s64, s64, s36
    s_add_u32 m0, s39, 104448
    s_mul_i32 s63, s63, 294912
    buffer_load_dwordx4 v4, s[12:15], s64 offen offset:0 lds
    buffer_load_dwordx4 v5, s[12:15], s64 offen offset:1024 lds
    buffer_load_dwordx4 v6, s[12:15], s64 offen offset:2048 lds
    buffer_load_dwordx4 v7, s[12:15], s64 offen offset:3072 lds
    s_add_u32 m0, s40, 104448
    s_add_u32 s64, s63, s37
    buffer_load_dwordx4 v3, s[16:19], s64 offen offset:0 lds
    buffer_load_dwordx4 v3, s[16:19], s64 offen offset:1024 lds
    buffer_load_dwordx4 v3, s[16:19], s64 offen offset:2048 lds
    s_add_u32 m0, s41, 104448
    s_add_u32 s64, s63, s38
    buffer_load_dwordx4 v3, s[16:19], s64 offen lds
    s_waitcnt vmcnt(16)
    s_barrier
    s_cmp_eq_u32 s62, 0
    s_cselect_b32 s63, 28, 24
    s_lshl_b32 s64, s63, 7
    s_add_u32 s64, s64, s36
    s_add_u32 m0, s39, 0
    s_mul_i32 s63, s63, 294912
    buffer_load_dwordx4 v4, s[12:15], s64 offen offset:0 lds
    buffer_load_dwordx4 v5, s[12:15], s64 offen offset:1024 lds
    buffer_load_dwordx4 v6, s[12:15], s64 offen offset:2048 lds
    buffer_load_dwordx4 v7, s[12:15], s64 offen offset:3072 lds
    s_add_u32 m0, s40, 0
    s_add_u32 s64, s63, s37
    buffer_load_dwordx4 v3, s[16:19], s64 offen offset:0 lds
    buffer_load_dwordx4 v3, s[16:19], s64 offen offset:1024 lds
    buffer_load_dwordx4 v3, s[16:19], s64 offen offset:2048 lds
    s_add_u32 m0, s41, 0
    s_add_u32 s64, s63, s38
    buffer_load_dwordx4 v3, s[16:19], s64 offen lds
    s_waitcnt vmcnt(16)
    s_barrier
    s_cmp_eq_u32 s62, 1
    s_cselect_b32 s63, 29, 25
    s_lshl_b32 s64, s63, 7
    s_add_u32 s64, s64, s36
    s_add_u32 m0, s39, 34816
    s_mul_i32 s63, s63, 294912
    buffer_load_dwordx4 v4, s[12:15], s64 offen offset:0 lds
    buffer_load_dwordx4 v5, s[12:15], s64 offen offset:1024 lds
    buffer_load_dwordx4 v6, s[12:15], s64 offen offset:2048 lds
    buffer_load_dwordx4 v7, s[12:15], s64 offen offset:3072 lds
    s_add_u32 m0, s40, 34816
    s_add_u32 s64, s63, s37
    buffer_load_dwordx4 v3, s[16:19], s64 offen offset:0 lds
    buffer_load_dwordx4 v3, s[16:19], s64 offen offset:1024 lds
    buffer_load_dwordx4 v3, s[16:19], s64 offen offset:2048 lds
    s_add_u32 m0, s41, 34816
    s_add_u32 s64, s63, s38
    buffer_load_dwordx4 v3, s[16:19], s64 offen lds
    s_waitcnt vmcnt(16)
    s_barrier
    s_cmp_eq_u32 s62, 2
    s_cselect_b32 s63, 30, 26
    s_lshl_b32 s64, s63, 7
    s_add_u32 s64, s64, s36
    s_add_u32 m0, s39, 69632
    s_mul_i32 s63, s63, 294912
    buffer_load_dwordx4 v4, s[12:15], s64 offen offset:0 lds
    buffer_load_dwordx4 v5, s[12:15], s64 offen offset:1024 lds
    buffer_load_dwordx4 v6, s[12:15], s64 offen offset:2048 lds
    buffer_load_dwordx4 v7, s[12:15], s64 offen offset:3072 lds
    s_add_u32 m0, s40, 69632
    s_add_u32 s64, s63, s37
    buffer_load_dwordx4 v3, s[16:19], s64 offen offset:0 lds
    buffer_load_dwordx4 v3, s[16:19], s64 offen offset:1024 lds
    buffer_load_dwordx4 v3, s[16:19], s64 offen offset:2048 lds
    s_add_u32 m0, s41, 69632
    s_add_u32 s64, s63, s38
    buffer_load_dwordx4 v3, s[16:19], s64 offen lds
    s_waitcnt vmcnt(16)
    s_barrier
    s_lshl_b32 s59, s50, 5
    s_add_u32 s59, s59, s51
    s_cmp_eq_u32 s3, 0
    s_cbranch_scc0 parallel_sum__linear_kernel_hedgehog__mixer_gmlp__prompt_kernel_fs_607
    s_lshl_b32 s58, s59, 7
    s_add_u32 s58, s58, 44924928
    v_mov_b32 v12, s69
    v_mov_b32 v13, s69
    v_mov_b32 v14, s69
    v_mov_b32 v15, s69
    s_mov_b64 exec, 0xff
    buffer_store_dwordx4 v[12:15], v3, s[20:23], s58 offen sc1
    s_mov_b64 exec, -1
parallel_sum__linear_kernel_hedgehog__mixer_gmlp__prompt_kernel_fs_607:
    s_cmp_eq_u32 s62, 3
    s_cselect_b32 s63, 31, 27
    s_lshl_b32 s64, s63, 7
    s_add_u32 s64, s64, s36
    s_add_u32 m0, s39, 104448
    s_mul_i32 s63, s63, 294912
    buffer_load_dwordx4 v4, s[12:15], s64 offen offset:0 lds
    buffer_load_dwordx4 v5, s[12:15], s64 offen offset:1024 lds
    buffer_load_dwordx4 v6, s[12:15], s64 offen offset:2048 lds
    buffer_load_dwordx4 v7, s[12:15], s64 offen offset:3072 lds
    s_add_u32 m0, s40, 104448
    s_add_u32 s64, s63, s37
    buffer_load_dwordx4 v3, s[16:19], s64 offen offset:0 lds
    buffer_load_dwordx4 v3, s[16:19], s64 offen offset:1024 lds
    buffer_load_dwordx4 v3, s[16:19], s64 offen offset:2048 lds
    s_add_u32 m0, s41, 104448
    s_add_u32 s64, s63, s38
    buffer_load_dwordx4 v3, s[16:19], s64 offen lds
    s_lshr_b32 s70, s33, 2
    s_and_b32 s71, s33, 3
    s_mul_i32 s72, s33, 9
    s_and_b32 s73, s33, 1
    s_add_u32 s72, s72, s73
    s_lshr_b32 s72, s72, 1
    s_mul_i32 s73, s70, 18
    s_sub_u32 s74, s72, s73
    s_mul_i32 s75, s70, 5
    s_cmp_eq_u32 s70, 3
    s_cselect_b32 s75, 14, s75
    s_add_u32 s75, s75, 72
    s_mul_i32 s76, s71, 829440
    s_add_u32 s76, s76, 33559552
    s_lshl_b32 s77, s32, 3
    s_add_u32 s77, s77, 4
    s_mul_i32 s77, s77, 92160
    s_add_u32 s77, s77, 20971520
    s_lshl_b32 s78, s42, 10
    s_add_u32 s78, s78, 26624
    v_add_u32 v16, 90112, v3
    v_add_u32 v17, 184320, v3
    v_add_u32 v18, 274432, v3
    v_and_b32 v20, 31, v2
    v_lshlrev_b32 v20, 7, v20
    s_lshr_b32 s58, s32, 1
    s_lshl_b32 s58, s58, 12
    s_add_u32 s58, s58, 44924928
    v_add_u32 v20, s58, v20
    v_and_b32 v21, 3, v2
    v_lshlrev_b32 v21, 13, v21
    s_and_b32 s58, s2, 63
    s_lshl_b32 s58, s58, 7
    s_add_u32 s58, s58, 44892160
    v_add_u32 v21, s58, v21
    v_subrev_u32 v23, 32, v2
    v_add_u32 v24, s73, v23
    v_subrev_u32 v25, 18, v23
    v_add_u32 v25, s75, v25
    v_cmp_gt_u32 vcc, 18, v23
    v_min_u32 v25, 89, v25
    s_nop 0
    v_cndmask_b32 v24, v25, v24, vcc
    v_subrev_u32 v25, 48, v24
    v_min_u32 v24, v24, v25
    v_lshrrev_b32 v25, 4, v24
    v_mul_u32_u24 v25, 48, v25
    v_add3_u32 v24, v24, v25, 48
    v_lshlrev_b32 v24, 7, v24
    v_add_u32 v24, 44990464, v24
    v_cmp_gt_u32 vcc, 32, v2
    s_nop 1
    v_cndmask_b32 v20, v24, v20, vcc
    s_waitcnt vmcnt(16)
    s_barrier
    s_cmp_eq_u32 s62, 0
    s_cselect_b32 s63, 0, 28
    s_lshl_b32 s64, s63, 7
    s_add_u32 s64, s64, s36
    s_add_u32 m0, s39, 0
    s_mul_i32 s63, s63, 294912
    buffer_load_dwordx4 v4, s[12:15], s64 offen offset:0 lds
    buffer_load_dwordx4 v5, s[12:15], s64 offen offset:1024 lds
    buffer_load_dwordx4 v6, s[12:15], s64 offen offset:2048 lds
    buffer_load_dwordx4 v7, s[12:15], s64 offen offset:3072 lds
    s_add_u32 m0, s40, 0
    s_add_u32 s64, s63, s37
    buffer_load_dwordx4 v3, s[16:19], s64 offen offset:0 lds
    buffer_load_dwordx4 v3, s[16:19], s64 offen offset:1024 lds
    buffer_load_dwordx4 v3, s[16:19], s64 offen offset:2048 lds
    s_add_u32 m0, s41, 0
    s_add_u32 s64, s63, s38
    buffer_load_dwordx4 v3, s[16:19], s64 offen lds
    s_waitcnt vmcnt(16)
    s_barrier
    s_cmp_eq_u32 s62, 1
    s_cselect_b32 s63, 1, 29
    s_lshl_b32 s64, s63, 7
    s_add_u32 s64, s64, s36
    s_add_u32 m0, s39, 34816
    s_mul_i32 s63, s63, 294912
    buffer_load_dwordx4 v4, s[12:15], s64 offen offset:0 lds
    buffer_load_dwordx4 v5, s[12:15], s64 offen offset:1024 lds
    buffer_load_dwordx4 v6, s[12:15], s64 offen offset:2048 lds
    buffer_load_dwordx4 v7, s[12:15], s64 offen offset:3072 lds
    s_add_u32 m0, s40, 34816
    s_add_u32 s64, s63, s37
    buffer_load_dwordx4 v3, s[16:19], s64 offen offset:0 lds
    buffer_load_dwordx4 v3, s[16:19], s64 offen offset:1024 lds
    buffer_load_dwordx4 v3, s[16:19], s64 offen offset:2048 lds
    s_add_u32 m0, s41, 34816
    s_add_u32 s64, s63, s38
    buffer_load_dwordx4 v3, s[16:19], s64 offen lds
    s_waitcnt vmcnt(16)
    s_barrier
    s_cmp_eq_u32 s62, 2
    s_cselect_b32 s63, 2, 30
    s_lshl_b32 s64, s63, 7
    s_add_u32 s64, s64, s36
    s_add_u32 m0, s39, 69632
    s_mul_i32 s63, s63, 294912
    buffer_load_dwordx4 v4, s[12:15], s64 offen offset:0 lds
    buffer_load_dwordx4 v5, s[12:15], s64 offen offset:1024 lds
    buffer_load_dwordx4 v6, s[12:15], s64 offen offset:2048 lds
    buffer_load_dwordx4 v7, s[12:15], s64 offen offset:3072 lds
    s_add_u32 m0, s40, 69632
    s_add_u32 s64, s63, s37
    buffer_load_dwordx4 v3, s[16:19], s64 offen offset:0 lds
    buffer_load_dwordx4 v3, s[16:19], s64 offen offset:1024 lds
    buffer_load_dwordx4 v3, s[16:19], s64 offen offset:2048 lds
    s_add_u32 m0, s41, 69632
    s_add_u32 s64, s63, s38
    buffer_load_dwordx4 v3, s[16:19], s64 offen lds
    s_waitcnt vmcnt(16)
    s_barrier
    s_cmp_eq_u32 s62, 3
    s_cselect_b32 s63, 3, 31
    s_lshl_b32 s64, s63, 7
    s_add_u32 s64, s64, s36
    s_add_u32 m0, s39, 104448
    s_mul_i32 s63, s63, 294912
    buffer_load_dwordx4 v4, s[12:15], s64 offen offset:0 lds
    buffer_load_dwordx4 v5, s[12:15], s64 offen offset:1024 lds
    buffer_load_dwordx4 v6, s[12:15], s64 offen offset:2048 lds
    buffer_load_dwordx4 v7, s[12:15], s64 offen offset:3072 lds
    s_add_u32 m0, s40, 104448
    s_add_u32 s64, s63, s37
    buffer_load_dwordx4 v3, s[16:19], s64 offen offset:0 lds
    buffer_load_dwordx4 v3, s[16:19], s64 offen offset:1024 lds
    buffer_load_dwordx4 v3, s[16:19], s64 offen offset:2048 lds
    s_add_u32 m0, s41, 104448
    s_add_u32 s64, s63, s38
    buffer_load_dwordx4 v3, s[16:19], s64 offen lds
    s_waitcnt vmcnt(16)
    s_barrier
    buffer_load_dword v22, v20, s[20:23], 0 offen sc1
    s_waitcnt vmcnt(9)
    s_barrier
    s_waitcnt vmcnt(0)
    s_barrier
parallel_sum__linear_kernel_hedgehog__mixer_gmlp__prompt_kernel_l3h:
    s_mov_b32 s24, s20
    s_mov_b32 s25, s21
    s_mov_b32 s27, 0x20000
    s_mov_b32 s58, 200000
parallel_sum__linear_kernel_hedgehog__mixer_gmlp__prompt_kernel_fl_608:
    v_cmp_ne_u32 vcc, s69, v22
    s_sub_u32 s58, s58, 1
    s_cmp_eq_u32 s58, 0
    s_cbranch_scc1 parallel_sum__linear_kernel_hedgehog__mixer_gmlp__prompt_kernel_fk_609
    s_cmp_eq_u64 vcc, 0
    s_cbranch_scc1 parallel_sum__linear_kernel_hedgehog__mixer_gmlp__prompt_kernel_fk_609
    s_sleep 6
    buffer_load_dword v22, v20, s[20:23], 0 offen sc1
    s_waitcnt vmcnt(0)
    s_branch parallel_sum__linear_kernel_hedgehog__mixer_gmlp__prompt_kernel_fl_608
parallel_sum__linear_kernel_hedgehog__mixer_gmlp__prompt_kernel_fk_609:
    s_add_u32 s63, s72, 0
    s_add_u32 s65, s72, 1
    s_cmp_eq_u32 s42, 0
    s_cselect_b32 s63, s63, s65
    s_mul_i32 s64, s63, 9216
    s_add_u32 s64, s64, s76
    s_add_u32 m0, s40, 0
    s_nop 0
    buffer_load_dwordx4 v3, s[20:23], s64 offen offset:0 lds
    buffer_load_dwordx4 v3, s[20:23], s64 offen offset:1024 lds
    buffer_load_dwordx4 v3, s[20:23], s64 offen offset:2048 lds
    s_add_u32 m0, s41, 0
    s_add_u32 s64, s64, 3072
    buffer_load_dwordx4 v3, s[20:23], s64 offen lds
    s_add_u32 s63, s72, 2
    s_add_u32 s65, s72, 3
    s_cmp_eq_u32 s42, 0
    s_cselect_b32 s63, s63, s65
    s_mul_i32 s64, s63, 9216
    s_add_u32 s64, s64, s76
    s_add_u32 m0, s40, 34816
    s_nop 0
    buffer_load_dwordx4 v3, s[20:23], s64 offen offset:0 lds
    buffer_load_dwordx4 v3, s[20:23], s64 offen offset:1024 lds
    buffer_load_dwordx4 v3, s[20:23], s64 offen offset:2048 lds
    s_add_u32 m0, s41, 34816
    s_add_u32 s64, s64, 3072
    buffer_load_dwordx4 v3, s[20:23], s64 offen lds
    s_add_u32 s63, s75, 0
    s_add_u32 s65, s75, 1
    s_cmp_eq_u32 s42, 0
    s_cselect_b32 s63, s63, s65
    s_mul_i32 s64, s63, 9216
    s_add_u32 s64, s64, s76
    s_add_u32 m0, s40, 69632
    s_nop 0
    buffer_load_dwordx4 v3, s[20:23], s64 offen offset:0 lds
    buffer_load_dwordx4 v3, s[20:23], s64 offen offset:1024 lds
    buffer_load_dwordx4 v3, s[20:23], s64 offen offset:2048 lds
    s_add_u32 m0, s41, 69632
    s_add_u32 s64, s64, 3072
    buffer_load_dwordx4 v3, s[20:23], s64 offen lds
    s_add_u32 s63, s75, 0
    s_add_u32 s65, s75, 1
    s_cmp_eq_u32 s42, 0
    s_cselect_b32 s63, s63, s65
    s_lshl_b32 s64, s63, 10
    s_add_u32 s64, s64, s77
    s_add_u32 m0, s78, 69632
    s_nop 0
    buffer_load_dwordx4 v3, s[20:23], s64 offen lds
    buffer_load_dwordx4 v16, s[20:23], s64 offen offset:2048 lds
    s_add_u32 m0, s78, 73728
    s_nop 0
    buffer_load_dwordx4 v17, s[20:23], s64 offen lds
    buffer_load_dwordx4 v18, s[20:23], s64 offen offset:2048 lds
    s_waitcnt vmcnt(12)
    s_barrier
    s_add_u32 s63, s75, 2
    s_add_u32 s65, s75, 3
    s_cmp_eq_u32 s42, 0
    s_cselect_b32 s63, s63, s65
    s_mul_i32 s64, s63, 9216
    s_add_u32 s64, s64, s76
    s_add_u32 m0, s40, 104448
    s_nop 0
    buffer_load_dwordx4 v3, s[20:23], s64 offen offset:0 lds
    buffer_load_dwordx4 v3, s[20:23], s64 offen offset:1024 lds
    buffer_load_dwordx4 v3, s[20:23], s64 offen offset:2048 lds
    s_add_u32 m0, s41, 104448
    s_add_u32 s64, s64, 3072
    buffer_load_dwordx4 v3, s[20:23], s64 offen lds
    s_add_u32 s63, s75, 2
    s_add_u32 s65, s75, 3
    s_cmp_eq_u32 s42, 0
    s_cselect_b32 s63, s63, s65
    s_lshl_b32 s64, s63, 10
    s_add_u32 s64, s64, s77
    s_add_u32 m0, s78, 104448
    s_nop 0
    buffer_load_dwordx4 v3, s[20:23], s64 offen lds
    buffer_load_dwordx4 v16, s[20:23], s64 offen offset:2048 lds
    s_add_u32 m0, s78, 108544
    s_nop 0
    buffer_load_dwordx4 v17, s[20:23], s64 offen lds
    buffer_load_dwordx4 v18, s[20:23], s64 offen offset:2048 lds
    s_waitcnt vmcnt(16)
    s_barrier
    s_add_u32 s63, s75, 4
    s_cmp_lt_u32 s70, 2
    s_cselect_b32 s63, s63, 100
    s_cmp_le_u32 s74, 0
    s_cselect_b32 s65, 4, 0
    s_add_u32 s65, s65, s73
    s_cmp_eq_u32 s42, 0
    s_cselect_b32 s63, s63, s65
    s_cmp_lt_u32 s63, 90
    s_cselect_b32 s26, 57671680, 0
    s_cselect_b32 s63, s63, 0
    s_mul_i32 s64, s63, 9216
    s_add_u32 s64, s64, s76
    s_add_u32 m0, s40, 0
    s_nop 0
    buffer_load_dwordx4 v3, s[24:27], s64 offen offset:0 lds
    buffer_load_dwordx4 v3, s[24:27], s64 offen offset:1024 lds
    buffer_load_dwordx4 v3, s[24:27], s64 offen offset:2048 lds
    s_add_u32 m0, s41, 0
    s_add_u32 s64, s64, 3072
    buffer_load_dwordx4 v3, s[24:27], s64 offen lds
    s_waitcnt vmcnt(12)
    s_barrier
    s_cmp_eq_u32 s3, 0
    s_cbranch_scc0 parallel_sum__linear_kernel_hedgehog__mixer_gmlp__prompt_kernel_fs_610
    s_lshl_b32 s58, s2, 7
    s_add_u32 s58, s58, 44892160
    v_mov_b32 v12, s69
    v_mov_b32 v13, s69
    v_mov_b32 v14, s69
    v_mov_b32 v15, s69
    s_mov_b64 exec, 0xff
    buffer_store_dwordx4 v[12:15], v3, s[20:23], s58 offen sc1
    s_mov_b64 exec, -1
parallel_sum__linear_kernel_hedgehog__mixer_gmlp__prompt_kernel_fs_610:
    s_cmp_le_u32 s74, 1
    s_cselect_b32 s63, 5, 1
    s_add_u32 s63, s63, s73
    s_cmp_le_u32 s74, 2
    s_cselect_b32 s65, 6, 2
    s_add_u32 s65, s65, s73
    s_cmp_eq_u32 s42, 0
    s_cselect_b32 s63, s63, s65
    s_mul_i32 s64, s63, 9216
    s_add_u32 s64, s64, s76
    s_add_u32 m0, s40, 34816
    s_nop 0
    buffer_load_dwordx4 v3, s[20:23], s64 offen offset:0 lds
    buffer_load_dwordx4 v3, s[20:23], s64 offen offset:1024 lds
    buffer_load_dwordx4 v3, s[20:23], s64 offen offset:2048 lds
    s_add_u32 m0, s41, 34816
    s_add_u32 s64, s64, 3072
    buffer_load_dwordx4 v3, s[20:23], s64 offen lds
    s_waitcnt vmcnt(8)
    s_barrier
    s_cmp_le_u32 s74, 3
    s_cselect_b32 s63, 7, 3
    s_add_u32 s63, s63, s73
    s_cmp_le_u32 s74, 4
    s_cselect_b32 s65, 8, 4
    s_add_u32 s65, s65, s73
    s_cmp_eq_u32 s42, 0
    s_cselect_b32 s63, s63, s65
    s_mul_i32 s64, s63, 9216
    s_add_u32 s64, s64, s76
    s_add_u32 m0, s40, 69632
    s_nop 0
    buffer_load_dwordx4 v3, s[20:23], s64 offen offset:0 lds
    buffer_load_dwordx4 v3, s[20:23], s64 offen offset:1024 lds
    buffer_load_dwordx4 v3, s[20:23], s64 offen offset:2048 lds
    s_add_u32 m0, s41, 69632
    s_add_u32 s64, s64, 3072
    buffer_load_dwordx4 v3, s[20:23], s64 offen lds
    s_cmp_eq_u32 s3, 1
    s_cbranch_scc0 parallel_sum__linear_kernel_hedgehog__mixer_gmlp__prompt_kernel_y_611
    buffer_load_dword v22, v21, s[20:23], 0 offen sc1
    s_waitcnt vmcnt(0)
    s_mov_b32 s58, 200000
parallel_sum__linear_kernel_hedgehog__mixer_gmlp__prompt_kernel_fl_612:
    v_cmp_ne_u32 vcc, s69, v22
    s_sub_u32 s58, s58, 1
    s_cmp_eq_u32 s58, 0
    s_cbranch_scc1 parallel_sum__linear_kernel_hedgehog__mixer_gmlp__prompt_kernel_fk_613
    s_cmp_eq_u64 vcc, 0
    s_cbranch_scc1 parallel_sum__linear_kernel_hedgehog__mixer_gmlp__prompt_kernel_fk_613
    s_sleep 6
    buffer_load_dword v22, v21, s[20:23], 0 offen sc1
    s_waitcnt vmcnt(0)
    s_branch parallel_sum__linear_kernel_hedgehog__mixer_gmlp__prompt_kernel_fl_612
parallel_sum__linear_kernel_hedgehog__mixer_gmlp__prompt_kernel_fk_613:
parallel_sum__linear_kernel_hedgehog__mixer_gmlp__prompt_kernel_y_611:
    s_barrier
    s_add_u32 s63, s75, 4
    s_cmp_lt_u32 s70, 2
    s_cselect_b32 s63, s63, 100
    s_cmp_le_u32 s74, 0
    s_cselect_b32 s65, 4, 0
    s_add_u32 s65, s65, s73
    s_cmp_eq_u32 s42, 0
    s_cselect_b32 s63, s63, s65
    s_cmp_lt_u32 s63, 90
    s_cselect_b32 s26, 57671680, 0
    s_cselect_b32 s63, s63, 0
    s_lshl_b32 s64, s63, 10
    s_add_u32 s64, s64, s77
    s_add_u32 m0, s78, 0
    s_nop 0
    buffer_load_dwordx4 v3, s[24:27], s64 offen lds
    buffer_load_dwordx4 v16, s[24:27], s64 offen offset:2048 lds
    s_add_u32 m0, s78, 4096
    s_nop 0
    buffer_load_dwordx4 v17, s[24:27], s64 offen lds
    buffer_load_dwordx4 v18, s[24:27], s64 offen offset:2048 lds
    s_cmp_le_u32 s74, 1
    s_cselect_b32 s63, 5, 1
    s_add_u32 s63, s63, s73
    s_cmp_le_u32 s74, 2
    s_cselect_b32 s65, 6, 2
    s_add_u32 s65, s65, s73
    s_cmp_eq_u32 s42, 0
    s_cselect_b32 s63, s63, s65
    s_lshl_b32 s64, s63, 10
    s_add_u32 s64, s64, s77
    s_add_u32 m0, s78, 34816
    s_nop 0
    buffer_load_dwordx4 v3, s[20:23], s64 offen lds
    buffer_load_dwordx4 v16, s[20:23], s64 offen offset:2048 lds
    s_add_u32 m0, s78, 38912
    s_nop 0
    buffer_load_dwordx4 v17, s[20:23], s64 offen lds
    buffer_load_dwordx4 v18, s[20:23], s64 offen offset:2048 lds
    s_cmp_le_u32 s74, 3
    s_cselect_b32 s63, 7, 3
    s_add_u32 s63, s63, s73
    s_cmp_le_u32 s74, 4
    s_cselect_b32 s65, 8, 4
    s_add_u32 s65, s65, s73
    s_cmp_eq_u32 s42, 0
    s_cselect_b32 s63, s63, s65
    s_lshl_b32 s64, s63, 10
    s_add_u32 s64, s64, s77
    s_add_u32 m0, s78, 69632
    s_nop 0
    buffer_load_dwordx4 v3, s[20:23], s64 offen lds
    buffer_load_dwordx4 v16, s[20:23], s64 offen offset:2048 lds
    s_add_u32 m0, s78, 73728
    s_nop 0
    buffer_load_dwordx4 v17, s[20:23], s64 offen lds
    buffer_load_dwordx4 v18, s[20:23], s64 offen offset:2048 lds
    s_waitcnt vmcnt(8)
    s_barrier
    s_cmp_le_u32 s74, 5
    s_cselect_b32 s63, 9, 5
    s_add_u32 s63, s63, s73
    s_cmp_le_u32 s74, 6
    s_cselect_b32 s65, 10, 6
    s_add_u32 s65, s65, s73
    s_cmp_eq_u32 s42, 0
    s_cselect_b32 s63, s63, s65
    s_mul_i32 s64, s63, 9216
    s_add_u32 s64, s64, s76
    s_add_u32 m0, s40, 104448
    s_nop 0
    buffer_load_dwordx4 v3, s[20:23], s64 offen offset:0 lds
    buffer_load_dwordx4 v3, s[20:23], s64 offen offset:1024 lds
    buffer_load_dwordx4 v3, s[20:23], s64 offen offset:2048 lds
    s_add_u32 m0, s41, 104448
    s_add_u32 s64, s64, 3072
    buffer_load_dwordx4 v3, s[20:23], s64 offen lds
    s_cmp_le_u32 s74, 5
    s_cselect_b32 s63, 9, 5
    s_add_u32 s63, s63, s73
    s_cmp_le_u32 s74, 6
    s_cselect_b32 s65, 10, 6
    s_add_u32 s65, s65, s73
    s_cmp_eq_u32 s42, 0
    s_cselect_b32 s63, s63, s65
    s_lshl_b32 s64, s63, 10
    s_add_u32 s64, s64, s77
    s_add_u32 m0, s78, 104448
    s_nop 0
    buffer_load_dwordx4 v3, s[20:23], s64 offen lds
    buffer_load_dwordx4 v16, s[20:23], s64 offen offset:2048 lds
    s_add_u32 m0, s78, 108544
    s_nop 0
    buffer_load_dwordx4 v17, s[20:23], s64 offen lds
    buffer_load_dwordx4 v18, s[20:23], s64 offen offset:2048 lds
    s_waitcnt vmcnt(12)
    s_barrier
    s_cmp_le_u32 s74, 7
    s_cselect_b32 s63, 11, 7
    s_add_u32 s63, s63, s73
    s_cmp_le_u32 s74, 8
    s_cselect_b32 s65, 12, 8
    s_add_u32 s65, s65, s73
    s_cmp_eq_u32 s42, 0
    s_cselect_b32 s63, s63, s65
    s_mul_i32 s64, s63, 9216
    s_add_u32 s64, s64, s76
    s_add_u32 m0, s40, 0
    s_nop 0
    buffer_load_dwordx4 v3, s[20:23], s64 offen offset:0 lds
    buffer_load_dwordx4 v3, s[20:23], s64 offen offset:1024 lds
    buffer_load_dwordx4 v3, s[20:23], s64 offen offset:2048 lds
    s_add_u32 m0, s41, 0
    s_add_u32 s64, s64, 3072
    buffer_load_dwordx4 v3, s[20:23], s64 offen lds
    s_cmp_le_u32 s74, 7
    s_cselect_b32 s63, 11, 7
    s_add_u32 s63, s63, s73
    s_cmp_le_u32 s74, 8
    s_cselect_b32 s65, 12, 8
    s_add_u32 s65, s65, s73
    s_cmp_eq_u32 s42, 0
    s_cselect_b32 s63, s63, s65
    s_lshl_b32 s64, s63, 10
    s_add_u32 s64, s64, s77
    s_add_u32 m0, s78, 0
    s_nop 0
    buffer_load_dwordx4 v3, s[20:23], s64 offen lds
    buffer_load_dwordx4 v16, s[20:23], s64 offen offset:2048 lds
    s_add_u32 m0, s78, 4096
    s_nop 0
    buffer_load_dwordx4 v17, s[20:23], s64 offen lds
    buffer_load_dwordx4 v18, s[20:23], s64 offen offset:2048 lds
    s_waitcnt vmcnt(16)
    s_barrier
    s_cmp_le_u32 s74, 9
    s_cselect_b32 s63, 13, 9
    s_add_u32 s63, s63, s73
    s_cmp_le_u32 s74, 10
    s_cselect_b32 s65, 14, 10
    s_add_u32 s65, s65, s73
    s_cmp_eq_u32 s42, 0
    s_cselect_b32 s63, s63, s65
    s_mul_i32 s64, s63, 9216
    s_add_u32 s64, s64, s76
    s_add_u32 m0, s40, 34816
    s_nop 0
    buffer_load_dwordx4 v3, s[20:23], s64 offen offset:0 lds
    buffer_load_dwordx4 v3, s[20:23], s64 offen offset:1024 lds
    buffer_load_dwordx4 v3, s[20:23], s64 offen offset:2048 lds
    s_add_u32 m0, s41, 34816
    s_add_u32 s64, s64, 3072
    buffer_load_dwordx4 v3, s[20:23], s64 offen lds
    s_cmp_le_u32 s74, 9
    s_cselect_b32 s63, 13, 9
    s_add_u32 s63, s63, s73
    s_cmp_le_u32 s74, 10
    s_cselect_b32 s65, 14, 10
    s_add_u32 s65, s65, s73
    s_cmp_eq_u32 s42, 0
    s_cselect_b32 s63, s63, s65
    s_lshl_b32 s64, s63, 10
    s_add_u32 s64, s64, s77
    s_add_u32 m0, s78, 34816
    s_nop 0
    buffer_load_dwordx4 v3, s[20:23], s64 offen lds
    buffer_load_dwordx4 v16, s[20:23], s64 offen offset:2048 lds
    s_add_u32 m0, s78, 38912
    s_nop 0
    buffer_load_dwordx4 v17, s[20:23], s64 offen lds
    buffer_load_dwordx4 v18, s[20:23], s64 offen offset:2048 lds
    s_waitcnt vmcnt(16)
    s_barrier
    s_cmp_le_u32 s74, 11
    s_cselect_b32 s63, 15, 11
    s_add_u32 s63, s63, s73
    s_cmp_le_u32 s74, 12
    s_cselect_b32 s65, 16, 12
    s_add_u32 s65, s65, s73
    s_cmp_eq_u32 s42, 0
    s_cselect_b32 s63, s63, s65
    s_mul_i32 s64, s63, 9216
    s_add_u32 s64, s64, s76
    s_add_u32 m0, s40, 69632
    s_nop 0
    buffer_load_dwordx4 v3, s[20:23], s64 offen offset:0 lds
    buffer_load_dwordx4 v3, s[20:23], s64 offen offset:1024 lds
    buffer_load_dwordx4 v3, s[20:23], s64 offen offset:2048 lds
    s_add_u32 m0, s41, 69632
    s_add_u32 s64, s64, 3072
    buffer_load_dwordx4 v3, s[20:23], s64 offen lds
    s_cmp_le_u32 s74, 11
    s_cselect_b32 s63, 15, 11
    s_add_u32 s63, s63, s73
    s_cmp_le_u32 s74, 12
    s_cselect_b32 s65, 16, 12
    s_add_u32 s65, s65, s73
    s_cmp_eq_u32 s42, 0
    s_cselect_b32 s63, s63, s65
    s_lshl_b32 s64, s63, 10
    s_add_u32 s64, s64, s77
    s_add_u32 m0, s78, 69632
    s_nop 0
    buffer_load_dwordx4 v3, s[20:23], s64 offen lds
    buffer_load_dwordx4 v16, s[20:23], s64 offen offset:2048 lds
    s_add_u32 m0, s78, 73728
    s_nop 0
    buffer_load_dwordx4 v17, s[20:23], s64 offen lds
    buffer_load_dwordx4 v18, s[20:23], s64 offen offset:2048 lds
    s_waitcnt vmcnt(16)
    s_barrier
    s_cmp_le_u32 s74, 13
    s_cselect_b32 s63, 17, 13
    s_add_u32 s63, s63, s73
    s_mov_b32 s65, 100
    s_cmp_eq_u32 s42, 0
    s_cselect_b32 s63, s63, s65
    s_cmp_lt_u32 s63, 90
    s_cselect_b32 s26, 57671680, 0
    s_cselect_b32 s63, s63, 0
    s_mul_i32 s64, s63, 9216
    s_add_u32 s64, s64, s76
    s_add_u32 m0, s40, 104448
    s_nop 0
    buffer_load_dwordx4 v3, s[24:27], s64 offen offset:0 lds
    buffer_load_dwordx4 v3, s[24:27], s64 offen offset:1024 lds
    buffer_load_dwordx4 v3, s[24:27], s64 offen offset:2048 lds
    s_add_u32 m0, s41, 104448
    s_add_u32 s64, s64, 3072
    buffer_load_dwordx4 v3, s[24:27], s64 offen lds
    s_cmp_le_u32 s74, 13
    s_cselect_b32 s63, 17, 13
    s_add_u32 s63, s63, s73
    s_mov_b32 s65, 100
    s_cmp_eq_u32 s42, 0
    s_cselect_b32 s63, s63, s65
    s_cmp_lt_u32 s63, 90
    s_cselect_b32 s26, 57671680, 0
    s_cselect_b32 s63, s63, 0
    s_lshl_b32 s64, s63, 10
    s_add_u32 s64, s64, s77
    s_add_u32 m0, s78, 104448
    s_nop 0
    buffer_load_dwordx4 v3, s[24:27], s64 offen lds
    buffer_load_dwordx4 v16, s[24:27], s64 offen offset:2048 lds
    s_add_u32 m0, s78, 108544
    s_nop 0
    buffer_load_dwordx4 v17, s[24:27], s64 offen lds
    buffer_load_dwordx4 v18, s[24:27], s64 offen offset:2048 lds
    s_waitcnt vmcnt(16)
    s_barrier
    s_waitcnt vmcnt(8)
    s_barrier
    s_waitcnt vmcnt(0)
    s_barrier
    s_add_u32 s3, s3, 4
    s_branch parallel_sum__linear_kernel_hedgehog__mixer_gmlp__prompt_kernel_final
parallel_sum__linear_kernel_hedgehog__mixer_gmlp__prompt_kernel_compute:
    s_mov_b32 s28, s8
    s_mov_b32 s29, s9
    s_mov_b32 s30, 4096
    s_mov_b32 s31, 0x20000
    v_mov_b32 v4, v3
    v_add_u32 v5, 69632, v3
    v_and_b32 v10, 15, v2
    v_lshrrev_b32 v11, 4, v2
    v_lshrrev_b32 v12, 1, v10
    v_xor_b32 v12, v12, v11
    v_lshlrev_b32 v12, 4, v12
    v_lshl_add_u32 v6, v10, 7, v12
    s_lshl_b32 s36, s3, 12
    s_add_u32 s36, s36, 18432
    v_add_u32 v6, s36, v6
    v_xor_b32 v7, 64, v6
    v_add_u32 v8, 69632, v6
    v_add_u32 v9, 69632, v7
    s_lshl_b32 s37, s32, 7
    s_lshl_b32 s38, s3, 5
    s_add_u32 s37, s37, s38
    s_lshl_b32 s38, s37, 1
    v_lshlrev_b32 v12, 1, v10
    buffer_load_ushort v13, v12, s[28:31], s38 offen
    buffer_load_ushort v14, v12, s[28:31], s38 offen offset:32
    s_lshl_b32 s38, s37, 4
    s_add_u32 s38, s38, 43909128
    v_lshlrev_b32 v12, 4, v10
    buffer_load_dword v15, v12, s[20:23], s38 offen sc1
    buffer_load_dword v1, v12, s[20:23], s38 offen offset:256 sc1
    s_barrier
    s_barrier
    ds_read_b128 v[52:55], v6 offset:0
    ds_read_b128 v[56:59], v6 offset:2048
    ds_read_b128 v[16:19], v4 offset:0
    ds_read_b128 v[20:23], v4 offset:1024
    ds_read_b128 v[24:27], v4 offset:2048
    ds_read_b128 v[28:31], v4 offset:3072
    ds_read_b128 v[32:35], v4 offset:4096
    ds_read_b128 v[36:39], v4 offset:5120
    ds_read_b128 v[40:43], v4 offset:6144
    ds_read_b128 v[44:47], v4 offset:7168
    ds_read_b128 v[48:51], v4 offset:8192
    s_waitcnt lgkmcnt(0)
    ds_read_b128 v[96:99], v7 offset:0
    v_mfma_f32_16x16x32_bf16 v[160:163], v[16:19], v[52:55], 0
    ds_read_b128 v[100:103], v7 offset:2048
    v_mfma_f32_16x16x32_bf16 v[164:167], v[16:19], v[56:59], 0
    ds_read_b128 v[60:63], v4 offset:9216
    v_mfma_f32_16x16x32_bf16 v[168:171], v[20:23], v[52:55], 0
    ds_read_b128 v[64:67], v4 offset:10240
    v_mfma_f32_16x16x32_bf16 v[172:175], v[20:23], v[56:59], 0
    ds_read_b128 v[68:71], v4 offset:11264
    v_mfma_f32_16x16x32_bf16 v[176:179], v[24:27], v[52:55], 0
    s_lshr_b32 s50, s2, 5
    ds_read_b128 v[72:75], v4 offset:12288
    v_mfma_f32_16x16x32_bf16 v[180:183], v[24:27], v[56:59], 0
    s_and_b32 s51, s2, 7
    ds_read_b128 v[76:79], v4 offset:13312
    v_mfma_f32_16x16x32_bf16 v[184:187], v[28:31], v[52:55], 0
    s_lshl_b32 s51, s51, 2
    ds_read_b128 v[80:83], v4 offset:14336
    v_mfma_f32_16x16x32_bf16 v[188:191], v[28:31], v[56:59], 0
    s_bfe_u32 s59, s2, 0x20003
    ds_read_b128 v[84:87], v4 offset:15360
    v_mfma_f32_16x16x32_bf16 v[192:195], v[32:35], v[52:55], 0
    s_add_u32 s51, s51, s59
    ds_read_b128 v[88:91], v4 offset:16384
    v_mfma_f32_16x16x32_bf16 v[196:199], v[32:35], v[56:59], 0
    s_and_b32 s54, s51, 3
    ds_read_b128 v[92:95], v4 offset:17408
    v_mfma_f32_16x16x32_bf16 v[200:203], v[36:39], v[52:55], 0
    s_lshl_b32 s57, s50, 3
    s_lshl_b32 s58, s3, 1
    v_mfma_f32_16x16x32_bf16 v[204:207], v[36:39], v[56:59], 0
    s_add_u32 s57, s57, s58
    s_mov_b32 s45, 1069066811
    v_mfma_f32_16x16x32_bf16 v[208:211], v[40:43], v[52:55], 0
    s_lshl_b32 s58, s3, 12
    s_add_u32 s58, s58, 141312
    v_mfma_f32_16x16x32_bf16 v[212:215], v[40:43], v[56:59], 0
    v_add_u32 v158, s58, v3
    v_add_u32 v159, 157696, v3
    v_mfma_f32_16x16x32_bf16 v[216:219], v[44:47], v[52:55], 0
    v_and_b32 v248, 31, v2
    s_and_b32 s52, s51, 1
    v_mfma_f32_16x16x32_bf16 v[220:223], v[44:47], v[56:59], 0
    s_lshl_b32 s52, s52, 1
    v_add_u32 v249, s52, v248
    v_mfma_f32_16x16x32_bf16 v[224:227], v[48:51], v[52:55], 0
    v_min_u32 v249, 23, v249
    v_and_b32 v250, 27, v248
    v_mfma_f32_16x16x32_bf16 v[228:231], v[48:51], v[56:59], 0
    v_cmp_eq_u32 vcc, 18, v250
    v_mov_b32 v251, 20
    s_waitcnt lgkmcnt(0)
    s_waitcnt vmcnt(0)
    s_barrier
    ds_read_b128 v[52:55], v6 offset:34816
    v_mfma_f32_16x16x32_bf16 v[160:163], v[60:63], v[96:99], v[160:163]
    ds_read_b128 v[56:59], v6 offset:36864
    v_mfma_f32_16x16x32_bf16 v[164:167], v[60:63], v[100:103], v[164:167]
    ds_read_b128 v[16:19], v4 offset:34816
    v_mfma_f32_16x16x32_bf16 v[168:171], v[64:67], v[96:99], v[168:171]
    ds_read_b128 v[20:23], v4 offset:35840
    v_mfma_f32_16x16x32_bf16 v[172:175], v[64:67], v[100:103], v[172:175]
    ds_read_b128 v[24:27], v4 offset:36864
    v_mfma_f32_16x16x32_bf16 v[176:179], v[68:71], v[96:99], v[176:179]
    v_lshrrev_b32 v253, 5, v2
    ds_read_b128 v[28:31], v4 offset:37888
    v_mfma_f32_16x16x32_bf16 v[180:183], v[68:71], v[100:103], v[180:183]
    v_cndmask_b32 v249, v249, v251, vcc
    ds_read_b128 v[32:35], v4 offset:38912
    v_mfma_f32_16x16x32_bf16 v[184:187], v[72:75], v[96:99], v[184:187]
    v_mul_u32_u24 v250, 24, v253
    ds_read_b128 v[36:39], v4 offset:39936
    v_mfma_f32_16x16x32_bf16 v[188:191], v[72:75], v[100:103], v[188:191]
    v_add_u32 v249, v249, v250
    ds_read_b128 v[40:43], v4 offset:40960
    v_mfma_f32_16x16x32_bf16 v[192:195], v[76:79], v[96:99], v[192:195]
    v_mul_u32_u24 v249, 40, v249
    ds_read_b128 v[44:47], v4 offset:41984
    v_mfma_f32_16x16x32_bf16 v[196:199], v[76:79], v[100:103], v[196:199]
    v_add_u32 v252, 139264, v249
    ds_read_b128 v[48:51], v4 offset:43008
    v_mfma_f32_16x16x32_bf16 v[200:203], v[80:83], v[96:99], v[200:203]
    v_bfe_u32 v254, v2, 4, 1
    v_mul_u32_u24 v254, 92160, v254
    v_mfma_f32_16x16x32_bf16 v[204:207], v[80:83], v[100:103], v[204:207]
    v_and_b32 v255, 15, v2
    v_lshl_add_u32 v254, v255, 4, v254
    v_mfma_f32_16x16x32_bf16 v[208:211], v[84:87], v[96:99], v[208:211]
    v_lshl_add_u32 v255, v253, 8, v254
    v_cmp_gt_u32 vcc, 32, v2
    v_mfma_f32_16x16x32_bf16 v[212:215], v[84:87], v[100:103], v[212:215]
    v_mov_b32 v248, 1073741824
    s_mul_i32 s57, s57, 184320
    v_mfma_f32_16x16x32_bf16 v[216:219], v[88:91], v[96:99], v[216:219]
    v_cndmask_b32 v254, v248, v254, vcc
    s_add_u32 s57, s57, 20971520
    v_mfma_f32_16x16x32_bf16 v[220:223], v[88:91], v[100:103], v[220:223]
    s_lshr_b32 s52, s51, 1
    s_lshl_b32 s52, s52, 10
    v_mfma_f32_16x16x32_bf16 v[224:227], v[92:95], v[96:99], v[224:227]
    s_and_b32 s53, s51, 1
    s_lshl_b32 s53, s53, 9
    v_mfma_f32_16x16x32_bf16 v[228:231], v[92:95], v[100:103], v[228:231]
    s_add_u32 s52, s52, s53
    s_add_u32 s52, s52, 73728
    s_waitcnt lgkmcnt(0)
    ds_read_b128 v[96:99], v7 offset:34816
    v_mfma_f32_16x16x32_bf16 v[160:163], v[16:19], v[52:55], v[160:163]
    ds_read_b128 v[100:103], v7 offset:36864
    v_mfma_f32_16x16x32_bf16 v[164:167], v[16:19], v[56:59], v[164:167]
    ds_read_b128 v[60:63], v4 offset:44032
    v_mfma_f32_16x16x32_bf16 v[168:171], v[20:23], v[52:55], v[168:171]
    ds_read_b128 v[64:67], v4 offset:45056
    v_mfma_f32_16x16x32_bf16 v[172:175], v[20:23], v[56:59], v[172:175]
    ds_read_b128 v[68:71], v4 offset:46080
    v_mfma_f32_16x16x32_bf16 v[176:179], v[24:27], v[52:55], v[176:179]
    s_add_u32 s52, s52, s57
    ds_read_b128 v[72:75], v4 offset:47104
    v_mfma_f32_16x16x32_bf16 v[180:183], v[24:27], v[56:59], v[180:183]
    s_lshr_b32 s53, s51, 4
    ds_read_b128 v[76:79], v4 offset:48128
    v_mfma_f32_16x16x32_bf16 v[184:187], v[28:31], v[52:55], v[184:187]
    s_lshl_b32 s53, s53, 10
    ds_read_b128 v[80:83], v4 offset:49152
    v_mfma_f32_16x16x32_bf16 v[188:191], v[28:31], v[56:59], v[188:191]
    s_bfe_u32 s55, s51, 0x20002
    ds_read_b128 v[84:87], v4 offset:50176
    v_mfma_f32_16x16x32_bf16 v[192:195], v[32:35], v[52:55], v[192:195]
    s_lshl_b32 s55, s55, 8
    ds_read_b128 v[88:91], v4 offset:51200
    v_mfma_f32_16x16x32_bf16 v[196:199], v[32:35], v[56:59], v[196:199]
    s_add_u32 s53, s53, s55
    ds_read_b128 v[92:95], v4 offset:52224
    v_mfma_f32_16x16x32_bf16 v[200:203], v[36:39], v[52:55], v[200:203]
    s_lshl_b32 s55, s54, 2
    s_add_u32 s53, s53, s55
    v_mfma_f32_16x16x32_bf16 v[204:207], v[36:39], v[56:59], v[204:207]
    s_add_u32 s53, s53, 90112
    s_add_u32 s53, s53, s57
    v_mfma_f32_16x16x32_bf16 v[208:211], v[40:43], v[52:55], v[208:211]
    v_mfma_f32_16x16x32_bf16 v[212:215], v[40:43], v[56:59], v[212:215]
    v_mfma_f32_16x16x32_bf16 v[216:219], v[44:47], v[52:55], v[216:219]
    v_mfma_f32_16x16x32_bf16 v[220:223], v[44:47], v[56:59], v[220:223]
    v_mfma_f32_16x16x32_bf16 v[224:227], v[48:51], v[52:55], v[224:227]
    v_mfma_f32_16x16x32_bf16 v[228:231], v[48:51], v[56:59], v[228:231]
    s_waitcnt lgkmcnt(0)
    s_barrier
    ds_read_b128 v[52:55], v8 offset:0
    v_mfma_f32_16x16x32_bf16 v[160:163], v[60:63], v[96:99], v[160:163]
    ds_read_b128 v[56:59], v8 offset:2048
    v_mfma_f32_16x16x32_bf16 v[164:167], v[60:63], v[100:103], v[164:167]
    ds_read_b128 v[16:19], v5 offset:0
    v_mfma_f32_16x16x32_bf16 v[168:171], v[64:67], v[96:99], v[168:171]
    ds_read_b128 v[20:23], v5 offset:1024
    v_mfma_f32_16x16x32_bf16 v[172:175], v[64:67], v[100:103], v[172:175]
    ds_read_b128 v[24:27], v5 offset:2048
    v_mfma_f32_16x16x32_bf16 v[176:179], v[68:71], v[96:99], v[176:179]
    ds_read_b128 v[28:31], v5 offset:3072
    v_mfma_f32_16x16x32_bf16 v[180:183], v[68:71], v[100:103], v[180:183]
    ds_read_b128 v[32:35], v5 offset:4096
    v_mfma_f32_16x16x32_bf16 v[184:187], v[72:75], v[96:99], v[184:187]
    ds_read_b128 v[36:39], v5 offset:5120
    v_mfma_f32_16x16x32_bf16 v[188:191], v[72:75], v[100:103], v[188:191]
    ds_read_b128 v[40:43], v5 offset:6144
    v_mfma_f32_16x16x32_bf16 v[192:195], v[76:79], v[96:99], v[192:195]
    ds_read_b128 v[44:47], v5 offset:7168
    v_mfma_f32_16x16x32_bf16 v[196:199], v[76:79], v[100:103], v[196:199]
    ds_read_b128 v[48:51], v5 offset:8192
    v_mfma_f32_16x16x32_bf16 v[200:203], v[80:83], v[96:99], v[200:203]
    v_mfma_f32_16x16x32_bf16 v[204:207], v[80:83], v[100:103], v[204:207]
    v_mfma_f32_16x16x32_bf16 v[208:211], v[84:87], v[96:99], v[208:211]
    v_mfma_f32_16x16x32_bf16 v[212:215], v[84:87], v[100:103], v[212:215]
    v_mfma_f32_16x16x32_bf16 v[216:219], v[88:91], v[96:99], v[216:219]
    v_mfma_f32_16x16x32_bf16 v[220:223], v[88:91], v[100:103], v[220:223]
    v_mfma_f32_16x16x32_bf16 v[224:227], v[92:95], v[96:99], v[224:227]
    v_mfma_f32_16x16x32_bf16 v[228:231], v[92:95], v[100:103], v[228:231]
    s_waitcnt lgkmcnt(0)
    ds_read_b128 v[96:99], v9 offset:0
    v_mfma_f32_16x16x32_bf16 v[160:163], v[16:19], v[52:55], v[160:163]
    ds_read_b128 v[100:103], v9 offset:2048
    v_mfma_f32_16x16x32_bf16 v[164:167], v[16:19], v[56:59], v[164:167]
    ds_read_b128 v[60:63], v5 offset:9216
    v_mfma_f32_16x16x32_bf16 v[168:171], v[20:23], v[52:55], v[168:171]
    ds_read_b128 v[64:67], v5 offset:10240
    v_mfma_f32_16x16x32_bf16 v[172:175], v[20:23], v[56:59], v[172:175]
    ds_read_b128 v[68:71], v5 offset:11264
    v_mfma_f32_16x16x32_bf16 v[176:179], v[24:27], v[52:55], v[176:179]
    ds_read_b128 v[72:75], v5 offset:12288
    v_mfma_f32_16x16x32_bf16 v[180:183], v[24:27], v[56:59], v[180:183]
    ds_read_b128 v[76:79], v5 offset:13312
    v_mfma_f32_16x16x32_bf16 v[184:187], v[28:31], v[52:55], v[184:187]
    ds_read_b128 v[80:83], v5 offset:14336
    v_mfma_f32_16x16x32_bf16 v[188:191], v[28:31], v[56:59], v[188:191]
    ds_read_b128 v[84:87], v5 offset:15360
    v_mfma_f32_16x16x32_bf16 v[192:195], v[32:35], v[52:55], v[192:195]
    ds_read_b128 v[88:91], v5 offset:16384
    v_mfma_f32_16x16x32_bf16 v[196:199], v[32:35], v[56:59], v[196:199]
    ds_read_b128 v[92:95], v5 offset:17408
    v_mfma_f32_16x16x32_bf16 v[200:203], v[36:39], v[52:55], v[200:203]
    v_mfma_f32_16x16x32_bf16 v[204:207], v[36:39], v[56:59], v[204:207]
    v_mfma_f32_16x16x32_bf16 v[208:211], v[40:43], v[52:55], v[208:211]
    v_mfma_f32_16x16x32_bf16 v[212:215], v[40:43], v[56:59], v[212:215]
    v_mfma_f32_16x16x32_bf16 v[216:219], v[44:47], v[52:55], v[216:219]
    v_mfma_f32_16x16x32_bf16 v[220:223], v[44:47], v[56:59], v[220:223]
    v_mfma_f32_16x16x32_bf16 v[224:227], v[48:51], v[52:55], v[224:227]
    v_mfma_f32_16x16x32_bf16 v[228:231], v[48:51], v[56:59], v[228:231]
    s_waitcnt lgkmcnt(0)
    s_barrier
    ds_read_b128 v[52:55], v8 offset:34816
    v_mfma_f32_16x16x32_bf16 v[160:163], v[60:63], v[96:99], v[160:163]
    ds_read_b128 v[56:59], v8 offset:36864
    v_mfma_f32_16x16x32_bf16 v[164:167], v[60:63], v[100:103], v[164:167]
    ds_read_b128 v[16:19], v5 offset:34816
    v_mfma_f32_16x16x32_bf16 v[168:171], v[64:67], v[96:99], v[168:171]
    ds_read_b128 v[20:23], v5 offset:35840
    v_mfma_f32_16x16x32_bf16 v[172:175], v[64:67], v[100:103], v[172:175]
    ds_read_b128 v[24:27], v5 offset:36864
    v_mfma_f32_16x16x32_bf16 v[176:179], v[68:71], v[96:99], v[176:179]
    ds_read_b128 v[28:31], v5 offset:37888
    v_mfma_f32_16x16x32_bf16 v[180:183], v[68:71], v[100:103], v[180:183]
    ds_read_b128 v[32:35], v5 offset:38912
    v_mfma_f32_16x16x32_bf16 v[184:187], v[72:75], v[96:99], v[184:187]
    ds_read_b128 v[36:39], v5 offset:39936
    v_mfma_f32_16x16x32_bf16 v[188:191], v[72:75], v[100:103], v[188:191]
    ds_read_b128 v[40:43], v5 offset:40960
    v_mfma_f32_16x16x32_bf16 v[192:195], v[76:79], v[96:99], v[192:195]
    ds_read_b128 v[44:47], v5 offset:41984
    v_mfma_f32_16x16x32_bf16 v[196:199], v[76:79], v[100:103], v[196:199]
    ds_read_b128 v[48:51], v5 offset:43008
    v_mfma_f32_16x16x32_bf16 v[200:203], v[80:83], v[96:99], v[200:203]
    v_mfma_f32_16x16x32_bf16 v[204:207], v[80:83], v[100:103], v[204:207]
    v_mfma_f32_16x16x32_bf16 v[208:211], v[84:87], v[96:99], v[208:211]
    v_mfma_f32_16x16x32_bf16 v[212:215], v[84:87], v[100:103], v[212:215]
    v_mfma_f32_16x16x32_bf16 v[216:219], v[88:91], v[96:99], v[216:219]
    v_mfma_f32_16x16x32_bf16 v[220:223], v[88:91], v[100:103], v[220:223]
    v_mfma_f32_16x16x32_bf16 v[224:227], v[92:95], v[96:99], v[224:227]
    v_mfma_f32_16x16x32_bf16 v[228:231], v[92:95], v[100:103], v[228:231]
    s_waitcnt lgkmcnt(0)
    ds_read_b128 v[96:99], v9 offset:34816
    v_mfma_f32_16x16x32_bf16 v[160:163], v[16:19], v[52:55], v[160:163]
    ds_read_b128 v[100:103], v9 offset:36864
    v_mfma_f32_16x16x32_bf16 v[164:167], v[16:19], v[56:59], v[164:167]
    ds_read_b128 v[60:63], v5 offset:44032
    v_mfma_f32_16x16x32_bf16 v[168:171], v[20:23], v[52:55], v[168:171]
    ds_read_b128 v[64:67], v5 offset:45056
    v_mfma_f32_16x16x32_bf16 v[172:175], v[20:23], v[56:59], v[172:175]
    ds_read_b128 v[68:71], v5 offset:46080
    v_mfma_f32_16x16x32_bf16 v[176:179], v[24:27], v[52:55], v[176:179]
    ds_read_b128 v[72:75], v5 offset:47104
    v_mfma_f32_16x16x32_bf16 v[180:183], v[24:27], v[56:59], v[180:183]
    ds_read_b128 v[76:79], v5 offset:48128
    v_mfma_f32_16x16x32_bf16 v[184:187], v[28:31], v[52:55], v[184:187]
    ds_read_b128 v[80:83], v5 offset:49152
    v_mfma_f32_16x16x32_bf16 v[188:191], v[28:31], v[56:59], v[188:191]
    ds_read_b128 v[84:87], v5 offset:50176
    v_mfma_f32_16x16x32_bf16 v[192:195], v[32:35], v[52:55], v[192:195]
    ds_read_b128 v[88:91], v5 offset:51200
    v_mfma_f32_16x16x32_bf16 v[196:199], v[32:35], v[56:59], v[196:199]
    ds_read_b128 v[92:95], v5 offset:52224
    v_mfma_f32_16x16x32_bf16 v[200:203], v[36:39], v[52:55], v[200:203]
    v_mfma_f32_16x16x32_bf16 v[204:207], v[36:39], v[56:59], v[204:207]
    v_mfma_f32_16x16x32_bf16 v[208:211], v[40:43], v[52:55], v[208:211]
    v_mfma_f32_16x16x32_bf16 v[212:215], v[40:43], v[56:59], v[212:215]
    v_mfma_f32_16x16x32_bf16 v[216:219], v[44:47], v[52:55], v[216:219]
    v_mfma_f32_16x16x32_bf16 v[220:223], v[44:47], v[56:59], v[220:223]
    v_mfma_f32_16x16x32_bf16 v[224:227], v[48:51], v[52:55], v[224:227]
    v_mfma_f32_16x16x32_bf16 v[228:231], v[48:51], v[56:59], v[228:231]
    s_waitcnt lgkmcnt(0)
    s_barrier
    ds_read_b128 v[52:55], v6 offset:0
    v_mfma_f32_16x16x32_bf16 v[160:163], v[60:63], v[96:99], v[160:163]
    ds_read_b128 v[56:59], v6 offset:2048
    v_mfma_f32_16x16x32_bf16 v[164:167], v[60:63], v[100:103], v[164:167]
    ds_read_b128 v[16:19], v4 offset:0
    v_mfma_f32_16x16x32_bf16 v[168:171], v[64:67], v[96:99], v[168:171]
    ds_read_b128 v[20:23], v4 offset:1024
    v_mfma_f32_16x16x32_bf16 v[172:175], v[64:67], v[100:103], v[172:175]
    ds_read_b128 v[24:27], v4 offset:2048
    v_mfma_f32_16x16x32_bf16 v[176:179], v[68:71], v[96:99], v[176:179]
    ds_read_b128 v[28:31], v4 offset:3072
    v_mfma_f32_16x16x32_bf16 v[180:183], v[68:71], v[100:103], v[180:183]
    ds_read_b128 v[32:35], v4 offset:4096
    v_mfma_f32_16x16x32_bf16 v[184:187], v[72:75], v[96:99], v[184:187]
    ds_read_b128 v[36:39], v4 offset:5120
    v_mfma_f32_16x16x32_bf16 v[188:191], v[72:75], v[100:103], v[188:191]
    ds_read_b128 v[40:43], v4 offset:6144
    v_mfma_f32_16x16x32_bf16 v[192:195], v[76:79], v[96:99], v[192:195]
    ds_read_b128 v[44:47], v4 offset:7168
    v_mfma_f32_16x16x32_bf16 v[196:199], v[76:79], v[100:103], v[196:199]
    ds_read_b128 v[48:51], v4 offset:8192
    v_mfma_f32_16x16x32_bf16 v[200:203], v[80:83], v[96:99], v[200:203]
    v_mfma_f32_16x16x32_bf16 v[204:207], v[80:83], v[100:103], v[204:207]
    v_mfma_f32_16x16x32_bf16 v[208:211], v[84:87], v[96:99], v[208:211]
    v_mfma_f32_16x16x32_bf16 v[212:215], v[84:87], v[100:103], v[212:215]
    v_mfma_f32_16x16x32_bf16 v[216:219], v[88:91], v[96:99], v[216:219]
    v_mfma_f32_16x16x32_bf16 v[220:223], v[88:91], v[100:103], v[220:223]
    v_mfma_f32_16x16x32_bf16 v[224:227], v[92:95], v[96:99], v[224:227]
    v_mfma_f32_16x16x32_bf16 v[228:231], v[92:95], v[100:103], v[228:231]
    s_waitcnt lgkmcnt(0)
    ds_read_b128 v[96:99], v7 offset:0
    v_mfma_f32_16x16x32_bf16 v[160:163], v[16:19], v[52:55], v[160:163]
    ds_read_b128 v[100:103], v7 offset:2048
    v_mfma_f32_16x16x32_bf16 v[164:167], v[16:19], v[56:59], v[164:167]
    ds_read_b128 v[60:63], v4 offset:9216
    v_mfma_f32_16x16x32_bf16 v[168:171], v[20:23], v[52:55], v[168:171]
    ds_read_b128 v[64:67], v4 offset:10240
    v_mfma_f32_16x16x32_bf16 v[172:175], v[20:23], v[56:59], v[172:175]
    ds_read_b128 v[68:71], v4 offset:11264
    v_mfma_f32_16x16x32_bf16 v[176:179], v[24:27], v[52:55], v[176:179]
    ds_read_b128 v[72:75], v4 offset:12288
    v_mfma_f32_16x16x32_bf16 v[180:183], v[24:27], v[56:59], v[180:183]
    ds_read_b128 v[76:79], v4 offset:13312
    v_mfma_f32_16x16x32_bf16 v[184:187], v[28:31], v[52:55], v[184:187]
    ds_read_b128 v[80:83], v4 offset:14336
    v_mfma_f32_16x16x32_bf16 v[188:191], v[28:31], v[56:59], v[188:191]
    ds_read_b128 v[84:87], v4 offset:15360
    v_mfma_f32_16x16x32_bf16 v[192:195], v[32:35], v[52:55], v[192:195]
    ds_read_b128 v[88:91], v4 offset:16384
    v_mfma_f32_16x16x32_bf16 v[196:199], v[32:35], v[56:59], v[196:199]
    ds_read_b128 v[92:95], v4 offset:17408
    v_mfma_f32_16x16x32_bf16 v[200:203], v[36:39], v[52:55], v[200:203]
    v_mfma_f32_16x16x32_bf16 v[204:207], v[36:39], v[56:59], v[204:207]
    v_mfma_f32_16x16x32_bf16 v[208:211], v[40:43], v[52:55], v[208:211]
    v_mfma_f32_16x16x32_bf16 v[212:215], v[40:43], v[56:59], v[212:215]
    v_mfma_f32_16x16x32_bf16 v[216:219], v[44:47], v[52:55], v[216:219]
    v_mfma_f32_16x16x32_bf16 v[220:223], v[44:47], v[56:59], v[220:223]
    v_mfma_f32_16x16x32_bf16 v[224:227], v[48:51], v[52:55], v[224:227]
    v_mfma_f32_16x16x32_bf16 v[228:231], v[48:51], v[56:59], v[228:231]
    s_waitcnt lgkmcnt(0)
    s_barrier
    ds_read_b128 v[52:55], v6 offset:34816
    v_mfma_f32_16x16x32_bf16 v[160:163], v[60:63], v[96:99], v[160:163]
    ds_read_b128 v[56:59], v6 offset:36864
    v_mfma_f32_16x16x32_bf16 v[164:167], v[60:63], v[100:103], v[164:167]
    ds_read_b128 v[16:19], v4 offset:34816
    v_mfma_f32_16x16x32_bf16 v[168:171], v[64:67], v[96:99], v[168:171]
    ds_read_b128 v[20:23], v4 offset:35840
    v_mfma_f32_16x16x32_bf16 v[172:175], v[64:67], v[100:103], v[172:175]
    ds_read_b128 v[24:27], v4 offset:36864
    v_mfma_f32_16x16x32_bf16 v[176:179], v[68:71], v[96:99], v[176:179]
    ds_read_b128 v[28:31], v4 offset:37888
    v_mfma_f32_16x16x32_bf16 v[180:183], v[68:71], v[100:103], v[180:183]
    ds_read_b128 v[32:35], v4 offset:38912
    v_mfma_f32_16x16x32_bf16 v[184:187], v[72:75], v[96:99], v[184:187]
    ds_read_b128 v[36:39], v4 offset:39936
    v_mfma_f32_16x16x32_bf16 v[188:191], v[72:75], v[100:103], v[188:191]
    ds_read_b128 v[40:43], v4 offset:40960
    v_mfma_f32_16x16x32_bf16 v[192:195], v[76:79], v[96:99], v[192:195]
    ds_read_b128 v[44:47], v4 offset:41984
    v_mfma_f32_16x16x32_bf16 v[196:199], v[76:79], v[100:103], v[196:199]
    ds_read_b128 v[48:51], v4 offset:43008
    v_mfma_f32_16x16x32_bf16 v[200:203], v[80:83], v[96:99], v[200:203]
    v_mfma_f32_16x16x32_bf16 v[204:207], v[80:83], v[100:103], v[204:207]
    v_mfma_f32_16x16x32_bf16 v[208:211], v[84:87], v[96:99], v[208:211]
    v_mfma_f32_16x16x32_bf16 v[212:215], v[84:87], v[100:103], v[212:215]
    v_mfma_f32_16x16x32_bf16 v[216:219], v[88:91], v[96:99], v[216:219]
    v_mfma_f32_16x16x32_bf16 v[220:223], v[88:91], v[100:103], v[220:223]
    v_mfma_f32_16x16x32_bf16 v[224:227], v[92:95], v[96:99], v[224:227]
    v_mfma_f32_16x16x32_bf16 v[228:231], v[92:95], v[100:103], v[228:231]
    s_waitcnt lgkmcnt(0)
    ds_read_b128 v[96:99], v7 offset:34816
    v_mfma_f32_16x16x32_bf16 v[160:163], v[16:19], v[52:55], v[160:163]
    ds_read_b128 v[100:103], v7 offset:36864
    v_mfma_f32_16x16x32_bf16 v[164:167], v[16:19], v[56:59], v[164:167]
    ds_read_b128 v[60:63], v4 offset:44032
    v_mfma_f32_16x16x32_bf16 v[168:171], v[20:23], v[52:55], v[168:171]
    ds_read_b128 v[64:67], v4 offset:45056
    v_mfma_f32_16x16x32_bf16 v[172:175], v[20:23], v[56:59], v[172:175]
    ds_read_b128 v[68:71], v4 offset:46080
    v_mfma_f32_16x16x32_bf16 v[176:179], v[24:27], v[52:55], v[176:179]
    ds_read_b128 v[72:75], v4 offset:47104
    v_mfma_f32_16x16x32_bf16 v[180:183], v[24:27], v[56:59], v[180:183]
    ds_read_b128 v[76:79], v4 offset:48128
    v_mfma_f32_16x16x32_bf16 v[184:187], v[28:31], v[52:55], v[184:187]
    ds_read_b128 v[80:83], v4 offset:49152
    v_mfma_f32_16x16x32_bf16 v[188:191], v[28:31], v[56:59], v[188:191]
    ds_read_b128 v[84:87], v4 offset:50176
    v_mfma_f32_16x16x32_bf16 v[192:195], v[32:35], v[52:55], v[192:195]
    ds_read_b128 v[88:91], v4 offset:51200
    v_mfma_f32_16x16x32_bf16 v[196:199], v[32:35], v[56:59], v[196:199]
    ds_read_b128 v[92:95], v4 offset:52224
    v_mfma_f32_16x16x32_bf16 v[200:203], v[36:39], v[52:55], v[200:203]
    v_mfma_f32_16x16x32_bf16 v[204:207], v[36:39], v[56:59], v[204:207]
    v_mfma_f32_16x16x32_bf16 v[208:211], v[40:43], v[52:55], v[208:211]
    v_mfma_f32_16x16x32_bf16 v[212:215], v[40:43], v[56:59], v[212:215]
    v_mfma_f32_16x16x32_bf16 v[216:219], v[44:47], v[52:55], v[216:219]
    v_mfma_f32_16x16x32_bf16 v[220:223], v[44:47], v[56:59], v[220:223]
    v_mfma_f32_16x16x32_bf16 v[224:227], v[48:51], v[52:55], v[224:227]
    v_mfma_f32_16x16x32_bf16 v[228:231], v[48:51], v[56:59], v[228:231]
    s_waitcnt lgkmcnt(0)
    s_barrier
    ds_read_b128 v[52:55], v8 offset:0
    v_mfma_f32_16x16x32_bf16 v[160:163], v[60:63], v[96:99], v[160:163]
    ds_read_b128 v[56:59], v8 offset:2048
    v_mfma_f32_16x16x32_bf16 v[164:167], v[60:63], v[100:103], v[164:167]
    ds_read_b128 v[16:19], v5 offset:0
    v_mfma_f32_16x16x32_bf16 v[168:171], v[64:67], v[96:99], v[168:171]
    ds_read_b128 v[20:23], v5 offset:1024
    v_mfma_f32_16x16x32_bf16 v[172:175], v[64:67], v[100:103], v[172:175]
    ds_read_b128 v[24:27], v5 offset:2048
    v_mfma_f32_16x16x32_bf16 v[176:179], v[68:71], v[96:99], v[176:179]
    ds_read_b128 v[28:31], v5 offset:3072
    v_mfma_f32_16x16x32_bf16 v[180:183], v[68:71], v[100:103], v[180:183]
    ds_read_b128 v[32:35], v5 offset:4096
    v_mfma_f32_16x16x32_bf16 v[184:187], v[72:75], v[96:99], v[184:187]
    ds_read_b128 v[36:39], v5 offset:5120
    v_mfma_f32_16x16x32_bf16 v[188:191], v[72:75], v[100:103], v[188:191]
    ds_read_b128 v[40:43], v5 offset:6144
    v_mfma_f32_16x16x32_bf16 v[192:195], v[76:79], v[96:99], v[192:195]
    ds_read_b128 v[44:47], v5 offset:7168
    v_mfma_f32_16x16x32_bf16 v[196:199], v[76:79], v[100:103], v[196:199]
    ds_read_b128 v[48:51], v5 offset:8192
    v_mfma_f32_16x16x32_bf16 v[200:203], v[80:83], v[96:99], v[200:203]
    v_mfma_f32_16x16x32_bf16 v[204:207], v[80:83], v[100:103], v[204:207]
    v_mfma_f32_16x16x32_bf16 v[208:211], v[84:87], v[96:99], v[208:211]
    v_mfma_f32_16x16x32_bf16 v[212:215], v[84:87], v[100:103], v[212:215]
    v_mfma_f32_16x16x32_bf16 v[216:219], v[88:91], v[96:99], v[216:219]
    v_mfma_f32_16x16x32_bf16 v[220:223], v[88:91], v[100:103], v[220:223]
    v_mfma_f32_16x16x32_bf16 v[224:227], v[92:95], v[96:99], v[224:227]
    v_mfma_f32_16x16x32_bf16 v[228:231], v[92:95], v[100:103], v[228:231]
    s_waitcnt lgkmcnt(0)
    ds_read_b128 v[96:99], v9 offset:0
    v_mfma_f32_16x16x32_bf16 v[160:163], v[16:19], v[52:55], v[160:163]
    ds_read_b128 v[100:103], v9 offset:2048
    v_mfma_f32_16x16x32_bf16 v[164:167], v[16:19], v[56:59], v[164:167]
    ds_read_b128 v[60:63], v5 offset:9216
    v_mfma_f32_16x16x32_bf16 v[168:171], v[20:23], v[52:55], v[168:171]
    ds_read_b128 v[64:67], v5 offset:10240
    v_mfma_f32_16x16x32_bf16 v[172:175], v[20:23], v[56:59], v[172:175]
    ds_read_b128 v[68:71], v5 offset:11264
    v_mfma_f32_16x16x32_bf16 v[176:179], v[24:27], v[52:55], v[176:179]
    ds_read_b128 v[72:75], v5 offset:12288
    v_mfma_f32_16x16x32_bf16 v[180:183], v[24:27], v[56:59], v[180:183]
    ds_read_b128 v[76:79], v5 offset:13312
    v_mfma_f32_16x16x32_bf16 v[184:187], v[28:31], v[52:55], v[184:187]
    ds_read_b128 v[80:83], v5 offset:14336
    v_mfma_f32_16x16x32_bf16 v[188:191], v[28:31], v[56:59], v[188:191]
    ds_read_b128 v[84:87], v5 offset:15360
    v_mfma_f32_16x16x32_bf16 v[192:195], v[32:35], v[52:55], v[192:195]
    ds_read_b128 v[88:91], v5 offset:16384
    v_mfma_f32_16x16x32_bf16 v[196:199], v[32:35], v[56:59], v[196:199]
    ds_read_b128 v[92:95], v5 offset:17408
    v_mfma_f32_16x16x32_bf16 v[200:203], v[36:39], v[52:55], v[200:203]
    v_mfma_f32_16x16x32_bf16 v[204:207], v[36:39], v[56:59], v[204:207]
    v_mfma_f32_16x16x32_bf16 v[208:211], v[40:43], v[52:55], v[208:211]
    v_mfma_f32_16x16x32_bf16 v[212:215], v[40:43], v[56:59], v[212:215]
    v_mfma_f32_16x16x32_bf16 v[216:219], v[44:47], v[52:55], v[216:219]
    v_mfma_f32_16x16x32_bf16 v[220:223], v[44:47], v[56:59], v[220:223]
    v_mfma_f32_16x16x32_bf16 v[224:227], v[48:51], v[52:55], v[224:227]
    v_mfma_f32_16x16x32_bf16 v[228:231], v[48:51], v[56:59], v[228:231]
    s_waitcnt lgkmcnt(0)
    s_barrier
    ds_read_b128 v[52:55], v8 offset:34816
    v_mfma_f32_16x16x32_bf16 v[160:163], v[60:63], v[96:99], v[160:163]
    ds_read_b128 v[56:59], v8 offset:36864
    v_mfma_f32_16x16x32_bf16 v[164:167], v[60:63], v[100:103], v[164:167]
    ds_read_b128 v[16:19], v5 offset:34816
    v_mfma_f32_16x16x32_bf16 v[168:171], v[64:67], v[96:99], v[168:171]
    ds_read_b128 v[20:23], v5 offset:35840
    v_mfma_f32_16x16x32_bf16 v[172:175], v[64:67], v[100:103], v[172:175]
    ds_read_b128 v[24:27], v5 offset:36864
    v_mfma_f32_16x16x32_bf16 v[176:179], v[68:71], v[96:99], v[176:179]
    ds_read_b128 v[28:31], v5 offset:37888
    v_mfma_f32_16x16x32_bf16 v[180:183], v[68:71], v[100:103], v[180:183]
    ds_read_b128 v[32:35], v5 offset:38912
    v_mfma_f32_16x16x32_bf16 v[184:187], v[72:75], v[96:99], v[184:187]
    ds_read_b128 v[36:39], v5 offset:39936
    v_mfma_f32_16x16x32_bf16 v[188:191], v[72:75], v[100:103], v[188:191]
    ds_read_b128 v[40:43], v5 offset:40960
    v_mfma_f32_16x16x32_bf16 v[192:195], v[76:79], v[96:99], v[192:195]
    ds_read_b128 v[44:47], v5 offset:41984
    v_mfma_f32_16x16x32_bf16 v[196:199], v[76:79], v[100:103], v[196:199]
    ds_read_b128 v[48:51], v5 offset:43008
    v_mfma_f32_16x16x32_bf16 v[200:203], v[80:83], v[96:99], v[200:203]
    v_mfma_f32_16x16x32_bf16 v[204:207], v[80:83], v[100:103], v[204:207]
    v_mfma_f32_16x16x32_bf16 v[208:211], v[84:87], v[96:99], v[208:211]
    v_mfma_f32_16x16x32_bf16 v[212:215], v[84:87], v[100:103], v[212:215]
    v_mfma_f32_16x16x32_bf16 v[216:219], v[88:91], v[96:99], v[216:219]
    v_mfma_f32_16x16x32_bf16 v[220:223], v[88:91], v[100:103], v[220:223]
    v_mfma_f32_16x16x32_bf16 v[224:227], v[92:95], v[96:99], v[224:227]
    v_mfma_f32_16x16x32_bf16 v[228:231], v[92:95], v[100:103], v[228:231]
    s_waitcnt lgkmcnt(0)
    ds_read_b128 v[96:99], v9 offset:34816
    v_mfma_f32_16x16x32_bf16 v[160:163], v[16:19], v[52:55], v[160:163]
    ds_read_b128 v[100:103], v9 offset:36864
    v_mfma_f32_16x16x32_bf16 v[164:167], v[16:19], v[56:59], v[164:167]
    ds_read_b128 v[60:63], v5 offset:44032
    v_mfma_f32_16x16x32_bf16 v[168:171], v[20:23], v[52:55], v[168:171]
    ds_read_b128 v[64:67], v5 offset:45056
    v_mfma_f32_16x16x32_bf16 v[172:175], v[20:23], v[56:59], v[172:175]
    ds_read_b128 v[68:71], v5 offset:46080
    v_mfma_f32_16x16x32_bf16 v[176:179], v[24:27], v[52:55], v[176:179]
    ds_read_b128 v[72:75], v5 offset:47104
    v_mfma_f32_16x16x32_bf16 v[180:183], v[24:27], v[56:59], v[180:183]
    ds_read_b128 v[76:79], v5 offset:48128
    v_mfma_f32_16x16x32_bf16 v[184:187], v[28:31], v[52:55], v[184:187]
    ds_read_b128 v[80:83], v5 offset:49152
    v_mfma_f32_16x16x32_bf16 v[188:191], v[28:31], v[56:59], v[188:191]
    ds_read_b128 v[84:87], v5 offset:50176
    v_mfma_f32_16x16x32_bf16 v[192:195], v[32:35], v[52:55], v[192:195]
    ds_read_b128 v[88:91], v5 offset:51200
    v_mfma_f32_16x16x32_bf16 v[196:199], v[32:35], v[56:59], v[196:199]
    ds_read_b128 v[92:95], v5 offset:52224
    v_mfma_f32_16x16x32_bf16 v[200:203], v[36:39], v[52:55], v[200:203]
    v_mfma_f32_16x16x32_bf16 v[204:207], v[36:39], v[56:59], v[204:207]
    v_mfma_f32_16x16x32_bf16 v[208:211], v[40:43], v[52:55], v[208:211]
    v_mfma_f32_16x16x32_bf16 v[212:215], v[40:43], v[56:59], v[212:215]
    v_mfma_f32_16x16x32_bf16 v[216:219], v[44:47], v[52:55], v[216:219]
    v_mfma_f32_16x16x32_bf16 v[220:223], v[44:47], v[56:59], v[220:223]
    v_mfma_f32_16x16x32_bf16 v[224:227], v[48:51], v[52:55], v[224:227]
    v_mfma_f32_16x16x32_bf16 v[228:231], v[48:51], v[56:59], v[228:231]
    s_waitcnt lgkmcnt(0)
    s_barrier
    ds_read_b128 v[52:55], v6 offset:0
    v_mfma_f32_16x16x32_bf16 v[160:163], v[60:63], v[96:99], v[160:163]
    ds_read_b128 v[56:59], v6 offset:2048
    v_mfma_f32_16x16x32_bf16 v[164:167], v[60:63], v[100:103], v[164:167]
    ds_read_b128 v[16:19], v4 offset:0
    v_mfma_f32_16x16x32_bf16 v[168:171], v[64:67], v[96:99], v[168:171]
    ds_read_b128 v[20:23], v4 offset:1024
    v_mfma_f32_16x16x32_bf16 v[172:175], v[64:67], v[100:103], v[172:175]
    ds_read_b128 v[24:27], v4 offset:2048
    v_mfma_f32_16x16x32_bf16 v[176:179], v[68:71], v[96:99], v[176:179]
    ds_read_b128 v[28:31], v4 offset:3072
    v_mfma_f32_16x16x32_bf16 v[180:183], v[68:71], v[100:103], v[180:183]
    ds_read_b128 v[32:35], v4 offset:4096
    v_mfma_f32_16x16x32_bf16 v[184:187], v[72:75], v[96:99], v[184:187]
    ds_read_b128 v[36:39], v4 offset:5120
    v_mfma_f32_16x16x32_bf16 v[188:191], v[72:75], v[100:103], v[188:191]
    ds_read_b128 v[40:43], v4 offset:6144
    v_mfma_f32_16x16x32_bf16 v[192:195], v[76:79], v[96:99], v[192:195]
    ds_read_b128 v[44:47], v4 offset:7168
    v_mfma_f32_16x16x32_bf16 v[196:199], v[76:79], v[100:103], v[196:199]
    ds_read_b128 v[48:51], v4 offset:8192
    v_mfma_f32_16x16x32_bf16 v[200:203], v[80:83], v[96:99], v[200:203]
    v_mfma_f32_16x16x32_bf16 v[204:207], v[80:83], v[100:103], v[204:207]
    v_mfma_f32_16x16x32_bf16 v[208:211], v[84:87], v[96:99], v[208:211]
    v_mfma_f32_16x16x32_bf16 v[212:215], v[84:87], v[100:103], v[212:215]
    v_mfma_f32_16x16x32_bf16 v[216:219], v[88:91], v[96:99], v[216:219]
    v_mfma_f32_16x16x32_bf16 v[220:223], v[88:91], v[100:103], v[220:223]
    v_mfma_f32_16x16x32_bf16 v[224:227], v[92:95], v[96:99], v[224:227]
    v_mfma_f32_16x16x32_bf16 v[228:231], v[92:95], v[100:103], v[228:231]
    s_waitcnt lgkmcnt(0)
    ds_read_b128 v[96:99], v7 offset:0
    v_mfma_f32_16x16x32_bf16 v[160:163], v[16:19], v[52:55], v[160:163]
    ds_read_b128 v[100:103], v7 offset:2048
    v_mfma_f32_16x16x32_bf16 v[164:167], v[16:19], v[56:59], v[164:167]
    ds_read_b128 v[60:63], v4 offset:9216
    v_mfma_f32_16x16x32_bf16 v[168:171], v[20:23], v[52:55], v[168:171]
    ds_read_b128 v[64:67], v4 offset:10240
    v_mfma_f32_16x16x32_bf16 v[172:175], v[20:23], v[56:59], v[172:175]
    ds_read_b128 v[68:71], v4 offset:11264
    v_mfma_f32_16x16x32_bf16 v[176:179], v[24:27], v[52:55], v[176:179]
    ds_read_b128 v[72:75], v4 offset:12288
    v_mfma_f32_16x16x32_bf16 v[180:183], v[24:27], v[56:59], v[180:183]
    ds_read_b128 v[76:79], v4 offset:13312
    v_mfma_f32_16x16x32_bf16 v[184:187], v[28:31], v[52:55], v[184:187]
    ds_read_b128 v[80:83], v4 offset:14336
    v_mfma_f32_16x16x32_bf16 v[188:191], v[28:31], v[56:59], v[188:191]
    ds_read_b128 v[84:87], v4 offset:15360
    v_mfma_f32_16x16x32_bf16 v[192:195], v[32:35], v[52:55], v[192:195]
    ds_read_b128 v[88:91], v4 offset:16384
    v_mfma_f32_16x16x32_bf16 v[196:199], v[32:35], v[56:59], v[196:199]
    ds_read_b128 v[92:95], v4 offset:17408
    v_mfma_f32_16x16x32_bf16 v[200:203], v[36:39], v[52:55], v[200:203]
    v_mfma_f32_16x16x32_bf16 v[204:207], v[36:39], v[56:59], v[204:207]
    v_mfma_f32_16x16x32_bf16 v[208:211], v[40:43], v[52:55], v[208:211]
    v_mfma_f32_16x16x32_bf16 v[212:215], v[40:43], v[56:59], v[212:215]
    v_mfma_f32_16x16x32_bf16 v[216:219], v[44:47], v[52:55], v[216:219]
    v_mfma_f32_16x16x32_bf16 v[220:223], v[44:47], v[56:59], v[220:223]
    v_mfma_f32_16x16x32_bf16 v[224:227], v[48:51], v[52:55], v[224:227]
    v_mfma_f32_16x16x32_bf16 v[228:231], v[48:51], v[56:59], v[228:231]
    s_waitcnt lgkmcnt(0)
    s_barrier
    ds_read_b128 v[52:55], v6 offset:34816
    v_mfma_f32_16x16x32_bf16 v[160:163], v[60:63], v[96:99], v[160:163]
    ds_read_b128 v[56:59], v6 offset:36864
    v_mfma_f32_16x16x32_bf16 v[164:167], v[60:63], v[100:103], v[164:167]
    ds_read_b128 v[16:19], v4 offset:34816
    v_mfma_f32_16x16x32_bf16 v[168:171], v[64:67], v[96:99], v[168:171]
    ds_read_b128 v[20:23], v4 offset:35840
    v_mfma_f32_16x16x32_bf16 v[172:175], v[64:67], v[100:103], v[172:175]
    ds_read_b128 v[24:27], v4 offset:36864
    v_mfma_f32_16x16x32_bf16 v[176:179], v[68:71], v[96:99], v[176:179]
    ds_read_b128 v[104:107], v159 offset:0
    ds_read_b128 v[28:31], v4 offset:37888
    v_mfma_f32_16x16x32_bf16 v[180:183], v[68:71], v[100:103], v[180:183]
    ds_read_b128 v[120:123], v158 offset:0
    ds_read_b128 v[32:35], v4 offset:38912
    v_mfma_f32_16x16x32_bf16 v[184:187], v[72:75], v[96:99], v[184:187]
    ds_read_b128 v[108:111], v159 offset:1024
    ds_read_b128 v[36:39], v4 offset:39936
    v_mfma_f32_16x16x32_bf16 v[188:191], v[72:75], v[100:103], v[188:191]
    ds_read_b128 v[124:127], v158 offset:1024
    ds_read_b128 v[40:43], v4 offset:40960
    v_mfma_f32_16x16x32_bf16 v[192:195], v[76:79], v[96:99], v[192:195]
    ds_read_b128 v[112:115], v159 offset:2048
    ds_read_b128 v[44:47], v4 offset:41984
    v_mfma_f32_16x16x32_bf16 v[196:199], v[76:79], v[100:103], v[196:199]
    ds_read_b128 v[128:131], v158 offset:2048
    ds_read_b128 v[48:51], v4 offset:43008
    v_mfma_f32_16x16x32_bf16 v[200:203], v[80:83], v[96:99], v[200:203]
    ds_read_b128 v[116:119], v159 offset:3072
    ds_read_b128 v[132:135], v158 offset:3072
    v_mfma_f32_16x16x32_bf16 v[204:207], v[80:83], v[100:103], v[204:207]
    v_mfma_f32_16x16x32_bf16 v[208:211], v[84:87], v[96:99], v[208:211]
    v_mfma_f32_16x16x32_bf16 v[212:215], v[84:87], v[100:103], v[212:215]
    v_mfma_f32_16x16x32_bf16 v[216:219], v[88:91], v[96:99], v[216:219]
    v_mfma_f32_16x16x32_bf16 v[220:223], v[88:91], v[100:103], v[220:223]
    v_mfma_f32_16x16x32_bf16 v[224:227], v[92:95], v[96:99], v[224:227]
    v_mfma_f32_16x16x32_bf16 v[228:231], v[92:95], v[100:103], v[228:231]
    s_waitcnt lgkmcnt(0)
    ds_read_b128 v[96:99], v7 offset:34816
    v_mfma_f32_16x16x32_bf16 v[160:163], v[16:19], v[52:55], v[160:163]
    ds_read_b128 v[100:103], v7 offset:36864
    v_mfma_f32_16x16x32_bf16 v[164:167], v[16:19], v[56:59], v[164:167]
    ds_read_b128 v[60:63], v4 offset:44032
    v_mfma_f32_16x16x32_bf16 v[168:171], v[20:23], v[52:55], v[168:171]
    ds_read_b128 v[64:67], v4 offset:45056
    v_mfma_f32_16x16x32_bf16 v[172:175], v[20:23], v[56:59], v[172:175]
    ds_read_b128 v[68:71], v4 offset:46080
    v_mfma_f32_16x16x32_bf16 v[176:179], v[24:27], v[52:55], v[176:179]
    v_mfma_f32_32x32x16_bf16 v[136:151], v[104:107], v[120:123], 0
    ds_read_b128 v[72:75], v4 offset:47104
    v_mfma_f32_16x16x32_bf16 v[180:183], v[24:27], v[56:59], v[180:183]
    v_mfma_f32_32x32x16_bf16 v[232:247], v[112:115], v[120:123], 0
    ds_read_b128 v[76:79], v4 offset:48128
    v_mfma_f32_16x16x32_bf16 v[184:187], v[28:31], v[52:55], v[184:187]
    v_mfma_f32_32x32x16_bf16 v[136:151], v[108:111], v[124:127], v[136:151]
    ds_read_b128 v[80:83], v4 offset:49152
    v_mfma_f32_16x16x32_bf16 v[188:191], v[28:31], v[56:59], v[188:191]
    v_mfma_f32_32x32x16_bf16 v[232:247], v[116:119], v[124:127], v[232:247]
    ds_read_b128 v[84:87], v4 offset:50176
    v_mfma_f32_16x16x32_bf16 v[192:195], v[32:35], v[52:55], v[192:195]
    ds_read_b128 v[88:91], v4 offset:51200
    v_mfma_f32_16x16x32_bf16 v[196:199], v[32:35], v[56:59], v[196:199]
    ds_read_b128 v[92:95], v4 offset:52224
    v_mfma_f32_16x16x32_bf16 v[200:203], v[36:39], v[52:55], v[200:203]
    v_mfma_f32_16x16x32_bf16 v[204:207], v[36:39], v[56:59], v[204:207]
    v_mfma_f32_16x16x32_bf16 v[208:211], v[40:43], v[52:55], v[208:211]
    v_mfma_f32_16x16x32_bf16 v[212:215], v[40:43], v[56:59], v[212:215]
    v_mfma_f32_16x16x32_bf16 v[216:219], v[44:47], v[52:55], v[216:219]
    v_mfma_f32_16x16x32_bf16 v[220:223], v[44:47], v[56:59], v[220:223]
    v_mfma_f32_16x16x32_bf16 v[224:227], v[48:51], v[52:55], v[224:227]
    v_mfma_f32_16x16x32_bf16 v[228:231], v[48:51], v[56:59], v[228:231]
    s_waitcnt lgkmcnt(0)
    s_barrier
    ds_read_b128 v[52:55], v8 offset:0
    v_mfma_f32_16x16x32_bf16 v[160:163], v[60:63], v[96:99], v[160:163]
    ds_read_b128 v[56:59], v8 offset:2048
    v_mfma_f32_16x16x32_bf16 v[164:167], v[60:63], v[100:103], v[164:167]
    ds_read_b128 v[16:19], v5 offset:0
    v_mfma_f32_16x16x32_bf16 v[168:171], v[64:67], v[96:99], v[168:171]
    ds_read_b128 v[20:23], v5 offset:1024
    v_mfma_f32_16x16x32_bf16 v[172:175], v[64:67], v[100:103], v[172:175]
    ds_read_b128 v[24:27], v5 offset:2048
    v_mfma_f32_16x16x32_bf16 v[176:179], v[68:71], v[96:99], v[176:179]
    s_cmp_eq_u32 s54, 1
    s_cselect_b64 vcc, -1, 0
    ds_read_b128 v[28:31], v5 offset:3072
    v_mfma_f32_16x16x32_bf16 v[180:183], v[68:71], v[100:103], v[180:183]
    v_cndmask_b32 v232, v232, v234, vcc
    ds_read_b128 v[32:35], v5 offset:4096
    v_mfma_f32_16x16x32_bf16 v[184:187], v[72:75], v[96:99], v[184:187]
    v_cndmask_b32 v233, v233, v235, vcc
    ds_read_b128 v[36:39], v5 offset:5120
    v_mfma_f32_16x16x32_bf16 v[188:191], v[72:75], v[100:103], v[188:191]
    s_cmp_eq_u32 s54, 2
    s_cselect_b64 vcc, -1, 0
    ds_read_b128 v[40:43], v5 offset:6144
    v_mfma_f32_16x16x32_bf16 v[192:195], v[76:79], v[96:99], v[192:195]
    v_cndmask_b32 v232, v232, v236, vcc
    ds_read_b128 v[44:47], v5 offset:7168
    v_mfma_f32_16x16x32_bf16 v[196:199], v[76:79], v[100:103], v[196:199]
    v_cndmask_b32 v233, v233, v237, vcc
    ds_read_b128 v[48:51], v5 offset:8192
    v_mfma_f32_16x16x32_bf16 v[200:203], v[80:83], v[96:99], v[200:203]
    s_cmp_eq_u32 s54, 3
    s_cselect_b64 vcc, -1, 0
    v_cndmask_b32 v232, v232, v238, vcc
    v_mfma_f32_16x16x32_bf16 v[204:207], v[80:83], v[100:103], v[204:207]
    v_cndmask_b32 v233, v233, v239, vcc
    v_mov_b32 v158, v232
    v_mfma_f32_16x16x32_bf16 v[208:211], v[84:87], v[96:99], v[208:211]
    v_mov_b32 v159, v233
    ds_read_b64 v[232:233], v252
    v_mfma_f32_16x16x32_bf16 v[212:215], v[84:87], v[100:103], v[212:215]
    ds_read_b64 v[234:235], v252 offset:8
    ds_read_b64 v[236:237], v252 offset:16
    v_mfma_f32_16x16x32_bf16 v[216:219], v[88:91], v[96:99], v[216:219]
    ds_read_b64 v[238:239], v252 offset:24
    ds_read_b32 v240, v252 offset:32
    v_mfma_f32_16x16x32_bf16 v[220:223], v[88:91], v[100:103], v[220:223]
    v_mov_b32 v241, 0
    v_mov_b32 v242, 0
    v_mfma_f32_16x16x32_bf16 v[224:227], v[92:95], v[96:99], v[224:227]
    v_mov_b32 v243, 0
    v_max3_f32 v248, v136, v137, v138
    v_mfma_f32_16x16x32_bf16 v[228:231], v[92:95], v[100:103], v[228:231]
    v_max3_f32 v249, v139, v140, v141
    v_max3_f32 v248, v248, v142, v143
    s_waitcnt lgkmcnt(0)
    ds_read_b128 v[96:99], v9 offset:0
    v_mfma_f32_16x16x32_bf16 v[160:163], v[16:19], v[52:55], v[160:163]
    ds_read_b128 v[100:103], v9 offset:2048
    v_mfma_f32_16x16x32_bf16 v[164:167], v[16:19], v[56:59], v[164:167]
    ds_read_b128 v[60:63], v5 offset:9216
    v_mfma_f32_16x16x32_bf16 v[168:171], v[20:23], v[52:55], v[168:171]
    ds_read_b128 v[64:67], v5 offset:10240
    v_mfma_f32_16x16x32_bf16 v[172:175], v[20:23], v[56:59], v[172:175]
    ds_read_b128 v[68:71], v5 offset:11264
    v_mfma_f32_16x16x32_bf16 v[176:179], v[24:27], v[52:55], v[176:179]
    v_max3_f32 v249, v249, v144, v145
    ds_read_b128 v[72:75], v5 offset:12288
    v_mfma_f32_16x16x32_bf16 v[180:183], v[24:27], v[56:59], v[180:183]
    v_max3_f32 v248, v248, v146, v147
    ds_read_b128 v[76:79], v5 offset:13312
    v_mfma_f32_16x16x32_bf16 v[184:187], v[28:31], v[52:55], v[184:187]
    v_max3_f32 v249, v249, v148, v149
    ds_read_b128 v[80:83], v5 offset:14336
    v_mfma_f32_16x16x32_bf16 v[188:191], v[28:31], v[56:59], v[188:191]
    v_max3_f32 v248, v248, v150, v151
    ds_read_b128 v[84:87], v5 offset:15360
    v_mfma_f32_16x16x32_bf16 v[192:195], v[32:35], v[52:55], v[192:195]
    v_max3_f32 v249, v249, v158, v159
    ds_read_b128 v[88:91], v5 offset:16384
    v_mfma_f32_16x16x32_bf16 v[196:199], v[32:35], v[56:59], v[196:199]
    v_max_f32 v248, v248, v249
    ds_read_b128 v[92:95], v5 offset:17408
    v_mfma_f32_16x16x32_bf16 v[200:203], v[36:39], v[52:55], v[200:203]
    v_mul_f32 v248, s45, v248
    v_fma_f32 v136, v136, s45, -v248
    v_mfma_f32_16x16x32_bf16 v[204:207], v[36:39], v[56:59], v[204:207]
    v_fma_f32 v137, v137, s45, -v248
    v_fma_f32 v138, v138, s45, -v248
    v_mfma_f32_16x16x32_bf16 v[208:211], v[40:43], v[52:55], v[208:211]
    v_fma_f32 v139, v139, s45, -v248
    v_fma_f32 v140, v140, s45, -v248
    v_mfma_f32_16x16x32_bf16 v[212:215], v[40:43], v[56:59], v[212:215]
    v_fma_f32 v141, v141, s45, -v248
    v_fma_f32 v142, v142, s45, -v248
    v_mfma_f32_16x16x32_bf16 v[216:219], v[44:47], v[52:55], v[216:219]
    v_fma_f32 v143, v143, s45, -v248
    v_fma_f32 v144, v144, s45, -v248
    v_mfma_f32_16x16x32_bf16 v[220:223], v[44:47], v[56:59], v[220:223]
    v_fma_f32 v145, v145, s45, -v248
    v_fma_f32 v146, v146, s45, -v248
    v_mfma_f32_16x16x32_bf16 v[224:227], v[48:51], v[52:55], v[224:227]
    v_fma_f32 v147, v147, s45, -v248
    v_fma_f32 v148, v148, s45, -v248
    v_mfma_f32_16x16x32_bf16 v[228:231], v[48:51], v[56:59], v[228:231]
    v_fma_f32 v149, v149, s45, -v248
    v_fma_f32 v150, v150, s45, -v248
    s_waitcnt lgkmcnt(0)
    s_barrier
    ds_read_b128 v[52:55], v8 offset:34816
    v_mfma_f32_16x16x32_bf16 v[160:163], v[60:63], v[96:99], v[160:163]
    ds_read_b128 v[56:59], v8 offset:36864
    v_mfma_f32_16x16x32_bf16 v[164:167], v[60:63], v[100:103], v[164:167]
    ds_read_b128 v[16:19], v5 offset:34816
    v_mfma_f32_16x16x32_bf16 v[168:171], v[64:67], v[96:99], v[168:171]
    ds_read_b128 v[20:23], v5 offset:35840
    v_mfma_f32_16x16x32_bf16 v[172:175], v[64:67], v[100:103], v[172:175]
    ds_read_b128 v[24:27], v5 offset:36864
    v_mfma_f32_16x16x32_bf16 v[176:179], v[68:71], v[96:99], v[176:179]
    v_fma_f32 v151, v151, s45, -v248
    ds_read_b128 v[28:31], v5 offset:37888
    v_mfma_f32_16x16x32_bf16 v[180:183], v[68:71], v[100:103], v[180:183]
    v_fma_f32 v158, v158, s45, -v248
    ds_read_b128 v[32:35], v5 offset:38912
    v_mfma_f32_16x16x32_bf16 v[184:187], v[72:75], v[96:99], v[184:187]
    v_fma_f32 v159, v159, s45, -v248
    ds_read_b128 v[36:39], v5 offset:39936
    v_mfma_f32_16x16x32_bf16 v[188:191], v[72:75], v[100:103], v[188:191]
    v_exp_f32 v136, v136
    ds_read_b128 v[40:43], v5 offset:40960
    v_mfma_f32_16x16x32_bf16 v[192:195], v[76:79], v[96:99], v[192:195]
    v_exp_f32 v137, v137
    ds_read_b128 v[44:47], v5 offset:41984
    v_mfma_f32_16x16x32_bf16 v[196:199], v[76:79], v[100:103], v[196:199]
    v_exp_f32 v138, v138
    ds_read_b128 v[48:51], v5 offset:43008
    v_mfma_f32_16x16x32_bf16 v[200:203], v[80:83], v[96:99], v[200:203]
    v_exp_f32 v139, v139
    v_mfma_f32_16x16x32_bf16 v[204:207], v[80:83], v[100:103], v[204:207]
    v_exp_f32 v140, v140
    v_mfma_f32_16x16x32_bf16 v[208:211], v[84:87], v[96:99], v[208:211]
    v_exp_f32 v141, v141
    v_mfma_f32_16x16x32_bf16 v[212:215], v[84:87], v[100:103], v[212:215]
    v_exp_f32 v142, v142
    v_mfma_f32_16x16x32_bf16 v[216:219], v[88:91], v[96:99], v[216:219]
    v_exp_f32 v143, v143
    v_mfma_f32_16x16x32_bf16 v[220:223], v[88:91], v[100:103], v[220:223]
    v_exp_f32 v144, v144
    v_mfma_f32_16x16x32_bf16 v[224:227], v[92:95], v[96:99], v[224:227]
    v_exp_f32 v145, v145
    v_mfma_f32_16x16x32_bf16 v[228:231], v[92:95], v[100:103], v[228:231]
    v_exp_f32 v146, v146
    s_waitcnt lgkmcnt(0)
    ds_read_b128 v[96:99], v9 offset:34816
    v_mfma_f32_16x16x32_bf16 v[160:163], v[16:19], v[52:55], v[160:163]
    ds_read_b128 v[100:103], v9 offset:36864
    v_mfma_f32_16x16x32_bf16 v[164:167], v[16:19], v[56:59], v[164:167]
    ds_read_b128 v[60:63], v5 offset:44032
    v_mfma_f32_16x16x32_bf16 v[168:171], v[20:23], v[52:55], v[168:171]
    ds_read_b128 v[64:67], v5 offset:45056
    v_mfma_f32_16x16x32_bf16 v[172:175], v[20:23], v[56:59], v[172:175]
    ds_read_b128 v[68:71], v5 offset:46080
    v_mfma_f32_16x16x32_bf16 v[176:179], v[24:27], v[52:55], v[176:179]
    v_exp_f32 v147, v147
    ds_read_b128 v[72:75], v5 offset:47104
    v_mfma_f32_16x16x32_bf16 v[180:183], v[24:27], v[56:59], v[180:183]
    v_exp_f32 v148, v148
    ds_read_b128 v[76:79], v5 offset:48128
    v_mfma_f32_16x16x32_bf16 v[184:187], v[28:31], v[52:55], v[184:187]
    v_exp_f32 v149, v149
    ds_read_b128 v[80:83], v5 offset:49152
    v_mfma_f32_16x16x32_bf16 v[188:191], v[28:31], v[56:59], v[188:191]
    v_exp_f32 v150, v150
    ds_read_b128 v[84:87], v5 offset:50176
    v_mfma_f32_16x16x32_bf16 v[192:195], v[32:35], v[52:55], v[192:195]
    v_exp_f32 v151, v151
    ds_read_b128 v[88:91], v5 offset:51200
    v_mfma_f32_16x16x32_bf16 v[196:199], v[32:35], v[56:59], v[196:199]
    v_exp_f32 v158, v158
    ds_read_b128 v[92:95], v5 offset:52224
    v_mfma_f32_16x16x32_bf16 v[200:203], v[36:39], v[52:55], v[200:203]
    v_exp_f32 v159, v159
    v_mfma_f32_16x16x32_bf16 v[204:207], v[36:39], v[56:59], v[204:207]
    v_add_f32 v249, v136, v137
    v_add_f32 v250, v138, v139
    v_mfma_f32_16x16x32_bf16 v[208:211], v[40:43], v[52:55], v[208:211]
    v_add_f32 v249, v249, v140
    v_add_f32 v250, v250, v141
    v_mfma_f32_16x16x32_bf16 v[212:215], v[40:43], v[56:59], v[212:215]
    v_add_f32 v249, v249, v142
    v_add_f32 v250, v250, v143
    v_mfma_f32_16x16x32_bf16 v[216:219], v[44:47], v[52:55], v[216:219]
    v_add_f32 v249, v249, v144
    v_add_f32 v250, v250, v145
    v_mfma_f32_16x16x32_bf16 v[220:223], v[44:47], v[56:59], v[220:223]
    v_add_f32 v249, v249, v146
    v_add_f32 v250, v250, v147
    v_mfma_f32_16x16x32_bf16 v[224:227], v[48:51], v[52:55], v[224:227]
    v_add_f32 v249, v249, v148
    v_add_f32 v250, v250, v149
    v_mfma_f32_16x16x32_bf16 v[228:231], v[48:51], v[56:59], v[228:231]
    v_add_f32 v249, v249, v150
    v_add_f32 v250, v250, v151
    s_waitcnt lgkmcnt(0)
    s_barrier
    ds_read_b128 v[52:55], v6 offset:0
    v_mfma_f32_16x16x32_bf16 v[160:163], v[60:63], v[96:99], v[160:163]
    ds_read_b128 v[56:59], v6 offset:2048
    v_mfma_f32_16x16x32_bf16 v[164:167], v[60:63], v[100:103], v[164:167]
    ds_read_b128 v[16:19], v4 offset:0
    v_mfma_f32_16x16x32_bf16 v[168:171], v[64:67], v[96:99], v[168:171]
    ds_read_b128 v[20:23], v4 offset:1024
    v_mfma_f32_16x16x32_bf16 v[172:175], v[64:67], v[100:103], v[172:175]
    ds_read_b128 v[24:27], v4 offset:2048
    v_mfma_f32_16x16x32_bf16 v[176:179], v[68:71], v[96:99], v[176:179]
    v_add_f32 v249, v249, v158
    ds_read_b128 v[28:31], v4 offset:3072
    v_mfma_f32_16x16x32_bf16 v[180:183], v[68:71], v[100:103], v[180:183]
    v_add_f32 v250, v250, v159
    ds_read_b128 v[32:35], v4 offset:4096
    v_mfma_f32_16x16x32_bf16 v[184:187], v[72:75], v[96:99], v[184:187]
    v_add_f32 v249, v249, v250
    ds_read_b128 v[36:39], v4 offset:5120
    v_mfma_f32_16x16x32_bf16 v[188:191], v[72:75], v[100:103], v[188:191]
    v_rcp_f32 v249, v249
    ds_read_b128 v[40:43], v4 offset:6144
    v_mfma_f32_16x16x32_bf16 v[192:195], v[76:79], v[96:99], v[192:195]
    s_nop 0
    ds_read_b128 v[44:47], v4 offset:7168
    v_mfma_f32_16x16x32_bf16 v[196:199], v[76:79], v[100:103], v[196:199]
    v_mul_f32 v136, v136, v249
    ds_read_b128 v[48:51], v4 offset:8192
    v_mfma_f32_16x16x32_bf16 v[200:203], v[80:83], v[96:99], v[200:203]
    v_mul_f32 v137, v137, v249
    v_mul_f32 v138, v138, v249
    v_mfma_f32_16x16x32_bf16 v[204:207], v[80:83], v[100:103], v[204:207]
    v_mul_f32 v139, v139, v249
    v_mul_f32 v140, v140, v249
    v_mfma_f32_16x16x32_bf16 v[208:211], v[84:87], v[96:99], v[208:211]
    v_mul_f32 v141, v141, v249
    v_mul_f32 v142, v142, v249
    v_mfma_f32_16x16x32_bf16 v[212:215], v[84:87], v[100:103], v[212:215]
    v_mul_f32 v143, v143, v249
    v_mul_f32 v144, v144, v249
    v_mfma_f32_16x16x32_bf16 v[216:219], v[88:91], v[96:99], v[216:219]
    v_mul_f32 v145, v145, v249
    v_mul_f32 v146, v146, v249
    v_mfma_f32_16x16x32_bf16 v[220:223], v[88:91], v[100:103], v[220:223]
    v_mul_f32 v147, v147, v249
    v_mul_f32 v148, v148, v249
    v_mfma_f32_16x16x32_bf16 v[224:227], v[92:95], v[96:99], v[224:227]
    v_mul_f32 v149, v149, v249
    v_mul_f32 v150, v150, v249
    v_mfma_f32_16x16x32_bf16 v[228:231], v[92:95], v[100:103], v[228:231]
    v_mul_f32 v151, v151, v249
    v_mul_f32 v158, v158, v249
    s_waitcnt lgkmcnt(0)
    ds_read_b128 v[96:99], v7 offset:0
    v_mfma_f32_16x16x32_bf16 v[160:163], v[16:19], v[52:55], v[160:163]
    ds_read_b128 v[100:103], v7 offset:2048
    v_mfma_f32_16x16x32_bf16 v[164:167], v[16:19], v[56:59], v[164:167]
    ds_read_b128 v[60:63], v4 offset:9216
    v_mfma_f32_16x16x32_bf16 v[168:171], v[20:23], v[52:55], v[168:171]
    ds_read_b128 v[64:67], v4 offset:10240
    v_mfma_f32_16x16x32_bf16 v[172:175], v[20:23], v[56:59], v[172:175]
    ds_read_b128 v[68:71], v4 offset:11264
    v_mfma_f32_16x16x32_bf16 v[176:179], v[24:27], v[52:55], v[176:179]
    v_mul_f32 v159, v159, v249
    ds_read_b128 v[72:75], v4 offset:12288
    v_mfma_f32_16x16x32_bf16 v[180:183], v[24:27], v[56:59], v[180:183]
    v_cvt_pk_bf16_f32 v120, v136, v137
    ds_read_b128 v[76:79], v4 offset:13312
    v_mfma_f32_16x16x32_bf16 v[184:187], v[28:31], v[52:55], v[184:187]
    v_cvt_pk_bf16_f32 v121, v138, v139
    ds_read_b128 v[80:83], v4 offset:14336
    v_mfma_f32_16x16x32_bf16 v[188:191], v[28:31], v[56:59], v[188:191]
    v_cvt_pk_bf16_f32 v122, v140, v141
    ds_read_b128 v[84:87], v4 offset:15360
    v_mfma_f32_16x16x32_bf16 v[192:195], v[32:35], v[52:55], v[192:195]
    v_cvt_pk_bf16_f32 v123, v142, v143
    ds_read_b128 v[88:91], v4 offset:16384
    v_mfma_f32_16x16x32_bf16 v[196:199], v[32:35], v[56:59], v[196:199]
    v_cvt_pk_bf16_f32 v124, v144, v145
    ds_read_b128 v[92:95], v4 offset:17408
    v_mfma_f32_16x16x32_bf16 v[200:203], v[36:39], v[52:55], v[200:203]
    v_cvt_pk_bf16_f32 v125, v146, v147
    v_cvt_pk_bf16_f32 v126, v148, v149
    v_mfma_f32_16x16x32_bf16 v[204:207], v[36:39], v[56:59], v[204:207]
    v_cvt_pk_bf16_f32 v127, v150, v151
    v_cvt_pk_bf16_f32 v244, v158, v159
    v_mfma_f32_16x16x32_bf16 v[208:211], v[40:43], v[52:55], v[208:211]
    v_mov_b32 v245, 0
    v_mov_b32 v246, 0
    v_mfma_f32_16x16x32_bf16 v[212:215], v[40:43], v[56:59], v[212:215]
    v_mov_b32 v247, 0
    v_mfma_f32_16x16x32_bf16 v[216:219], v[44:47], v[52:55], v[216:219]
    v_mfma_f32_16x16x32_bf16 v[220:223], v[44:47], v[56:59], v[220:223]
    v_mfma_f32_16x16x32_bf16 v[224:227], v[48:51], v[52:55], v[224:227]
    v_mfma_f32_16x16x32_bf16 v[228:231], v[48:51], v[56:59], v[228:231]
    s_waitcnt lgkmcnt(0)
    s_barrier
    ds_read_b128 v[52:55], v6 offset:34816
    v_mfma_f32_16x16x32_bf16 v[160:163], v[60:63], v[96:99], v[160:163]
    ds_read_b128 v[56:59], v6 offset:36864
    v_mfma_f32_16x16x32_bf16 v[164:167], v[60:63], v[100:103], v[164:167]
    ds_read_b128 v[16:19], v4 offset:34816
    v_mfma_f32_16x16x32_bf16 v[168:171], v[64:67], v[96:99], v[168:171]
    ds_read_b128 v[20:23], v4 offset:35840
    v_mfma_f32_16x16x32_bf16 v[172:175], v[64:67], v[100:103], v[172:175]
    ds_read_b128 v[24:27], v4 offset:36864
    v_mfma_f32_16x16x32_bf16 v[176:179], v[68:71], v[96:99], v[176:179]
    v_mfma_f32_32x32x16_bf16 v[136:151], v[232:235], v[120:123], 0
    ds_read_b128 v[28:31], v4 offset:37888
    v_mfma_f32_16x16x32_bf16 v[180:183], v[68:71], v[100:103], v[180:183]
    v_mfma_f32_32x32x16_bf16 v[136:151], v[236:239], v[124:127], v[136:151]
    ds_read_b128 v[32:35], v4 offset:38912
    v_mfma_f32_16x16x32_bf16 v[184:187], v[72:75], v[96:99], v[184:187]
    v_mfma_f32_32x32x16_bf16 v[136:151], v[240:243], v[244:247], v[136:151]
    ds_read_b128 v[36:39], v4 offset:39936
    v_mfma_f32_16x16x32_bf16 v[188:191], v[72:75], v[100:103], v[188:191]
    ds_read_b128 v[40:43], v4 offset:40960
    v_mfma_f32_16x16x32_bf16 v[192:195], v[76:79], v[96:99], v[192:195]
    ds_read_b128 v[44:47], v4 offset:41984
    v_mfma_f32_16x16x32_bf16 v[196:199], v[76:79], v[100:103], v[196:199]
    ds_read_b128 v[48:51], v4 offset:43008
    v_mfma_f32_16x16x32_bf16 v[200:203], v[80:83], v[96:99], v[200:203]
    v_mfma_f32_16x16x32_bf16 v[204:207], v[80:83], v[100:103], v[204:207]
    v_mfma_f32_16x16x32_bf16 v[208:211], v[84:87], v[96:99], v[208:211]
    v_mfma_f32_16x16x32_bf16 v[212:215], v[84:87], v[100:103], v[212:215]
    v_mfma_f32_16x16x32_bf16 v[216:219], v[88:91], v[96:99], v[216:219]
    v_mfma_f32_16x16x32_bf16 v[220:223], v[88:91], v[100:103], v[220:223]
    v_mfma_f32_16x16x32_bf16 v[224:227], v[92:95], v[96:99], v[224:227]
    v_mfma_f32_16x16x32_bf16 v[228:231], v[92:95], v[100:103], v[228:231]
    s_waitcnt lgkmcnt(0)
    ds_read_b128 v[96:99], v7 offset:34816
    v_mfma_f32_16x16x32_bf16 v[160:163], v[16:19], v[52:55], v[160:163]
    ds_read_b128 v[100:103], v7 offset:36864
    v_mfma_f32_16x16x32_bf16 v[164:167], v[16:19], v[56:59], v[164:167]
    ds_read_b128 v[60:63], v4 offset:44032
    v_mfma_f32_16x16x32_bf16 v[168:171], v[20:23], v[52:55], v[168:171]
    ds_read_b128 v[64:67], v4 offset:45056
    v_mfma_f32_16x16x32_bf16 v[172:175], v[20:23], v[56:59], v[172:175]
    ds_read_b128 v[68:71], v4 offset:46080
    v_mfma_f32_16x16x32_bf16 v[176:179], v[24:27], v[52:55], v[176:179]
    v_add_f32 v248, 897988541, v146
    ds_read_b128 v[72:75], v4 offset:47104
    v_mfma_f32_16x16x32_bf16 v[180:183], v[24:27], v[56:59], v[180:183]
    v_rcp_f32 v248, v248
    ds_read_b128 v[76:79], v4 offset:48128
    v_mfma_f32_16x16x32_bf16 v[184:187], v[28:31], v[52:55], v[184:187]
    s_nop 0
    ds_read_b128 v[80:83], v4 offset:49152
    v_mfma_f32_16x16x32_bf16 v[188:191], v[28:31], v[56:59], v[188:191]
    v_mul_f32 v136, v136, v248
    ds_read_b128 v[84:87], v4 offset:50176
    v_mfma_f32_16x16x32_bf16 v[192:195], v[32:35], v[52:55], v[192:195]
    v_mul_f32 v137, v137, v248
    ds_read_b128 v[88:91], v4 offset:51200
    v_mfma_f32_16x16x32_bf16 v[196:199], v[32:35], v[56:59], v[196:199]
    v_mul_f32 v138, v138, v248
    ds_read_b128 v[92:95], v4 offset:52224
    v_mfma_f32_16x16x32_bf16 v[200:203], v[36:39], v[52:55], v[200:203]
    v_mul_f32 v139, v139, v248
    v_mul_f32 v140, v140, v248
    v_mfma_f32_16x16x32_bf16 v[204:207], v[36:39], v[56:59], v[204:207]
    v_mul_f32 v141, v141, v248
    v_mul_f32 v142, v142, v248
    v_mfma_f32_16x16x32_bf16 v[208:211], v[40:43], v[52:55], v[208:211]
    v_mul_f32 v143, v143, v248
    v_mul_f32 v144, v144, v248
    v_mfma_f32_16x16x32_bf16 v[212:215], v[40:43], v[56:59], v[212:215]
    v_mul_f32 v145, v145, v248
    v_cvt_pk_bf16_f32 v152, v136, v137
    v_mfma_f32_16x16x32_bf16 v[216:219], v[44:47], v[52:55], v[216:219]
    v_cvt_pk_bf16_f32 v153, v138, v139
    v_cvt_pk_bf16_f32 v154, v140, v141
    v_mfma_f32_16x16x32_bf16 v[220:223], v[44:47], v[56:59], v[220:223]
    v_cvt_pk_bf16_f32 v155, v142, v143
    v_cvt_pk_bf16_f32 v156, v144, v145
    v_mfma_f32_16x16x32_bf16 v[224:227], v[48:51], v[52:55], v[224:227]
    buffer_store_dwordx4 v[152:155], v255, s[20:23], s52 offen sc1
    buffer_store_dword v156, v254, s[20:23], s53 offen sc1
    v_mfma_f32_16x16x32_bf16 v[228:231], v[48:51], v[56:59], v[228:231]
    s_add_u32 s52, s52, 184320
    s_add_u32 s53, s53, 184320
    s_waitcnt lgkmcnt(0)
    s_barrier
    ds_read_b128 v[52:55], v8 offset:0
    v_mfma_f32_16x16x32_bf16 v[160:163], v[60:63], v[96:99], v[160:163]
    ds_read_b128 v[56:59], v8 offset:2048
    v_mfma_f32_16x16x32_bf16 v[164:167], v[60:63], v[100:103], v[164:167]
    ds_read_b128 v[16:19], v5 offset:0
    v_mfma_f32_16x16x32_bf16 v[168:171], v[64:67], v[96:99], v[168:171]
    ds_read_b128 v[20:23], v5 offset:1024
    v_mfma_f32_16x16x32_bf16 v[172:175], v[64:67], v[100:103], v[172:175]
    ds_read_b128 v[24:27], v5 offset:2048
    v_mfma_f32_16x16x32_bf16 v[176:179], v[68:71], v[96:99], v[176:179]
    v_mfma_f32_32x32x16_bf16 v[136:151], v[104:107], v[128:131], 0
    ds_read_b128 v[28:31], v5 offset:3072
    v_mfma_f32_16x16x32_bf16 v[180:183], v[68:71], v[100:103], v[180:183]
    v_mfma_f32_32x32x16_bf16 v[232:247], v[112:115], v[128:131], 0
    ds_read_b128 v[32:35], v5 offset:4096
    v_mfma_f32_16x16x32_bf16 v[184:187], v[72:75], v[96:99], v[184:187]
    v_mfma_f32_32x32x16_bf16 v[136:151], v[108:111], v[132:135], v[136:151]
    ds_read_b128 v[36:39], v5 offset:5120
    v_mfma_f32_16x16x32_bf16 v[188:191], v[72:75], v[100:103], v[188:191]
    v_mfma_f32_32x32x16_bf16 v[232:247], v[116:119], v[132:135], v[232:247]
    ds_read_b128 v[40:43], v5 offset:6144
    v_mfma_f32_16x16x32_bf16 v[192:195], v[76:79], v[96:99], v[192:195]
    ds_read_b128 v[44:47], v5 offset:7168
    v_mfma_f32_16x16x32_bf16 v[196:199], v[76:79], v[100:103], v[196:199]
    ds_read_b128 v[48:51], v5 offset:8192
    v_mfma_f32_16x16x32_bf16 v[200:203], v[80:83], v[96:99], v[200:203]
    v_mfma_f32_16x16x32_bf16 v[204:207], v[80:83], v[100:103], v[204:207]
    v_mfma_f32_16x16x32_bf16 v[208:211], v[84:87], v[96:99], v[208:211]
    v_mfma_f32_16x16x32_bf16 v[212:215], v[84:87], v[100:103], v[212:215]
    v_mfma_f32_16x16x32_bf16 v[216:219], v[88:91], v[96:99], v[216:219]
    v_mfma_f32_16x16x32_bf16 v[220:223], v[88:91], v[100:103], v[220:223]
    v_mfma_f32_16x16x32_bf16 v[224:227], v[92:95], v[96:99], v[224:227]
    v_mfma_f32_16x16x32_bf16 v[228:231], v[92:95], v[100:103], v[228:231]
    s_waitcnt lgkmcnt(0)
    ds_read_b128 v[96:99], v9 offset:0
    v_mfma_f32_16x16x32_bf16 v[160:163], v[16:19], v[52:55], v[160:163]
    ds_read_b128 v[100:103], v9 offset:2048
    v_mfma_f32_16x16x32_bf16 v[164:167], v[16:19], v[56:59], v[164:167]
    ds_read_b128 v[60:63], v5 offset:9216
    v_mfma_f32_16x16x32_bf16 v[168:171], v[20:23], v[52:55], v[168:171]
    ds_read_b128 v[64:67], v5 offset:10240
    v_mfma_f32_16x16x32_bf16 v[172:175], v[20:23], v[56:59], v[172:175]
    ds_read_b128 v[68:71], v5 offset:11264
    v_mfma_f32_16x16x32_bf16 v[176:179], v[24:27], v[52:55], v[176:179]
    s_cmp_eq_u32 s54, 1
    s_cselect_b64 vcc, -1, 0
    ds_read_b128 v[72:75], v5 offset:12288
    v_mfma_f32_16x16x32_bf16 v[180:183], v[24:27], v[56:59], v[180:183]
    v_cndmask_b32 v232, v232, v234, vcc
    ds_read_b128 v[76:79], v5 offset:13312
    v_mfma_f32_16x16x32_bf16 v[184:187], v[28:31], v[52:55], v[184:187]
    v_cndmask_b32 v233, v233, v235, vcc
    ds_read_b128 v[80:83], v5 offset:14336
    v_mfma_f32_16x16x32_bf16 v[188:191], v[28:31], v[56:59], v[188:191]
    s_cmp_eq_u32 s54, 2
    s_cselect_b64 vcc, -1, 0
    ds_read_b128 v[84:87], v5 offset:15360
    v_mfma_f32_16x16x32_bf16 v[192:195], v[32:35], v[52:55], v[192:195]
    v_cndmask_b32 v232, v232, v236, vcc
    ds_read_b128 v[88:91], v5 offset:16384
    v_mfma_f32_16x16x32_bf16 v[196:199], v[32:35], v[56:59], v[196:199]
    v_cndmask_b32 v233, v233, v237, vcc
    ds_read_b128 v[92:95], v5 offset:17408
    v_mfma_f32_16x16x32_bf16 v[200:203], v[36:39], v[52:55], v[200:203]
    s_cmp_eq_u32 s54, 3
    s_cselect_b64 vcc, -1, 0
    v_cndmask_b32 v232, v232, v238, vcc
    v_mfma_f32_16x16x32_bf16 v[204:207], v[36:39], v[56:59], v[204:207]
    v_cndmask_b32 v233, v233, v239, vcc
    v_mov_b32 v158, v232
    v_mfma_f32_16x16x32_bf16 v[208:211], v[40:43], v[52:55], v[208:211]
    v_mov_b32 v159, v233
    ds_read_b64 v[232:233], v252
    v_mfma_f32_16x16x32_bf16 v[212:215], v[40:43], v[56:59], v[212:215]
    ds_read_b64 v[234:235], v252 offset:8
    ds_read_b64 v[236:237], v252 offset:16
    v_mfma_f32_16x16x32_bf16 v[216:219], v[44:47], v[52:55], v[216:219]
    ds_read_b64 v[238:239], v252 offset:24
    ds_read_b32 v240, v252 offset:32
    v_mfma_f32_16x16x32_bf16 v[220:223], v[44:47], v[56:59], v[220:223]
    v_mov_b32 v241, 0
    v_mov_b32 v242, 0
    v_mfma_f32_16x16x32_bf16 v[224:227], v[48:51], v[52:55], v[224:227]
    v_mov_b32 v243, 0
    v_max3_f32 v248, v136, v137, v138
    v_mfma_f32_16x16x32_bf16 v[228:231], v[48:51], v[56:59], v[228:231]
    v_max3_f32 v249, v139, v140, v141
    v_max3_f32 v248, v248, v142, v143
    s_waitcnt lgkmcnt(0)
    s_barrier
    ds_read_b128 v[52:55], v8 offset:34816
    v_mfma_f32_16x16x32_bf16 v[160:163], v[60:63], v[96:99], v[160:163]
    ds_read_b128 v[56:59], v8 offset:36864
    v_mfma_f32_16x16x32_bf16 v[164:167], v[60:63], v[100:103], v[164:167]
    ds_read_b128 v[16:19], v5 offset:34816
    v_mfma_f32_16x16x32_bf16 v[168:171], v[64:67], v[96:99], v[168:171]
    ds_read_b128 v[20:23], v5 offset:35840
    v_mfma_f32_16x16x32_bf16 v[172:175], v[64:67], v[100:103], v[172:175]
    ds_read_b128 v[24:27], v5 offset:36864
    v_mfma_f32_16x16x32_bf16 v[176:179], v[68:71], v[96:99], v[176:179]
    v_max3_f32 v249, v249, v144, v145
    ds_read_b128 v[28:31], v5 offset:37888
    v_mfma_f32_16x16x32_bf16 v[180:183], v[68:71], v[100:103], v[180:183]
    v_max3_f32 v248, v248, v146, v147
    ds_read_b128 v[32:35], v5 offset:38912
    v_mfma_f32_16x16x32_bf16 v[184:187], v[72:75], v[96:99], v[184:187]
    v_max3_f32 v249, v249, v148, v149
    ds_read_b128 v[36:39], v5 offset:39936
    v_mfma_f32_16x16x32_bf16 v[188:191], v[72:75], v[100:103], v[188:191]
    v_max3_f32 v248, v248, v150, v151
    ds_read_b128 v[40:43], v5 offset:40960
    v_mfma_f32_16x16x32_bf16 v[192:195], v[76:79], v[96:99], v[192:195]
    v_max3_f32 v249, v249, v158, v159
    ds_read_b128 v[44:47], v5 offset:41984
    v_mfma_f32_16x16x32_bf16 v[196:199], v[76:79], v[100:103], v[196:199]
    v_max_f32 v248, v248, v249
    ds_read_b128 v[48:51], v5 offset:43008
    v_mfma_f32_16x16x32_bf16 v[200:203], v[80:83], v[96:99], v[200:203]
    v_mul_f32 v248, s45, v248
    v_fma_f32 v136, v136, s45, -v248
    v_mfma_f32_16x16x32_bf16 v[204:207], v[80:83], v[100:103], v[204:207]
    v_fma_f32 v137, v137, s45, -v248
    v_fma_f32 v138, v138, s45, -v248
    v_mfma_f32_16x16x32_bf16 v[208:211], v[84:87], v[96:99], v[208:211]
    v_fma_f32 v139, v139, s45, -v248
    v_fma_f32 v140, v140, s45, -v248
    v_mfma_f32_16x16x32_bf16 v[212:215], v[84:87], v[100:103], v[212:215]
    v_fma_f32 v141, v141, s45, -v248
    v_fma_f32 v142, v142, s45, -v248
    v_mfma_f32_16x16x32_bf16 v[216:219], v[88:91], v[96:99], v[216:219]
    v_fma_f32 v143, v143, s45, -v248
    v_fma_f32 v144, v144, s45, -v248
    v_mfma_f32_16x16x32_bf16 v[220:223], v[88:91], v[100:103], v[220:223]
    v_fma_f32 v145, v145, s45, -v248
    v_fma_f32 v146, v146, s45, -v248
    v_mfma_f32_16x16x32_bf16 v[224:227], v[92:95], v[96:99], v[224:227]
    v_fma_f32 v147, v147, s45, -v248
    v_fma_f32 v148, v148, s45, -v248
    v_mfma_f32_16x16x32_bf16 v[228:231], v[92:95], v[100:103], v[228:231]
    v_fma_f32 v149, v149, s45, -v248
    v_fma_f32 v150, v150, s45, -v248
    s_waitcnt lgkmcnt(0)
    ds_read_b128 v[96:99], v9 offset:34816
    v_mfma_f32_16x16x32_bf16 v[160:163], v[16:19], v[52:55], v[160:163]
    ds_read_b128 v[100:103], v9 offset:36864
    v_mfma_f32_16x16x32_bf16 v[164:167], v[16:19], v[56:59], v[164:167]
    ds_read_b128 v[60:63], v5 offset:44032
    v_mfma_f32_16x16x32_bf16 v[168:171], v[20:23], v[52:55], v[168:171]
    ds_read_b128 v[64:67], v5 offset:45056
    v_mfma_f32_16x16x32_bf16 v[172:175], v[20:23], v[56:59], v[172:175]
    ds_read_b128 v[68:71], v5 offset:46080
    v_mfma_f32_16x16x32_bf16 v[176:179], v[24:27], v[52:55], v[176:179]
    v_fma_f32 v151, v151, s45, -v248
    ds_read_b128 v[72:75], v5 offset:47104
    v_mfma_f32_16x16x32_bf16 v[180:183], v[24:27], v[56:59], v[180:183]
    v_fma_f32 v158, v158, s45, -v248
    ds_read_b128 v[76:79], v5 offset:48128
    v_mfma_f32_16x16x32_bf16 v[184:187], v[28:31], v[52:55], v[184:187]
    v_fma_f32 v159, v159, s45, -v248
    ds_read_b128 v[80:83], v5 offset:49152
    v_mfma_f32_16x16x32_bf16 v[188:191], v[28:31], v[56:59], v[188:191]
    v_exp_f32 v136, v136
    ds_read_b128 v[84:87], v5 offset:50176
    v_mfma_f32_16x16x32_bf16 v[192:195], v[32:35], v[52:55], v[192:195]
    v_exp_f32 v137, v137
    ds_read_b128 v[88:91], v5 offset:51200
    v_mfma_f32_16x16x32_bf16 v[196:199], v[32:35], v[56:59], v[196:199]
    v_exp_f32 v138, v138
    ds_read_b128 v[92:95], v5 offset:52224
    v_mfma_f32_16x16x32_bf16 v[200:203], v[36:39], v[52:55], v[200:203]
    v_exp_f32 v139, v139
    v_mfma_f32_16x16x32_bf16 v[204:207], v[36:39], v[56:59], v[204:207]
    v_exp_f32 v140, v140
    v_mfma_f32_16x16x32_bf16 v[208:211], v[40:43], v[52:55], v[208:211]
    v_exp_f32 v141, v141
    v_mfma_f32_16x16x32_bf16 v[212:215], v[40:43], v[56:59], v[212:215]
    v_exp_f32 v142, v142
    v_mfma_f32_16x16x32_bf16 v[216:219], v[44:47], v[52:55], v[216:219]
    v_exp_f32 v143, v143
    v_mfma_f32_16x16x32_bf16 v[220:223], v[44:47], v[56:59], v[220:223]
    v_exp_f32 v144, v144
    v_mfma_f32_16x16x32_bf16 v[224:227], v[48:51], v[52:55], v[224:227]
    v_exp_f32 v145, v145
    v_mfma_f32_16x16x32_bf16 v[228:231], v[48:51], v[56:59], v[228:231]
    v_exp_f32 v146, v146
    s_waitcnt lgkmcnt(0)
    s_barrier
    ds_read_b128 v[52:55], v6 offset:0
    v_mfma_f32_16x16x32_bf16 v[160:163], v[60:63], v[96:99], v[160:163]
    ds_read_b128 v[56:59], v6 offset:2048
    v_mfma_f32_16x16x32_bf16 v[164:167], v[60:63], v[100:103], v[164:167]
    ds_read_b128 v[16:19], v4 offset:0
    v_mfma_f32_16x16x32_bf16 v[168:171], v[64:67], v[96:99], v[168:171]
    ds_read_b128 v[20:23], v4 offset:1024
    v_mfma_f32_16x16x32_bf16 v[172:175], v[64:67], v[100:103], v[172:175]
    ds_read_b128 v[24:27], v4 offset:2048
    v_mfma_f32_16x16x32_bf16 v[176:179], v[68:71], v[96:99], v[176:179]
    v_exp_f32 v147, v147
    ds_read_b128 v[28:31], v4 offset:3072
    v_mfma_f32_16x16x32_bf16 v[180:183], v[68:71], v[100:103], v[180:183]
    v_exp_f32 v148, v148
    ds_read_b128 v[32:35], v4 offset:4096
    v_mfma_f32_16x16x32_bf16 v[184:187], v[72:75], v[96:99], v[184:187]
    v_exp_f32 v149, v149
    ds_read_b128 v[36:39], v4 offset:5120
    v_mfma_f32_16x16x32_bf16 v[188:191], v[72:75], v[100:103], v[188:191]
    v_exp_f32 v150, v150
    ds_read_b128 v[40:43], v4 offset:6144
    v_mfma_f32_16x16x32_bf16 v[192:195], v[76:79], v[96:99], v[192:195]
    v_exp_f32 v151, v151
    ds_read_b128 v[44:47], v4 offset:7168
    v_mfma_f32_16x16x32_bf16 v[196:199], v[76:79], v[100:103], v[196:199]
    v_exp_f32 v158, v158
    ds_read_b128 v[48:51], v4 offset:8192
    v_mfma_f32_16x16x32_bf16 v[200:203], v[80:83], v[96:99], v[200:203]
    v_exp_f32 v159, v159
    v_mfma_f32_16x16x32_bf16 v[204:207], v[80:83], v[100:103], v[204:207]
    v_add_f32 v249, v136, v137
    v_add_f32 v250, v138, v139
    v_mfma_f32_16x16x32_bf16 v[208:211], v[84:87], v[96:99], v[208:211]
    v_add_f32 v249, v249, v140
    v_add_f32 v250, v250, v141
    v_mfma_f32_16x16x32_bf16 v[212:215], v[84:87], v[100:103], v[212:215]
    v_add_f32 v249, v249, v142
    v_add_f32 v250, v250, v143
    v_mfma_f32_16x16x32_bf16 v[216:219], v[88:91], v[96:99], v[216:219]
    v_add_f32 v249, v249, v144
    v_add_f32 v250, v250, v145
    v_mfma_f32_16x16x32_bf16 v[220:223], v[88:91], v[100:103], v[220:223]
    v_add_f32 v249, v249, v146
    v_add_f32 v250, v250, v147
    v_mfma_f32_16x16x32_bf16 v[224:227], v[92:95], v[96:99], v[224:227]
    v_add_f32 v249, v249, v148
    v_add_f32 v250, v250, v149
    v_mfma_f32_16x16x32_bf16 v[228:231], v[92:95], v[100:103], v[228:231]
    v_add_f32 v249, v249, v150
    v_add_f32 v250, v250, v151
    s_waitcnt lgkmcnt(0)
    ds_read_b128 v[96:99], v7 offset:0
    v_mfma_f32_16x16x32_bf16 v[160:163], v[16:19], v[52:55], v[160:163]
    ds_read_b128 v[100:103], v7 offset:2048
    v_mfma_f32_16x16x32_bf16 v[164:167], v[16:19], v[56:59], v[164:167]
    ds_read_b128 v[60:63], v4 offset:9216
    v_mfma_f32_16x16x32_bf16 v[168:171], v[20:23], v[52:55], v[168:171]
    ds_read_b128 v[64:67], v4 offset:10240
    v_mfma_f32_16x16x32_bf16 v[172:175], v[20:23], v[56:59], v[172:175]
    ds_read_b128 v[68:71], v4 offset:11264
    v_mfma_f32_16x16x32_bf16 v[176:179], v[24:27], v[52:55], v[176:179]
    v_add_f32 v249, v249, v158
    ds_read_b128 v[72:75], v4 offset:12288
    v_mfma_f32_16x16x32_bf16 v[180:183], v[24:27], v[56:59], v[180:183]
    v_add_f32 v250, v250, v159
    ds_read_b128 v[76:79], v4 offset:13312
    v_mfma_f32_16x16x32_bf16 v[184:187], v[28:31], v[52:55], v[184:187]
    v_add_f32 v249, v249, v250
    ds_read_b128 v[80:83], v4 offset:14336
    v_mfma_f32_16x16x32_bf16 v[188:191], v[28:31], v[56:59], v[188:191]
    v_rcp_f32 v249, v249
    ds_read_b128 v[84:87], v4 offset:15360
    v_mfma_f32_16x16x32_bf16 v[192:195], v[32:35], v[52:55], v[192:195]
    s_nop 0
    ds_read_b128 v[88:91], v4 offset:16384
    v_mfma_f32_16x16x32_bf16 v[196:199], v[32:35], v[56:59], v[196:199]
    v_mul_f32 v136, v136, v249
    ds_read_b128 v[92:95], v4 offset:17408
    v_mfma_f32_16x16x32_bf16 v[200:203], v[36:39], v[52:55], v[200:203]
    v_mul_f32 v137, v137, v249
    v_mul_f32 v138, v138, v249
    v_mfma_f32_16x16x32_bf16 v[204:207], v[36:39], v[56:59], v[204:207]
    v_mul_f32 v139, v139, v249
    v_mul_f32 v140, v140, v249
    v_mfma_f32_16x16x32_bf16 v[208:211], v[40:43], v[52:55], v[208:211]
    v_mul_f32 v141, v141, v249
    v_mul_f32 v142, v142, v249
    v_mfma_f32_16x16x32_bf16 v[212:215], v[40:43], v[56:59], v[212:215]
    v_mul_f32 v143, v143, v249
    v_mul_f32 v144, v144, v249
    v_mfma_f32_16x16x32_bf16 v[216:219], v[44:47], v[52:55], v[216:219]
    v_mul_f32 v145, v145, v249
    v_mul_f32 v146, v146, v249
    v_mfma_f32_16x16x32_bf16 v[220:223], v[44:47], v[56:59], v[220:223]
    v_mul_f32 v147, v147, v249
    v_mul_f32 v148, v148, v249
    v_mfma_f32_16x16x32_bf16 v[224:227], v[48:51], v[52:55], v[224:227]
    v_mul_f32 v149, v149, v249
    v_mul_f32 v150, v150, v249
    v_mfma_f32_16x16x32_bf16 v[228:231], v[48:51], v[56:59], v[228:231]
    v_mul_f32 v151, v151, v249
    v_mul_f32 v158, v158, v249
    s_waitcnt lgkmcnt(0)
    s_barrier
    ds_read_b128 v[52:55], v6 offset:34816
    v_mfma_f32_16x16x32_bf16 v[160:163], v[60:63], v[96:99], v[160:163]
    ds_read_b128 v[56:59], v6 offset:36864
    v_mfma_f32_16x16x32_bf16 v[164:167], v[60:63], v[100:103], v[164:167]
    ds_read_b128 v[16:19], v4 offset:34816
    v_mfma_f32_16x16x32_bf16 v[168:171], v[64:67], v[96:99], v[168:171]
    ds_read_b128 v[20:23], v4 offset:35840
    v_mfma_f32_16x16x32_bf16 v[172:175], v[64:67], v[100:103], v[172:175]
    ds_read_b128 v[24:27], v4 offset:36864
    v_mfma_f32_16x16x32_bf16 v[176:179], v[68:71], v[96:99], v[176:179]
    v_mul_f32 v159, v159, v249
    ds_read_b128 v[28:31], v4 offset:37888
    v_mfma_f32_16x16x32_bf16 v[180:183], v[68:71], v[100:103], v[180:183]
    v_cvt_pk_bf16_f32 v120, v136, v137
    ds_read_b128 v[32:35], v4 offset:38912
    v_mfma_f32_16x16x32_bf16 v[184:187], v[72:75], v[96:99], v[184:187]
    v_cvt_pk_bf16_f32 v121, v138, v139
    ds_read_b128 v[36:39], v4 offset:39936
    v_mfma_f32_16x16x32_bf16 v[188:191], v[72:75], v[100:103], v[188:191]
    v_cvt_pk_bf16_f32 v122, v140, v141
    ds_read_b128 v[40:43], v4 offset:40960
    v_mfma_f32_16x16x32_bf16 v[192:195], v[76:79], v[96:99], v[192:195]
    v_cvt_pk_bf16_f32 v123, v142, v143
    ds_read_b128 v[44:47], v4 offset:41984
    v_mfma_f32_16x16x32_bf16 v[196:199], v[76:79], v[100:103], v[196:199]
    v_cvt_pk_bf16_f32 v124, v144, v145
    ds_read_b128 v[48:51], v4 offset:43008
    v_mfma_f32_16x16x32_bf16 v[200:203], v[80:83], v[96:99], v[200:203]
    v_cvt_pk_bf16_f32 v125, v146, v147
    v_cvt_pk_bf16_f32 v126, v148, v149
    v_mfma_f32_16x16x32_bf16 v[204:207], v[80:83], v[100:103], v[204:207]
    v_cvt_pk_bf16_f32 v127, v150, v151
    v_cvt_pk_bf16_f32 v244, v158, v159
    v_mfma_f32_16x16x32_bf16 v[208:211], v[84:87], v[96:99], v[208:211]
    v_mov_b32 v245, 0
    v_mov_b32 v246, 0
    v_mfma_f32_16x16x32_bf16 v[212:215], v[84:87], v[100:103], v[212:215]
    v_mov_b32 v247, 0
    v_mfma_f32_16x16x32_bf16 v[216:219], v[88:91], v[96:99], v[216:219]
    v_mfma_f32_16x16x32_bf16 v[220:223], v[88:91], v[100:103], v[220:223]
    v_mfma_f32_16x16x32_bf16 v[224:227], v[92:95], v[96:99], v[224:227]
    v_mfma_f32_16x16x32_bf16 v[228:231], v[92:95], v[100:103], v[228:231]
    s_waitcnt lgkmcnt(0)
    ds_read_b128 v[96:99], v7 offset:34816
    v_mfma_f32_16x16x32_bf16 v[160:163], v[16:19], v[52:55], v[160:163]
    ds_read_b128 v[100:103], v7 offset:36864
    v_mfma_f32_16x16x32_bf16 v[164:167], v[16:19], v[56:59], v[164:167]
    ds_read_b128 v[60:63], v4 offset:44032
    v_mfma_f32_16x16x32_bf16 v[168:171], v[20:23], v[52:55], v[168:171]
    ds_read_b128 v[64:67], v4 offset:45056
    v_mfma_f32_16x16x32_bf16 v[172:175], v[20:23], v[56:59], v[172:175]
    ds_read_b128 v[68:71], v4 offset:46080
    v_mfma_f32_16x16x32_bf16 v[176:179], v[24:27], v[52:55], v[176:179]
    v_mfma_f32_32x32x16_bf16 v[136:151], v[232:235], v[120:123], 0
    ds_read_b128 v[72:75], v4 offset:47104
    v_mfma_f32_16x16x32_bf16 v[180:183], v[24:27], v[56:59], v[180:183]
    v_mfma_f32_32x32x16_bf16 v[136:151], v[236:239], v[124:127], v[136:151]
    ds_read_b128 v[76:79], v4 offset:48128
    v_mfma_f32_16x16x32_bf16 v[184:187], v[28:31], v[52:55], v[184:187]
    v_mfma_f32_32x32x16_bf16 v[136:151], v[240:243], v[244:247], v[136:151]
    ds_read_b128 v[80:83], v4 offset:49152
    v_mfma_f32_16x16x32_bf16 v[188:191], v[28:31], v[56:59], v[188:191]
    ds_read_b128 v[84:87], v4 offset:50176
    v_mfma_f32_16x16x32_bf16 v[192:195], v[32:35], v[52:55], v[192:195]
    ds_read_b128 v[88:91], v4 offset:51200
    v_mfma_f32_16x16x32_bf16 v[196:199], v[32:35], v[56:59], v[196:199]
    ds_read_b128 v[92:95], v4 offset:52224
    v_mfma_f32_16x16x32_bf16 v[200:203], v[36:39], v[52:55], v[200:203]
    v_mfma_f32_16x16x32_bf16 v[204:207], v[36:39], v[56:59], v[204:207]
    v_mfma_f32_16x16x32_bf16 v[208:211], v[40:43], v[52:55], v[208:211]
    v_mfma_f32_16x16x32_bf16 v[212:215], v[40:43], v[56:59], v[212:215]
    v_mfma_f32_16x16x32_bf16 v[216:219], v[44:47], v[52:55], v[216:219]
    v_mfma_f32_16x16x32_bf16 v[220:223], v[44:47], v[56:59], v[220:223]
    v_mfma_f32_16x16x32_bf16 v[224:227], v[48:51], v[52:55], v[224:227]
    v_mfma_f32_16x16x32_bf16 v[228:231], v[48:51], v[56:59], v[228:231]
    s_waitcnt lgkmcnt(0)
    s_barrier
    ds_read_b128 v[52:55], v8 offset:0
    v_mfma_f32_16x16x32_bf16 v[160:163], v[60:63], v[96:99], v[160:163]
    ds_read_b128 v[56:59], v8 offset:2048
    v_mfma_f32_16x16x32_bf16 v[164:167], v[60:63], v[100:103], v[164:167]
    ds_read_b128 v[16:19], v5 offset:0
    v_mfma_f32_16x16x32_bf16 v[168:171], v[64:67], v[96:99], v[168:171]
    ds_read_b128 v[20:23], v5 offset:1024
    v_mfma_f32_16x16x32_bf16 v[172:175], v[64:67], v[100:103], v[172:175]
    ds_read_b128 v[24:27], v5 offset:2048
    v_mfma_f32_16x16x32_bf16 v[176:179], v[68:71], v[96:99], v[176:179]
    v_add_f32 v248, 897988541, v146
    ds_read_b128 v[28:31], v5 offset:3072
    v_mfma_f32_16x16x32_bf16 v[180:183], v[68:71], v[100:103], v[180:183]
    v_rcp_f32 v248, v248
    ds_read_b128 v[32:35], v5 offset:4096
    v_mfma_f32_16x16x32_bf16 v[184:187], v[72:75], v[96:99], v[184:187]
    s_nop 0
    ds_read_b128 v[36:39], v5 offset:5120
    v_mfma_f32_16x16x32_bf16 v[188:191], v[72:75], v[100:103], v[188:191]
    v_mul_f32 v136, v136, v248
    ds_read_b128 v[40:43], v5 offset:6144
    v_mfma_f32_16x16x32_bf16 v[192:195], v[76:79], v[96:99], v[192:195]
    v_mul_f32 v137, v137, v248
    ds_read_b128 v[44:47], v5 offset:7168
    v_mfma_f32_16x16x32_bf16 v[196:199], v[76:79], v[100:103], v[196:199]
    v_mul_f32 v138, v138, v248
    ds_read_b128 v[48:51], v5 offset:8192
    v_mfma_f32_16x16x32_bf16 v[200:203], v[80:83], v[96:99], v[200:203]
    v_mul_f32 v139, v139, v248
    v_mul_f32 v140, v140, v248
    v_mfma_f32_16x16x32_bf16 v[204:207], v[80:83], v[100:103], v[204:207]
    v_mul_f32 v141, v141, v248
    v_mul_f32 v142, v142, v248
    v_mfma_f32_16x16x32_bf16 v[208:211], v[84:87], v[96:99], v[208:211]
    v_mul_f32 v143, v143, v248
    v_mul_f32 v144, v144, v248
    v_mfma_f32_16x16x32_bf16 v[212:215], v[84:87], v[100:103], v[212:215]
    v_mul_f32 v145, v145, v248
    v_cvt_pk_bf16_f32 v152, v136, v137
    v_mfma_f32_16x16x32_bf16 v[216:219], v[88:91], v[96:99], v[216:219]
    v_cvt_pk_bf16_f32 v153, v138, v139
    v_cvt_pk_bf16_f32 v154, v140, v141
    v_mfma_f32_16x16x32_bf16 v[220:223], v[88:91], v[100:103], v[220:223]
    v_cvt_pk_bf16_f32 v155, v142, v143
    v_cvt_pk_bf16_f32 v156, v144, v145
    v_mfma_f32_16x16x32_bf16 v[224:227], v[92:95], v[96:99], v[224:227]
    buffer_store_dwordx4 v[152:155], v255, s[20:23], s52 offen sc1
    buffer_store_dword v156, v254, s[20:23], s53 offen sc1
    v_mfma_f32_16x16x32_bf16 v[228:231], v[92:95], v[100:103], v[228:231]
    s_waitcnt lgkmcnt(0)
    ds_read_b128 v[96:99], v9 offset:0
    v_mfma_f32_16x16x32_bf16 v[160:163], v[16:19], v[52:55], v[160:163]
    ds_read_b128 v[100:103], v9 offset:2048
    v_mfma_f32_16x16x32_bf16 v[164:167], v[16:19], v[56:59], v[164:167]
    ds_read_b128 v[60:63], v5 offset:9216
    v_mfma_f32_16x16x32_bf16 v[168:171], v[20:23], v[52:55], v[168:171]
    ds_read_b128 v[64:67], v5 offset:10240
    v_mfma_f32_16x16x32_bf16 v[172:175], v[20:23], v[56:59], v[172:175]
    ds_read_b128 v[68:71], v5 offset:11264
    v_mfma_f32_16x16x32_bf16 v[176:179], v[24:27], v[52:55], v[176:179]
    ds_read_b128 v[72:75], v5 offset:12288
    v_mfma_f32_16x16x32_bf16 v[180:183], v[24:27], v[56:59], v[180:183]
    ds_read_b128 v[76:79], v5 offset:13312
    v_mfma_f32_16x16x32_bf16 v[184:187], v[28:31], v[52:55], v[184:187]
    ds_read_b128 v[80:83], v5 offset:14336
    v_mfma_f32_16x16x32_bf16 v[188:191], v[28:31], v[56:59], v[188:191]
    ds_read_b128 v[84:87], v5 offset:15360
    v_mfma_f32_16x16x32_bf16 v[192:195], v[32:35], v[52:55], v[192:195]
    ds_read_b128 v[88:91], v5 offset:16384
    v_mfma_f32_16x16x32_bf16 v[196:199], v[32:35], v[56:59], v[196:199]
    ds_read_b128 v[92:95], v5 offset:17408
    v_mfma_f32_16x16x32_bf16 v[200:203], v[36:39], v[52:55], v[200:203]
    v_mfma_f32_16x16x32_bf16 v[204:207], v[36:39], v[56:59], v[204:207]
    v_mfma_f32_16x16x32_bf16 v[208:211], v[40:43], v[52:55], v[208:211]
    v_mfma_f32_16x16x32_bf16 v[212:215], v[40:43], v[56:59], v[212:215]
    v_mfma_f32_16x16x32_bf16 v[216:219], v[44:47], v[52:55], v[216:219]
    v_mfma_f32_16x16x32_bf16 v[220:223], v[44:47], v[56:59], v[220:223]
    v_mfma_f32_16x16x32_bf16 v[224:227], v[48:51], v[52:55], v[224:227]
    v_mfma_f32_16x16x32_bf16 v[228:231], v[48:51], v[56:59], v[228:231]
    s_waitcnt lgkmcnt(0)
    s_barrier
    ds_read_b128 v[52:55], v8 offset:34816
    v_mfma_f32_16x16x32_bf16 v[160:163], v[60:63], v[96:99], v[160:163]
    ds_read_b128 v[56:59], v8 offset:36864
    v_mfma_f32_16x16x32_bf16 v[164:167], v[60:63], v[100:103], v[164:167]
    ds_read_b128 v[16:19], v5 offset:34816
    v_mfma_f32_16x16x32_bf16 v[168:171], v[64:67], v[96:99], v[168:171]
    ds_read_b128 v[20:23], v5 offset:35840
    v_mfma_f32_16x16x32_bf16 v[172:175], v[64:67], v[100:103], v[172:175]
    ds_read_b128 v[24:27], v5 offset:36864
    v_mfma_f32_16x16x32_bf16 v[176:179], v[68:71], v[96:99], v[176:179]
    ds_read_b128 v[28:31], v5 offset:37888
    v_mfma_f32_16x16x32_bf16 v[180:183], v[68:71], v[100:103], v[180:183]
    ds_read_b128 v[32:35], v5 offset:38912
    v_mfma_f32_16x16x32_bf16 v[184:187], v[72:75], v[96:99], v[184:187]
    ds_read_b128 v[36:39], v5 offset:39936
    v_mfma_f32_16x16x32_bf16 v[188:191], v[72:75], v[100:103], v[188:191]
    ds_read_b128 v[40:43], v5 offset:40960
    v_mfma_f32_16x16x32_bf16 v[192:195], v[76:79], v[96:99], v[192:195]
    ds_read_b128 v[44:47], v5 offset:41984
    v_mfma_f32_16x16x32_bf16 v[196:199], v[76:79], v[100:103], v[196:199]
    ds_read_b128 v[48:51], v5 offset:43008
    v_mfma_f32_16x16x32_bf16 v[200:203], v[80:83], v[96:99], v[200:203]
    v_mfma_f32_16x16x32_bf16 v[204:207], v[80:83], v[100:103], v[204:207]
    v_mfma_f32_16x16x32_bf16 v[208:211], v[84:87], v[96:99], v[208:211]
    v_mfma_f32_16x16x32_bf16 v[212:215], v[84:87], v[100:103], v[212:215]
    v_mfma_f32_16x16x32_bf16 v[216:219], v[88:91], v[96:99], v[216:219]
    v_mfma_f32_16x16x32_bf16 v[220:223], v[88:91], v[100:103], v[220:223]
    v_mfma_f32_16x16x32_bf16 v[224:227], v[92:95], v[96:99], v[224:227]
    v_mfma_f32_16x16x32_bf16 v[228:231], v[92:95], v[100:103], v[228:231]
    s_waitcnt lgkmcnt(0)
    ds_read_b128 v[96:99], v9 offset:34816
    v_mfma_f32_16x16x32_bf16 v[160:163], v[16:19], v[52:55], v[160:163]
    ds_read_b128 v[100:103], v9 offset:36864
    v_mfma_f32_16x16x32_bf16 v[164:167], v[16:19], v[56:59], v[164:167]
    ds_read_b128 v[60:63], v5 offset:44032
    v_mfma_f32_16x16x32_bf16 v[168:171], v[20:23], v[52:55], v[168:171]
    ds_read_b128 v[64:67], v5 offset:45056
    v_mfma_f32_16x16x32_bf16 v[172:175], v[20:23], v[56:59], v[172:175]
    ds_read_b128 v[68:71], v5 offset:46080
    v_mfma_f32_16x16x32_bf16 v[176:179], v[24:27], v[52:55], v[176:179]
    ds_read_b128 v[72:75], v5 offset:47104
    v_mfma_f32_16x16x32_bf16 v[180:183], v[24:27], v[56:59], v[180:183]
    ds_read_b128 v[76:79], v5 offset:48128
    v_mfma_f32_16x16x32_bf16 v[184:187], v[28:31], v[52:55], v[184:187]
    ds_read_b128 v[80:83], v5 offset:49152
    v_mfma_f32_16x16x32_bf16 v[188:191], v[28:31], v[56:59], v[188:191]
    ds_read_b128 v[84:87], v5 offset:50176
    v_mfma_f32_16x16x32_bf16 v[192:195], v[32:35], v[52:55], v[192:195]
    ds_read_b128 v[88:91], v5 offset:51200
    v_mfma_f32_16x16x32_bf16 v[196:199], v[32:35], v[56:59], v[196:199]
    ds_read_b128 v[92:95], v5 offset:52224
    v_mfma_f32_16x16x32_bf16 v[200:203], v[36:39], v[52:55], v[200:203]
    v_mfma_f32_16x16x32_bf16 v[204:207], v[36:39], v[56:59], v[204:207]
    v_mfma_f32_16x16x32_bf16 v[208:211], v[40:43], v[52:55], v[208:211]
    v_mfma_f32_16x16x32_bf16 v[212:215], v[40:43], v[56:59], v[212:215]
    v_mfma_f32_16x16x32_bf16 v[216:219], v[44:47], v[52:55], v[216:219]
    v_mfma_f32_16x16x32_bf16 v[220:223], v[44:47], v[56:59], v[220:223]
    v_mfma_f32_16x16x32_bf16 v[224:227], v[48:51], v[52:55], v[224:227]
    v_mfma_f32_16x16x32_bf16 v[228:231], v[48:51], v[56:59], v[228:231]
    s_waitcnt lgkmcnt(0)
    s_mov_b32 s48, 4
parallel_sum__linear_kernel_hedgehog__mixer_gmlp__prompt_kernel_cl:
    s_barrier
    ds_read_b128 v[52:55], v6 offset:0
    v_mfma_f32_16x16x32_bf16 v[160:163], v[60:63], v[96:99], v[160:163]
    ds_read_b128 v[56:59], v6 offset:2048
    v_mfma_f32_16x16x32_bf16 v[164:167], v[60:63], v[100:103], v[164:167]
    ds_read_b128 v[16:19], v4 offset:0
    v_mfma_f32_16x16x32_bf16 v[168:171], v[64:67], v[96:99], v[168:171]
    ds_read_b128 v[20:23], v4 offset:1024
    v_mfma_f32_16x16x32_bf16 v[172:175], v[64:67], v[100:103], v[172:175]
    ds_read_b128 v[24:27], v4 offset:2048
    v_mfma_f32_16x16x32_bf16 v[176:179], v[68:71], v[96:99], v[176:179]
    ds_read_b128 v[28:31], v4 offset:3072
    v_mfma_f32_16x16x32_bf16 v[180:183], v[68:71], v[100:103], v[180:183]
    ds_read_b128 v[32:35], v4 offset:4096
    v_mfma_f32_16x16x32_bf16 v[184:187], v[72:75], v[96:99], v[184:187]
    ds_read_b128 v[36:39], v4 offset:5120
    v_mfma_f32_16x16x32_bf16 v[188:191], v[72:75], v[100:103], v[188:191]
    ds_read_b128 v[40:43], v4 offset:6144
    v_mfma_f32_16x16x32_bf16 v[192:195], v[76:79], v[96:99], v[192:195]
    ds_read_b128 v[44:47], v4 offset:7168
    v_mfma_f32_16x16x32_bf16 v[196:199], v[76:79], v[100:103], v[196:199]
    ds_read_b128 v[48:51], v4 offset:8192
    v_mfma_f32_16x16x32_bf16 v[200:203], v[80:83], v[96:99], v[200:203]
    v_mfma_f32_16x16x32_bf16 v[204:207], v[80:83], v[100:103], v[204:207]
    v_mfma_f32_16x16x32_bf16 v[208:211], v[84:87], v[96:99], v[208:211]
    v_mfma_f32_16x16x32_bf16 v[212:215], v[84:87], v[100:103], v[212:215]
    v_mfma_f32_16x16x32_bf16 v[216:219], v[88:91], v[96:99], v[216:219]
    v_mfma_f32_16x16x32_bf16 v[220:223], v[88:91], v[100:103], v[220:223]
    v_mfma_f32_16x16x32_bf16 v[224:227], v[92:95], v[96:99], v[224:227]
    v_mfma_f32_16x16x32_bf16 v[228:231], v[92:95], v[100:103], v[228:231]
    s_waitcnt lgkmcnt(0)
    ds_read_b128 v[96:99], v7 offset:0
    v_mfma_f32_16x16x32_bf16 v[160:163], v[16:19], v[52:55], v[160:163]
    ds_read_b128 v[100:103], v7 offset:2048
    v_mfma_f32_16x16x32_bf16 v[164:167], v[16:19], v[56:59], v[164:167]
    ds_read_b128 v[60:63], v4 offset:9216
    v_mfma_f32_16x16x32_bf16 v[168:171], v[20:23], v[52:55], v[168:171]
    ds_read_b128 v[64:67], v4 offset:10240
    v_mfma_f32_16x16x32_bf16 v[172:175], v[20:23], v[56:59], v[172:175]
    ds_read_b128 v[68:71], v4 offset:11264
    v_mfma_f32_16x16x32_bf16 v[176:179], v[24:27], v[52:55], v[176:179]
    ds_read_b128 v[72:75], v4 offset:12288
    v_mfma_f32_16x16x32_bf16 v[180:183], v[24:27], v[56:59], v[180:183]
    ds_read_b128 v[76:79], v4 offset:13312
    v_mfma_f32_16x16x32_bf16 v[184:187], v[28:31], v[52:55], v[184:187]
    ds_read_b128 v[80:83], v4 offset:14336
    v_mfma_f32_16x16x32_bf16 v[188:191], v[28:31], v[56:59], v[188:191]
    ds_read_b128 v[84:87], v4 offset:15360
    v_mfma_f32_16x16x32_bf16 v[192:195], v[32:35], v[52:55], v[192:195]
    ds_read_b128 v[88:91], v4 offset:16384
    v_mfma_f32_16x16x32_bf16 v[196:199], v[32:35], v[56:59], v[196:199]
    ds_read_b128 v[92:95], v4 offset:17408
    v_mfma_f32_16x16x32_bf16 v[200:203], v[36:39], v[52:55], v[200:203]
    v_mfma_f32_16x16x32_bf16 v[204:207], v[36:39], v[56:59], v[204:207]
    v_mfma_f32_16x16x32_bf16 v[208:211], v[40:43], v[52:55], v[208:211]
    v_mfma_f32_16x16x32_bf16 v[212:215], v[40:43], v[56:59], v[212:215]
    v_mfma_f32_16x16x32_bf16 v[216:219], v[44:47], v[52:55], v[216:219]
    v_mfma_f32_16x16x32_bf16 v[220:223], v[44:47], v[56:59], v[220:223]
    v_mfma_f32_16x16x32_bf16 v[224:227], v[48:51], v[52:55], v[224:227]
    v_mfma_f32_16x16x32_bf16 v[228:231], v[48:51], v[56:59], v[228:231]
    s_waitcnt lgkmcnt(0)
    s_barrier
    ds_read_b128 v[52:55], v6 offset:34816
    v_mfma_f32_16x16x32_bf16 v[160:163], v[60:63], v[96:99], v[160:163]
    ds_read_b128 v[56:59], v6 offset:36864
    v_mfma_f32_16x16x32_bf16 v[164:167], v[60:63], v[100:103], v[164:167]
    ds_read_b128 v[16:19], v4 offset:34816
    v_mfma_f32_16x16x32_bf16 v[168:171], v[64:67], v[96:99], v[168:171]
    ds_read_b128 v[20:23], v4 offset:35840
    v_mfma_f32_16x16x32_bf16 v[172:175], v[64:67], v[100:103], v[172:175]
    ds_read_b128 v[24:27], v4 offset:36864
    v_mfma_f32_16x16x32_bf16 v[176:179], v[68:71], v[96:99], v[176:179]
    ds_read_b128 v[28:31], v4 offset:37888
    v_mfma_f32_16x16x32_bf16 v[180:183], v[68:71], v[100:103], v[180:183]
    ds_read_b128 v[32:35], v4 offset:38912
    v_mfma_f32_16x16x32_bf16 v[184:187], v[72:75], v[96:99], v[184:187]
    ds_read_b128 v[36:39], v4 offset:39936
    v_mfma_f32_16x16x32_bf16 v[188:191], v[72:75], v[100:103], v[188:191]
    ds_read_b128 v[40:43], v4 offset:40960
    v_mfma_f32_16x16x32_bf16 v[192:195], v[76:79], v[96:99], v[192:195]
    ds_read_b128 v[44:47], v4 offset:41984
    v_mfma_f32_16x16x32_bf16 v[196:199], v[76:79], v[100:103], v[196:199]
    ds_read_b128 v[48:51], v4 offset:43008
    v_mfma_f32_16x16x32_bf16 v[200:203], v[80:83], v[96:99], v[200:203]
    v_mfma_f32_16x16x32_bf16 v[204:207], v[80:83], v[100:103], v[204:207]
    v_mfma_f32_16x16x32_bf16 v[208:211], v[84:87], v[96:99], v[208:211]
    v_mfma_f32_16x16x32_bf16 v[212:215], v[84:87], v[100:103], v[212:215]
    v_mfma_f32_16x16x32_bf16 v[216:219], v[88:91], v[96:99], v[216:219]
    v_mfma_f32_16x16x32_bf16 v[220:223], v[88:91], v[100:103], v[220:223]
    v_mfma_f32_16x16x32_bf16 v[224:227], v[92:95], v[96:99], v[224:227]
    v_mfma_f32_16x16x32_bf16 v[228:231], v[92:95], v[100:103], v[228:231]
    s_waitcnt lgkmcnt(0)
    ds_read_b128 v[96:99], v7 offset:34816
    v_mfma_f32_16x16x32_bf16 v[160:163], v[16:19], v[52:55], v[160:163]
    ds_read_b128 v[100:103], v7 offset:36864
    v_mfma_f32_16x16x32_bf16 v[164:167], v[16:19], v[56:59], v[164:167]
    ds_read_b128 v[60:63], v4 offset:44032
    v_mfma_f32_16x16x32_bf16 v[168:171], v[20:23], v[52:55], v[168:171]
    ds_read_b128 v[64:67], v4 offset:45056
    v_mfma_f32_16x16x32_bf16 v[172:175], v[20:23], v[56:59], v[172:175]
    ds_read_b128 v[68:71], v4 offset:46080
    v_mfma_f32_16x16x32_bf16 v[176:179], v[24:27], v[52:55], v[176:179]
    ds_read_b128 v[72:75], v4 offset:47104
    v_mfma_f32_16x16x32_bf16 v[180:183], v[24:27], v[56:59], v[180:183]
    ds_read_b128 v[76:79], v4 offset:48128
    v_mfma_f32_16x16x32_bf16 v[184:187], v[28:31], v[52:55], v[184:187]
    ds_read_b128 v[80:83], v4 offset:49152
    v_mfma_f32_16x16x32_bf16 v[188:191], v[28:31], v[56:59], v[188:191]
    ds_read_b128 v[84:87], v4 offset:50176
    v_mfma_f32_16x16x32_bf16 v[192:195], v[32:35], v[52:55], v[192:195]
    ds_read_b128 v[88:91], v4 offset:51200
    v_mfma_f32_16x16x32_bf16 v[196:199], v[32:35], v[56:59], v[196:199]
    ds_read_b128 v[92:95], v4 offset:52224
    v_mfma_f32_16x16x32_bf16 v[200:203], v[36:39], v[52:55], v[200:203]
    v_mfma_f32_16x16x32_bf16 v[204:207], v[36:39], v[56:59], v[204:207]
    v_mfma_f32_16x16x32_bf16 v[208:211], v[40:43], v[52:55], v[208:211]
    v_mfma_f32_16x16x32_bf16 v[212:215], v[40:43], v[56:59], v[212:215]
    v_mfma_f32_16x16x32_bf16 v[216:219], v[44:47], v[52:55], v[216:219]
    v_mfma_f32_16x16x32_bf16 v[220:223], v[44:47], v[56:59], v[220:223]
    v_mfma_f32_16x16x32_bf16 v[224:227], v[48:51], v[52:55], v[224:227]
    v_mfma_f32_16x16x32_bf16 v[228:231], v[48:51], v[56:59], v[228:231]
    s_waitcnt lgkmcnt(0)
    s_barrier
    ds_read_b128 v[52:55], v8 offset:0
    v_mfma_f32_16x16x32_bf16 v[160:163], v[60:63], v[96:99], v[160:163]
    ds_read_b128 v[56:59], v8 offset:2048
    v_mfma_f32_16x16x32_bf16 v[164:167], v[60:63], v[100:103], v[164:167]
    ds_read_b128 v[16:19], v5 offset:0
    v_mfma_f32_16x16x32_bf16 v[168:171], v[64:67], v[96:99], v[168:171]
    ds_read_b128 v[20:23], v5 offset:1024
    v_mfma_f32_16x16x32_bf16 v[172:175], v[64:67], v[100:103], v[172:175]
    ds_read_b128 v[24:27], v5 offset:2048
    v_mfma_f32_16x16x32_bf16 v[176:179], v[68:71], v[96:99], v[176:179]
    ds_read_b128 v[28:31], v5 offset:3072
    v_mfma_f32_16x16x32_bf16 v[180:183], v[68:71], v[100:103], v[180:183]
    ds_read_b128 v[32:35], v5 offset:4096
    v_mfma_f32_16x16x32_bf16 v[184:187], v[72:75], v[96:99], v[184:187]
    ds_read_b128 v[36:39], v5 offset:5120
    v_mfma_f32_16x16x32_bf16 v[188:191], v[72:75], v[100:103], v[188:191]
    ds_read_b128 v[40:43], v5 offset:6144
    v_mfma_f32_16x16x32_bf16 v[192:195], v[76:79], v[96:99], v[192:195]
    ds_read_b128 v[44:47], v5 offset:7168
    v_mfma_f32_16x16x32_bf16 v[196:199], v[76:79], v[100:103], v[196:199]
    ds_read_b128 v[48:51], v5 offset:8192
    v_mfma_f32_16x16x32_bf16 v[200:203], v[80:83], v[96:99], v[200:203]
    v_mfma_f32_16x16x32_bf16 v[204:207], v[80:83], v[100:103], v[204:207]
    v_mfma_f32_16x16x32_bf16 v[208:211], v[84:87], v[96:99], v[208:211]
    v_mfma_f32_16x16x32_bf16 v[212:215], v[84:87], v[100:103], v[212:215]
    v_mfma_f32_16x16x32_bf16 v[216:219], v[88:91], v[96:99], v[216:219]
    v_mfma_f32_16x16x32_bf16 v[220:223], v[88:91], v[100:103], v[220:223]
    v_mfma_f32_16x16x32_bf16 v[224:227], v[92:95], v[96:99], v[224:227]
    v_mfma_f32_16x16x32_bf16 v[228:231], v[92:95], v[100:103], v[228:231]
    s_waitcnt lgkmcnt(0)
    ds_read_b128 v[96:99], v9 offset:0
    v_mfma_f32_16x16x32_bf16 v[160:163], v[16:19], v[52:55], v[160:163]
    ds_read_b128 v[100:103], v9 offset:2048
    v_mfma_f32_16x16x32_bf16 v[164:167], v[16:19], v[56:59], v[164:167]
    ds_read_b128 v[60:63], v5 offset:9216
    v_mfma_f32_16x16x32_bf16 v[168:171], v[20:23], v[52:55], v[168:171]
    ds_read_b128 v[64:67], v5 offset:10240
    v_mfma_f32_16x16x32_bf16 v[172:175], v[20:23], v[56:59], v[172:175]
    ds_read_b128 v[68:71], v5 offset:11264
    v_mfma_f32_16x16x32_bf16 v[176:179], v[24:27], v[52:55], v[176:179]
    ds_read_b128 v[72:75], v5 offset:12288
    v_mfma_f32_16x16x32_bf16 v[180:183], v[24:27], v[56:59], v[180:183]
    ds_read_b128 v[76:79], v5 offset:13312
    v_mfma_f32_16x16x32_bf16 v[184:187], v[28:31], v[52:55], v[184:187]
    ds_read_b128 v[80:83], v5 offset:14336
    v_mfma_f32_16x16x32_bf16 v[188:191], v[28:31], v[56:59], v[188:191]
    ds_read_b128 v[84:87], v5 offset:15360
    v_mfma_f32_16x16x32_bf16 v[192:195], v[32:35], v[52:55], v[192:195]
    ds_read_b128 v[88:91], v5 offset:16384
    v_mfma_f32_16x16x32_bf16 v[196:199], v[32:35], v[56:59], v[196:199]
    ds_read_b128 v[92:95], v5 offset:17408
    v_mfma_f32_16x16x32_bf16 v[200:203], v[36:39], v[52:55], v[200:203]
    v_mfma_f32_16x16x32_bf16 v[204:207], v[36:39], v[56:59], v[204:207]
    v_mfma_f32_16x16x32_bf16 v[208:211], v[40:43], v[52:55], v[208:211]
    v_mfma_f32_16x16x32_bf16 v[212:215], v[40:43], v[56:59], v[212:215]
    v_mfma_f32_16x16x32_bf16 v[216:219], v[44:47], v[52:55], v[216:219]
    v_mfma_f32_16x16x32_bf16 v[220:223], v[44:47], v[56:59], v[220:223]
    v_mfma_f32_16x16x32_bf16 v[224:227], v[48:51], v[52:55], v[224:227]
    v_mfma_f32_16x16x32_bf16 v[228:231], v[48:51], v[56:59], v[228:231]
    s_waitcnt lgkmcnt(0)
    s_barrier
    ds_read_b128 v[52:55], v8 offset:34816
    v_mfma_f32_16x16x32_bf16 v[160:163], v[60:63], v[96:99], v[160:163]
    ds_read_b128 v[56:59], v8 offset:36864
    v_mfma_f32_16x16x32_bf16 v[164:167], v[60:63], v[100:103], v[164:167]
    ds_read_b128 v[16:19], v5 offset:34816
    v_mfma_f32_16x16x32_bf16 v[168:171], v[64:67], v[96:99], v[168:171]
    ds_read_b128 v[20:23], v5 offset:35840
    v_mfma_f32_16x16x32_bf16 v[172:175], v[64:67], v[100:103], v[172:175]
    ds_read_b128 v[24:27], v5 offset:36864
    v_mfma_f32_16x16x32_bf16 v[176:179], v[68:71], v[96:99], v[176:179]
    ds_read_b128 v[28:31], v5 offset:37888
    v_mfma_f32_16x16x32_bf16 v[180:183], v[68:71], v[100:103], v[180:183]
    ds_read_b128 v[32:35], v5 offset:38912
    v_mfma_f32_16x16x32_bf16 v[184:187], v[72:75], v[96:99], v[184:187]
    ds_read_b128 v[36:39], v5 offset:39936
    v_mfma_f32_16x16x32_bf16 v[188:191], v[72:75], v[100:103], v[188:191]
    ds_read_b128 v[40:43], v5 offset:40960
    v_mfma_f32_16x16x32_bf16 v[192:195], v[76:79], v[96:99], v[192:195]
    ds_read_b128 v[44:47], v5 offset:41984
    v_mfma_f32_16x16x32_bf16 v[196:199], v[76:79], v[100:103], v[196:199]
    ds_read_b128 v[48:51], v5 offset:43008
    v_mfma_f32_16x16x32_bf16 v[200:203], v[80:83], v[96:99], v[200:203]
    v_mfma_f32_16x16x32_bf16 v[204:207], v[80:83], v[100:103], v[204:207]
    v_mfma_f32_16x16x32_bf16 v[208:211], v[84:87], v[96:99], v[208:211]
    v_mfma_f32_16x16x32_bf16 v[212:215], v[84:87], v[100:103], v[212:215]
    v_mfma_f32_16x16x32_bf16 v[216:219], v[88:91], v[96:99], v[216:219]
    v_mfma_f32_16x16x32_bf16 v[220:223], v[88:91], v[100:103], v[220:223]
    v_mfma_f32_16x16x32_bf16 v[224:227], v[92:95], v[96:99], v[224:227]
    v_mfma_f32_16x16x32_bf16 v[228:231], v[92:95], v[100:103], v[228:231]
    s_waitcnt lgkmcnt(0)
    ds_read_b128 v[96:99], v9 offset:34816
    v_mfma_f32_16x16x32_bf16 v[160:163], v[16:19], v[52:55], v[160:163]
    ds_read_b128 v[100:103], v9 offset:36864
    v_mfma_f32_16x16x32_bf16 v[164:167], v[16:19], v[56:59], v[164:167]
    ds_read_b128 v[60:63], v5 offset:44032
    v_mfma_f32_16x16x32_bf16 v[168:171], v[20:23], v[52:55], v[168:171]
    ds_read_b128 v[64:67], v5 offset:45056
    v_mfma_f32_16x16x32_bf16 v[172:175], v[20:23], v[56:59], v[172:175]
    ds_read_b128 v[68:71], v5 offset:46080
    v_mfma_f32_16x16x32_bf16 v[176:179], v[24:27], v[52:55], v[176:179]
    ds_read_b128 v[72:75], v5 offset:47104
    v_mfma_f32_16x16x32_bf16 v[180:183], v[24:27], v[56:59], v[180:183]
    ds_read_b128 v[76:79], v5 offset:48128
    v_mfma_f32_16x16x32_bf16 v[184:187], v[28:31], v[52:55], v[184:187]
    ds_read_b128 v[80:83], v5 offset:49152
    v_mfma_f32_16x16x32_bf16 v[188:191], v[28:31], v[56:59], v[188:191]
    ds_read_b128 v[84:87], v5 offset:50176
    v_mfma_f32_16x16x32_bf16 v[192:195], v[32:35], v[52:55], v[192:195]
    ds_read_b128 v[88:91], v5 offset:51200
    v_mfma_f32_16x16x32_bf16 v[196:199], v[32:35], v[56:59], v[196:199]
    ds_read_b128 v[92:95], v5 offset:52224
    v_mfma_f32_16x16x32_bf16 v[200:203], v[36:39], v[52:55], v[200:203]
    v_mfma_f32_16x16x32_bf16 v[204:207], v[36:39], v[56:59], v[204:207]
    v_mfma_f32_16x16x32_bf16 v[208:211], v[40:43], v[52:55], v[208:211]
    v_mfma_f32_16x16x32_bf16 v[212:215], v[40:43], v[56:59], v[212:215]
    v_mfma_f32_16x16x32_bf16 v[216:219], v[44:47], v[52:55], v[216:219]
    v_mfma_f32_16x16x32_bf16 v[220:223], v[44:47], v[56:59], v[220:223]
    v_mfma_f32_16x16x32_bf16 v[224:227], v[48:51], v[52:55], v[224:227]
    v_mfma_f32_16x16x32_bf16 v[228:231], v[48:51], v[56:59], v[228:231]
    s_waitcnt lgkmcnt(0)
    s_add_u32 s48, s48, 1
    s_cmp_lt_u32 s48, 5
    s_cbranch_scc1 parallel_sum__linear_kernel_hedgehog__mixer_gmlp__prompt_kernel_cl
    s_waitcnt vmcnt(0)
    s_lshr_b32 s40, s37, 4
    s_mul_i32 s41, s33, 9
    s_and_b32 s42, s33, 1
    s_add_u32 s43, s41, s42
    s_lshr_b32 s43, s43, 1
    s_add_u32 s44, s41, 8
    s_cmp_eq_u32 s42, 0
    s_cselect_b32 s44, s44, s41
    s_lshr_b32 s44, s44, 1
    s_lshl_b32 s42, s42, 3
    s_mul_i32 s54, s40, 90
    s_add_u32 s55, s54, s44
    s_add_u32 s54, s54, s43
    s_lshl_b32 s54, s54, 10
    s_lshl_b32 s55, s55, 10
    s_add_u32 s55, s55, s42
    s_add_u32 s54, s54, 20971520
    s_add_u32 s55, s55, 20971520
    s_add_u32 s56, s54, 92160
    s_add_u32 s57, s55, 92160
    v_add_u32 v12, 0, v3
    buffer_load_dwordx4 v[104:107], v12, s[20:23], s54 offen offset:0
    buffer_load_dwordx4 v[108:111], v12, s[20:23], s54 offen offset:1024
    buffer_load_dwordx4 v[112:115], v12, s[20:23], s54 offen offset:2048
    buffer_load_dwordx4 v[116:119], v12, s[20:23], s54 offen offset:3072
    buffer_load_dwordx2 v[120:121], v12, s[20:23], s55 offen sc1
    buffer_load_dwordx4 v[122:125], v12, s[20:23], s56 offen offset:0
    buffer_load_dwordx4 v[126:129], v12, s[20:23], s56 offen offset:1024
    buffer_load_dwordx4 v[130:133], v12, s[20:23], s56 offen offset:2048
    buffer_load_dwordx4 v[134:137], v12, s[20:23], s56 offen offset:3072
    buffer_load_dwordx2 v[138:139], v12, s[20:23], s57 offen sc1
    s_barrier
    ds_read_b128 v[52:55], v6 offset:0
    v_mfma_f32_16x16x32_bf16 v[160:163], v[60:63], v[96:99], v[160:163]
    ds_read_b128 v[56:59], v6 offset:2048
    v_mfma_f32_16x16x32_bf16 v[164:167], v[60:63], v[100:103], v[164:167]
    ds_read_b128 v[16:19], v4 offset:0
    v_mfma_f32_16x16x32_bf16 v[168:171], v[64:67], v[96:99], v[168:171]
    ds_read_b128 v[20:23], v4 offset:1024
    v_mfma_f32_16x16x32_bf16 v[172:175], v[64:67], v[100:103], v[172:175]
    ds_read_b128 v[24:27], v4 offset:2048
    v_mfma_f32_16x16x32_bf16 v[176:179], v[68:71], v[96:99], v[176:179]
    ds_read_b128 v[28:31], v4 offset:3072
    v_mfma_f32_16x16x32_bf16 v[180:183], v[68:71], v[100:103], v[180:183]
    ds_read_b128 v[32:35], v4 offset:4096
    v_mfma_f32_16x16x32_bf16 v[184:187], v[72:75], v[96:99], v[184:187]
    ds_read_b128 v[36:39], v4 offset:5120
    v_mfma_f32_16x16x32_bf16 v[188:191], v[72:75], v[100:103], v[188:191]
    ds_read_b128 v[40:43], v4 offset:6144
    v_mfma_f32_16x16x32_bf16 v[192:195], v[76:79], v[96:99], v[192:195]
    ds_read_b128 v[44:47], v4 offset:7168
    v_mfma_f32_16x16x32_bf16 v[196:199], v[76:79], v[100:103], v[196:199]
    ds_read_b128 v[48:51], v4 offset:8192
    v_mfma_f32_16x16x32_bf16 v[200:203], v[80:83], v[96:99], v[200:203]
    v_mfma_f32_16x16x32_bf16 v[204:207], v[80:83], v[100:103], v[204:207]
    v_mfma_f32_16x16x32_bf16 v[208:211], v[84:87], v[96:99], v[208:211]
    v_mfma_f32_16x16x32_bf16 v[212:215], v[84:87], v[100:103], v[212:215]
    v_mfma_f32_16x16x32_bf16 v[216:219], v[88:91], v[96:99], v[216:219]
    v_mfma_f32_16x16x32_bf16 v[220:223], v[88:91], v[100:103], v[220:223]
    v_mfma_f32_16x16x32_bf16 v[224:227], v[92:95], v[96:99], v[224:227]
    v_mfma_f32_16x16x32_bf16 v[228:231], v[92:95], v[100:103], v[228:231]
    s_waitcnt lgkmcnt(0)
    ds_read_b128 v[96:99], v7 offset:0
    v_mfma_f32_16x16x32_bf16 v[160:163], v[16:19], v[52:55], v[160:163]
    ds_read_b128 v[100:103], v7 offset:2048
    v_mfma_f32_16x16x32_bf16 v[164:167], v[16:19], v[56:59], v[164:167]
    ds_read_b128 v[60:63], v4 offset:9216
    v_mfma_f32_16x16x32_bf16 v[168:171], v[20:23], v[52:55], v[168:171]
    ds_read_b128 v[64:67], v4 offset:10240
    v_mfma_f32_16x16x32_bf16 v[172:175], v[20:23], v[56:59], v[172:175]
    ds_read_b128 v[68:71], v4 offset:11264
    v_mfma_f32_16x16x32_bf16 v[176:179], v[24:27], v[52:55], v[176:179]
    ds_read_b128 v[72:75], v4 offset:12288
    v_mfma_f32_16x16x32_bf16 v[180:183], v[24:27], v[56:59], v[180:183]
    ds_read_b128 v[76:79], v4 offset:13312
    v_mfma_f32_16x16x32_bf16 v[184:187], v[28:31], v[52:55], v[184:187]
    ds_read_b128 v[80:83], v4 offset:14336
    v_mfma_f32_16x16x32_bf16 v[188:191], v[28:31], v[56:59], v[188:191]
    ds_read_b128 v[84:87], v4 offset:15360
    v_mfma_f32_16x16x32_bf16 v[192:195], v[32:35], v[52:55], v[192:195]
    ds_read_b128 v[88:91], v4 offset:16384
    v_mfma_f32_16x16x32_bf16 v[196:199], v[32:35], v[56:59], v[196:199]
    ds_read_b128 v[92:95], v4 offset:17408
    v_mfma_f32_16x16x32_bf16 v[200:203], v[36:39], v[52:55], v[200:203]
    v_mfma_f32_16x16x32_bf16 v[204:207], v[36:39], v[56:59], v[204:207]
    v_mfma_f32_16x16x32_bf16 v[208:211], v[40:43], v[52:55], v[208:211]
    v_mfma_f32_16x16x32_bf16 v[212:215], v[40:43], v[56:59], v[212:215]
    v_mfma_f32_16x16x32_bf16 v[216:219], v[44:47], v[52:55], v[216:219]
    v_mfma_f32_16x16x32_bf16 v[220:223], v[44:47], v[56:59], v[220:223]
    v_mfma_f32_16x16x32_bf16 v[224:227], v[48:51], v[52:55], v[224:227]
    v_mfma_f32_16x16x32_bf16 v[228:231], v[48:51], v[56:59], v[228:231]
    s_waitcnt lgkmcnt(0)
    s_barrier
    ds_read_b128 v[52:55], v6 offset:34816
    v_mfma_f32_16x16x32_bf16 v[160:163], v[60:63], v[96:99], v[160:163]
    ds_read_b128 v[56:59], v6 offset:36864
    v_mfma_f32_16x16x32_bf16 v[164:167], v[60:63], v[100:103], v[164:167]
    ds_read_b128 v[16:19], v4 offset:34816
    v_mfma_f32_16x16x32_bf16 v[168:171], v[64:67], v[96:99], v[168:171]
    ds_read_b128 v[20:23], v4 offset:35840
    v_mfma_f32_16x16x32_bf16 v[172:175], v[64:67], v[100:103], v[172:175]
    ds_read_b128 v[24:27], v4 offset:36864
    v_mfma_f32_16x16x32_bf16 v[176:179], v[68:71], v[96:99], v[176:179]
    ds_read_b128 v[28:31], v4 offset:37888
    v_mfma_f32_16x16x32_bf16 v[180:183], v[68:71], v[100:103], v[180:183]
    ds_read_b128 v[32:35], v4 offset:38912
    v_mfma_f32_16x16x32_bf16 v[184:187], v[72:75], v[96:99], v[184:187]
    ds_read_b128 v[36:39], v4 offset:39936
    v_mfma_f32_16x16x32_bf16 v[188:191], v[72:75], v[100:103], v[188:191]
    ds_read_b128 v[40:43], v4 offset:40960
    v_mfma_f32_16x16x32_bf16 v[192:195], v[76:79], v[96:99], v[192:195]
    ds_read_b128 v[44:47], v4 offset:41984
    v_mfma_f32_16x16x32_bf16 v[196:199], v[76:79], v[100:103], v[196:199]
    ds_read_b128 v[48:51], v4 offset:43008
    v_mfma_f32_16x16x32_bf16 v[200:203], v[80:83], v[96:99], v[200:203]
    v_mfma_f32_16x16x32_bf16 v[204:207], v[80:83], v[100:103], v[204:207]
    v_mfma_f32_16x16x32_bf16 v[208:211], v[84:87], v[96:99], v[208:211]
    v_mfma_f32_16x16x32_bf16 v[212:215], v[84:87], v[100:103], v[212:215]
    v_mfma_f32_16x16x32_bf16 v[216:219], v[88:91], v[96:99], v[216:219]
    v_mfma_f32_16x16x32_bf16 v[220:223], v[88:91], v[100:103], v[220:223]
    v_mfma_f32_16x16x32_bf16 v[224:227], v[92:95], v[96:99], v[224:227]
    v_mfma_f32_16x16x32_bf16 v[228:231], v[92:95], v[100:103], v[228:231]
    s_waitcnt lgkmcnt(0)
    ds_read_b128 v[96:99], v7 offset:34816
    v_mfma_f32_16x16x32_bf16 v[160:163], v[16:19], v[52:55], v[160:163]
    ds_read_b128 v[100:103], v7 offset:36864
    v_mfma_f32_16x16x32_bf16 v[164:167], v[16:19], v[56:59], v[164:167]
    ds_read_b128 v[60:63], v4 offset:44032
    v_mfma_f32_16x16x32_bf16 v[168:171], v[20:23], v[52:55], v[168:171]
    ds_read_b128 v[64:67], v4 offset:45056
    v_mfma_f32_16x16x32_bf16 v[172:175], v[20:23], v[56:59], v[172:175]
    ds_read_b128 v[68:71], v4 offset:46080
    v_mfma_f32_16x16x32_bf16 v[176:179], v[24:27], v[52:55], v[176:179]
    ds_read_b128 v[72:75], v4 offset:47104
    v_mfma_f32_16x16x32_bf16 v[180:183], v[24:27], v[56:59], v[180:183]
    ds_read_b128 v[76:79], v4 offset:48128
    v_mfma_f32_16x16x32_bf16 v[184:187], v[28:31], v[52:55], v[184:187]
    ds_read_b128 v[80:83], v4 offset:49152
    v_mfma_f32_16x16x32_bf16 v[188:191], v[28:31], v[56:59], v[188:191]
    ds_read_b128 v[84:87], v4 offset:50176
    v_mfma_f32_16x16x32_bf16 v[192:195], v[32:35], v[52:55], v[192:195]
    ds_read_b128 v[88:91], v4 offset:51200
    v_mfma_f32_16x16x32_bf16 v[196:199], v[32:35], v[56:59], v[196:199]
    ds_read_b128 v[92:95], v4 offset:52224
    v_mfma_f32_16x16x32_bf16 v[200:203], v[36:39], v[52:55], v[200:203]
    v_mfma_f32_16x16x32_bf16 v[204:207], v[36:39], v[56:59], v[204:207]
    v_mfma_f32_16x16x32_bf16 v[208:211], v[40:43], v[52:55], v[208:211]
    v_mfma_f32_16x16x32_bf16 v[212:215], v[40:43], v[56:59], v[212:215]
    v_mfma_f32_16x16x32_bf16 v[216:219], v[44:47], v[52:55], v[216:219]
    v_mfma_f32_16x16x32_bf16 v[220:223], v[44:47], v[56:59], v[220:223]
    v_mfma_f32_16x16x32_bf16 v[224:227], v[48:51], v[52:55], v[224:227]
    v_mfma_f32_16x16x32_bf16 v[228:231], v[48:51], v[56:59], v[228:231]
    s_waitcnt lgkmcnt(0)
    s_barrier
    ds_read_b128 v[52:55], v8 offset:0
    v_mfma_f32_16x16x32_bf16 v[160:163], v[60:63], v[96:99], v[160:163]
    ds_read_b128 v[56:59], v8 offset:2048
    v_mfma_f32_16x16x32_bf16 v[164:167], v[60:63], v[100:103], v[164:167]
    ds_read_b128 v[16:19], v5 offset:0
    v_mfma_f32_16x16x32_bf16 v[168:171], v[64:67], v[96:99], v[168:171]
    ds_read_b128 v[20:23], v5 offset:1024
    v_mfma_f32_16x16x32_bf16 v[172:175], v[64:67], v[100:103], v[172:175]
    ds_read_b128 v[24:27], v5 offset:2048
    v_mfma_f32_16x16x32_bf16 v[176:179], v[68:71], v[96:99], v[176:179]
    ds_read_b128 v[28:31], v5 offset:3072
    v_mfma_f32_16x16x32_bf16 v[180:183], v[68:71], v[100:103], v[180:183]
    ds_read_b128 v[32:35], v5 offset:4096
    v_mfma_f32_16x16x32_bf16 v[184:187], v[72:75], v[96:99], v[184:187]
    ds_read_b128 v[36:39], v5 offset:5120
    v_mfma_f32_16x16x32_bf16 v[188:191], v[72:75], v[100:103], v[188:191]
    ds_read_b128 v[40:43], v5 offset:6144
    v_mfma_f32_16x16x32_bf16 v[192:195], v[76:79], v[96:99], v[192:195]
    ds_read_b128 v[44:47], v5 offset:7168
    v_mfma_f32_16x16x32_bf16 v[196:199], v[76:79], v[100:103], v[196:199]
    ds_read_b128 v[48:51], v5 offset:8192
    v_mfma_f32_16x16x32_bf16 v[200:203], v[80:83], v[96:99], v[200:203]
    v_mfma_f32_16x16x32_bf16 v[204:207], v[80:83], v[100:103], v[204:207]
    v_mfma_f32_16x16x32_bf16 v[208:211], v[84:87], v[96:99], v[208:211]
    v_mfma_f32_16x16x32_bf16 v[212:215], v[84:87], v[100:103], v[212:215]
    v_mfma_f32_16x16x32_bf16 v[216:219], v[88:91], v[96:99], v[216:219]
    v_mfma_f32_16x16x32_bf16 v[220:223], v[88:91], v[100:103], v[220:223]
    v_mfma_f32_16x16x32_bf16 v[224:227], v[92:95], v[96:99], v[224:227]
    v_mfma_f32_16x16x32_bf16 v[228:231], v[92:95], v[100:103], v[228:231]
    s_waitcnt lgkmcnt(0)
    ds_read_b128 v[96:99], v9 offset:0
    v_mfma_f32_16x16x32_bf16 v[160:163], v[16:19], v[52:55], v[160:163]
    ds_read_b128 v[100:103], v9 offset:2048
    v_mfma_f32_16x16x32_bf16 v[164:167], v[16:19], v[56:59], v[164:167]
    ds_read_b128 v[60:63], v5 offset:9216
    v_mfma_f32_16x16x32_bf16 v[168:171], v[20:23], v[52:55], v[168:171]
    ds_read_b128 v[64:67], v5 offset:10240
    v_mfma_f32_16x16x32_bf16 v[172:175], v[20:23], v[56:59], v[172:175]
    ds_read_b128 v[68:71], v5 offset:11264
    v_mfma_f32_16x16x32_bf16 v[176:179], v[24:27], v[52:55], v[176:179]
    ds_read_b128 v[72:75], v5 offset:12288
    v_mfma_f32_16x16x32_bf16 v[180:183], v[24:27], v[56:59], v[180:183]
    ds_read_b128 v[76:79], v5 offset:13312
    v_mfma_f32_16x16x32_bf16 v[184:187], v[28:31], v[52:55], v[184:187]
    ds_read_b128 v[80:83], v5 offset:14336
    v_mfma_f32_16x16x32_bf16 v[188:191], v[28:31], v[56:59], v[188:191]
    ds_read_b128 v[84:87], v5 offset:15360
    v_mfma_f32_16x16x32_bf16 v[192:195], v[32:35], v[52:55], v[192:195]
    ds_read_b128 v[88:91], v5 offset:16384
    v_mfma_f32_16x16x32_bf16 v[196:199], v[32:35], v[56:59], v[196:199]
    ds_read_b128 v[92:95], v5 offset:17408
    v_mfma_f32_16x16x32_bf16 v[200:203], v[36:39], v[52:55], v[200:203]
    v_mfma_f32_16x16x32_bf16 v[204:207], v[36:39], v[56:59], v[204:207]
    v_mfma_f32_16x16x32_bf16 v[208:211], v[40:43], v[52:55], v[208:211]
    v_mfma_f32_16x16x32_bf16 v[212:215], v[40:43], v[56:59], v[212:215]
    v_mfma_f32_16x16x32_bf16 v[216:219], v[44:47], v[52:55], v[216:219]
    v_mfma_f32_16x16x32_bf16 v[220:223], v[44:47], v[56:59], v[220:223]
    v_mfma_f32_16x16x32_bf16 v[224:227], v[48:51], v[52:55], v[224:227]
    v_mfma_f32_16x16x32_bf16 v[228:231], v[48:51], v[56:59], v[228:231]
    s_waitcnt lgkmcnt(0)
    s_barrier
    ds_read_b128 v[52:55], v8 offset:34816
    v_mfma_f32_16x16x32_bf16 v[160:163], v[60:63], v[96:99], v[160:163]
    ds_read_b128 v[56:59], v8 offset:36864
    v_mfma_f32_16x16x32_bf16 v[164:167], v[60:63], v[100:103], v[164:167]
    ds_read_b128 v[16:19], v5 offset:34816
    v_mfma_f32_16x16x32_bf16 v[168:171], v[64:67], v[96:99], v[168:171]
    ds_read_b128 v[20:23], v5 offset:35840
    v_mfma_f32_16x16x32_bf16 v[172:175], v[64:67], v[100:103], v[172:175]
    ds_read_b128 v[24:27], v5 offset:36864
    v_mfma_f32_16x16x32_bf16 v[176:179], v[68:71], v[96:99], v[176:179]
    ds_read_b128 v[28:31], v5 offset:37888
    v_mfma_f32_16x16x32_bf16 v[180:183], v[68:71], v[100:103], v[180:183]
    ds_read_b128 v[32:35], v5 offset:38912
    v_mfma_f32_16x16x32_bf16 v[184:187], v[72:75], v[96:99], v[184:187]
    ds_read_b128 v[36:39], v5 offset:39936
    v_mfma_f32_16x16x32_bf16 v[188:191], v[72:75], v[100:103], v[188:191]
    ds_read_b128 v[40:43], v5 offset:40960
    v_mfma_f32_16x16x32_bf16 v[192:195], v[76:79], v[96:99], v[192:195]
    ds_read_b128 v[44:47], v5 offset:41984
    v_mfma_f32_16x16x32_bf16 v[196:199], v[76:79], v[100:103], v[196:199]
    ds_read_b128 v[48:51], v5 offset:43008
    v_mfma_f32_16x16x32_bf16 v[200:203], v[80:83], v[96:99], v[200:203]
    v_mfma_f32_16x16x32_bf16 v[204:207], v[80:83], v[100:103], v[204:207]
    v_mfma_f32_16x16x32_bf16 v[208:211], v[84:87], v[96:99], v[208:211]
    v_mfma_f32_16x16x32_bf16 v[212:215], v[84:87], v[100:103], v[212:215]
    v_mfma_f32_16x16x32_bf16 v[216:219], v[88:91], v[96:99], v[216:219]
    v_mfma_f32_16x16x32_bf16 v[220:223], v[88:91], v[100:103], v[220:223]
    v_mfma_f32_16x16x32_bf16 v[224:227], v[92:95], v[96:99], v[224:227]
    v_mfma_f32_16x16x32_bf16 v[228:231], v[92:95], v[100:103], v[228:231]
    s_waitcnt lgkmcnt(0)
    ds_read_b128 v[96:99], v9 offset:34816
    v_mfma_f32_16x16x32_bf16 v[160:163], v[16:19], v[52:55], v[160:163]
    ds_read_b128 v[100:103], v9 offset:36864
    v_mfma_f32_16x16x32_bf16 v[164:167], v[16:19], v[56:59], v[164:167]
    ds_read_b128 v[60:63], v5 offset:44032
    v_mfma_f32_16x16x32_bf16 v[168:171], v[20:23], v[52:55], v[168:171]
    ds_read_b128 v[64:67], v5 offset:45056
    v_mfma_f32_16x16x32_bf16 v[172:175], v[20:23], v[56:59], v[172:175]
    ds_read_b128 v[68:71], v5 offset:46080
    v_mfma_f32_16x16x32_bf16 v[176:179], v[24:27], v[52:55], v[176:179]
    ds_read_b128 v[72:75], v5 offset:47104
    v_mfma_f32_16x16x32_bf16 v[180:183], v[24:27], v[56:59], v[180:183]
    ds_read_b128 v[76:79], v5 offset:48128
    v_mfma_f32_16x16x32_bf16 v[184:187], v[28:31], v[52:55], v[184:187]
    ds_read_b128 v[80:83], v5 offset:49152
    v_mfma_f32_16x16x32_bf16 v[188:191], v[28:31], v[56:59], v[188:191]
    ds_read_b128 v[84:87], v5 offset:50176
    v_mfma_f32_16x16x32_bf16 v[192:195], v[32:35], v[52:55], v[192:195]
    ds_read_b128 v[88:91], v5 offset:51200
    v_mfma_f32_16x16x32_bf16 v[196:199], v[32:35], v[56:59], v[196:199]
    ds_read_b128 v[92:95], v5 offset:52224
    v_mfma_f32_16x16x32_bf16 v[200:203], v[36:39], v[52:55], v[200:203]
    v_mfma_f32_16x16x32_bf16 v[204:207], v[36:39], v[56:59], v[204:207]
    v_mfma_f32_16x16x32_bf16 v[208:211], v[40:43], v[52:55], v[208:211]
    v_mfma_f32_16x16x32_bf16 v[212:215], v[40:43], v[56:59], v[212:215]
    v_mfma_f32_16x16x32_bf16 v[216:219], v[44:47], v[52:55], v[216:219]
    v_mfma_f32_16x16x32_bf16 v[220:223], v[44:47], v[56:59], v[220:223]
    v_mfma_f32_16x16x32_bf16 v[224:227], v[48:51], v[52:55], v[224:227]
    v_mfma_f32_16x16x32_bf16 v[228:231], v[48:51], v[56:59], v[228:231]
    s_waitcnt lgkmcnt(0)
    s_barrier
    ds_read_b128 v[52:55], v6 offset:0
    v_mfma_f32_16x16x32_bf16 v[160:163], v[60:63], v[96:99], v[160:163]
    ds_read_b128 v[56:59], v6 offset:2048
    v_mfma_f32_16x16x32_bf16 v[164:167], v[60:63], v[100:103], v[164:167]
    ds_read_b128 v[16:19], v4 offset:0
    v_mfma_f32_16x16x32_bf16 v[168:171], v[64:67], v[96:99], v[168:171]
    ds_read_b128 v[20:23], v4 offset:1024
    v_mfma_f32_16x16x32_bf16 v[172:175], v[64:67], v[100:103], v[172:175]
    ds_read_b128 v[24:27], v4 offset:2048
    v_mfma_f32_16x16x32_bf16 v[176:179], v[68:71], v[96:99], v[176:179]
    ds_read_b128 v[28:31], v4 offset:3072
    v_mfma_f32_16x16x32_bf16 v[180:183], v[68:71], v[100:103], v[180:183]
    ds_read_b128 v[32:35], v4 offset:4096
    v_mfma_f32_16x16x32_bf16 v[184:187], v[72:75], v[96:99], v[184:187]
    ds_read_b128 v[36:39], v4 offset:5120
    v_mfma_f32_16x16x32_bf16 v[188:191], v[72:75], v[100:103], v[188:191]
    ds_read_b128 v[40:43], v4 offset:6144
    v_mfma_f32_16x16x32_bf16 v[192:195], v[76:79], v[96:99], v[192:195]
    ds_read_b128 v[44:47], v4 offset:7168
    v_mfma_f32_16x16x32_bf16 v[196:199], v[76:79], v[100:103], v[196:199]
    ds_read_b128 v[48:51], v4 offset:8192
    v_mfma_f32_16x16x32_bf16 v[200:203], v[80:83], v[96:99], v[200:203]
    v_mfma_f32_16x16x32_bf16 v[204:207], v[80:83], v[100:103], v[204:207]
    v_mfma_f32_16x16x32_bf16 v[208:211], v[84:87], v[96:99], v[208:211]
    v_mfma_f32_16x16x32_bf16 v[212:215], v[84:87], v[100:103], v[212:215]
    v_mfma_f32_16x16x32_bf16 v[216:219], v[88:91], v[96:99], v[216:219]
    v_mfma_f32_16x16x32_bf16 v[220:223], v[88:91], v[100:103], v[220:223]
    v_mfma_f32_16x16x32_bf16 v[224:227], v[92:95], v[96:99], v[224:227]
    v_mfma_f32_16x16x32_bf16 v[228:231], v[92:95], v[100:103], v[228:231]
    s_waitcnt lgkmcnt(0)
    ds_read_b128 v[96:99], v7 offset:0
    v_mfma_f32_16x16x32_bf16 v[160:163], v[16:19], v[52:55], v[160:163]
    ds_read_b128 v[100:103], v7 offset:2048
    v_mfma_f32_16x16x32_bf16 v[164:167], v[16:19], v[56:59], v[164:167]
    ds_read_b128 v[60:63], v4 offset:9216
    v_mfma_f32_16x16x32_bf16 v[168:171], v[20:23], v[52:55], v[168:171]
    ds_read_b128 v[64:67], v4 offset:10240
    v_mfma_f32_16x16x32_bf16 v[172:175], v[20:23], v[56:59], v[172:175]
    ds_read_b128 v[68:71], v4 offset:11264
    v_mfma_f32_16x16x32_bf16 v[176:179], v[24:27], v[52:55], v[176:179]
    ds_read_b128 v[72:75], v4 offset:12288
    v_mfma_f32_16x16x32_bf16 v[180:183], v[24:27], v[56:59], v[180:183]
    ds_read_b128 v[76:79], v4 offset:13312
    v_mfma_f32_16x16x32_bf16 v[184:187], v[28:31], v[52:55], v[184:187]
    ds_read_b128 v[80:83], v4 offset:14336
    v_mfma_f32_16x16x32_bf16 v[188:191], v[28:31], v[56:59], v[188:191]
    ds_read_b128 v[84:87], v4 offset:15360
    v_mfma_f32_16x16x32_bf16 v[192:195], v[32:35], v[52:55], v[192:195]
    ds_read_b128 v[88:91], v4 offset:16384
    v_mfma_f32_16x16x32_bf16 v[196:199], v[32:35], v[56:59], v[196:199]
    ds_read_b128 v[92:95], v4 offset:17408
    v_mfma_f32_16x16x32_bf16 v[200:203], v[36:39], v[52:55], v[200:203]
    v_mfma_f32_16x16x32_bf16 v[204:207], v[36:39], v[56:59], v[204:207]
    v_mfma_f32_16x16x32_bf16 v[208:211], v[40:43], v[52:55], v[208:211]
    v_mfma_f32_16x16x32_bf16 v[212:215], v[40:43], v[56:59], v[212:215]
    v_mfma_f32_16x16x32_bf16 v[216:219], v[44:47], v[52:55], v[216:219]
    v_mfma_f32_16x16x32_bf16 v[220:223], v[44:47], v[56:59], v[220:223]
    v_mfma_f32_16x16x32_bf16 v[224:227], v[48:51], v[52:55], v[224:227]
    v_mfma_f32_16x16x32_bf16 v[228:231], v[48:51], v[56:59], v[228:231]
    s_waitcnt lgkmcnt(0)
    s_barrier
    ds_read_b128 v[52:55], v6 offset:34816
    v_mfma_f32_16x16x32_bf16 v[160:163], v[60:63], v[96:99], v[160:163]
    ds_read_b128 v[56:59], v6 offset:36864
    v_mfma_f32_16x16x32_bf16 v[164:167], v[60:63], v[100:103], v[164:167]
    ds_read_b128 v[16:19], v4 offset:34816
    v_mfma_f32_16x16x32_bf16 v[168:171], v[64:67], v[96:99], v[168:171]
    ds_read_b128 v[20:23], v4 offset:35840
    v_mfma_f32_16x16x32_bf16 v[172:175], v[64:67], v[100:103], v[172:175]
    ds_read_b128 v[24:27], v4 offset:36864
    v_mfma_f32_16x16x32_bf16 v[176:179], v[68:71], v[96:99], v[176:179]
    ds_read_b128 v[28:31], v4 offset:37888
    v_mfma_f32_16x16x32_bf16 v[180:183], v[68:71], v[100:103], v[180:183]
    ds_read_b128 v[32:35], v4 offset:38912
    v_mfma_f32_16x16x32_bf16 v[184:187], v[72:75], v[96:99], v[184:187]
    ds_read_b128 v[36:39], v4 offset:39936
    v_mfma_f32_16x16x32_bf16 v[188:191], v[72:75], v[100:103], v[188:191]
    ds_read_b128 v[40:43], v4 offset:40960
    v_mfma_f32_16x16x32_bf16 v[192:195], v[76:79], v[96:99], v[192:195]
    ds_read_b128 v[44:47], v4 offset:41984
    v_mfma_f32_16x16x32_bf16 v[196:199], v[76:79], v[100:103], v[196:199]
    ds_read_b128 v[48:51], v4 offset:43008
    v_mfma_f32_16x16x32_bf16 v[200:203], v[80:83], v[96:99], v[200:203]
    v_mfma_f32_16x16x32_bf16 v[204:207], v[80:83], v[100:103], v[204:207]
    v_mfma_f32_16x16x32_bf16 v[208:211], v[84:87], v[96:99], v[208:211]
    v_mfma_f32_16x16x32_bf16 v[212:215], v[84:87], v[100:103], v[212:215]
    v_mfma_f32_16x16x32_bf16 v[216:219], v[88:91], v[96:99], v[216:219]
    v_mfma_f32_16x16x32_bf16 v[220:223], v[88:91], v[100:103], v[220:223]
    v_mfma_f32_16x16x32_bf16 v[224:227], v[92:95], v[96:99], v[224:227]
    v_mfma_f32_16x16x32_bf16 v[228:231], v[92:95], v[100:103], v[228:231]
    s_waitcnt lgkmcnt(0)
    ds_read_b128 v[96:99], v7 offset:34816
    v_mfma_f32_16x16x32_bf16 v[160:163], v[16:19], v[52:55], v[160:163]
    ds_read_b128 v[100:103], v7 offset:36864
    v_mfma_f32_16x16x32_bf16 v[164:167], v[16:19], v[56:59], v[164:167]
    ds_read_b128 v[60:63], v4 offset:44032
    v_mfma_f32_16x16x32_bf16 v[168:171], v[20:23], v[52:55], v[168:171]
    ds_read_b128 v[64:67], v4 offset:45056
    v_mfma_f32_16x16x32_bf16 v[172:175], v[20:23], v[56:59], v[172:175]
    ds_read_b128 v[68:71], v4 offset:46080
    v_mfma_f32_16x16x32_bf16 v[176:179], v[24:27], v[52:55], v[176:179]
    ds_read_b128 v[72:75], v4 offset:47104
    v_mfma_f32_16x16x32_bf16 v[180:183], v[24:27], v[56:59], v[180:183]
    ds_read_b128 v[76:79], v4 offset:48128
    v_mfma_f32_16x16x32_bf16 v[184:187], v[28:31], v[52:55], v[184:187]
    ds_read_b128 v[80:83], v4 offset:49152
    v_mfma_f32_16x16x32_bf16 v[188:191], v[28:31], v[56:59], v[188:191]
    ds_read_b128 v[84:87], v4 offset:50176
    v_mfma_f32_16x16x32_bf16 v[192:195], v[32:35], v[52:55], v[192:195]
    ds_read_b128 v[88:91], v4 offset:51200
    v_mfma_f32_16x16x32_bf16 v[196:199], v[32:35], v[56:59], v[196:199]
    ds_read_b128 v[92:95], v4 offset:52224
    v_mfma_f32_16x16x32_bf16 v[200:203], v[36:39], v[52:55], v[200:203]
    v_mfma_f32_16x16x32_bf16 v[204:207], v[36:39], v[56:59], v[204:207]
    v_mfma_f32_16x16x32_bf16 v[208:211], v[40:43], v[52:55], v[208:211]
    v_mfma_f32_16x16x32_bf16 v[212:215], v[40:43], v[56:59], v[212:215]
    v_mfma_f32_16x16x32_bf16 v[216:219], v[44:47], v[52:55], v[216:219]
    v_mfma_f32_16x16x32_bf16 v[220:223], v[44:47], v[56:59], v[220:223]
    v_mfma_f32_16x16x32_bf16 v[224:227], v[48:51], v[52:55], v[224:227]
    v_mfma_f32_16x16x32_bf16 v[228:231], v[48:51], v[56:59], v[228:231]
    s_waitcnt lgkmcnt(0)
    s_barrier
    ds_read_b128 v[52:55], v8 offset:0
    v_mfma_f32_16x16x32_bf16 v[160:163], v[60:63], v[96:99], v[160:163]
    ds_read_b128 v[56:59], v8 offset:2048
    v_mfma_f32_16x16x32_bf16 v[164:167], v[60:63], v[100:103], v[164:167]
    ds_read_b128 v[16:19], v5 offset:0
    v_mfma_f32_16x16x32_bf16 v[168:171], v[64:67], v[96:99], v[168:171]
    ds_read_b128 v[20:23], v5 offset:1024
    v_mfma_f32_16x16x32_bf16 v[172:175], v[64:67], v[100:103], v[172:175]
    ds_read_b128 v[24:27], v5 offset:2048
    v_mfma_f32_16x16x32_bf16 v[176:179], v[68:71], v[96:99], v[176:179]
    ds_read_b128 v[28:31], v5 offset:3072
    v_mfma_f32_16x16x32_bf16 v[180:183], v[68:71], v[100:103], v[180:183]
    ds_read_b128 v[32:35], v5 offset:4096
    v_mfma_f32_16x16x32_bf16 v[184:187], v[72:75], v[96:99], v[184:187]
    ds_read_b128 v[36:39], v5 offset:5120
    v_mfma_f32_16x16x32_bf16 v[188:191], v[72:75], v[100:103], v[188:191]
    ds_read_b128 v[40:43], v5 offset:6144
    v_mfma_f32_16x16x32_bf16 v[192:195], v[76:79], v[96:99], v[192:195]
    ds_read_b128 v[44:47], v5 offset:7168
    v_mfma_f32_16x16x32_bf16 v[196:199], v[76:79], v[100:103], v[196:199]
    ds_read_b128 v[48:51], v5 offset:8192
    v_mfma_f32_16x16x32_bf16 v[200:203], v[80:83], v[96:99], v[200:203]
    v_mfma_f32_16x16x32_bf16 v[204:207], v[80:83], v[100:103], v[204:207]
    v_mfma_f32_16x16x32_bf16 v[208:211], v[84:87], v[96:99], v[208:211]
    v_mfma_f32_16x16x32_bf16 v[212:215], v[84:87], v[100:103], v[212:215]
    v_mfma_f32_16x16x32_bf16 v[216:219], v[88:91], v[96:99], v[216:219]
    v_mfma_f32_16x16x32_bf16 v[220:223], v[88:91], v[100:103], v[220:223]
    v_mfma_f32_16x16x32_bf16 v[224:227], v[92:95], v[96:99], v[224:227]
    v_mfma_f32_16x16x32_bf16 v[228:231], v[92:95], v[100:103], v[228:231]
    s_waitcnt lgkmcnt(0)
    ds_read_b128 v[96:99], v9 offset:0
    v_mfma_f32_16x16x32_bf16 v[160:163], v[16:19], v[52:55], v[160:163]
    ds_read_b128 v[100:103], v9 offset:2048
    v_mfma_f32_16x16x32_bf16 v[164:167], v[16:19], v[56:59], v[164:167]
    ds_read_b128 v[60:63], v5 offset:9216
    v_mfma_f32_16x16x32_bf16 v[168:171], v[20:23], v[52:55], v[168:171]
    ds_read_b128 v[64:67], v5 offset:10240
    v_mfma_f32_16x16x32_bf16 v[172:175], v[20:23], v[56:59], v[172:175]
    ds_read_b128 v[68:71], v5 offset:11264
    v_mfma_f32_16x16x32_bf16 v[176:179], v[24:27], v[52:55], v[176:179]
    ds_read_b128 v[72:75], v5 offset:12288
    v_mfma_f32_16x16x32_bf16 v[180:183], v[24:27], v[56:59], v[180:183]
    ds_read_b128 v[76:79], v5 offset:13312
    v_mfma_f32_16x16x32_bf16 v[184:187], v[28:31], v[52:55], v[184:187]
    ds_read_b128 v[80:83], v5 offset:14336
    v_mfma_f32_16x16x32_bf16 v[188:191], v[28:31], v[56:59], v[188:191]
    ds_read_b128 v[84:87], v5 offset:15360
    v_mfma_f32_16x16x32_bf16 v[192:195], v[32:35], v[52:55], v[192:195]
    ds_read_b128 v[88:91], v5 offset:16384
    v_mfma_f32_16x16x32_bf16 v[196:199], v[32:35], v[56:59], v[196:199]
    ds_read_b128 v[92:95], v5 offset:17408
    v_mfma_f32_16x16x32_bf16 v[200:203], v[36:39], v[52:55], v[200:203]
    v_mfma_f32_16x16x32_bf16 v[204:207], v[36:39], v[56:59], v[204:207]
    v_mfma_f32_16x16x32_bf16 v[208:211], v[40:43], v[52:55], v[208:211]
    v_mfma_f32_16x16x32_bf16 v[212:215], v[40:43], v[56:59], v[212:215]
    v_mfma_f32_16x16x32_bf16 v[216:219], v[44:47], v[52:55], v[216:219]
    v_mfma_f32_16x16x32_bf16 v[220:223], v[44:47], v[56:59], v[220:223]
    v_mfma_f32_16x16x32_bf16 v[224:227], v[48:51], v[52:55], v[224:227]
    v_mfma_f32_16x16x32_bf16 v[228:231], v[48:51], v[56:59], v[228:231]
    s_waitcnt lgkmcnt(0)
    s_barrier
    ds_read_b128 v[52:55], v8 offset:34816
    v_mfma_f32_16x16x32_bf16 v[160:163], v[60:63], v[96:99], v[160:163]
    ds_read_b128 v[56:59], v8 offset:36864
    v_mfma_f32_16x16x32_bf16 v[164:167], v[60:63], v[100:103], v[164:167]
    ds_read_b128 v[16:19], v5 offset:34816
    v_mfma_f32_16x16x32_bf16 v[168:171], v[64:67], v[96:99], v[168:171]
    ds_read_b128 v[20:23], v5 offset:35840
    v_mfma_f32_16x16x32_bf16 v[172:175], v[64:67], v[100:103], v[172:175]
    ds_read_b128 v[24:27], v5 offset:36864
    v_mfma_f32_16x16x32_bf16 v[176:179], v[68:71], v[96:99], v[176:179]
    ds_read_b128 v[28:31], v5 offset:37888
    v_mfma_f32_16x16x32_bf16 v[180:183], v[68:71], v[100:103], v[180:183]
    ds_read_b128 v[32:35], v5 offset:38912
    v_mfma_f32_16x16x32_bf16 v[184:187], v[72:75], v[96:99], v[184:187]
    ds_read_b128 v[36:39], v5 offset:39936
    v_mfma_f32_16x16x32_bf16 v[188:191], v[72:75], v[100:103], v[188:191]
    ds_read_b128 v[40:43], v5 offset:40960
    v_mfma_f32_16x16x32_bf16 v[192:195], v[76:79], v[96:99], v[192:195]
    ds_read_b128 v[44:47], v5 offset:41984
    v_mfma_f32_16x16x32_bf16 v[196:199], v[76:79], v[100:103], v[196:199]
    ds_read_b128 v[48:51], v5 offset:43008
    v_mfma_f32_16x16x32_bf16 v[200:203], v[80:83], v[96:99], v[200:203]
    v_mfma_f32_16x16x32_bf16 v[204:207], v[80:83], v[100:103], v[204:207]
    v_mfma_f32_16x16x32_bf16 v[208:211], v[84:87], v[96:99], v[208:211]
    v_mfma_f32_16x16x32_bf16 v[212:215], v[84:87], v[100:103], v[212:215]
    v_mfma_f32_16x16x32_bf16 v[216:219], v[88:91], v[96:99], v[216:219]
    v_mfma_f32_16x16x32_bf16 v[220:223], v[88:91], v[100:103], v[220:223]
    v_mfma_f32_16x16x32_bf16 v[224:227], v[92:95], v[96:99], v[224:227]
    v_mfma_f32_16x16x32_bf16 v[228:231], v[92:95], v[100:103], v[228:231]
    s_waitcnt lgkmcnt(0)
    ds_read_b128 v[96:99], v9 offset:34816
    v_mfma_f32_16x16x32_bf16 v[160:163], v[16:19], v[52:55], v[160:163]
    ds_read_b128 v[100:103], v9 offset:36864
    v_mfma_f32_16x16x32_bf16 v[164:167], v[16:19], v[56:59], v[164:167]
    ds_read_b128 v[60:63], v5 offset:44032
    v_mfma_f32_16x16x32_bf16 v[168:171], v[20:23], v[52:55], v[168:171]
    ds_read_b128 v[64:67], v5 offset:45056
    v_mfma_f32_16x16x32_bf16 v[172:175], v[20:23], v[56:59], v[172:175]
    ds_read_b128 v[68:71], v5 offset:46080
    v_mfma_f32_16x16x32_bf16 v[176:179], v[24:27], v[52:55], v[176:179]
    ds_read_b128 v[72:75], v5 offset:47104
    v_mfma_f32_16x16x32_bf16 v[180:183], v[24:27], v[56:59], v[180:183]
    ds_read_b128 v[76:79], v5 offset:48128
    v_mfma_f32_16x16x32_bf16 v[184:187], v[28:31], v[52:55], v[184:187]
    ds_read_b128 v[80:83], v5 offset:49152
    v_mfma_f32_16x16x32_bf16 v[188:191], v[28:31], v[56:59], v[188:191]
    ds_read_b128 v[84:87], v5 offset:50176
    v_mfma_f32_16x16x32_bf16 v[192:195], v[32:35], v[52:55], v[192:195]
    ds_read_b128 v[88:91], v5 offset:51200
    v_mfma_f32_16x16x32_bf16 v[196:199], v[32:35], v[56:59], v[196:199]
    ds_read_b128 v[92:95], v5 offset:52224
    v_mfma_f32_16x16x32_bf16 v[200:203], v[36:39], v[52:55], v[200:203]
    v_mfma_f32_16x16x32_bf16 v[204:207], v[36:39], v[56:59], v[204:207]
    v_mfma_f32_16x16x32_bf16 v[208:211], v[40:43], v[52:55], v[208:211]
    v_mfma_f32_16x16x32_bf16 v[212:215], v[40:43], v[56:59], v[212:215]
    v_mfma_f32_16x16x32_bf16 v[216:219], v[44:47], v[52:55], v[216:219]
    v_mfma_f32_16x16x32_bf16 v[220:223], v[44:47], v[56:59], v[220:223]
    v_mfma_f32_16x16x32_bf16 v[224:227], v[48:51], v[52:55], v[224:227]
    v_mfma_f32_16x16x32_bf16 v[228:231], v[48:51], v[56:59], v[228:231]
    s_waitcnt lgkmcnt(0)
    v_mfma_f32_16x16x32_bf16 v[160:163], v[60:63], v[96:99], v[160:163]
    v_mfma_f32_16x16x32_bf16 v[164:167], v[60:63], v[100:103], v[164:167]
    v_mfma_f32_16x16x32_bf16 v[168:171], v[64:67], v[96:99], v[168:171]
    v_mfma_f32_16x16x32_bf16 v[172:175], v[64:67], v[100:103], v[172:175]
    v_mfma_f32_16x16x32_bf16 v[176:179], v[68:71], v[96:99], v[176:179]
    v_mfma_f32_16x16x32_bf16 v[180:183], v[68:71], v[100:103], v[180:183]
    v_mfma_f32_16x16x32_bf16 v[184:187], v[72:75], v[96:99], v[184:187]
    v_mfma_f32_16x16x32_bf16 v[188:191], v[72:75], v[100:103], v[188:191]
    v_mfma_f32_16x16x32_bf16 v[192:195], v[76:79], v[96:99], v[192:195]
    v_mfma_f32_16x16x32_bf16 v[196:199], v[76:79], v[100:103], v[196:199]
    v_mfma_f32_16x16x32_bf16 v[200:203], v[80:83], v[96:99], v[200:203]
    v_mfma_f32_16x16x32_bf16 v[204:207], v[80:83], v[100:103], v[204:207]
    v_mfma_f32_16x16x32_bf16 v[208:211], v[84:87], v[96:99], v[208:211]
    v_mfma_f32_16x16x32_bf16 v[212:215], v[84:87], v[100:103], v[212:215]
    v_mfma_f32_16x16x32_bf16 v[216:219], v[88:91], v[96:99], v[216:219]
    v_mfma_f32_16x16x32_bf16 v[220:223], v[88:91], v[100:103], v[220:223]
    v_mfma_f32_16x16x32_bf16 v[224:227], v[92:95], v[96:99], v[224:227]
    v_mfma_f32_16x16x32_bf16 v[228:231], v[92:95], v[100:103], v[228:231]
parallel_sum__linear_kernel_hedgehog__mixer_gmlp__prompt_kernel_late:
    s_waitcnt vmcnt(0)
    v_lshlrev_b32 v13, 16, v13
    v_lshlrev_b32 v14, 16, v14
    v_mul_f32 v13, v13, v15
    v_mul_f32 v14, v14, v1
    v_add_u32 v6, s36, v3
    v_add_u32 v7, 1024, v6
    v_add_u32 v8, 69632, v6
    v_add_u32 v9, 69632, v7
    s_nop 3
    v_fma_f32 v224, v224, v15, v13
    v_fma_f32 v225, v225, v15, v13
    v_lshlrev_b32 v16, 16, v120
    v_and_b32 v17, 0xffff0000, v120
    v_mul_f32 v16, v16, v224
    v_mul_f32 v17, v17, v225
    v_cvt_pk_bf16_f32 v120, v16, v17
    v_fma_f32 v226, v226, v15, v13
    v_fma_f32 v227, v227, v15, v13
    v_lshlrev_b32 v18, 16, v121
    v_and_b32 v19, 0xffff0000, v121
    v_mul_f32 v18, v18, v226
    v_mul_f32 v19, v19, v227
    v_cvt_pk_bf16_f32 v121, v18, v19
    buffer_store_dwordx2 v[120:121], v3, s[20:23], s55 offen sc1
    v_fma_f32 v160, v160, v15, v13
    v_fma_f32 v161, v161, v15, v13
    v_lshlrev_b32 v16, 16, v104
    v_and_b32 v17, 0xffff0000, v104
    v_mul_f32 v16, v16, v160
    v_mul_f32 v17, v17, v161
    v_cvt_pk_bf16_f32 v104, v16, v17
    v_fma_f32 v162, v162, v15, v13
    v_fma_f32 v163, v163, v15, v13
    v_lshlrev_b32 v18, 16, v105
    v_and_b32 v19, 0xffff0000, v105
    v_mul_f32 v18, v18, v162
    v_mul_f32 v19, v19, v163
    v_cvt_pk_bf16_f32 v105, v18, v19
    v_fma_f32 v168, v168, v15, v13
    v_fma_f32 v169, v169, v15, v13
    v_lshlrev_b32 v20, 16, v106
    v_and_b32 v21, 0xffff0000, v106
    v_mul_f32 v20, v20, v168
    v_mul_f32 v21, v21, v169
    v_cvt_pk_bf16_f32 v106, v20, v21
    v_fma_f32 v170, v170, v15, v13
    v_fma_f32 v171, v171, v15, v13
    v_lshlrev_b32 v22, 16, v107
    v_and_b32 v23, 0xffff0000, v107
    v_mul_f32 v22, v22, v170
    v_mul_f32 v23, v23, v171
    v_cvt_pk_bf16_f32 v107, v22, v23
    buffer_store_dwordx4 v[104:107], v3, s[20:23], s54 offen offset:0 sc1
    ds_write_b128 v6, v[104:107] offset:0
    v_fma_f32 v176, v176, v15, v13
    v_fma_f32 v177, v177, v15, v13
    v_lshlrev_b32 v16, 16, v108
    v_and_b32 v17, 0xffff0000, v108
    v_mul_f32 v16, v16, v176
    v_mul_f32 v17, v17, v177
    v_cvt_pk_bf16_f32 v108, v16, v17
    v_fma_f32 v178, v178, v15, v13
    v_fma_f32 v179, v179, v15, v13
    v_lshlrev_b32 v18, 16, v109
    v_and_b32 v19, 0xffff0000, v109
    v_mul_f32 v18, v18, v178
    v_mul_f32 v19, v19, v179
    v_cvt_pk_bf16_f32 v109, v18, v19
    v_fma_f32 v184, v184, v15, v13
    v_fma_f32 v185, v185, v15, v13
    v_lshlrev_b32 v20, 16, v110
    v_and_b32 v21, 0xffff0000, v110
    v_mul_f32 v20, v20, v184
    v_mul_f32 v21, v21, v185
    v_cvt_pk_bf16_f32 v110, v20, v21
    v_fma_f32 v186, v186, v15, v13
    v_fma_f32 v187, v187, v15, v13
    v_lshlrev_b32 v22, 16, v111
    v_and_b32 v23, 0xffff0000, v111
    v_mul_f32 v22, v22, v186
    v_mul_f32 v23, v23, v187
    v_cvt_pk_bf16_f32 v111, v22, v23
    buffer_store_dwordx4 v[108:111], v3, s[20:23], s54 offen offset:1024 sc1
    ds_write_b128 v7, v[108:111] offset:0
    v_fma_f32 v192, v192, v15, v13
    v_fma_f32 v193, v193, v15, v13
    v_lshlrev_b32 v16, 16, v112
    v_and_b32 v17, 0xffff0000, v112
    v_mul_f32 v16, v16, v192
    v_mul_f32 v17, v17, v193
    v_cvt_pk_bf16_f32 v112, v16, v17
    v_fma_f32 v194, v194, v15, v13
    v_fma_f32 v195, v195, v15, v13
    v_lshlrev_b32 v18, 16, v113
    v_and_b32 v19, 0xffff0000, v113
    v_mul_f32 v18, v18, v194
    v_mul_f32 v19, v19, v195
    v_cvt_pk_bf16_f32 v113, v18, v19
    v_fma_f32 v200, v200, v15, v13
    v_fma_f32 v201, v201, v15, v13
    v_lshlrev_b32 v20, 16, v114
    v_and_b32 v21, 0xffff0000, v114
    v_mul_f32 v20, v20, v200
    v_mul_f32 v21, v21, v201
    v_cvt_pk_bf16_f32 v114, v20, v21
    v_fma_f32 v202, v202, v15, v13
    v_fma_f32 v203, v203, v15, v13
    v_lshlrev_b32 v22, 16, v115
    v_and_b32 v23, 0xffff0000, v115
    v_mul_f32 v22, v22, v202
    v_mul_f32 v23, v23, v203
    v_cvt_pk_bf16_f32 v115, v22, v23
    buffer_store_dwordx4 v[112:115], v3, s[20:23], s54 offen offset:2048 sc1
    ds_write_b128 v6, v[112:115] offset:34816
    v_fma_f32 v208, v208, v15, v13
    v_fma_f32 v209, v209, v15, v13
    v_lshlrev_b32 v16, 16, v116
    v_and_b32 v17, 0xffff0000, v116
    v_mul_f32 v16, v16, v208
    v_mul_f32 v17, v17, v209
    v_cvt_pk_bf16_f32 v116, v16, v17
    v_fma_f32 v210, v210, v15, v13
    v_fma_f32 v211, v211, v15, v13
    v_lshlrev_b32 v18, 16, v117
    v_and_b32 v19, 0xffff0000, v117
    v_mul_f32 v18, v18, v210
    v_mul_f32 v19, v19, v211
    v_cvt_pk_bf16_f32 v117, v18, v19
    v_fma_f32 v216, v216, v15, v13
    v_fma_f32 v217, v217, v15, v13
    v_lshlrev_b32 v20, 16, v118
    v_and_b32 v21, 0xffff0000, v118
    v_mul_f32 v20, v20, v216
    v_mul_f32 v21, v21, v217
    v_cvt_pk_bf16_f32 v118, v20, v21
    v_fma_f32 v218, v218, v15, v13
    v_fma_f32 v219, v219, v15, v13
    v_lshlrev_b32 v22, 16, v119
    v_and_b32 v23, 0xffff0000, v119
    v_mul_f32 v22, v22, v218
    v_mul_f32 v23, v23, v219
    v_cvt_pk_bf16_f32 v119, v22, v23
    buffer_store_dwordx4 v[116:119], v3, s[20:23], s54 offen offset:3072 sc1
    ds_write_b128 v7, v[116:119] offset:34816
    v_fma_f32 v228, v228, v1, v14
    v_fma_f32 v229, v229, v1, v14
    v_lshlrev_b32 v16, 16, v138
    v_and_b32 v17, 0xffff0000, v138
    v_mul_f32 v16, v16, v228
    v_mul_f32 v17, v17, v229
    v_cvt_pk_bf16_f32 v138, v16, v17
    v_fma_f32 v230, v230, v1, v14
    v_fma_f32 v231, v231, v1, v14
    v_lshlrev_b32 v18, 16, v139
    v_and_b32 v19, 0xffff0000, v139
    v_mul_f32 v18, v18, v230
    v_mul_f32 v19, v19, v231
    v_cvt_pk_bf16_f32 v139, v18, v19
    buffer_store_dwordx2 v[138:139], v3, s[20:23], s57 offen sc1
    v_fma_f32 v164, v164, v1, v14
    v_fma_f32 v165, v165, v1, v14
    v_lshlrev_b32 v16, 16, v122
    v_and_b32 v17, 0xffff0000, v122
    v_mul_f32 v16, v16, v164
    v_mul_f32 v17, v17, v165
    v_cvt_pk_bf16_f32 v122, v16, v17
    v_fma_f32 v166, v166, v1, v14
    v_fma_f32 v167, v167, v1, v14
    v_lshlrev_b32 v18, 16, v123
    v_and_b32 v19, 0xffff0000, v123
    v_mul_f32 v18, v18, v166
    v_mul_f32 v19, v19, v167
    v_cvt_pk_bf16_f32 v123, v18, v19
    v_fma_f32 v172, v172, v1, v14
    v_fma_f32 v173, v173, v1, v14
    v_lshlrev_b32 v20, 16, v124
    v_and_b32 v21, 0xffff0000, v124
    v_mul_f32 v20, v20, v172
    v_mul_f32 v21, v21, v173
    v_cvt_pk_bf16_f32 v124, v20, v21
    v_fma_f32 v174, v174, v1, v14
    v_fma_f32 v175, v175, v1, v14
    v_lshlrev_b32 v22, 16, v125
    v_and_b32 v23, 0xffff0000, v125
    v_mul_f32 v22, v22, v174
    v_mul_f32 v23, v23, v175
    v_cvt_pk_bf16_f32 v125, v22, v23
    buffer_store_dwordx4 v[122:125], v3, s[20:23], s56 offen offset:0 sc1
    ds_write_b128 v6, v[122:125] offset:2048
    v_fma_f32 v180, v180, v1, v14
    v_fma_f32 v181, v181, v1, v14
    v_lshlrev_b32 v16, 16, v126
    v_and_b32 v17, 0xffff0000, v126
    v_mul_f32 v16, v16, v180
    v_mul_f32 v17, v17, v181
    v_cvt_pk_bf16_f32 v126, v16, v17
    v_fma_f32 v182, v182, v1, v14
    v_fma_f32 v183, v183, v1, v14
    v_lshlrev_b32 v18, 16, v127
    v_and_b32 v19, 0xffff0000, v127
    v_mul_f32 v18, v18, v182
    v_mul_f32 v19, v19, v183
    v_cvt_pk_bf16_f32 v127, v18, v19
    v_fma_f32 v188, v188, v1, v14
    v_fma_f32 v189, v189, v1, v14
    v_lshlrev_b32 v20, 16, v128
    v_and_b32 v21, 0xffff0000, v128
    v_mul_f32 v20, v20, v188
    v_mul_f32 v21, v21, v189
    v_cvt_pk_bf16_f32 v128, v20, v21
    v_fma_f32 v190, v190, v1, v14
    v_fma_f32 v191, v191, v1, v14
    v_lshlrev_b32 v22, 16, v129
    v_and_b32 v23, 0xffff0000, v129
    v_mul_f32 v22, v22, v190
    v_mul_f32 v23, v23, v191
    v_cvt_pk_bf16_f32 v129, v22, v23
    buffer_store_dwordx4 v[126:129], v3, s[20:23], s56 offen offset:1024 sc1
    ds_write_b128 v7, v[126:129] offset:2048
    v_fma_f32 v196, v196, v1, v14
    v_fma_f32 v197, v197, v1, v14
    v_lshlrev_b32 v16, 16, v130
    v_and_b32 v17, 0xffff0000, v130
    v_mul_f32 v16, v16, v196
    v_mul_f32 v17, v17, v197
    v_cvt_pk_bf16_f32 v130, v16, v17
    v_fma_f32 v198, v198, v1, v14
    v_fma_f32 v199, v199, v1, v14
    v_lshlrev_b32 v18, 16, v131
    v_and_b32 v19, 0xffff0000, v131
    v_mul_f32 v18, v18, v198
    v_mul_f32 v19, v19, v199
    v_cvt_pk_bf16_f32 v131, v18, v19
    v_fma_f32 v204, v204, v1, v14
    v_fma_f32 v205, v205, v1, v14
    v_lshlrev_b32 v20, 16, v132
    v_and_b32 v21, 0xffff0000, v132
    v_mul_f32 v20, v20, v204
    v_mul_f32 v21, v21, v205
    v_cvt_pk_bf16_f32 v132, v20, v21
    v_fma_f32 v206, v206, v1, v14
    v_fma_f32 v207, v207, v1, v14
    v_lshlrev_b32 v22, 16, v133
    v_and_b32 v23, 0xffff0000, v133
    v_mul_f32 v22, v22, v206
    v_mul_f32 v23, v23, v207
    v_cvt_pk_bf16_f32 v133, v22, v23
    buffer_store_dwordx4 v[130:133], v3, s[20:23], s56 offen offset:2048 sc1
    ds_write_b128 v6, v[130:133] offset:36864
    v_fma_f32 v212, v212, v1, v14
    v_fma_f32 v213, v213, v1, v14
    v_lshlrev_b32 v16, 16, v134
    v_and_b32 v17, 0xffff0000, v134
    v_mul_f32 v16, v16, v212
    v_mul_f32 v17, v17, v213
    v_cvt_pk_bf16_f32 v134, v16, v17
    v_fma_f32 v214, v214, v1, v14
    v_fma_f32 v215, v215, v1, v14
    v_lshlrev_b32 v18, 16, v135
    v_and_b32 v19, 0xffff0000, v135
    v_mul_f32 v18, v18, v214
    v_mul_f32 v19, v19, v215
    v_cvt_pk_bf16_f32 v135, v18, v19
    v_fma_f32 v220, v220, v1, v14
    v_fma_f32 v221, v221, v1, v14
    v_lshlrev_b32 v20, 16, v136
    v_and_b32 v21, 0xffff0000, v136
    v_mul_f32 v20, v20, v220
    v_mul_f32 v21, v21, v221
    v_cvt_pk_bf16_f32 v136, v20, v21
    v_fma_f32 v222, v222, v1, v14
    v_fma_f32 v223, v223, v1, v14
    v_lshlrev_b32 v22, 16, v137
    v_and_b32 v23, 0xffff0000, v137
    v_mul_f32 v22, v22, v222
    v_mul_f32 v23, v23, v223
    v_cvt_pk_bf16_f32 v137, v22, v23
    buffer_store_dwordx4 v[134:137], v3, s[20:23], s56 offen offset:3072 sc1
    ds_write_b128 v7, v[134:137] offset:36864
    s_waitcnt lgkmcnt(0)
    s_barrier
    ds_read_b128 v[52:55], v6 offset:0
    ds_read_b128 v[56:59], v6 offset:2048
    ds_read_b128 v[16:19], v4 offset:0
    ds_read_b128 v[20:23], v4 offset:1024
    ds_read_b128 v[24:27], v4 offset:2048
    ds_read_b128 v[28:31], v4 offset:3072
    ds_read_b128 v[32:35], v4 offset:4096
    ds_read_b128 v[36:39], v4 offset:5120
    ds_read_b128 v[40:43], v4 offset:6144
    ds_read_b128 v[44:47], v4 offset:7168
    ds_read_b128 v[48:51], v4 offset:8192
    s_waitcnt lgkmcnt(0)
    ds_read_b128 v[96:99], v7 offset:0
    v_mfma_f32_16x16x32_bf16 v[160:163], v[16:19], v[52:55], 0
    ds_read_b128 v[100:103], v7 offset:2048
    v_mfma_f32_16x16x32_bf16 v[164:167], v[16:19], v[56:59], 0
    ds_read_b128 v[60:63], v4 offset:9216
    v_mfma_f32_16x16x32_bf16 v[168:171], v[20:23], v[52:55], 0
    ds_read_b128 v[64:67], v4 offset:10240
    v_mfma_f32_16x16x32_bf16 v[172:175], v[20:23], v[56:59], 0
    ds_read_b128 v[68:71], v4 offset:11264
    v_mfma_f32_16x16x32_bf16 v[176:179], v[24:27], v[52:55], 0
    ds_read_b128 v[72:75], v4 offset:12288
    v_mfma_f32_16x16x32_bf16 v[180:183], v[24:27], v[56:59], 0
    ds_read_b128 v[76:79], v4 offset:13312
    v_mfma_f32_16x16x32_bf16 v[184:187], v[28:31], v[52:55], 0
    ds_read_b128 v[80:83], v4 offset:14336
    v_mfma_f32_16x16x32_bf16 v[188:191], v[28:31], v[56:59], 0
    ds_read_b128 v[84:87], v4 offset:15360
    v_mfma_f32_16x16x32_bf16 v[192:195], v[32:35], v[52:55], 0
    ds_read_b128 v[88:91], v4 offset:16384
    v_mfma_f32_16x16x32_bf16 v[196:199], v[32:35], v[56:59], 0
    ds_read_b128 v[92:95], v4 offset:17408
    v_mfma_f32_16x16x32_bf16 v[200:203], v[36:39], v[52:55], 0
    v_mfma_f32_16x16x32_bf16 v[204:207], v[36:39], v[56:59], 0
    v_mfma_f32_16x16x32_bf16 v[208:211], v[40:43], v[52:55], 0
    v_mfma_f32_16x16x32_bf16 v[212:215], v[40:43], v[56:59], 0
    v_mfma_f32_16x16x32_bf16 v[216:219], v[44:47], v[52:55], 0
    v_mfma_f32_16x16x32_bf16 v[220:223], v[44:47], v[56:59], 0
    v_mfma_f32_16x16x32_bf16 v[224:227], v[48:51], v[52:55], 0
    v_mfma_f32_16x16x32_bf16 v[228:231], v[48:51], v[56:59], 0
    s_waitcnt lgkmcnt(0)
    s_barrier
    ds_read_b128 v[52:55], v6 offset:34816
    v_mfma_f32_16x16x32_bf16 v[160:163], v[60:63], v[96:99], v[160:163]
    ds_read_b128 v[56:59], v6 offset:36864
    v_mfma_f32_16x16x32_bf16 v[164:167], v[60:63], v[100:103], v[164:167]
    ds_read_b128 v[16:19], v4 offset:34816
    v_mfma_f32_16x16x32_bf16 v[168:171], v[64:67], v[96:99], v[168:171]
    ds_read_b128 v[20:23], v4 offset:35840
    v_mfma_f32_16x16x32_bf16 v[172:175], v[64:67], v[100:103], v[172:175]
    ds_read_b128 v[24:27], v4 offset:36864
    v_mfma_f32_16x16x32_bf16 v[176:179], v[68:71], v[96:99], v[176:179]
    ds_read_b128 v[28:31], v4 offset:37888
    v_mfma_f32_16x16x32_bf16 v[180:183], v[68:71], v[100:103], v[180:183]
    ds_read_b128 v[32:35], v4 offset:38912
    v_mfma_f32_16x16x32_bf16 v[184:187], v[72:75], v[96:99], v[184:187]
    ds_read_b128 v[36:39], v4 offset:39936
    v_mfma_f32_16x16x32_bf16 v[188:191], v[72:75], v[100:103], v[188:191]
    ds_read_b128 v[40:43], v4 offset:40960
    v_mfma_f32_16x16x32_bf16 v[192:195], v[76:79], v[96:99], v[192:195]
    ds_read_b128 v[44:47], v4 offset:41984
    v_mfma_f32_16x16x32_bf16 v[196:199], v[76:79], v[100:103], v[196:199]
    ds_read_b128 v[48:51], v4 offset:43008
    v_mfma_f32_16x16x32_bf16 v[200:203], v[80:83], v[96:99], v[200:203]
    v_mfma_f32_16x16x32_bf16 v[204:207], v[80:83], v[100:103], v[204:207]
    v_mfma_f32_16x16x32_bf16 v[208:211], v[84:87], v[96:99], v[208:211]
    v_mfma_f32_16x16x32_bf16 v[212:215], v[84:87], v[100:103], v[212:215]
    v_mfma_f32_16x16x32_bf16 v[216:219], v[88:91], v[96:99], v[216:219]
    v_mfma_f32_16x16x32_bf16 v[220:223], v[88:91], v[100:103], v[220:223]
    v_mfma_f32_16x16x32_bf16 v[224:227], v[92:95], v[96:99], v[224:227]
    v_mfma_f32_16x16x32_bf16 v[228:231], v[92:95], v[100:103], v[228:231]
    s_waitcnt lgkmcnt(0)
    ds_read_b128 v[96:99], v7 offset:34816
    v_mfma_f32_16x16x32_bf16 v[160:163], v[16:19], v[52:55], v[160:163]
    ds_read_b128 v[100:103], v7 offset:36864
    v_mfma_f32_16x16x32_bf16 v[164:167], v[16:19], v[56:59], v[164:167]
    ds_read_b128 v[60:63], v4 offset:44032
    v_mfma_f32_16x16x32_bf16 v[168:171], v[20:23], v[52:55], v[168:171]
    ds_read_b128 v[64:67], v4 offset:45056
    v_mfma_f32_16x16x32_bf16 v[172:175], v[20:23], v[56:59], v[172:175]
    ds_read_b128 v[68:71], v4 offset:46080
    v_mfma_f32_16x16x32_bf16 v[176:179], v[24:27], v[52:55], v[176:179]
    ds_read_b128 v[72:75], v4 offset:47104
    v_mfma_f32_16x16x32_bf16 v[180:183], v[24:27], v[56:59], v[180:183]
    ds_read_b128 v[76:79], v4 offset:48128
    v_mfma_f32_16x16x32_bf16 v[184:187], v[28:31], v[52:55], v[184:187]
    ds_read_b128 v[80:83], v4 offset:49152
    v_mfma_f32_16x16x32_bf16 v[188:191], v[28:31], v[56:59], v[188:191]
    ds_read_b128 v[84:87], v4 offset:50176
    v_mfma_f32_16x16x32_bf16 v[192:195], v[32:35], v[52:55], v[192:195]
    ds_read_b128 v[88:91], v4 offset:51200
    v_mfma_f32_16x16x32_bf16 v[196:199], v[32:35], v[56:59], v[196:199]
    ds_read_b128 v[92:95], v4 offset:52224
    v_mfma_f32_16x16x32_bf16 v[200:203], v[36:39], v[52:55], v[200:203]
    v_mfma_f32_16x16x32_bf16 v[204:207], v[36:39], v[56:59], v[204:207]
    v_mfma_f32_16x16x32_bf16 v[208:211], v[40:43], v[52:55], v[208:211]
    v_mfma_f32_16x16x32_bf16 v[212:215], v[40:43], v[56:59], v[212:215]
    v_mfma_f32_16x16x32_bf16 v[216:219], v[44:47], v[52:55], v[216:219]
    v_mfma_f32_16x16x32_bf16 v[220:223], v[44:47], v[56:59], v[220:223]
    v_mfma_f32_16x16x32_bf16 v[224:227], v[48:51], v[52:55], v[224:227]
    v_mfma_f32_16x16x32_bf16 v[228:231], v[48:51], v[56:59], v[228:231]
    s_waitcnt lgkmcnt(0)
    s_waitcnt vmcnt(0)
    s_barrier
    ds_read_b128 v[52:55], v8 offset:0
    v_mfma_f32_16x16x32_bf16 v[160:163], v[60:63], v[96:99], v[160:163]
    ds_read_b128 v[56:59], v8 offset:2048
    v_mfma_f32_16x16x32_bf16 v[164:167], v[60:63], v[100:103], v[164:167]
    ds_read_b128 v[16:19], v5 offset:0
    v_mfma_f32_16x16x32_bf16 v[168:171], v[64:67], v[96:99], v[168:171]
    ds_read_b128 v[20:23], v5 offset:1024
    v_mfma_f32_16x16x32_bf16 v[172:175], v[64:67], v[100:103], v[172:175]
    ds_read_b128 v[24:27], v5 offset:2048
    v_mfma_f32_16x16x32_bf16 v[176:179], v[68:71], v[96:99], v[176:179]
    ds_read_b128 v[28:31], v5 offset:3072
    v_mfma_f32_16x16x32_bf16 v[180:183], v[68:71], v[100:103], v[180:183]
    ds_read_b128 v[32:35], v5 offset:4096
    v_mfma_f32_16x16x32_bf16 v[184:187], v[72:75], v[96:99], v[184:187]
    ds_read_b128 v[36:39], v5 offset:5120
    v_mfma_f32_16x16x32_bf16 v[188:191], v[72:75], v[100:103], v[188:191]
    ds_read_b128 v[40:43], v5 offset:6144
    v_mfma_f32_16x16x32_bf16 v[192:195], v[76:79], v[96:99], v[192:195]
    ds_read_b128 v[44:47], v5 offset:7168
    v_mfma_f32_16x16x32_bf16 v[196:199], v[76:79], v[100:103], v[196:199]
    ds_read_b128 v[48:51], v5 offset:8192
    v_mfma_f32_16x16x32_bf16 v[200:203], v[80:83], v[96:99], v[200:203]
    v_mfma_f32_16x16x32_bf16 v[204:207], v[80:83], v[100:103], v[204:207]
    v_mfma_f32_16x16x32_bf16 v[208:211], v[84:87], v[96:99], v[208:211]
    v_mfma_f32_16x16x32_bf16 v[212:215], v[84:87], v[100:103], v[212:215]
    v_mfma_f32_16x16x32_bf16 v[216:219], v[88:91], v[96:99], v[216:219]
    v_mfma_f32_16x16x32_bf16 v[220:223], v[88:91], v[100:103], v[220:223]
    v_mfma_f32_16x16x32_bf16 v[224:227], v[92:95], v[96:99], v[224:227]
    v_mfma_f32_16x16x32_bf16 v[228:231], v[92:95], v[100:103], v[228:231]
    s_waitcnt lgkmcnt(0)
    ds_read_b128 v[96:99], v9 offset:0
    v_mfma_f32_16x16x32_bf16 v[160:163], v[16:19], v[52:55], v[160:163]
    ds_read_b128 v[100:103], v9 offset:2048
    v_mfma_f32_16x16x32_bf16 v[164:167], v[16:19], v[56:59], v[164:167]
    ds_read_b128 v[60:63], v5 offset:9216
    v_mfma_f32_16x16x32_bf16 v[168:171], v[20:23], v[52:55], v[168:171]
    ds_read_b128 v[64:67], v5 offset:10240
    v_mfma_f32_16x16x32_bf16 v[172:175], v[20:23], v[56:59], v[172:175]
    ds_read_b128 v[68:71], v5 offset:11264
    v_mfma_f32_16x16x32_bf16 v[176:179], v[24:27], v[52:55], v[176:179]
    ds_read_b128 v[72:75], v5 offset:12288
    v_mfma_f32_16x16x32_bf16 v[180:183], v[24:27], v[56:59], v[180:183]
    ds_read_b128 v[76:79], v5 offset:13312
    v_mfma_f32_16x16x32_bf16 v[184:187], v[28:31], v[52:55], v[184:187]
    ds_read_b128 v[80:83], v5 offset:14336
    v_mfma_f32_16x16x32_bf16 v[188:191], v[28:31], v[56:59], v[188:191]
    ds_read_b128 v[84:87], v5 offset:15360
    v_mfma_f32_16x16x32_bf16 v[192:195], v[32:35], v[52:55], v[192:195]
    ds_read_b128 v[88:91], v5 offset:16384
    v_mfma_f32_16x16x32_bf16 v[196:199], v[32:35], v[56:59], v[196:199]
    ds_read_b128 v[92:95], v5 offset:17408
    v_mfma_f32_16x16x32_bf16 v[200:203], v[36:39], v[52:55], v[200:203]
    v_mfma_f32_16x16x32_bf16 v[204:207], v[36:39], v[56:59], v[204:207]
    v_mfma_f32_16x16x32_bf16 v[208:211], v[40:43], v[52:55], v[208:211]
    v_mfma_f32_16x16x32_bf16 v[212:215], v[40:43], v[56:59], v[212:215]
    v_mfma_f32_16x16x32_bf16 v[216:219], v[44:47], v[52:55], v[216:219]
    v_mfma_f32_16x16x32_bf16 v[220:223], v[44:47], v[56:59], v[220:223]
    v_mfma_f32_16x16x32_bf16 v[224:227], v[48:51], v[52:55], v[224:227]
    v_mfma_f32_16x16x32_bf16 v[228:231], v[48:51], v[56:59], v[228:231]
    s_waitcnt lgkmcnt(0)
    s_barrier
    ds_read_b128 v[52:55], v8 offset:34816
    v_mfma_f32_16x16x32_bf16 v[160:163], v[60:63], v[96:99], v[160:163]
    ds_read_b128 v[56:59], v8 offset:36864
    v_mfma_f32_16x16x32_bf16 v[164:167], v[60:63], v[100:103], v[164:167]
    ds_read_b128 v[16:19], v5 offset:34816
    v_mfma_f32_16x16x32_bf16 v[168:171], v[64:67], v[96:99], v[168:171]
    ds_read_b128 v[20:23], v5 offset:35840
    v_mfma_f32_16x16x32_bf16 v[172:175], v[64:67], v[100:103], v[172:175]
    ds_read_b128 v[24:27], v5 offset:36864
    v_mfma_f32_16x16x32_bf16 v[176:179], v[68:71], v[96:99], v[176:179]
    ds_read_b128 v[28:31], v5 offset:37888
    v_mfma_f32_16x16x32_bf16 v[180:183], v[68:71], v[100:103], v[180:183]
    ds_read_b128 v[32:35], v5 offset:38912
    v_mfma_f32_16x16x32_bf16 v[184:187], v[72:75], v[96:99], v[184:187]
    ds_read_b128 v[36:39], v5 offset:39936
    v_mfma_f32_16x16x32_bf16 v[188:191], v[72:75], v[100:103], v[188:191]
    ds_read_b128 v[40:43], v5 offset:40960
    v_mfma_f32_16x16x32_bf16 v[192:195], v[76:79], v[96:99], v[192:195]
    ds_read_b128 v[44:47], v5 offset:41984
    v_mfma_f32_16x16x32_bf16 v[196:199], v[76:79], v[100:103], v[196:199]
    ds_read_b128 v[48:51], v5 offset:43008
    v_mfma_f32_16x16x32_bf16 v[200:203], v[80:83], v[96:99], v[200:203]
    v_mfma_f32_16x16x32_bf16 v[204:207], v[80:83], v[100:103], v[204:207]
    v_mfma_f32_16x16x32_bf16 v[208:211], v[84:87], v[96:99], v[208:211]
    v_mfma_f32_16x16x32_bf16 v[212:215], v[84:87], v[100:103], v[212:215]
    v_mfma_f32_16x16x32_bf16 v[216:219], v[88:91], v[96:99], v[216:219]
    v_mfma_f32_16x16x32_bf16 v[220:223], v[88:91], v[100:103], v[220:223]
    v_mfma_f32_16x16x32_bf16 v[224:227], v[92:95], v[96:99], v[224:227]
    v_mfma_f32_16x16x32_bf16 v[228:231], v[92:95], v[100:103], v[228:231]
    s_waitcnt lgkmcnt(0)
    ds_read_b128 v[96:99], v9 offset:34816
    v_mfma_f32_16x16x32_bf16 v[160:163], v[16:19], v[52:55], v[160:163]
    ds_read_b128 v[100:103], v9 offset:36864
    v_mfma_f32_16x16x32_bf16 v[164:167], v[16:19], v[56:59], v[164:167]
    ds_read_b128 v[60:63], v5 offset:44032
    v_mfma_f32_16x16x32_bf16 v[168:171], v[20:23], v[52:55], v[168:171]
    ds_read_b128 v[64:67], v5 offset:45056
    v_mfma_f32_16x16x32_bf16 v[172:175], v[20:23], v[56:59], v[172:175]
    ds_read_b128 v[68:71], v5 offset:46080
    v_mfma_f32_16x16x32_bf16 v[176:179], v[24:27], v[52:55], v[176:179]
    ds_read_b128 v[72:75], v5 offset:47104
    v_mfma_f32_16x16x32_bf16 v[180:183], v[24:27], v[56:59], v[180:183]
    ds_read_b128 v[76:79], v5 offset:48128
    v_mfma_f32_16x16x32_bf16 v[184:187], v[28:31], v[52:55], v[184:187]
    ds_read_b128 v[80:83], v5 offset:49152
    v_mfma_f32_16x16x32_bf16 v[188:191], v[28:31], v[56:59], v[188:191]
    ds_read_b128 v[84:87], v5 offset:50176
    v_mfma_f32_16x16x32_bf16 v[192:195], v[32:35], v[52:55], v[192:195]
    ds_read_b128 v[88:91], v5 offset:51200
    v_mfma_f32_16x16x32_bf16 v[196:199], v[32:35], v[56:59], v[196:199]
    ds_read_b128 v[92:95], v5 offset:52224
    v_mfma_f32_16x16x32_bf16 v[200:203], v[36:39], v[52:55], v[200:203]
    v_mfma_f32_16x16x32_bf16 v[204:207], v[36:39], v[56:59], v[204:207]
    v_mfma_f32_16x16x32_bf16 v[208:211], v[40:43], v[52:55], v[208:211]
    v_mfma_f32_16x16x32_bf16 v[212:215], v[40:43], v[56:59], v[212:215]
    v_mfma_f32_16x16x32_bf16 v[216:219], v[44:47], v[52:55], v[216:219]
    v_mfma_f32_16x16x32_bf16 v[220:223], v[44:47], v[56:59], v[220:223]
    v_mfma_f32_16x16x32_bf16 v[224:227], v[48:51], v[52:55], v[224:227]
    v_mfma_f32_16x16x32_bf16 v[228:231], v[48:51], v[56:59], v[228:231]
    s_waitcnt lgkmcnt(0)
    s_barrier
    v_and_b32 v232, 7, v2
    v_bfe_u32 v233, v2, 3, 1
    v_lshl_add_u32 v232, v232, 3, v233
    s_and_b32 s58, s2, 0xc6
    v_add_u32 v232, s58, v232
    v_lshlrev_b32 v232, 7, v232
    v_add_u32 v232, 44892160, v232
    s_mov_b32 s48, 0
parallel_sum__linear_kernel_hedgehog__mixer_gmlp__prompt_kernel_c3:
    s_barrier
    ds_read_b128 v[52:55], v6 offset:0
    v_mfma_f32_16x16x32_bf16 v[160:163], v[60:63], v[96:99], v[160:163]
    ds_read_b128 v[56:59], v6 offset:2048
    v_mfma_f32_16x16x32_bf16 v[164:167], v[60:63], v[100:103], v[164:167]
    ds_read_b128 v[16:19], v4 offset:0
    v_mfma_f32_16x16x32_bf16 v[168:171], v[64:67], v[96:99], v[168:171]
    ds_read_b128 v[20:23], v4 offset:1024
    v_mfma_f32_16x16x32_bf16 v[172:175], v[64:67], v[100:103], v[172:175]
    ds_read_b128 v[24:27], v4 offset:2048
    v_mfma_f32_16x16x32_bf16 v[176:179], v[68:71], v[96:99], v[176:179]
    ds_read_b128 v[28:31], v4 offset:3072
    v_mfma_f32_16x16x32_bf16 v[180:183], v[68:71], v[100:103], v[180:183]
    ds_read_b128 v[32:35], v4 offset:4096
    v_mfma_f32_16x16x32_bf16 v[184:187], v[72:75], v[96:99], v[184:187]
    ds_read_b128 v[36:39], v4 offset:5120
    v_mfma_f32_16x16x32_bf16 v[188:191], v[72:75], v[100:103], v[188:191]
    ds_read_b128 v[40:43], v4 offset:6144
    v_mfma_f32_16x16x32_bf16 v[192:195], v[76:79], v[96:99], v[192:195]
    ds_read_b128 v[44:47], v4 offset:7168
    v_mfma_f32_16x16x32_bf16 v[196:199], v[76:79], v[100:103], v[196:199]
    ds_read_b128 v[48:51], v4 offset:8192
    v_mfma_f32_16x16x32_bf16 v[200:203], v[80:83], v[96:99], v[200:203]
    v_mfma_f32_16x16x32_bf16 v[204:207], v[80:83], v[100:103], v[204:207]
    v_mfma_f32_16x16x32_bf16 v[208:211], v[84:87], v[96:99], v[208:211]
    v_mfma_f32_16x16x32_bf16 v[212:215], v[84:87], v[100:103], v[212:215]
    v_mfma_f32_16x16x32_bf16 v[216:219], v[88:91], v[96:99], v[216:219]
    v_mfma_f32_16x16x32_bf16 v[220:223], v[88:91], v[100:103], v[220:223]
    v_mfma_f32_16x16x32_bf16 v[224:227], v[92:95], v[96:99], v[224:227]
    v_mfma_f32_16x16x32_bf16 v[228:231], v[92:95], v[100:103], v[228:231]
    s_waitcnt lgkmcnt(0)
    ds_read_b128 v[96:99], v7 offset:0
    v_mfma_f32_16x16x32_bf16 v[160:163], v[16:19], v[52:55], v[160:163]
    ds_read_b128 v[100:103], v7 offset:2048
    v_mfma_f32_16x16x32_bf16 v[164:167], v[16:19], v[56:59], v[164:167]
    ds_read_b128 v[60:63], v4 offset:9216
    v_mfma_f32_16x16x32_bf16 v[168:171], v[20:23], v[52:55], v[168:171]
    ds_read_b128 v[64:67], v4 offset:10240
    v_mfma_f32_16x16x32_bf16 v[172:175], v[20:23], v[56:59], v[172:175]
    ds_read_b128 v[68:71], v4 offset:11264
    v_mfma_f32_16x16x32_bf16 v[176:179], v[24:27], v[52:55], v[176:179]
    ds_read_b128 v[72:75], v4 offset:12288
    v_mfma_f32_16x16x32_bf16 v[180:183], v[24:27], v[56:59], v[180:183]
    ds_read_b128 v[76:79], v4 offset:13312
    v_mfma_f32_16x16x32_bf16 v[184:187], v[28:31], v[52:55], v[184:187]
    ds_read_b128 v[80:83], v4 offset:14336
    v_mfma_f32_16x16x32_bf16 v[188:191], v[28:31], v[56:59], v[188:191]
    ds_read_b128 v[84:87], v4 offset:15360
    v_mfma_f32_16x16x32_bf16 v[192:195], v[32:35], v[52:55], v[192:195]
    ds_read_b128 v[88:91], v4 offset:16384
    v_mfma_f32_16x16x32_bf16 v[196:199], v[32:35], v[56:59], v[196:199]
    ds_read_b128 v[92:95], v4 offset:17408
    v_mfma_f32_16x16x32_bf16 v[200:203], v[36:39], v[52:55], v[200:203]
    v_mfma_f32_16x16x32_bf16 v[204:207], v[36:39], v[56:59], v[204:207]
    v_mfma_f32_16x16x32_bf16 v[208:211], v[40:43], v[52:55], v[208:211]
    v_mfma_f32_16x16x32_bf16 v[212:215], v[40:43], v[56:59], v[212:215]
    v_mfma_f32_16x16x32_bf16 v[216:219], v[44:47], v[52:55], v[216:219]
    v_mfma_f32_16x16x32_bf16 v[220:223], v[44:47], v[56:59], v[220:223]
    v_mfma_f32_16x16x32_bf16 v[224:227], v[48:51], v[52:55], v[224:227]
    v_mfma_f32_16x16x32_bf16 v[228:231], v[48:51], v[56:59], v[228:231]
    s_waitcnt lgkmcnt(0)
    s_barrier
    ds_read_b128 v[52:55], v6 offset:34816
    v_mfma_f32_16x16x32_bf16 v[160:163], v[60:63], v[96:99], v[160:163]
    ds_read_b128 v[56:59], v6 offset:36864
    v_mfma_f32_16x16x32_bf16 v[164:167], v[60:63], v[100:103], v[164:167]
    ds_read_b128 v[16:19], v4 offset:34816
    v_mfma_f32_16x16x32_bf16 v[168:171], v[64:67], v[96:99], v[168:171]
    ds_read_b128 v[20:23], v4 offset:35840
    v_mfma_f32_16x16x32_bf16 v[172:175], v[64:67], v[100:103], v[172:175]
    ds_read_b128 v[24:27], v4 offset:36864
    v_mfma_f32_16x16x32_bf16 v[176:179], v[68:71], v[96:99], v[176:179]
    ds_read_b128 v[28:31], v4 offset:37888
    v_mfma_f32_16x16x32_bf16 v[180:183], v[68:71], v[100:103], v[180:183]
    ds_read_b128 v[32:35], v4 offset:38912
    v_mfma_f32_16x16x32_bf16 v[184:187], v[72:75], v[96:99], v[184:187]
    ds_read_b128 v[36:39], v4 offset:39936
    v_mfma_f32_16x16x32_bf16 v[188:191], v[72:75], v[100:103], v[188:191]
    ds_read_b128 v[40:43], v4 offset:40960
    v_mfma_f32_16x16x32_bf16 v[192:195], v[76:79], v[96:99], v[192:195]
    ds_read_b128 v[44:47], v4 offset:41984
    v_mfma_f32_16x16x32_bf16 v[196:199], v[76:79], v[100:103], v[196:199]
    ds_read_b128 v[48:51], v4 offset:43008
    v_mfma_f32_16x16x32_bf16 v[200:203], v[80:83], v[96:99], v[200:203]
    v_mfma_f32_16x16x32_bf16 v[204:207], v[80:83], v[100:103], v[204:207]
    v_mfma_f32_16x16x32_bf16 v[208:211], v[84:87], v[96:99], v[208:211]
    v_mfma_f32_16x16x32_bf16 v[212:215], v[84:87], v[100:103], v[212:215]
    v_mfma_f32_16x16x32_bf16 v[216:219], v[88:91], v[96:99], v[216:219]
    v_mfma_f32_16x16x32_bf16 v[220:223], v[88:91], v[100:103], v[220:223]
    v_mfma_f32_16x16x32_bf16 v[224:227], v[92:95], v[96:99], v[224:227]
    v_mfma_f32_16x16x32_bf16 v[228:231], v[92:95], v[100:103], v[228:231]
    s_waitcnt lgkmcnt(0)
    ds_read_b128 v[96:99], v7 offset:34816
    v_mfma_f32_16x16x32_bf16 v[160:163], v[16:19], v[52:55], v[160:163]
    ds_read_b128 v[100:103], v7 offset:36864
    v_mfma_f32_16x16x32_bf16 v[164:167], v[16:19], v[56:59], v[164:167]
    ds_read_b128 v[60:63], v4 offset:44032
    v_mfma_f32_16x16x32_bf16 v[168:171], v[20:23], v[52:55], v[168:171]
    ds_read_b128 v[64:67], v4 offset:45056
    v_mfma_f32_16x16x32_bf16 v[172:175], v[20:23], v[56:59], v[172:175]
    ds_read_b128 v[68:71], v4 offset:46080
    v_mfma_f32_16x16x32_bf16 v[176:179], v[24:27], v[52:55], v[176:179]
    ds_read_b128 v[72:75], v4 offset:47104
    v_mfma_f32_16x16x32_bf16 v[180:183], v[24:27], v[56:59], v[180:183]
    ds_read_b128 v[76:79], v4 offset:48128
    v_mfma_f32_16x16x32_bf16 v[184:187], v[28:31], v[52:55], v[184:187]
    ds_read_b128 v[80:83], v4 offset:49152
    v_mfma_f32_16x16x32_bf16 v[188:191], v[28:31], v[56:59], v[188:191]
    ds_read_b128 v[84:87], v4 offset:50176
    v_mfma_f32_16x16x32_bf16 v[192:195], v[32:35], v[52:55], v[192:195]
    ds_read_b128 v[88:91], v4 offset:51200
    v_mfma_f32_16x16x32_bf16 v[196:199], v[32:35], v[56:59], v[196:199]
    ds_read_b128 v[92:95], v4 offset:52224
    v_mfma_f32_16x16x32_bf16 v[200:203], v[36:39], v[52:55], v[200:203]
    v_mfma_f32_16x16x32_bf16 v[204:207], v[36:39], v[56:59], v[204:207]
    v_mfma_f32_16x16x32_bf16 v[208:211], v[40:43], v[52:55], v[208:211]
    v_mfma_f32_16x16x32_bf16 v[212:215], v[40:43], v[56:59], v[212:215]
    v_mfma_f32_16x16x32_bf16 v[216:219], v[44:47], v[52:55], v[216:219]
    v_mfma_f32_16x16x32_bf16 v[220:223], v[44:47], v[56:59], v[220:223]
    v_mfma_f32_16x16x32_bf16 v[224:227], v[48:51], v[52:55], v[224:227]
    v_mfma_f32_16x16x32_bf16 v[228:231], v[48:51], v[56:59], v[228:231]
    s_waitcnt lgkmcnt(0)
    s_barrier
    ds_read_b128 v[52:55], v8 offset:0
    v_mfma_f32_16x16x32_bf16 v[160:163], v[60:63], v[96:99], v[160:163]
    ds_read_b128 v[56:59], v8 offset:2048
    v_mfma_f32_16x16x32_bf16 v[164:167], v[60:63], v[100:103], v[164:167]
    ds_read_b128 v[16:19], v5 offset:0
    v_mfma_f32_16x16x32_bf16 v[168:171], v[64:67], v[96:99], v[168:171]
    ds_read_b128 v[20:23], v5 offset:1024
    v_mfma_f32_16x16x32_bf16 v[172:175], v[64:67], v[100:103], v[172:175]
    ds_read_b128 v[24:27], v5 offset:2048
    v_mfma_f32_16x16x32_bf16 v[176:179], v[68:71], v[96:99], v[176:179]
    ds_read_b128 v[28:31], v5 offset:3072
    v_mfma_f32_16x16x32_bf16 v[180:183], v[68:71], v[100:103], v[180:183]
    ds_read_b128 v[32:35], v5 offset:4096
    v_mfma_f32_16x16x32_bf16 v[184:187], v[72:75], v[96:99], v[184:187]
    ds_read_b128 v[36:39], v5 offset:5120
    v_mfma_f32_16x16x32_bf16 v[188:191], v[72:75], v[100:103], v[188:191]
    ds_read_b128 v[40:43], v5 offset:6144
    v_mfma_f32_16x16x32_bf16 v[192:195], v[76:79], v[96:99], v[192:195]
    ds_read_b128 v[44:47], v5 offset:7168
    v_mfma_f32_16x16x32_bf16 v[196:199], v[76:79], v[100:103], v[196:199]
    ds_read_b128 v[48:51], v5 offset:8192
    v_mfma_f32_16x16x32_bf16 v[200:203], v[80:83], v[96:99], v[200:203]
    v_mfma_f32_16x16x32_bf16 v[204:207], v[80:83], v[100:103], v[204:207]
    v_mfma_f32_16x16x32_bf16 v[208:211], v[84:87], v[96:99], v[208:211]
    v_mfma_f32_16x16x32_bf16 v[212:215], v[84:87], v[100:103], v[212:215]
    v_mfma_f32_16x16x32_bf16 v[216:219], v[88:91], v[96:99], v[216:219]
    v_mfma_f32_16x16x32_bf16 v[220:223], v[88:91], v[100:103], v[220:223]
    v_mfma_f32_16x16x32_bf16 v[224:227], v[92:95], v[96:99], v[224:227]
    v_mfma_f32_16x16x32_bf16 v[228:231], v[92:95], v[100:103], v[228:231]
    s_waitcnt lgkmcnt(0)
    ds_read_b128 v[96:99], v9 offset:0
    v_mfma_f32_16x16x32_bf16 v[160:163], v[16:19], v[52:55], v[160:163]
    ds_read_b128 v[100:103], v9 offset:2048
    v_mfma_f32_16x16x32_bf16 v[164:167], v[16:19], v[56:59], v[164:167]
    ds_read_b128 v[60:63], v5 offset:9216
    v_mfma_f32_16x16x32_bf16 v[168:171], v[20:23], v[52:55], v[168:171]
    ds_read_b128 v[64:67], v5 offset:10240
    v_mfma_f32_16x16x32_bf16 v[172:175], v[20:23], v[56:59], v[172:175]
    ds_read_b128 v[68:71], v5 offset:11264
    v_mfma_f32_16x16x32_bf16 v[176:179], v[24:27], v[52:55], v[176:179]
    ds_read_b128 v[72:75], v5 offset:12288
    v_mfma_f32_16x16x32_bf16 v[180:183], v[24:27], v[56:59], v[180:183]
    ds_read_b128 v[76:79], v5 offset:13312
    v_mfma_f32_16x16x32_bf16 v[184:187], v[28:31], v[52:55], v[184:187]
    ds_read_b128 v[80:83], v5 offset:14336
    v_mfma_f32_16x16x32_bf16 v[188:191], v[28:31], v[56:59], v[188:191]
    ds_read_b128 v[84:87], v5 offset:15360
    v_mfma_f32_16x16x32_bf16 v[192:195], v[32:35], v[52:55], v[192:195]
    ds_read_b128 v[88:91], v5 offset:16384
    v_mfma_f32_16x16x32_bf16 v[196:199], v[32:35], v[56:59], v[196:199]
    ds_read_b128 v[92:95], v5 offset:17408
    v_mfma_f32_16x16x32_bf16 v[200:203], v[36:39], v[52:55], v[200:203]
    v_mfma_f32_16x16x32_bf16 v[204:207], v[36:39], v[56:59], v[204:207]
    v_mfma_f32_16x16x32_bf16 v[208:211], v[40:43], v[52:55], v[208:211]
    v_mfma_f32_16x16x32_bf16 v[212:215], v[40:43], v[56:59], v[212:215]
    v_mfma_f32_16x16x32_bf16 v[216:219], v[44:47], v[52:55], v[216:219]
    v_mfma_f32_16x16x32_bf16 v[220:223], v[44:47], v[56:59], v[220:223]
    v_mfma_f32_16x16x32_bf16 v[224:227], v[48:51], v[52:55], v[224:227]
    v_mfma_f32_16x16x32_bf16 v[228:231], v[48:51], v[56:59], v[228:231]
    s_waitcnt lgkmcnt(0)
    s_barrier
    ds_read_b128 v[52:55], v8 offset:34816
    v_mfma_f32_16x16x32_bf16 v[160:163], v[60:63], v[96:99], v[160:163]
    ds_read_b128 v[56:59], v8 offset:36864
    v_mfma_f32_16x16x32_bf16 v[164:167], v[60:63], v[100:103], v[164:167]
    ds_read_b128 v[16:19], v5 offset:34816
    v_mfma_f32_16x16x32_bf16 v[168:171], v[64:67], v[96:99], v[168:171]
    ds_read_b128 v[20:23], v5 offset:35840
    v_mfma_f32_16x16x32_bf16 v[172:175], v[64:67], v[100:103], v[172:175]
    ds_read_b128 v[24:27], v5 offset:36864
    v_mfma_f32_16x16x32_bf16 v[176:179], v[68:71], v[96:99], v[176:179]
    ds_read_b128 v[28:31], v5 offset:37888
    v_mfma_f32_16x16x32_bf16 v[180:183], v[68:71], v[100:103], v[180:183]
    ds_read_b128 v[32:35], v5 offset:38912
    v_mfma_f32_16x16x32_bf16 v[184:187], v[72:75], v[96:99], v[184:187]
    ds_read_b128 v[36:39], v5 offset:39936
    v_mfma_f32_16x16x32_bf16 v[188:191], v[72:75], v[100:103], v[188:191]
    ds_read_b128 v[40:43], v5 offset:40960
    v_mfma_f32_16x16x32_bf16 v[192:195], v[76:79], v[96:99], v[192:195]
    ds_read_b128 v[44:47], v5 offset:41984
    v_mfma_f32_16x16x32_bf16 v[196:199], v[76:79], v[100:103], v[196:199]
    ds_read_b128 v[48:51], v5 offset:43008
    v_mfma_f32_16x16x32_bf16 v[200:203], v[80:83], v[96:99], v[200:203]
    v_mfma_f32_16x16x32_bf16 v[204:207], v[80:83], v[100:103], v[204:207]
    v_mfma_f32_16x16x32_bf16 v[208:211], v[84:87], v[96:99], v[208:211]
    v_mfma_f32_16x16x32_bf16 v[212:215], v[84:87], v[100:103], v[212:215]
    v_mfma_f32_16x16x32_bf16 v[216:219], v[88:91], v[96:99], v[216:219]
    v_mfma_f32_16x16x32_bf16 v[220:223], v[88:91], v[100:103], v[220:223]
    v_mfma_f32_16x16x32_bf16 v[224:227], v[92:95], v[96:99], v[224:227]
    v_mfma_f32_16x16x32_bf16 v[228:231], v[92:95], v[100:103], v[228:231]
    s_waitcnt lgkmcnt(0)
    ds_read_b128 v[96:99], v9 offset:34816
    v_mfma_f32_16x16x32_bf16 v[160:163], v[16:19], v[52:55], v[160:163]
    ds_read_b128 v[100:103], v9 offset:36864
    v_mfma_f32_16x16x32_bf16 v[164:167], v[16:19], v[56:59], v[164:167]
    ds_read_b128 v[60:63], v5 offset:44032
    v_mfma_f32_16x16x32_bf16 v[168:171], v[20:23], v[52:55], v[168:171]
    ds_read_b128 v[64:67], v5 offset:45056
    v_mfma_f32_16x16x32_bf16 v[172:175], v[20:23], v[56:59], v[172:175]
    ds_read_b128 v[68:71], v5 offset:46080
    v_mfma_f32_16x16x32_bf16 v[176:179], v[24:27], v[52:55], v[176:179]
    ds_read_b128 v[72:75], v5 offset:47104
    v_mfma_f32_16x16x32_bf16 v[180:183], v[24:27], v[56:59], v[180:183]
    ds_read_b128 v[76:79], v5 offset:48128
    v_mfma_f32_16x16x32_bf16 v[184:187], v[28:31], v[52:55], v[184:187]
    ds_read_b128 v[80:83], v5 offset:49152
    v_mfma_f32_16x16x32_bf16 v[188:191], v[28:31], v[56:59], v[188:191]
    ds_read_b128 v[84:87], v5 offset:50176
    v_mfma_f32_16x16x32_bf16 v[192:195], v[32:35], v[52:55], v[192:195]
    ds_read_b128 v[88:91], v5 offset:51200
    v_mfma_f32_16x16x32_bf16 v[196:199], v[32:35], v[56:59], v[196:199]
    ds_read_b128 v[92:95], v5 offset:52224
    v_mfma_f32_16x16x32_bf16 v[200:203], v[36:39], v[52:55], v[200:203]
    v_mfma_f32_16x16x32_bf16 v[204:207], v[36:39], v[56:59], v[204:207]
    v_mfma_f32_16x16x32_bf16 v[208:211], v[40:43], v[52:55], v[208:211]
    v_mfma_f32_16x16x32_bf16 v[212:215], v[40:43], v[56:59], v[212:215]
    v_mfma_f32_16x16x32_bf16 v[216:219], v[44:47], v[52:55], v[216:219]
    v_mfma_f32_16x16x32_bf16 v[220:223], v[44:47], v[56:59], v[220:223]
    v_mfma_f32_16x16x32_bf16 v[224:227], v[48:51], v[52:55], v[224:227]
    v_mfma_f32_16x16x32_bf16 v[228:231], v[48:51], v[56:59], v[228:231]
    s_waitcnt lgkmcnt(0)
    s_cmp_eq_u32 s48, 0
    s_cbranch_scc0 parallel_sum__linear_kernel_hedgehog__mixer_gmlp__prompt_kernel_pz
    buffer_load_dword v233, v232, s[20:23], 0 offen sc1
parallel_sum__linear_kernel_hedgehog__mixer_gmlp__prompt_kernel_pz:
    s_add_u32 s48, s48, 1
    s_cmp_lt_u32 s48, 2
    s_cbranch_scc1 parallel_sum__linear_kernel_hedgehog__mixer_gmlp__prompt_kernel_c3
    v_mfma_f32_16x16x32_bf16 v[160:163], v[60:63], v[96:99], v[160:163]
    v_mfma_f32_16x16x32_bf16 v[164:167], v[60:63], v[100:103], v[164:167]
    v_mfma_f32_16x16x32_bf16 v[168:171], v[64:67], v[96:99], v[168:171]
    v_mfma_f32_16x16x32_bf16 v[172:175], v[64:67], v[100:103], v[172:175]
    v_mfma_f32_16x16x32_bf16 v[176:179], v[68:71], v[96:99], v[176:179]
    v_mfma_f32_16x16x32_bf16 v[180:183], v[68:71], v[100:103], v[180:183]
    v_mfma_f32_16x16x32_bf16 v[184:187], v[72:75], v[96:99], v[184:187]
    v_mfma_f32_16x16x32_bf16 v[188:191], v[72:75], v[100:103], v[188:191]
    v_mfma_f32_16x16x32_bf16 v[192:195], v[76:79], v[96:99], v[192:195]
    v_mfma_f32_16x16x32_bf16 v[196:199], v[76:79], v[100:103], v[196:199]
    v_mfma_f32_16x16x32_bf16 v[200:203], v[80:83], v[96:99], v[200:203]
    v_mfma_f32_16x16x32_bf16 v[204:207], v[80:83], v[100:103], v[204:207]
    v_mfma_f32_16x16x32_bf16 v[208:211], v[84:87], v[96:99], v[208:211]
    v_mfma_f32_16x16x32_bf16 v[212:215], v[84:87], v[100:103], v[212:215]
    v_mfma_f32_16x16x32_bf16 v[216:219], v[88:91], v[96:99], v[216:219]
    v_mfma_f32_16x16x32_bf16 v[220:223], v[88:91], v[100:103], v[220:223]
    v_mfma_f32_16x16x32_bf16 v[224:227], v[92:95], v[96:99], v[224:227]
    v_mfma_f32_16x16x32_bf16 v[228:231], v[92:95], v[100:103], v[228:231]
    s_waitcnt vmcnt(0)
    s_mov_b32 s58, 200000
parallel_sum__linear_kernel_hedgehog__mixer_gmlp__prompt_kernel_fl_2001:
    v_cmp_ne_u32 vcc, s69, v233
    s_sub_u32 s58, s58, 1
    s_cmp_eq_u32 s58, 0
    s_cbranch_scc1 parallel_sum__linear_kernel_hedgehog__mixer_gmlp__prompt_kernel_fk_2002
    s_cmp_eq_u64 vcc, 0
    s_cbranch_scc1 parallel_sum__linear_kernel_hedgehog__mixer_gmlp__prompt_kernel_fk_2002
    s_sleep 6
    buffer_load_dword v233, v232, s[20:23], 0 offen sc1
    s_waitcnt vmcnt(0)
    s_branch parallel_sum__linear_kernel_hedgehog__mixer_gmlp__prompt_kernel_fl_2001
parallel_sum__linear_kernel_hedgehog__mixer_gmlp__prompt_kernel_fk_2002:
    s_lshr_b32 s70, s33, 2
    s_and_b32 s71, s33, 3
    s_lshl_b32 s40, s32, 2
    s_add_u32 s40, s40, s71
    s_lshl_b32 s40, s40, 2
    s_add_u32 s40, s40, s3
    s_lshl_b32 s40, s40, 2
    s_add_u32 s40, s40, s70
    s_mul_i32 s40, s40, 9216
    s_add_u32 s40, s40, 45088768
    s_lshl_b32 s40, s32, 2
    s_add_u32 s40, s40, s3
    s_mul_i32 s40, s40, 144
    s_mul_i32 s41, s33, 9
    s_add_u32 s40, s40, s41
    s_lshl_b32 s40, s40, 10
    s_nop 1
    s_cmp_eq_u32 s3, s70
    s_cbranch_scc1 parallel_sum__linear_kernel_hedgehog__mixer_gmlp__prompt_kernel_own
    v_cvt_pk_bf16_f32 v16, v160, v161
    v_cvt_pk_bf16_f32 v17, v162, v163
    v_cvt_pk_bf16_f32 v18, v164, v165
    v_cvt_pk_bf16_f32 v19, v166, v167
    buffer_store_dwordx4 v[16:19], v3, s[20:23], s40 offen offset:0 sc1
    v_cvt_pk_bf16_f32 v20, v168, v169
    v_cvt_pk_bf16_f32 v21, v170, v171
    v_cvt_pk_bf16_f32 v22, v172, v173
    v_cvt_pk_bf16_f32 v23, v174, v175
    buffer_store_dwordx4 v[20:23], v3, s[20:23], s40 offen offset:1024 sc1
    v_cvt_pk_bf16_f32 v16, v176, v177
    v_cvt_pk_bf16_f32 v17, v178, v179
    v_cvt_pk_bf16_f32 v18, v180, v181
    v_cvt_pk_bf16_f32 v19, v182, v183
    buffer_store_dwordx4 v[16:19], v3, s[20:23], s40 offen offset:2048 sc1
    v_cvt_pk_bf16_f32 v20, v184, v185
    v_cvt_pk_bf16_f32 v21, v186, v187
    v_cvt_pk_bf16_f32 v22, v188, v189
    v_cvt_pk_bf16_f32 v23, v190, v191
    buffer_store_dwordx4 v[20:23], v3, s[20:23], s40 offen offset:3072 sc1
    v_cvt_pk_bf16_f32 v16, v192, v193
    v_cvt_pk_bf16_f32 v17, v194, v195
    v_cvt_pk_bf16_f32 v18, v196, v197
    v_cvt_pk_bf16_f32 v19, v198, v199
    s_add_u32 s40, s40, 4096
    buffer_store_dwordx4 v[16:19], v3, s[20:23], s40 offen offset:0 sc1
    v_cvt_pk_bf16_f32 v20, v200, v201
    v_cvt_pk_bf16_f32 v21, v202, v203
    v_cvt_pk_bf16_f32 v22, v204, v205
    v_cvt_pk_bf16_f32 v23, v206, v207
    buffer_store_dwordx4 v[20:23], v3, s[20:23], s40 offen offset:1024 sc1
    v_cvt_pk_bf16_f32 v16, v208, v209
    v_cvt_pk_bf16_f32 v17, v210, v211
    v_cvt_pk_bf16_f32 v18, v212, v213
    v_cvt_pk_bf16_f32 v19, v214, v215
    buffer_store_dwordx4 v[16:19], v3, s[20:23], s40 offen offset:2048 sc1
    v_cvt_pk_bf16_f32 v20, v216, v217
    v_cvt_pk_bf16_f32 v21, v218, v219
    v_cvt_pk_bf16_f32 v22, v220, v221
    v_cvt_pk_bf16_f32 v23, v222, v223
    buffer_store_dwordx4 v[20:23], v3, s[20:23], s40 offen offset:3072 sc1
    v_cvt_pk_bf16_f32 v16, v224, v225
    v_cvt_pk_bf16_f32 v17, v226, v227
    v_cvt_pk_bf16_f32 v18, v228, v229
    v_cvt_pk_bf16_f32 v19, v230, v231
    s_add_u32 s40, s40, 4096
    buffer_store_dwordx4 v[16:19], v3, s[20:23], s40 offen offset:0 sc1
    s_branch parallel_sum__linear_kernel_hedgehog__mixer_gmlp__prompt_kernel_final
parallel_sum__linear_kernel_hedgehog__mixer_gmlp__prompt_kernel_own:
    ds_write_b128 v3, v[160:163] offset:0
    ds_write_b128 v3, v[164:167] offset:1024
    ds_write_b128 v3, v[168:171] offset:2048
    ds_write_b128 v3, v[172:175] offset:3072
    ds_write_b128 v3, v[176:179] offset:4096
    ds_write_b128 v3, v[180:183] offset:5120
    ds_write_b128 v3, v[184:187] offset:6144
    ds_write_b128 v3, v[188:191] offset:7168
    ds_write_b128 v3, v[192:195] offset:8192
    ds_write_b128 v3, v[196:199] offset:9216
    ds_write_b128 v3, v[200:203] offset:10240
    ds_write_b128 v3, v[204:207] offset:11264
    ds_write_b128 v3, v[208:211] offset:12288
    ds_write_b128 v3, v[212:215] offset:13312
    ds_write_b128 v3, v[216:219] offset:14336
    ds_write_b128 v3, v[220:223] offset:15360
    ds_write_b128 v3, v[224:227] offset:16384
    ds_write_b128 v3, v[228:231] offset:17408
parallel_sum__linear_kernel_hedgehog__mixer_gmlp__prompt_kernel_final:
    s_mov_b32 s6, s100
    s_mov_b32 s7, s101
    s_mov_b32 s8, s88
    s_mov_b32 s9, s89
    s_lshl_b32 s46, s32, 7
    s_lshl_b32 s47, s70, 5
    s_add_u32 s46, s46, s47
    s_mul_i32 s46, s46, 1152
    s_mul_i32 s47, s71, 288
    s_add_u32 s46, s46, s47
    s_lshl_b32 s47, s3, 5
    s_add_u32 s46, s46, s47
    v_and_b32 v10, 15, v2
    v_mul_u32_u24 v10, 1152, v10
    v_lshrrev_b32 v11, 4, v2
    v_lshl_add_u32 v10, v11, 3, v10
    v_add_u32 v11, 18432, v10
    v_mov_b32 v9, 1073741824
    s_cmp_eq_u32 s3, 0
    s_cselect_b64 vcc, -1, 0
    v_cndmask_b32 v24, v9, v10, vcc
    v_cndmask_b32 v25, v9, v11, vcc
    v_cndmask_b32 v26, v9, v3, vcc
    s_lshl_b32 s41, s3, 11
    v_add_u32 v27, s41, v3
    s_waitcnt lgkmcnt(0)
    s_mov_b32 s24, s6
    s_mov_b32 s25, s7
    s_mov_b32 s26, 2359296
    s_mov_b32 s27, 0x20000
    s_mov_b32 s28, s8
    s_mov_b32 s29, s9
    s_mov_b32 s30, 2359296
    s_mov_b32 s31, 0x20000
    buffer_load_dwordx2 v[64:65], v10, s[24:27], s46 offen offset:0
    buffer_load_dwordx2 v[66:67], v11, s[24:27], s46 offen offset:0
    buffer_load_dwordx2 v[68:69], v24, s[24:27], s46 offen offset:256
    buffer_load_dwordx2 v[70:71], v25, s[24:27], s46 offen offset:256
    s_lshl_b32 s40, s32, 2
    s_add_u32 s40, s40, s71
    s_lshl_b32 s40, s40, 2
    s_add_u32 s40, s40, s70
    s_mul_i32 s40, s40, 36864
    s_lshl_b32 s41, s3, 10
    s_add_u32 s40, s40, s41
    s_add_u32 s40, s40, 45088768
    s_lshl_b32 s40, s32, 2
    s_add_u32 s40, s40, s70
    s_mul_i32 s40, s40, 144
    s_mul_i32 s47, s71, 9
    s_add_u32 s40, s40, s47
    s_add_u32 s40, s40, s3
    s_lshl_b32 s40, s40, 10
    v_and_b32 v20, 3, v2
    v_lshlrev_b32 v20, 8, v20
    s_andn2_b32 s58, s2, 6
    s_lshl_b32 s58, s58, 7
    s_add_u32 s58, s58, 44957696
    v_add_u32 v20, s58, v20
    s_waitcnt vmcnt(4) lgkmcnt(0)
    s_barrier
    s_cmp_eq_u32 s3, 7
    s_cbranch_scc0 parallel_sum__linear_kernel_hedgehog__mixer_gmlp__prompt_kernel_fs_2003
    s_lshl_b32 s58, s2, 7
    s_add_u32 s58, s58, 44957696
    v_mov_b32 v12, s69
    v_mov_b32 v13, s69
    v_mov_b32 v14, s69
    v_mov_b32 v15, s69
    s_mov_b64 exec, 0xff
    buffer_store_dwordx4 v[12:15], v3, s[20:23], s58 offen sc1
    s_mov_b64 exec, -1
parallel_sum__linear_kernel_hedgehog__mixer_gmlp__prompt_kernel_fs_2003:
    s_add_u32 s42, s70, 1
    s_and_b32 s42, s42, 3
    s_mul_i32 s42, s42, 36864
    s_add_u32 s42, s42, s40
    s_add_u32 s43, s70, 2
    s_and_b32 s43, s43, 3
    s_mul_i32 s43, s43, 36864
    s_add_u32 s43, s43, s40
    s_add_u32 s44, s70, 3
    s_and_b32 s44, s44, 3
    s_mul_i32 s44, s44, 36864
    s_add_u32 s44, s44, s40
    ds_read_b128 v[72:75], v27 offset:0
    ds_read_b128 v[76:79], v27 offset:1024
    ds_read_b128 v[80:83], v27 offset:16384
    ds_read_b128 v[84:87], v27 offset:17408
    s_cmp_eq_u32 s3, 7
    s_cbranch_scc0 parallel_sum__linear_kernel_hedgehog__mixer_gmlp__prompt_kernel_pp
    buffer_load_dword v22, v20, s[20:23], 0 offen sc1
    s_waitcnt vmcnt(0)
    s_mov_b32 s58, 200000
parallel_sum__linear_kernel_hedgehog__mixer_gmlp__prompt_kernel_fl_2004:
    v_cmp_ne_u32 vcc, s69, v22
    s_sub_u32 s58, s58, 1
    s_cmp_eq_u32 s58, 0
    s_cbranch_scc1 parallel_sum__linear_kernel_hedgehog__mixer_gmlp__prompt_kernel_fk_2005
    s_cmp_eq_u64 vcc, 0
    s_cbranch_scc1 parallel_sum__linear_kernel_hedgehog__mixer_gmlp__prompt_kernel_fk_2005
    s_sleep 6
    buffer_load_dword v22, v20, s[20:23], 0 offen sc1
    s_waitcnt vmcnt(0)
    s_branch parallel_sum__linear_kernel_hedgehog__mixer_gmlp__prompt_kernel_fl_2004
parallel_sum__linear_kernel_hedgehog__mixer_gmlp__prompt_kernel_fk_2005:
parallel_sum__linear_kernel_hedgehog__mixer_gmlp__prompt_kernel_pp:
    s_barrier
    buffer_load_dwordx4 v[32:35], v3, s[20:23], s42 offen sc1
    buffer_load_dwordx4 v[36:39], v3, s[20:23], s43 offen sc1
    buffer_load_dwordx4 v[40:43], v3, s[20:23], s44 offen sc1
    s_add_u32 s42, s42, 8192
    buffer_load_dwordx4 v[44:47], v26, s[20:23], s42 offen sc1
    s_add_u32 s43, s43, 8192
    buffer_load_dwordx4 v[48:51], v26, s[20:23], s43 offen sc1
    s_add_u32 s44, s44, 8192
    buffer_load_dwordx4 v[52:55], v26, s[20:23], s44 offen sc1
    s_waitcnt lgkmcnt(0)
    s_waitcnt vmcnt(3)
    v_lshlrev_b32 v16, 16, v64
    v_and_b32 v17, 0xffff0000, v64
    v_lshlrev_b32 v18, 16, v65
    v_and_b32 v19, 0xffff0000, v65
    v_add_f32 v72, v72, v16
    v_add_f32 v73, v73, v17
    v_add_f32 v74, v74, v18
    v_add_f32 v75, v75, v19
    v_lshlrev_b32 v16, 16, v32
    v_and_b32 v17, 0xffff0000, v32
    v_lshlrev_b32 v18, 16, v33
    v_and_b32 v19, 0xffff0000, v33
    v_add_f32 v72, v72, v16
    v_add_f32 v73, v73, v17
    v_add_f32 v74, v74, v18
    v_add_f32 v75, v75, v19
    v_lshlrev_b32 v16, 16, v36
    v_and_b32 v17, 0xffff0000, v36
    v_lshlrev_b32 v18, 16, v37
    v_and_b32 v19, 0xffff0000, v37
    v_add_f32 v72, v72, v16
    v_add_f32 v73, v73, v17
    v_add_f32 v74, v74, v18
    v_add_f32 v75, v75, v19
    v_lshlrev_b32 v16, 16, v40
    v_and_b32 v17, 0xffff0000, v40
    v_lshlrev_b32 v18, 16, v41
    v_and_b32 v19, 0xffff0000, v41
    v_add_f32 v72, v72, v16
    v_add_f32 v73, v73, v17
    v_add_f32 v74, v74, v18
    v_add_f32 v75, v75, v19
    v_cvt_pk_bf16_f32 v64, v72, v73
    v_cvt_pk_bf16_f32 v65, v74, v75
    buffer_store_dwordx2 v[64:65], v10, s[28:31], s46 offen offset:0
    v_lshlrev_b32 v16, 16, v66
    v_and_b32 v17, 0xffff0000, v66
    v_lshlrev_b32 v18, 16, v67
    v_and_b32 v19, 0xffff0000, v67
    v_add_f32 v76, v76, v16
    v_add_f32 v77, v77, v17
    v_add_f32 v78, v78, v18
    v_add_f32 v79, v79, v19
    v_lshlrev_b32 v16, 16, v34
    v_and_b32 v17, 0xffff0000, v34
    v_lshlrev_b32 v18, 16, v35
    v_and_b32 v19, 0xffff0000, v35
    v_add_f32 v76, v76, v16
    v_add_f32 v77, v77, v17
    v_add_f32 v78, v78, v18
    v_add_f32 v79, v79, v19
    v_lshlrev_b32 v16, 16, v38
    v_and_b32 v17, 0xffff0000, v38
    v_lshlrev_b32 v18, 16, v39
    v_and_b32 v19, 0xffff0000, v39
    v_add_f32 v76, v76, v16
    v_add_f32 v77, v77, v17
    v_add_f32 v78, v78, v18
    v_add_f32 v79, v79, v19
    v_lshlrev_b32 v16, 16, v42
    v_and_b32 v17, 0xffff0000, v42
    v_lshlrev_b32 v18, 16, v43
    v_and_b32 v19, 0xffff0000, v43
    v_add_f32 v76, v76, v16
    v_add_f32 v77, v77, v17
    v_add_f32 v78, v78, v18
    v_add_f32 v79, v79, v19
    v_cvt_pk_bf16_f32 v66, v76, v77
    v_cvt_pk_bf16_f32 v67, v78, v79
    buffer_store_dwordx2 v[66:67], v11, s[28:31], s46 offen offset:0
    s_waitcnt vmcnt(2)
    v_lshlrev_b32 v16, 16, v68
    v_and_b32 v17, 0xffff0000, v68
    v_lshlrev_b32 v18, 16, v69
    v_and_b32 v19, 0xffff0000, v69
    v_add_f32 v80, v80, v16
    v_add_f32 v81, v81, v17
    v_add_f32 v82, v82, v18
    v_add_f32 v83, v83, v19
    v_lshlrev_b32 v16, 16, v44
    v_and_b32 v17, 0xffff0000, v44
    v_lshlrev_b32 v18, 16, v45
    v_and_b32 v19, 0xffff0000, v45
    v_add_f32 v80, v80, v16
    v_add_f32 v81, v81, v17
    v_add_f32 v82, v82, v18
    v_add_f32 v83, v83, v19
    v_lshlrev_b32 v16, 16, v48
    v_and_b32 v17, 0xffff0000, v48
    v_lshlrev_b32 v18, 16, v49
    v_and_b32 v19, 0xffff0000, v49
    v_add_f32 v80, v80, v16
    v_add_f32 v81, v81, v17
    v_add_f32 v82, v82, v18
    v_add_f32 v83, v83, v19
    v_lshlrev_b32 v16, 16, v52
    v_and_b32 v17, 0xffff0000, v52
    v_lshlrev_b32 v18, 16, v53
    v_and_b32 v19, 0xffff0000, v53
    v_add_f32 v80, v80, v16
    v_add_f32 v81, v81, v17
    v_add_f32 v82, v82, v18
    v_add_f32 v83, v83, v19
    v_cvt_pk_bf16_f32 v68, v80, v81
    v_cvt_pk_bf16_f32 v69, v82, v83
    buffer_store_dwordx2 v[68:69], v24, s[28:31], s46 offen offset:256
    v_lshlrev_b32 v16, 16, v70
    v_and_b32 v17, 0xffff0000, v70
    v_lshlrev_b32 v18, 16, v71
    v_and_b32 v19, 0xffff0000, v71
    v_add_f32 v84, v84, v16
    v_add_f32 v85, v85, v17
    v_add_f32 v86, v86, v18
    v_add_f32 v87, v87, v19
    v_lshlrev_b32 v16, 16, v46
    v_and_b32 v17, 0xffff0000, v46
    v_lshlrev_b32 v18, 16, v47
    v_and_b32 v19, 0xffff0000, v47
    v_add_f32 v84, v84, v16
    v_add_f32 v85, v85, v17
    v_add_f32 v86, v86, v18
    v_add_f32 v87, v87, v19
    v_lshlrev_b32 v16, 16, v50
    v_and_b32 v17, 0xffff0000, v50
    v_lshlrev_b32 v18, 16, v51
    v_and_b32 v19, 0xffff0000, v51
    v_add_f32 v84, v84, v16
    v_add_f32 v85, v85, v17
    v_add_f32 v86, v86, v18
    v_add_f32 v87, v87, v19
    v_lshlrev_b32 v16, 16, v54
    v_and_b32 v17, 0xffff0000, v54
    v_lshlrev_b32 v18, 16, v55
    v_and_b32 v19, 0xffff0000, v55
    v_add_f32 v84, v84, v16
    v_add_f32 v85, v85, v17
    v_add_f32 v86, v86, v18
    v_add_f32 v87, v87, v19
    v_cvt_pk_bf16_f32 v70, v84, v85
    v_cvt_pk_bf16_f32 v71, v86, v87
    buffer_store_dwordx2 v[70:71], v25, s[28:31], s46 offen offset:256
parallel_sum__linear_kernel_hedgehog__mixer_gmlp__prompt_kernel_end:
    s_endpgm
.section .rodata,"a"
.p2align 6
.amdhsa_kernel parallel_sum__linear_kernel_hedgehog__mixer_gmlp__prompt_kernel
  .amdhsa_next_free_vgpr 256
  .amdhsa_next_free_sgpr 102
  .amdhsa_accum_offset 256
  .amdhsa_group_segment_fixed_size 0
  .amdhsa_kernarg_size 96
  .amdhsa_user_sgpr_count 2
  .amdhsa_user_sgpr_kernarg_segment_ptr 1
  .amdhsa_system_sgpr_workgroup_id_x 1
.end_amdhsa_kernel
```
